```python
import torch

def _softmax(x, axis=-1):
    return torch.softmax(x, dim=axis)

def _gelu(x):
    return torch.nn.functional.gelu(x, approximate='tanh')

def _silu(x):
    return torch.nn.functional.silu(x)

def _sigmoid(x):
    return torch.sigmoid(x)

def _layernorm(x, axis=-1, eps=1e-05):
    m = x.mean(dim=axis, keepdim=True)
    v = x.var(dim=axis, keepdim=True, unbiased=False)
    return (x - m) / torch.sqrt(v + eps)

def _scatter_add(tgt, idx, src, axis=0):
    return tgt.clone().index_add_(axis, idx, src)

def _segment_sum(src, seg, n):
    out = torch.zeros((n,) + src.shape[1:], dtype=src.dtype)
    return out.index_add_(0, seg, src)

def _pad(x, pw):
    flat = tuple((v for pair in reversed(pw) for v in pair))
    return torch.nn.functional.pad(x, flat)
kernel_name = 'gated_mix__grouped_kv_mqa__mixer_gmlp__prompt'

def setup_inputs():

    _w = lambda a: (lambda t: t.to(torch.bfloat16) if t.is_floating_point() else t)(torch.as_tensor(a))

    def _A_setup():
        B, S, D, H = (1, 2048, 576, 32)
        Dh = D // H
        return {'x': _w((lambda *s: torch.randn(*s, dtype=torch.bfloat16) * 0.05)(B, S, D)), 'wq': _w((lambda *s: torch.randn(*s, dtype=torch.bfloat16) * 3.2)(D, H * Dh)), 'wk': _w((lambda *s: torch.randn(*s, dtype=torch.bfloat16) * 3.2)(D, Dh)), 'wv': _w((lambda *s: torch.randn(*s, dtype=torch.bfloat16) * 0.4)(D, Dh)), 'wo': _w((lambda *s: torch.randn(*s, dtype=torch.bfloat16) * 0.4)(H * Dh, D))}
    _A_in = _A_setup()

    def _B_setup():
        B, S, D, F = (1, 2048, 576, 4608)
        Fh = F // 2
        return {'x': _w((lambda *s: torch.randn(*s, dtype=torch.bfloat16) * 0.05)(B, S, D)), 'w_in': _w((lambda *s: torch.randn(*s, dtype=torch.bfloat16) * 1.6)(D, 2 * Fh)), 'w_sp': _w(0.01 * (lambda *s: torch.randn(*s, dtype=torch.bfloat16) * 1.6)(S, S)), 'b_sp': _w(1.0 + 0.01 * (lambda *s: torch.randn(*s, dtype=torch.bfloat16) * 0.1)(S)), 'w_out': _w((lambda *s: torch.randn(*s, dtype=torch.bfloat16) * 0.1)(Fh, D))}
    _B_in = _B_setup()
    return {'A_x': _A_in['x'], 'A_wq': _A_in['wq'], 'A_wk': _A_in['wk'], 'A_wv': _A_in['wv'], 'A_wo': _A_in['wo'], 'B_x': _B_in['x'], 'B_w_in': _B_in['w_in'], 'B_w_sp': _B_in['w_sp'], 'B_b_sp': _B_in['b_sp'], 'B_w_out': _B_in['w_out'], 'gate_w': _w((lambda *s: torch.randn(*s, dtype=torch.bfloat16) * 0.1)(576) * 16.0)}

def reference(A_x, A_wq, A_wk, A_wv, A_wo, B_x, B_w_in, B_w_sp, B_b_sp, B_w_out, gate_w):

    def _A_ref(x, wq, wk, wv, wo):
        B, S, D = x.shape
        H = 32
        Dh = D // H
        q = (lambda x, *d: x.permute(*d))((x @ wq).reshape(B, S, H, Dh), 0, 2, 1, 3)
        k = x @ wk
        v = x @ wv
        scores = torch.einsum('bhqd,bkd->bhqk', q, k) * Dh ** (-0.5)
        p = _softmax(scores, axis=-1)
        o = torch.einsum('bhqk,bkd->bhqd', p, v)
        return (lambda x, *d: x.permute(*d))(o, 0, 2, 1, 3).reshape(B, S, H * Dh) @ wo

    def _B_ref(x, w_in, w_sp, b_sp, w_out):
        B, S, D = x.shape
        F = w_in.shape[-1]
        Fh = F // 2
        z = _gelu(torch.einsum('bsd,df->bsf', x, w_in))
        z1 = z[..., :Fh].clone()
        z2 = _layernorm(z[..., Fh:], axis=-1)
        g = torch.einsum('ts,bsf->btf', w_sp, z2) + b_sp[None, :, None]
        return torch.einsum('bsf,fd->bsd', z1 * g, w_out)
    x = A_x
    g = _sigmoid((x * gate_w).sum(-1, keepdims=True))
    a = _A_ref(x, A_wq, A_wk, A_wv, A_wo)
    b = _B_ref(x, B_w_in, B_w_sp, B_b_sp, B_w_out)
    return g * a + (1 - g) * b
```

```asm
; @launch grid=(512,1,1) block=(256,1,1) lds=81920
.amdgcn_target "amdgcn-amd-amdhsa--gfx950"
.text
.globl gated_mix__grouped_kv_mqa__mixer_gmlp__prompt_kernel
.p2align 8
.type gated_mix__grouped_kv_mqa__mixer_gmlp__prompt_kernel,@function
gated_mix__grouped_kv_mqa__mixer_gmlp__prompt_kernel:
  s_cmp_ge_u32 s2, 512
  s_cbranch_scc1 K_END
  s_cmp_ge_u32 s2, 256
  s_cbranch_scc1 K_ATT
K_GEMM:
  s_load_dwordx4 s[4:7], s[0:1], 0
  s_load_dwordx2 s[8:9], s[0:1], 48
  s_load_dwordx4 s[16:19], s[0:1], 96
  s_load_dwordx4 s[52:55], s[0:1], 56
  s_load_dwordx2 s[64:65], s[0:1], 88
  s_load_dwordx4 s[68:71], s[0:1], 16
  v_lshrrev_b32 v1, 6, v0
  s_nop 0
  v_readfirstlane_b32 s20, v1
  v_and_b32 v1, 63, v0
  s_lshr_b32 s31, s2, 3
  s_and_b32 s32, s2, 3
  s_and_b32 s34, s31, 3
  s_lshl_b32 s21, s32, 2
  s_add_u32 s21, s21, s34
  s_lshr_b32 s35, s31, 2
  s_and_b32 s22, s2, 4
  s_lshl_b32 s22, s22, 1
  s_add_u32 s22, s22, s35
  s_lshl_b32 s23, s21, 2
  s_add_u32 s23, s23, s20
  s_lshl_b32 s39, s34, 1
  s_add_u32 s39, s39, s35
  s_cmp_ge_u32 s39, 9
  s_cselect_b32 s40, 9, 0
  s_sub_u32 s39, s39, s40
  s_and_b32 s39, s39, 14
  s_mul_i32 s24, s39, 589824
  s_lshl_b32 s25, s39, 7
  s_lshl_b32 s28, s39, 1
  s_add_u32 s28, s28, s20
  s_cmp_ge_u32 s28, 18
  s_cselect_b32 s29, 18, 0
  s_sub_u32 s28, s28, s29
  s_mul_i32 s28, s28, 294912
  s_lshl_b32 s26, s20, 11
  s_lshl_b32 s27, s20, 12
  s_add_u32 s27, s27, 49152
  s_lshl_b32 s30, s20, 10
  s_add_u32 s30, s30, 40960
  v_and_b32 v23, 7, v1
  v_lshrrev_b32 v24, 5, v1
  v_lshlrev_b32 v24, 3, v24
  v_bfe_u32 v25, v1, 3, 2
  s_lshl_b32 s44, s23, 5
  v_add3_u32 v24, v24, v25, s44
  v_lshrrev_b32 v25, 4, v1
  v_xor_b32 v25, v25, v23
  v_lshlrev_b32 v25, 4, v25
  v_xor_b32 v26, 64, v25
  v_mul_u32_u24 v27, 1152, v24
  v_add_u32 v5, v27, v25
  v_add_u32 v6, v27, v26
  v_add_u32 v6, 17408, v6
  v_add_u32 v7, 2560, v5
  v_add_u32 v8, 2560, v6
  s_lshl_b32 s42, s22, 8
  s_mul_i32 s43, s20, 73728
  s_add_u32 s42, s42, s43
  s_add_u32 s42, s42, 4608
  v_bfe_u32 v2, v1, 2, 2
  v_mul_u32_u24 v2, 9216, v2
  v_lshrrev_b32 v3, 4, v1
  v_lshl_add_u32 v2, v3, 6, v2
  s_and_b32 s44, s20, 1
  s_lshl_b32 s45, s44, 1
  v_and_b32 v3, 3, v1
  v_xor_b32 v3, s45, v3
  v_lshl_add_u32 v2, v3, 4, v2
  v_add_u32 v2, s42, v2
  v_add_u32 v3, 35840, v2
  v_lshrrev_b32 v29, 1, v1
  v_and_b32 v27, 19, v29
  v_bfe_u32 v28, v29, 2, 1
  v_lshl_add_u32 v27, v28, 3, v27
  v_bfe_u32 v28, v29, 3, 1
  v_lshl_add_u32 v27, v28, 2, v27
  v_mul_u32_u24 v4, 9216, v27
  v_and_b32 v27, 1, v1
  v_lshl_add_u32 v4, v27, 4, v4
  s_lshl_b32 s45, s22, 5
  s_add_u32 s45, s45, 8704
  v_add_u32 v4, s45, v4
  s_waitcnt lgkmcnt(0)
  s_mov_b64 s[48:49], s[6:7]
  s_mov_b64 s[60:61], s[68:69]
  s_mov_b64 s[50:51], s[70:71]
  s_mov_b32 s6, 2359296
  s_mov_b32 s7, 0x00020000
  s_mov_b32 s10, 5308416
  s_mov_b32 s11, 0x00020000
  s_add_u32 s66, s26, 0
  s_add_u32 s67, s26, 8192
  s_add_u32 s68, s26, 16384
  s_add_u32 s69, s26, 24576
  s_add_u32 s70, s26, 32768
  s_mov_b32 s71, s30
  s_add_u32 s72, s30, 4096
  s_mov_b32 s73, s27
  s_add_u32 s63, s27, 16384
  s_mov_b32 s33, 294912
  s_mov_b32 s36, 5308416
  s_mov_b32 s38, 147456
  s_movk_i32 s3, 1152
  s_mov_b32 m0, s73
  s_nop 0
  buffer_load_dwordx4 v5, s[4:7], s25 offen offset:0 lds
  buffer_load_dwordx4 v6, s[4:7], s25 offen offset:1024 lds
  buffer_load_dwordx4 v7, s[4:7], s25 offen offset:2048 lds
  buffer_load_dwordx4 v8, s[4:7], s25 offen offset:3072 lds
  s_addk_i32 s25, 128
  s_cmp_eq_u32 s25, s3
  s_cselect_b32 s25, 0, s25
  s_mov_b32 m0, s66
  s_nop 0
  buffer_load_dwordx4 v2, s[8:11], s24 offen lds
  buffer_load_dwordx4 v3, s[8:11], s24 offen offset:1024 lds
  s_add_u32 s24, s24, s33
  s_mov_b32 m0, s71
  s_nop 0
  buffer_load_dwordx4 v4, s[8:11], s28 offen lds
  s_add_u32 s28, s28, 1179648
  s_cmp_ge_u32 s28, s36
  s_cselect_b32 s29, s36, 0
  s_sub_u32 s28, s28, s29
  s_mov_b32 m0, s67
  s_nop 0
  buffer_load_dwordx4 v2, s[8:11], s24 offen lds
  buffer_load_dwordx4 v3, s[8:11], s24 offen offset:1024 lds
  s_add_u32 s24, s24, s33
  s_cmp_eq_u32 s24, s36
  s_cselect_b32 s24, 0, s24
  v_mul_u32_u24 v27, 36, v27
  v_lshrrev_b32 v20, 2, v1
  v_mul_u32_u24 v20, 1152, v20
  v_bfe_u32 v28, v1, 1, 1
  v_lshl_add_u32 v20, v28, 4, v20
  v_add_u32 v20, v20, v27
  v_mul_u32_u24 v28, 1152, v29
  v_add3_u32 v28, v28, v27, 32
  s_cmp_eq_u32 s20, 2
  s_cselect_b64 vcc, -1, 0
  v_cndmask_b32 v20, v20, v28, vcc
  v_mul_u32_u24 v28, 36, v29
  s_cmp_eq_u32 s20, 3
  s_cselect_b64 vcc, -1, 0
  v_cndmask_b32 v20, v20, v28, vcc
  s_mul_i32 s44, s22, 72
  s_cmp_eq_u32 s20, 1
  s_cselect_b32 s45, 18432, 0
  s_add_u32 s44, s44, s45
  s_and_b32 s45, s22, 1
  s_lshl_b32 s45, s45, 4
  s_cmp_ge_u32 s22, 4
  s_cselect_b32 s45, 32, s45
  s_cmp_eq_u32 s20, 3
  s_cselect_b32 s44, s45, s44
  s_movk_i32 s58, 1152
  s_cselect_b32 s58, 36, s58
  v_add_u32 v20, s44, v20
  s_lshl_b32 s44, s58, 5
  s_sub_u32 s44, s44, 1024
  v_add_u32 v244, s44, v20
  s_mul_i32 s42, s58, 576
  s_lshl_b32 s58, s58, 6
  s_mul_i32 s59, s58, s39
  s_lshr_b32 s44, 0x2c, s22
  s_and_b32 s44, s44, 1
  s_cmp_eq_u32 s44, 1
  s_cselect_b32 s40, s50, s60
  s_cselect_b32 s41, s51, s61
  s_cmp_eq_u32 s20, 3
  s_cselect_b32 s40, s40, s48
  s_cselect_b32 s41, s41, s49
  s_mov_b32 s43, 0x00020000
  s_mov_b32 s12, s18
  s_mov_b32 s13, s19
  s_mov_b32 s14, 29360128
  s_mov_b32 s15, 0x00020000
  s_mov_b32 s56, s54
  s_mov_b32 s57, s55
  s_mov_b32 s54, 8388608
  s_mov_b32 s55, 0x00020000
  s_mov_b32 m0, s68
  s_nop 0
  buffer_load_dwordx4 v20, s[40:43], s59 offen lds
  buffer_load_dwordx4 v244, s[40:43], s59 offen offset:1024 lds
  s_add_u32 s59, s59, s58
  s_cmp_eq_u32 s59, s42
  s_cselect_b32 s59, 0, s59
  s_mov_b32 m0, s63
  s_nop 0
  buffer_load_dwordx4 v5, s[4:7], s25 offen offset:0 lds
  buffer_load_dwordx4 v6, s[4:7], s25 offen offset:1024 lds
  buffer_load_dwordx4 v7, s[4:7], s25 offen offset:2048 lds
  buffer_load_dwordx4 v8, s[4:7], s25 offen offset:3072 lds
  s_addk_i32 s25, 128
  s_cmp_eq_u32 s25, s3
  s_cselect_b32 s25, 0, s25
  s_mov_b32 m0, s69
  s_nop 0
  buffer_load_dwordx4 v2, s[8:11], s24 offen lds
  buffer_load_dwordx4 v3, s[8:11], s24 offen offset:1024 lds
  s_add_u32 s24, s24, s33
  v_lshlrev_b32 v27, 12, v24
  v_add_u32 v12, v27, v25
  v_add_u32 v13, v27, v26
  v_add_u32 v13, 64512, v13
  v_add_u32 v14, 14336, v12
  v_add_u32 v15, 14336, v13
  s_xor_b32 s37, s21, s35
  s_lshl_b32 s45, s22, 13
  s_add_u32 s45, s45, s26
  s_add_u32 s45, s45, 65536
  v_lshlrev_b32 v19, 4, v1
  v_add_u32 v9, s45, v19
  s_lshl_b32 s45, s22, 10
  s_mul_i32 s46, s20, 147456
  s_add_u32 s45, s45, s46
  s_add_u32 s45, s45, 196608
  v_add_u32 v10, s45, v19
  v_lshrrev_b32 v27, 4, v1
  v_and_b32 v29, 3, v1
  v_lshlrev_b32 v28, 3, v29
  v_bfe_u32 v29, v1, 2, 3
  v_lshl_add_u32 v18, v29, 5, v28
  v_lshrrev_b32 v29, 5, v1
  v_lshl_add_u32 v18, v29, 9, v18
  v_lshl_add_u32 v28, v27, 11, v28
  v_bfe_u32 v29, v1, 2, 2
  v_lshl_add_u32 v28, v29, 6, v28
  v_and_b32 v29, 1, v27
  v_lshl_add_u32 v16, v29, 5, v28
  v_xor_b32 v17, 32, v16
  v_and_b32 v28, 15, v1
  v_lshlrev_b32 v245, 4, v28
  v_lshl_add_u32 v245, v29, 9, v245
  v_lshrrev_b32 v29, 5, v1
  v_lshl_add_u32 v245, v29, 11, v245
  v_bfe_u32 v29, v1, 2, 2
  v_lshl_add_u32 v29, v27, 3, v29
  v_lshlrev_b32 v246, 5, v29
  v_and_b32 v29, 1, v1
  v_lshlrev_b32 v23, 4, v29
  v_add_u32 v23, 4096, v23
  v_lshlrev_b32 v29, 3, v29
  v_add_u32 v29, 6144, v29
  v_and_b32 v24, 2, v1
  v_cmp_eq_u32 vcc, 0, v24
  s_nop 1
  v_cndmask_b32 v29, v29, v23, vcc
  v_add_u32 v246, v246, v29
  v_bfe_u32 v29, v1, 1, 3
  v_xor_b32 v29, v29, v27
  v_lshlrev_b32 v28, 7, v28
  v_lshl_add_u32 v28, v29, 4, v28
  v_add_u32 v21, s27, v28
  v_xor_b32 v28, 64, v28
  v_add_u32 v22, s27, v28
  s_mov_b32 s60, 0xbdd2d3e8
  s_mov_b32 s61, 0xbdd2d3e8
  v_mov_b32 v30, 0xc0135761
  v_mov_b32 v31, 0xc0135761
  s_bfe_u32 s47, s22, 0x20001
  s_lshl_b32 s47, s47, 3
  s_bfe_u32 s45, s23, 0x30001
  s_add_u32 s47, s47, s45
  s_lshl_b32 s47, s47, 3
  s_and_b32 s45, s2, 7
  s_add_u32 s47, s47, s45
  s_lshl_b32 s47, s47, 7
  s_and_b32 s45, s23, 1
  s_lshl_b32 s45, s45, 3
  s_add_u32 s47, s47, s45
  s_add_u32 s47, s47, 25419776
  s_setprio 2
  s_waitcnt vmcnt(13)
  ds_read_b128 v[68:71], v21 offset:0
  ds_read_b128 v[72:75], v21 offset:2048
  ds_read_b128 v[76:79], v22 offset:0
  ds_read_b128 v[80:83], v22 offset:2048
  s_waitcnt vmcnt(10)
  s_barrier
  ds_read_b64_tr_b16 v[32:33], v16 offset:0
  ds_read_b64_tr_b16 v[34:35], v16 offset:1024
  ds_read_b64_tr_b16 v[36:37], v17 offset:0
  ds_read_b64_tr_b16 v[38:39], v17 offset:1024
  ds_read_b64_tr_b16 v[40:41], v16 offset:256
  ds_read_b64_tr_b16 v[42:43], v16 offset:1280
  ds_read_b64_tr_b16 v[44:45], v17 offset:256
  ds_read_b64_tr_b16 v[46:47], v17 offset:1280
  ds_read_b64_tr_b16 v[48:49], v16 offset:512
  ds_read_b64_tr_b16 v[50:51], v16 offset:1536
  ds_read_b64_tr_b16 v[52:53], v17 offset:512
  ds_read_b64_tr_b16 v[54:55], v17 offset:1536
  ds_read_b64_tr_b16 v[56:57], v16 offset:768
  ds_read_b64_tr_b16 v[58:59], v16 offset:1792
  ds_read_b64_tr_b16 v[60:61], v17 offset:768
  ds_read_b64_tr_b16 v[62:63], v17 offset:1792
  ds_read_b64_tr_b16 v[64:65], v18 offset:40960
  ds_read_b64_tr_b16 v[66:67], v18 offset:41216
  s_waitcnt vmcnt(8)
  s_barrier
  s_waitcnt lgkmcnt(15)
  v_mfma_f32_16x16x32_bf16 v[100:103], v[68:71], v[32:35], 0
  s_mov_b32 m0, s70
  v_mfma_f32_16x16x32_bf16 v[104:107], v[72:75], v[32:35], 0
  ds_read_b64_tr_b16 v[32:33], v16 offset:8192
  ds_read_b64_tr_b16 v[34:35], v16 offset:9216
  s_waitcnt lgkmcnt(14)
  v_mfma_f32_16x16x32_bf16 v[108:111], v[68:71], v[36:39], 0
  buffer_load_dwordx4 v2, s[8:11], s24 offen lds
  v_mfma_f32_16x16x32_bf16 v[112:115], v[72:75], v[36:39], 0
  ds_read_b64_tr_b16 v[36:37], v17 offset:8192
  ds_read_b64_tr_b16 v[38:39], v17 offset:9216
  v_mfma_f32_16x16x32_bf16 v[116:119], v[68:71], v[40:43], 0
  buffer_load_dwordx4 v3, s[8:11], s24 offen offset:1024 lds
  v_mfma_f32_16x16x32_bf16 v[120:123], v[72:75], v[40:43], 0
  ds_read_b64_tr_b16 v[40:41], v16 offset:8448
  s_waitcnt lgkmcnt(13)
  v_mfma_f32_16x16x32_bf16 v[124:127], v[68:71], v[44:47], 0
  ds_read_b64_tr_b16 v[42:43], v16 offset:9472
  s_add_u32 s24, s24, s33
  v_mfma_f32_16x16x32_bf16 v[128:131], v[72:75], v[44:47], 0
  ds_read_b64_tr_b16 v[44:45], v17 offset:8448
  ds_read_b64_tr_b16 v[46:47], v17 offset:9472
  v_mfma_f32_16x16x32_bf16 v[132:135], v[68:71], v[48:51], 0
  s_cmp_eq_u32 s24, s36
  s_cselect_b32 s24, 0, s24
  s_mov_b32 m0, s73
  v_mfma_f32_16x16x32_bf16 v[136:139], v[72:75], v[48:51], 0
  ds_read_b64_tr_b16 v[48:49], v16 offset:8704
  s_waitcnt lgkmcnt(13)
  v_mfma_f32_16x16x32_bf16 v[140:143], v[68:71], v[52:55], 0
  ds_read_b64_tr_b16 v[50:51], v16 offset:9728
  v_mfma_f32_16x16x32_bf16 v[144:147], v[72:75], v[52:55], 0
  ds_read_b64_tr_b16 v[52:53], v17 offset:8704
  ds_read_b64_tr_b16 v[54:55], v17 offset:9728
  v_mfma_f32_16x16x32_bf16 v[148:151], v[68:71], v[56:59], 0
  buffer_load_dwordx4 v5, s[4:7], s25 offen offset:0 lds
  v_mfma_f32_16x16x32_bf16 v[152:155], v[72:75], v[56:59], 0
  ds_read_b64_tr_b16 v[56:57], v16 offset:8960
  ds_read_b64_tr_b16 v[58:59], v16 offset:9984
  s_waitcnt lgkmcnt(14)
  v_mfma_f32_16x16x32_bf16 v[156:159], v[68:71], v[60:63], 0
  buffer_load_dwordx4 v6, s[4:7], s25 offen offset:1024 lds
  v_mfma_f32_16x16x32_bf16 v[160:163], v[72:75], v[60:63], 0
  ds_read_b64_tr_b16 v[60:61], v17 offset:8960
  ds_read_b64_tr_b16 v[62:63], v17 offset:9984
  v_mfma_f32_16x16x32_bf16 v[164:167], v[68:71], v[64:67], 0
  v_mfma_f32_16x16x32_bf16 v[168:171], v[72:75], v[64:67], 0
  ds_read_b64_tr_b16 v[64:65], v18 offset:41984
  ds_read_b64_tr_b16 v[66:67], v18 offset:42240
  s_waitcnt vmcnt(10)
  s_barrier
  s_waitcnt lgkmcnt(15)
  v_mfma_f32_16x16x32_bf16 v[100:103], v[76:79], v[32:35], v[100:103]
  ds_read_b64_tr_b16 v[196:197], v245 offset:16384
  v_mfma_f32_16x16x32_bf16 v[104:107], v[80:83], v[32:35], v[104:107]
  ds_read_b64_tr_b16 v[198:199], v245 offset:16640
  s_waitcnt lgkmcnt(14)
  v_mfma_f32_16x16x32_bf16 v[108:111], v[76:79], v[36:39], v[108:111]
  ds_read_b64_tr_b16 v[200:201], v245 offset:16392
  ds_read_b64_tr_b16 v[202:203], v245 offset:16648
  v_mfma_f32_16x16x32_bf16 v[112:115], v[80:83], v[36:39], v[112:115]
  s_mov_b32 m0, s66
  ds_read_b64_tr_b16 v[204:205], v246 offset:16384
  v_mfma_f32_16x16x32_bf16 v[116:119], v[76:79], v[40:43], v[116:119]
  buffer_load_dwordx4 v20, s[40:43], s59 offen lds
  v_mfma_f32_16x16x32_bf16 v[120:123], v[80:83], v[40:43], v[120:123]
  ds_read_b64_tr_b16 v[206:207], v246 offset:16512
  ds_read_b64_tr_b16 v[208:209], v245 offset:17408
  s_waitcnt lgkmcnt(15)
  v_mfma_f32_16x16x32_bf16 v[124:127], v[76:79], v[44:47], v[124:127]
  buffer_load_dwordx4 v244, s[40:43], s59 offen offset:1024 lds
  v_mfma_f32_16x16x32_bf16 v[128:131], v[80:83], v[44:47], v[128:131]
  s_add_u32 s59, s59, s58
  s_cmp_eq_u32 s59, s42
  s_cselect_b32 s59, 0, s59
  v_mfma_f32_16x16x32_bf16 v[132:135], v[76:79], v[48:51], v[132:135]
  s_waitcnt vmcnt(8)
  ds_read_b128 v[84:87], v21 offset:16384
  v_mfma_f32_16x16x32_bf16 v[136:139], v[80:83], v[48:51], v[136:139]
  ds_read_b64_tr_b16 v[210:211], v245 offset:17664
  s_waitcnt lgkmcnt(13)
  v_mfma_f32_16x16x32_bf16 v[140:143], v[76:79], v[52:55], v[140:143]
  ds_read_b128 v[88:91], v21 offset:18432
  ds_read_b64_tr_b16 v[212:213], v245 offset:17416
  v_mfma_f32_16x16x32_bf16 v[144:147], v[80:83], v[52:55], v[144:147]
  ds_read_b128 v[92:95], v22 offset:16384
  ds_read_b64_tr_b16 v[214:215], v245 offset:17672
  v_mfma_f32_16x16x32_bf16 v[148:151], v[76:79], v[56:59], v[148:151]
  ds_read_b128 v[96:99], v22 offset:18432
  s_mov_b32 m0, s73
  v_mfma_f32_16x16x32_bf16 v[152:155], v[80:83], v[56:59], v[152:155]
  ds_read_b64_tr_b16 v[216:217], v246 offset:17408
  s_waitcnt lgkmcnt(15)
  v_mfma_f32_16x16x32_bf16 v[156:159], v[76:79], v[60:63], v[156:159]
  buffer_load_dwordx4 v7, s[4:7], s25 offen offset:2048 lds
  v_mfma_f32_16x16x32_bf16 v[160:163], v[80:83], v[60:63], v[160:163]
  buffer_load_dwordx4 v8, s[4:7], s25 offen offset:3072 lds
  v_mfma_f32_16x16x32_bf16 v[164:167], v[76:79], v[64:67], v[164:167]
  s_addk_i32 s25, 128
  s_cmp_eq_u32 s25, s3
  s_cselect_b32 s25, 0, s25
  v_mfma_f32_16x16x32_bf16 v[168:171], v[80:83], v[64:67], v[168:171]
  ds_read_b64_tr_b16 v[218:219], v246 offset:17536
  s_waitcnt vmcnt(8)
  s_barrier
  s_waitcnt lgkmcnt(14)
  v_mfma_f32_16x16x32_bf16 v[172:175], v[196:199], v[68:71], 0
  ds_read_b64_tr_b16 v[32:33], v16 offset:24576
  ds_read_b64_tr_b16 v[34:35], v16 offset:25600
  v_mfma_f32_16x16x32_bf16 v[176:179], v[196:199], v[72:75], 0
  ds_read_b64_tr_b16 v[36:37], v17 offset:24576
  s_waitcnt lgkmcnt(13)
  v_mfma_f32_16x16x32_bf16 v[180:183], v[200:203], v[68:71], 0
  ds_read_b64_tr_b16 v[38:39], v17 offset:25600
  ds_read_b64_tr_b16 v[40:41], v16 offset:24832
  v_mfma_f32_16x16x32_bf16 v[184:187], v[200:203], v[72:75], 0
  ds_read_b64_tr_b16 v[42:43], v16 offset:25856
  ds_read_b64_tr_b16 v[44:45], v17 offset:24832
  v_mfma_f32_16x16x32_bf16 v[188:191], v[204:207], v[68:71], 0
  ds_read_b64_tr_b16 v[46:47], v17 offset:25856
  ds_read_b64_tr_b16 v[48:49], v16 offset:25088
  v_mfma_f32_16x16x32_bf16 v[192:195], v[204:207], v[72:75], 0
  ds_read_b64_tr_b16 v[50:51], v16 offset:26112
  ds_read_b64_tr_b16 v[52:53], v17 offset:25088
  s_waitcnt lgkmcnt(14)
  v_mfma_f32_16x16x32_bf16 v[172:175], v[208:211], v[76:79], v[172:175]
  s_mov_b32 m0, s67
  ds_read_b64_tr_b16 v[54:55], v17 offset:26112
  v_mfma_f32_16x16x32_bf16 v[176:179], v[208:211], v[80:83], v[176:179]
  buffer_load_dwordx4 v2, s[8:11], s24 offen lds
  ds_read_b64_tr_b16 v[56:57], v16 offset:25344
  v_mfma_f32_16x16x32_bf16 v[180:183], v[212:215], v[76:79], v[180:183]
  buffer_load_dwordx4 v3, s[8:11], s24 offen offset:1024 lds
  ds_read_b64_tr_b16 v[58:59], v16 offset:26368
  v_mfma_f32_16x16x32_bf16 v[184:187], v[212:215], v[80:83], v[184:187]
  s_add_u32 s24, s24, s33
  s_mov_b32 m0, s72
  s_waitcnt lgkmcnt(14)
  v_mfma_f32_16x16x32_bf16 v[188:191], v[216:219], v[76:79], v[188:191]
  buffer_load_dwordx4 v4, s[8:11], s28 offen lds
  s_add_u32 s28, s28, 1179648
  v_mfma_f32_16x16x32_bf16 v[192:195], v[216:219], v[80:83], v[192:195]
  s_cmp_ge_u32 s28, s36
  s_cselect_b32 s29, s36, 0
  s_sub_u32 s28, s28, s29
  s_waitcnt vmcnt(9)
  s_barrier
  s_waitcnt lgkmcnt(12)
  v_mfma_f32_16x16x32_bf16 v[100:103], v[84:87], v[32:35], v[100:103]
  ds_read_b64_tr_b16 v[60:61], v17 offset:25344
  v_mfma_f32_16x16x32_bf16 v[104:107], v[88:91], v[32:35], v[104:107]
  ds_read_b64_tr_b16 v[62:63], v17 offset:26368
  ds_read_b64_tr_b16 v[64:65], v18 offset:43008
  s_waitcnt lgkmcnt(11)
  v_mfma_f32_16x16x32_bf16 v[108:111], v[84:87], v[36:39], v[108:111]
  ds_read_b64_tr_b16 v[66:67], v18 offset:43264
  ds_read_b64_tr_b16 v[32:33], v16 offset:32768
  v_mfma_f32_16x16x32_bf16 v[112:115], v[88:91], v[36:39], v[112:115]
  ds_read_b64_tr_b16 v[34:35], v16 offset:33792
  ds_read_b64_tr_b16 v[36:37], v17 offset:32768
  v_mfma_f32_16x16x32_bf16 v[116:119], v[84:87], v[40:43], v[116:119]
  ds_read_b64_tr_b16 v[38:39], v17 offset:33792
  s_mov_b32 m0, s68
  v_mfma_f32_16x16x32_bf16 v[120:123], v[88:91], v[40:43], v[120:123]
  ds_read_b64_tr_b16 v[40:41], v16 offset:33024
  s_waitcnt lgkmcnt(13)
  v_mfma_f32_16x16x32_bf16 v[124:127], v[84:87], v[44:47], v[124:127]
  ds_read_b64_tr_b16 v[42:43], v16 offset:34048
  buffer_load_dwordx4 v2, s[8:11], s24 offen lds
  v_mfma_f32_16x16x32_bf16 v[128:131], v[88:91], v[44:47], v[128:131]
  ds_read_b64_tr_b16 v[44:45], v17 offset:33024
  ds_read_b64_tr_b16 v[46:47], v17 offset:34048
  v_mfma_f32_16x16x32_bf16 v[132:135], v[84:87], v[48:51], v[132:135]
  buffer_load_dwordx4 v3, s[8:11], s24 offen offset:1024 lds
  s_add_u32 s24, s24, s33
  v_mfma_f32_16x16x32_bf16 v[136:139], v[88:91], v[48:51], v[136:139]
  ds_read_b64_tr_b16 v[48:49], v16 offset:33280
  s_waitcnt lgkmcnt(13)
  v_mfma_f32_16x16x32_bf16 v[140:143], v[84:87], v[52:55], v[140:143]
  ds_read_b64_tr_b16 v[50:51], v16 offset:34304
  s_cmp_eq_u32 s24, s36
  s_cselect_b32 s24, 0, s24
  v_mfma_f32_16x16x32_bf16 v[144:147], v[88:91], v[52:55], v[144:147]
  ds_read_b64_tr_b16 v[52:53], v17 offset:33280
  ds_read_b64_tr_b16 v[54:55], v17 offset:34304
  v_mfma_f32_16x16x32_bf16 v[148:151], v[84:87], v[56:59], v[148:151]
  s_mov_b32 m0, s63
  s_nop 0
  buffer_load_dwordx4 v5, s[4:7], s25 offen offset:0 lds
  v_mfma_f32_16x16x32_bf16 v[152:155], v[88:91], v[56:59], v[152:155]
  ds_read_b64_tr_b16 v[56:57], v16 offset:33536
  s_waitcnt lgkmcnt(13)
  v_mfma_f32_16x16x32_bf16 v[156:159], v[84:87], v[60:63], v[156:159]
  ds_read_b64_tr_b16 v[58:59], v16 offset:34560
  v_mfma_f32_16x16x32_bf16 v[160:163], v[88:91], v[60:63], v[160:163]
  ds_read_b64_tr_b16 v[60:61], v17 offset:33536
  ds_read_b64_tr_b16 v[62:63], v17 offset:34560
  v_mfma_f32_16x16x32_bf16 v[164:167], v[84:87], v[64:67], v[164:167]
  buffer_load_dwordx4 v6, s[4:7], s25 offen offset:1024 lds
  v_mfma_f32_16x16x32_bf16 v[168:171], v[88:91], v[64:67], v[168:171]
  ds_read_b64_tr_b16 v[64:65], v18 offset:44032
  ds_read_b64_tr_b16 v[66:67], v18 offset:44288
  s_waitcnt vmcnt(9)
  s_barrier
  s_waitcnt lgkmcnt(15)
  v_mfma_f32_16x16x32_bf16 v[100:103], v[92:95], v[32:35], v[100:103]
  ds_read_b64_tr_b16 v[196:197], v245 offset:0
  v_mfma_f32_16x16x32_bf16 v[104:107], v[96:99], v[32:35], v[104:107]
  ds_read_b64_tr_b16 v[198:199], v245 offset:256
  s_waitcnt lgkmcnt(14)
  v_mfma_f32_16x16x32_bf16 v[108:111], v[92:95], v[36:39], v[108:111]
  ds_read_b64_tr_b16 v[200:201], v245 offset:8
  ds_read_b64_tr_b16 v[202:203], v245 offset:264
  v_mfma_f32_16x16x32_bf16 v[112:115], v[96:99], v[36:39], v[112:115]
  s_mov_b32 m0, s69
  ds_read_b64_tr_b16 v[204:205], v246 offset:0
  v_mfma_f32_16x16x32_bf16 v[116:119], v[92:95], v[40:43], v[116:119]
  buffer_load_dwordx4 v20, s[40:43], s59 offen lds
  v_mfma_f32_16x16x32_bf16 v[120:123], v[96:99], v[40:43], v[120:123]
  ds_read_b64_tr_b16 v[206:207], v246 offset:128
  ds_read_b64_tr_b16 v[208:209], v245 offset:1024
  s_waitcnt lgkmcnt(15)
  v_mfma_f32_16x16x32_bf16 v[124:127], v[92:95], v[44:47], v[124:127]
  buffer_load_dwordx4 v244, s[40:43], s59 offen offset:1024 lds
  v_mfma_f32_16x16x32_bf16 v[128:131], v[96:99], v[44:47], v[128:131]
  s_add_u32 s59, s59, s58
  s_cmp_eq_u32 s59, s42
  s_cselect_b32 s59, 0, s59
  v_mfma_f32_16x16x32_bf16 v[132:135], v[92:95], v[48:51], v[132:135]
  s_waitcnt vmcnt(9)
  ds_read_b128 v[68:71], v21 offset:0
  v_mfma_f32_16x16x32_bf16 v[136:139], v[96:99], v[48:51], v[136:139]
  ds_read_b64_tr_b16 v[210:211], v245 offset:1280
  s_waitcnt lgkmcnt(13)
  v_mfma_f32_16x16x32_bf16 v[140:143], v[92:95], v[52:55], v[140:143]
  ds_read_b128 v[72:75], v21 offset:2048
  ds_read_b64_tr_b16 v[212:213], v245 offset:1032
  v_mfma_f32_16x16x32_bf16 v[144:147], v[96:99], v[52:55], v[144:147]
  ds_read_b128 v[76:79], v22 offset:0
  ds_read_b64_tr_b16 v[214:215], v245 offset:1288
  v_mfma_f32_16x16x32_bf16 v[148:151], v[92:95], v[56:59], v[148:151]
  ds_read_b128 v[80:83], v22 offset:2048
  s_mov_b32 m0, s63
  v_mfma_f32_16x16x32_bf16 v[152:155], v[96:99], v[56:59], v[152:155]
  ds_read_b64_tr_b16 v[216:217], v246 offset:1024
  s_waitcnt lgkmcnt(15)
  v_mfma_f32_16x16x32_bf16 v[156:159], v[92:95], v[60:63], v[156:159]
  buffer_load_dwordx4 v7, s[4:7], s25 offen offset:2048 lds
  v_mfma_f32_16x16x32_bf16 v[160:163], v[96:99], v[60:63], v[160:163]
  buffer_load_dwordx4 v8, s[4:7], s25 offen offset:3072 lds
  v_mfma_f32_16x16x32_bf16 v[164:167], v[92:95], v[64:67], v[164:167]
  s_addk_i32 s25, 128
  s_cmp_eq_u32 s25, s3
  s_cselect_b32 s25, 0, s25
  v_mfma_f32_16x16x32_bf16 v[168:171], v[96:99], v[64:67], v[168:171]
  ds_read_b64_tr_b16 v[218:219], v246 offset:1152
  s_waitcnt vmcnt(8)
  s_barrier
  s_waitcnt lgkmcnt(14)
  v_mfma_f32_16x16x32_bf16 v[172:175], v[196:199], v[84:87], v[172:175]
  ds_read_b64_tr_b16 v[32:33], v16 offset:8192
  v_mfma_f32_16x16x32_bf16 v[176:179], v[196:199], v[88:91], v[176:179]
  ds_read_b64_tr_b16 v[34:35], v16 offset:9216
  s_waitcnt lgkmcnt(12)
  v_mfma_f32_16x16x32_bf16 v[180:183], v[200:203], v[84:87], v[180:183]
  ds_read_b64_tr_b16 v[36:37], v17 offset:8192
  ds_read_b64_tr_b16 v[38:39], v17 offset:9216
  v_mfma_f32_16x16x32_bf16 v[184:187], v[200:203], v[88:91], v[184:187]
  ds_read_b64_tr_b16 v[40:41], v16 offset:8448
  ds_read_b64_tr_b16 v[42:43], v16 offset:9472
  v_mfma_f32_16x16x32_bf16 v[188:191], v[204:207], v[84:87], v[188:191]
  ds_read_b64_tr_b16 v[44:45], v17 offset:8448
  ds_read_b64_tr_b16 v[46:47], v17 offset:9472
  v_mfma_f32_16x16x32_bf16 v[192:195], v[204:207], v[88:91], v[192:195]
  ds_read_b64_tr_b16 v[48:49], v16 offset:8704
  s_waitcnt lgkmcnt(12)
  v_mfma_f32_16x16x32_bf16 v[172:175], v[208:211], v[92:95], v[172:175]
  ds_read_b64_tr_b16 v[50:51], v16 offset:9728
  v_mfma_f32_16x16x32_bf16 v[176:179], v[208:211], v[96:99], v[176:179]
  ds_read_b64_tr_b16 v[52:53], v17 offset:8704
  ds_read_b64_tr_b16 v[54:55], v17 offset:9728
  v_mfma_f32_16x16x32_bf16 v[180:183], v[212:215], v[92:95], v[180:183]
  s_mov_b32 m0, s70
  ds_read_b64_tr_b16 v[56:57], v16 offset:8960
  v_mfma_f32_16x16x32_bf16 v[184:187], v[212:215], v[96:99], v[184:187]
  ds_read_b64_tr_b16 v[58:59], v16 offset:9984
  s_waitcnt lgkmcnt(14)
  v_mfma_f32_16x16x32_bf16 v[188:191], v[216:219], v[92:95], v[188:191]
  buffer_load_dwordx4 v2, s[8:11], s24 offen lds
  v_mfma_f32_16x16x32_bf16 v[192:195], v[216:219], v[96:99], v[192:195]
  buffer_load_dwordx4 v3, s[8:11], s24 offen offset:1024 lds
  s_add_u32 s24, s24, s33
  s_waitcnt vmcnt(8)
  s_barrier
  s_waitcnt lgkmcnt(12)
  v_mfma_f32_16x16x32_bf16 v[100:103], v[68:71], v[32:35], v[100:103]
  ds_read_b64_tr_b16 v[60:61], v17 offset:8960
  v_mfma_f32_16x16x32_bf16 v[104:107], v[72:75], v[32:35], v[104:107]
  ds_read_b64_tr_b16 v[62:63], v17 offset:9984
  ds_read_b64_tr_b16 v[64:65], v18 offset:45056
  s_waitcnt lgkmcnt(11)
  v_mfma_f32_16x16x32_bf16 v[108:111], v[68:71], v[36:39], v[108:111]
  ds_read_b64_tr_b16 v[66:67], v18 offset:45312
  ds_read_b64_tr_b16 v[32:33], v16 offset:16384
  v_mfma_f32_16x16x32_bf16 v[112:115], v[72:75], v[36:39], v[112:115]
  ds_read_b64_tr_b16 v[34:35], v16 offset:17408
  ds_read_b64_tr_b16 v[36:37], v17 offset:16384
  v_mfma_f32_16x16x32_bf16 v[116:119], v[68:71], v[40:43], v[116:119]
  ds_read_b64_tr_b16 v[38:39], v17 offset:17408
  s_mov_b32 m0, s66
  v_mfma_f32_16x16x32_bf16 v[120:123], v[72:75], v[40:43], v[120:123]
  ds_read_b64_tr_b16 v[40:41], v16 offset:16640
  s_waitcnt lgkmcnt(13)
  v_mfma_f32_16x16x32_bf16 v[124:127], v[68:71], v[44:47], v[124:127]
  ds_read_b64_tr_b16 v[42:43], v16 offset:17664
  buffer_load_dwordx4 v2, s[8:11], s24 offen lds
  v_mfma_f32_16x16x32_bf16 v[128:131], v[72:75], v[44:47], v[128:131]
  ds_read_b64_tr_b16 v[44:45], v17 offset:16640
  ds_read_b64_tr_b16 v[46:47], v17 offset:17664
  v_mfma_f32_16x16x32_bf16 v[132:135], v[68:71], v[48:51], v[132:135]
  buffer_load_dwordx4 v3, s[8:11], s24 offen offset:1024 lds
  s_add_u32 s24, s24, s33
  v_mfma_f32_16x16x32_bf16 v[136:139], v[72:75], v[48:51], v[136:139]
  ds_read_b64_tr_b16 v[48:49], v16 offset:16896
  s_waitcnt lgkmcnt(13)
  v_mfma_f32_16x16x32_bf16 v[140:143], v[68:71], v[52:55], v[140:143]
  ds_read_b64_tr_b16 v[50:51], v16 offset:17920
  s_cmp_eq_u32 s24, s36
  s_cselect_b32 s24, 0, s24
  v_mfma_f32_16x16x32_bf16 v[144:147], v[72:75], v[52:55], v[144:147]
  ds_read_b64_tr_b16 v[52:53], v17 offset:16896
  ds_read_b64_tr_b16 v[54:55], v17 offset:17920
  v_mfma_f32_16x16x32_bf16 v[148:151], v[68:71], v[56:59], v[148:151]
  s_mov_b32 m0, s73
  s_nop 0
  buffer_load_dwordx4 v5, s[4:7], s25 offen offset:0 lds
  v_mfma_f32_16x16x32_bf16 v[152:155], v[72:75], v[56:59], v[152:155]
  ds_read_b64_tr_b16 v[56:57], v16 offset:17152
  s_waitcnt lgkmcnt(13)
  v_mfma_f32_16x16x32_bf16 v[156:159], v[68:71], v[60:63], v[156:159]
  ds_read_b64_tr_b16 v[58:59], v16 offset:18176
  v_mfma_f32_16x16x32_bf16 v[160:163], v[72:75], v[60:63], v[160:163]
  ds_read_b64_tr_b16 v[60:61], v17 offset:17152
  ds_read_b64_tr_b16 v[62:63], v17 offset:18176
  v_mfma_f32_16x16x32_bf16 v[164:167], v[68:71], v[64:67], v[164:167]
  buffer_load_dwordx4 v6, s[4:7], s25 offen offset:1024 lds
  v_mfma_f32_16x16x32_bf16 v[168:171], v[72:75], v[64:67], v[168:171]
  ds_read_b64_tr_b16 v[64:65], v18 offset:46080
  ds_read_b64_tr_b16 v[66:67], v18 offset:46336
  s_waitcnt vmcnt(8)
  s_barrier
  s_waitcnt lgkmcnt(15)
  v_mfma_f32_16x16x32_bf16 v[100:103], v[76:79], v[32:35], v[100:103]
  ds_read_b64_tr_b16 v[196:197], v245 offset:24576
  v_mfma_f32_16x16x32_bf16 v[104:107], v[80:83], v[32:35], v[104:107]
  ds_read_b64_tr_b16 v[198:199], v245 offset:24832
  s_waitcnt lgkmcnt(14)
  v_mfma_f32_16x16x32_bf16 v[108:111], v[76:79], v[36:39], v[108:111]
  ds_read_b64_tr_b16 v[200:201], v245 offset:24584
  ds_read_b64_tr_b16 v[202:203], v245 offset:24840
  v_mfma_f32_16x16x32_bf16 v[112:115], v[80:83], v[36:39], v[112:115]
  s_mov_b32 m0, s67
  ds_read_b64_tr_b16 v[204:205], v246 offset:24576
  v_mfma_f32_16x16x32_bf16 v[116:119], v[76:79], v[40:43], v[116:119]
  buffer_load_dwordx4 v20, s[40:43], s59 offen lds
  v_mfma_f32_16x16x32_bf16 v[120:123], v[80:83], v[40:43], v[120:123]
  ds_read_b64_tr_b16 v[206:207], v246 offset:24704
  ds_read_b64_tr_b16 v[208:209], v245 offset:25600
  s_waitcnt lgkmcnt(15)
  v_mfma_f32_16x16x32_bf16 v[124:127], v[76:79], v[44:47], v[124:127]
  buffer_load_dwordx4 v244, s[40:43], s59 offen offset:1024 lds
  v_mfma_f32_16x16x32_bf16 v[128:131], v[80:83], v[44:47], v[128:131]
  s_add_u32 s59, s59, s58
  s_cmp_eq_u32 s59, s42
  s_cselect_b32 s59, 0, s59
  v_mfma_f32_16x16x32_bf16 v[132:135], v[76:79], v[48:51], v[132:135]
  s_waitcnt vmcnt(8)
  ds_read_b128 v[84:87], v21 offset:16384
  v_mfma_f32_16x16x32_bf16 v[136:139], v[80:83], v[48:51], v[136:139]
  ds_read_b64_tr_b16 v[210:211], v245 offset:25856
  s_waitcnt lgkmcnt(13)
  v_mfma_f32_16x16x32_bf16 v[140:143], v[76:79], v[52:55], v[140:143]
  ds_read_b128 v[88:91], v21 offset:18432
  ds_read_b64_tr_b16 v[212:213], v245 offset:25608
  v_mfma_f32_16x16x32_bf16 v[144:147], v[80:83], v[52:55], v[144:147]
  ds_read_b128 v[92:95], v22 offset:16384
  ds_read_b64_tr_b16 v[214:215], v245 offset:25864
  v_mfma_f32_16x16x32_bf16 v[148:151], v[76:79], v[56:59], v[148:151]
  ds_read_b128 v[96:99], v22 offset:18432
  s_mov_b32 m0, s73
  v_mfma_f32_16x16x32_bf16 v[152:155], v[80:83], v[56:59], v[152:155]
  ds_read_b64_tr_b16 v[216:217], v246 offset:25600
  s_waitcnt lgkmcnt(15)
  v_mfma_f32_16x16x32_bf16 v[156:159], v[76:79], v[60:63], v[156:159]
  buffer_load_dwordx4 v7, s[4:7], s25 offen offset:2048 lds
  v_mfma_f32_16x16x32_bf16 v[160:163], v[80:83], v[60:63], v[160:163]
  buffer_load_dwordx4 v8, s[4:7], s25 offen offset:3072 lds
  v_mfma_f32_16x16x32_bf16 v[164:167], v[76:79], v[64:67], v[164:167]
  s_addk_i32 s25, 128
  s_cmp_eq_u32 s25, s3
  s_cselect_b32 s25, 0, s25
  v_mfma_f32_16x16x32_bf16 v[168:171], v[80:83], v[64:67], v[168:171]
  ds_read_b64_tr_b16 v[218:219], v246 offset:25728
  s_waitcnt vmcnt(8)
  s_barrier
  s_waitcnt lgkmcnt(14)
  v_mfma_f32_16x16x32_bf16 v[172:175], v[196:199], v[68:71], v[172:175]
  ds_read_b64_tr_b16 v[32:33], v16 offset:32768
  ds_read_b64_tr_b16 v[34:35], v16 offset:33792
  v_mfma_f32_16x16x32_bf16 v[176:179], v[196:199], v[72:75], v[176:179]
  ds_read_b64_tr_b16 v[36:37], v17 offset:32768
  s_waitcnt lgkmcnt(13)
  v_mfma_f32_16x16x32_bf16 v[180:183], v[200:203], v[68:71], v[180:183]
  ds_read_b64_tr_b16 v[38:39], v17 offset:33792
  ds_read_b64_tr_b16 v[40:41], v16 offset:33024
  v_mfma_f32_16x16x32_bf16 v[184:187], v[200:203], v[72:75], v[184:187]
  ds_read_b64_tr_b16 v[42:43], v16 offset:34048
  ds_read_b64_tr_b16 v[44:45], v17 offset:33024
  v_mfma_f32_16x16x32_bf16 v[188:191], v[204:207], v[68:71], v[188:191]
  ds_read_b64_tr_b16 v[46:47], v17 offset:34048
  ds_read_b64_tr_b16 v[48:49], v16 offset:33280
  v_mfma_f32_16x16x32_bf16 v[192:195], v[204:207], v[72:75], v[192:195]
  ds_read_b64_tr_b16 v[50:51], v16 offset:34304
  ds_read_b64_tr_b16 v[52:53], v17 offset:33280
  s_waitcnt lgkmcnt(14)
  v_mfma_f32_16x16x32_bf16 v[172:175], v[208:211], v[76:79], v[172:175]
  s_mov_b32 m0, s68
  ds_read_b64_tr_b16 v[54:55], v17 offset:34304
  v_mfma_f32_16x16x32_bf16 v[176:179], v[208:211], v[80:83], v[176:179]
  buffer_load_dwordx4 v2, s[8:11], s24 offen lds
  ds_read_b64_tr_b16 v[56:57], v16 offset:33536
  v_mfma_f32_16x16x32_bf16 v[180:183], v[212:215], v[76:79], v[180:183]
  buffer_load_dwordx4 v3, s[8:11], s24 offen offset:1024 lds
  ds_read_b64_tr_b16 v[58:59], v16 offset:34560
  v_mfma_f32_16x16x32_bf16 v[184:187], v[212:215], v[80:83], v[184:187]
  s_add_u32 s24, s24, s33
  s_mov_b32 m0, s71
  s_waitcnt lgkmcnt(14)
  v_mfma_f32_16x16x32_bf16 v[188:191], v[216:219], v[76:79], v[188:191]
  buffer_load_dwordx4 v4, s[8:11], s28 offen lds
  s_add_u32 s28, s28, 1179648
  v_mfma_f32_16x16x32_bf16 v[192:195], v[216:219], v[80:83], v[192:195]
  s_cmp_ge_u32 s28, s36
  s_cselect_b32 s29, s36, 0
  s_sub_u32 s28, s28, s29
  s_waitcnt vmcnt(9)
  s_barrier
  s_waitcnt lgkmcnt(12)
  v_mfma_f32_16x16x32_bf16 v[100:103], v[84:87], v[32:35], v[100:103]
  ds_read_b64_tr_b16 v[60:61], v17 offset:33536
  v_mfma_f32_16x16x32_bf16 v[104:107], v[88:91], v[32:35], v[104:107]
  ds_read_b64_tr_b16 v[62:63], v17 offset:34560
  ds_read_b64_tr_b16 v[64:65], v18 offset:47104
  s_waitcnt lgkmcnt(11)
  v_mfma_f32_16x16x32_bf16 v[108:111], v[84:87], v[36:39], v[108:111]
  ds_read_b64_tr_b16 v[66:67], v18 offset:47360
  ds_read_b64_tr_b16 v[32:33], v16 offset:0
  v_mfma_f32_16x16x32_bf16 v[112:115], v[88:91], v[36:39], v[112:115]
  ds_read_b64_tr_b16 v[34:35], v16 offset:1024
  ds_read_b64_tr_b16 v[36:37], v17 offset:0
  v_mfma_f32_16x16x32_bf16 v[116:119], v[84:87], v[40:43], v[116:119]
  ds_read_b64_tr_b16 v[38:39], v17 offset:1024
  s_mov_b32 m0, s69
  v_mfma_f32_16x16x32_bf16 v[120:123], v[88:91], v[40:43], v[120:123]
  ds_read_b64_tr_b16 v[40:41], v16 offset:256
  s_waitcnt lgkmcnt(13)
  v_mfma_f32_16x16x32_bf16 v[124:127], v[84:87], v[44:47], v[124:127]
  ds_read_b64_tr_b16 v[42:43], v16 offset:1280
  buffer_load_dwordx4 v2, s[8:11], s24 offen lds
  v_mfma_f32_16x16x32_bf16 v[128:131], v[88:91], v[44:47], v[128:131]
  ds_read_b64_tr_b16 v[44:45], v17 offset:256
  ds_read_b64_tr_b16 v[46:47], v17 offset:1280
  v_mfma_f32_16x16x32_bf16 v[132:135], v[84:87], v[48:51], v[132:135]
  buffer_load_dwordx4 v3, s[8:11], s24 offen offset:1024 lds
  s_add_u32 s24, s24, s33
  v_mfma_f32_16x16x32_bf16 v[136:139], v[88:91], v[48:51], v[136:139]
  ds_read_b64_tr_b16 v[48:49], v16 offset:512
  s_waitcnt lgkmcnt(13)
  v_mfma_f32_16x16x32_bf16 v[140:143], v[84:87], v[52:55], v[140:143]
  ds_read_b64_tr_b16 v[50:51], v16 offset:1536
  s_cmp_eq_u32 s24, s36
  s_cselect_b32 s24, 0, s24
  v_mfma_f32_16x16x32_bf16 v[144:147], v[88:91], v[52:55], v[144:147]
  ds_read_b64_tr_b16 v[52:53], v17 offset:512
  ds_read_b64_tr_b16 v[54:55], v17 offset:1536
  v_mfma_f32_16x16x32_bf16 v[148:151], v[84:87], v[56:59], v[148:151]
  s_mov_b32 m0, s63
  s_nop 0
  buffer_load_dwordx4 v5, s[4:7], s25 offen offset:0 lds
  v_mfma_f32_16x16x32_bf16 v[152:155], v[88:91], v[56:59], v[152:155]
  ds_read_b64_tr_b16 v[56:57], v16 offset:768
  s_waitcnt lgkmcnt(13)
  v_mfma_f32_16x16x32_bf16 v[156:159], v[84:87], v[60:63], v[156:159]
  ds_read_b64_tr_b16 v[58:59], v16 offset:1792
  v_mfma_f32_16x16x32_bf16 v[160:163], v[88:91], v[60:63], v[160:163]
  ds_read_b64_tr_b16 v[60:61], v17 offset:768
  ds_read_b64_tr_b16 v[62:63], v17 offset:1792
  v_mfma_f32_16x16x32_bf16 v[164:167], v[84:87], v[64:67], v[164:167]
  buffer_load_dwordx4 v6, s[4:7], s25 offen offset:1024 lds
  v_mfma_f32_16x16x32_bf16 v[168:171], v[88:91], v[64:67], v[168:171]
  ds_read_b64_tr_b16 v[64:65], v18 offset:48128
  ds_read_b64_tr_b16 v[66:67], v18 offset:48384
  s_waitcnt vmcnt(9)
  s_barrier
  s_waitcnt lgkmcnt(15)
  v_mfma_f32_16x16x32_bf16 v[100:103], v[92:95], v[32:35], v[100:103]
  ds_read_b64_tr_b16 v[196:197], v245 offset:8192
  v_mfma_f32_16x16x32_bf16 v[104:107], v[96:99], v[32:35], v[104:107]
  ds_read_b64_tr_b16 v[198:199], v245 offset:8448
  s_waitcnt lgkmcnt(14)
  v_mfma_f32_16x16x32_bf16 v[108:111], v[92:95], v[36:39], v[108:111]
  ds_read_b64_tr_b16 v[200:201], v245 offset:8200
  ds_read_b64_tr_b16 v[202:203], v245 offset:8456
  v_mfma_f32_16x16x32_bf16 v[112:115], v[96:99], v[36:39], v[112:115]
  s_mov_b32 m0, s70
  ds_read_b64_tr_b16 v[204:205], v246 offset:8192
  v_mfma_f32_16x16x32_bf16 v[116:119], v[92:95], v[40:43], v[116:119]
  buffer_load_dwordx4 v20, s[40:43], s59 offen lds
  v_mfma_f32_16x16x32_bf16 v[120:123], v[96:99], v[40:43], v[120:123]
  ds_read_b64_tr_b16 v[206:207], v246 offset:8320
  ds_read_b64_tr_b16 v[208:209], v245 offset:9216
  s_waitcnt lgkmcnt(15)
  v_mfma_f32_16x16x32_bf16 v[124:127], v[92:95], v[44:47], v[124:127]
  buffer_load_dwordx4 v244, s[40:43], s59 offen offset:1024 lds
  v_mfma_f32_16x16x32_bf16 v[128:131], v[96:99], v[44:47], v[128:131]
  s_add_u32 s59, s59, s58
  s_cmp_eq_u32 s59, s42
  s_cselect_b32 s59, 0, s59
  v_mfma_f32_16x16x32_bf16 v[132:135], v[92:95], v[48:51], v[132:135]
  s_waitcnt vmcnt(9)
  ds_read_b128 v[68:71], v21 offset:0
  v_mfma_f32_16x16x32_bf16 v[136:139], v[96:99], v[48:51], v[136:139]
  ds_read_b64_tr_b16 v[210:211], v245 offset:9472
  s_waitcnt lgkmcnt(13)
  v_mfma_f32_16x16x32_bf16 v[140:143], v[92:95], v[52:55], v[140:143]
  ds_read_b128 v[72:75], v21 offset:2048
  ds_read_b64_tr_b16 v[212:213], v245 offset:9224
  v_mfma_f32_16x16x32_bf16 v[144:147], v[96:99], v[52:55], v[144:147]
  ds_read_b128 v[76:79], v22 offset:0
  ds_read_b64_tr_b16 v[214:215], v245 offset:9480
  v_mfma_f32_16x16x32_bf16 v[148:151], v[92:95], v[56:59], v[148:151]
  ds_read_b128 v[80:83], v22 offset:2048
  s_mov_b32 m0, s63
  v_mfma_f32_16x16x32_bf16 v[152:155], v[96:99], v[56:59], v[152:155]
  ds_read_b64_tr_b16 v[216:217], v246 offset:9216
  s_waitcnt lgkmcnt(15)
  v_mfma_f32_16x16x32_bf16 v[156:159], v[92:95], v[60:63], v[156:159]
  buffer_load_dwordx4 v7, s[4:7], s25 offen offset:2048 lds
  v_mfma_f32_16x16x32_bf16 v[160:163], v[96:99], v[60:63], v[160:163]
  buffer_load_dwordx4 v8, s[4:7], s25 offen offset:3072 lds
  v_mfma_f32_16x16x32_bf16 v[164:167], v[92:95], v[64:67], v[164:167]
  s_addk_i32 s25, 128
  s_cmp_eq_u32 s25, s3
  s_cselect_b32 s25, 0, s25
  v_mfma_f32_16x16x32_bf16 v[168:171], v[96:99], v[64:67], v[168:171]
  ds_read_b64_tr_b16 v[218:219], v246 offset:9344
  s_waitcnt vmcnt(8)
  s_barrier
  s_waitcnt lgkmcnt(14)
  v_mfma_f32_16x16x32_bf16 v[172:175], v[196:199], v[84:87], v[172:175]
  ds_read_b64_tr_b16 v[32:33], v16 offset:16384
  v_mfma_f32_16x16x32_bf16 v[176:179], v[196:199], v[88:91], v[176:179]
  ds_read_b64_tr_b16 v[34:35], v16 offset:17408
  s_waitcnt lgkmcnt(12)
  v_mfma_f32_16x16x32_bf16 v[180:183], v[200:203], v[84:87], v[180:183]
  ds_read_b64_tr_b16 v[36:37], v17 offset:16384
  ds_read_b64_tr_b16 v[38:39], v17 offset:17408
  v_mfma_f32_16x16x32_bf16 v[184:187], v[200:203], v[88:91], v[184:187]
  ds_read_b64_tr_b16 v[40:41], v16 offset:16640
  ds_read_b64_tr_b16 v[42:43], v16 offset:17664
  v_mfma_f32_16x16x32_bf16 v[188:191], v[204:207], v[84:87], v[188:191]
  ds_read_b64_tr_b16 v[44:45], v17 offset:16640
  ds_read_b64_tr_b16 v[46:47], v17 offset:17664
  v_mfma_f32_16x16x32_bf16 v[192:195], v[204:207], v[88:91], v[192:195]
  ds_read_b64_tr_b16 v[48:49], v16 offset:16896
  s_waitcnt lgkmcnt(12)
  v_mfma_f32_16x16x32_bf16 v[172:175], v[208:211], v[92:95], v[172:175]
  ds_read_b64_tr_b16 v[50:51], v16 offset:17920
  v_mfma_f32_16x16x32_bf16 v[176:179], v[208:211], v[96:99], v[176:179]
  ds_read_b64_tr_b16 v[52:53], v17 offset:16896
  ds_read_b64_tr_b16 v[54:55], v17 offset:17920
  v_mfma_f32_16x16x32_bf16 v[180:183], v[212:215], v[92:95], v[180:183]
  s_mov_b32 m0, s66
  ds_read_b64_tr_b16 v[56:57], v16 offset:17152
  v_mfma_f32_16x16x32_bf16 v[184:187], v[212:215], v[96:99], v[184:187]
  ds_read_b64_tr_b16 v[58:59], v16 offset:18176
  s_waitcnt lgkmcnt(14)
  v_mfma_f32_16x16x32_bf16 v[188:191], v[216:219], v[92:95], v[188:191]
  buffer_load_dwordx4 v2, s[8:11], s24 offen lds
  v_mfma_f32_16x16x32_bf16 v[192:195], v[216:219], v[96:99], v[192:195]
  buffer_load_dwordx4 v3, s[8:11], s24 offen offset:1024 lds
  s_add_u32 s24, s24, s33
  s_waitcnt vmcnt(8)
  s_barrier
  s_waitcnt lgkmcnt(12)
  v_mfma_f32_16x16x32_bf16 v[100:103], v[68:71], v[32:35], v[100:103]
  ds_read_b64_tr_b16 v[60:61], v17 offset:17152
  v_mfma_f32_16x16x32_bf16 v[104:107], v[72:75], v[32:35], v[104:107]
  ds_read_b64_tr_b16 v[62:63], v17 offset:18176
  ds_read_b64_tr_b16 v[64:65], v18 offset:40960
  s_waitcnt lgkmcnt(11)
  v_mfma_f32_16x16x32_bf16 v[108:111], v[68:71], v[36:39], v[108:111]
  ds_read_b64_tr_b16 v[66:67], v18 offset:41216
  ds_read_b64_tr_b16 v[32:33], v16 offset:24576
  v_mfma_f32_16x16x32_bf16 v[112:115], v[72:75], v[36:39], v[112:115]
  ds_read_b64_tr_b16 v[34:35], v16 offset:25600
  ds_read_b64_tr_b16 v[36:37], v17 offset:24576
  v_mfma_f32_16x16x32_bf16 v[116:119], v[68:71], v[40:43], v[116:119]
  ds_read_b64_tr_b16 v[38:39], v17 offset:25600
  s_mov_b32 m0, s67
  v_mfma_f32_16x16x32_bf16 v[120:123], v[72:75], v[40:43], v[120:123]
  ds_read_b64_tr_b16 v[40:41], v16 offset:24832
  s_waitcnt lgkmcnt(13)
  v_mfma_f32_16x16x32_bf16 v[124:127], v[68:71], v[44:47], v[124:127]
  ds_read_b64_tr_b16 v[42:43], v16 offset:25856
  buffer_load_dwordx4 v2, s[8:11], s24 offen lds
  v_mfma_f32_16x16x32_bf16 v[128:131], v[72:75], v[44:47], v[128:131]
  ds_read_b64_tr_b16 v[44:45], v17 offset:24832
  ds_read_b64_tr_b16 v[46:47], v17 offset:25856
  v_mfma_f32_16x16x32_bf16 v[132:135], v[68:71], v[48:51], v[132:135]
  buffer_load_dwordx4 v3, s[8:11], s24 offen offset:1024 lds
  s_add_u32 s24, s24, s33
  v_mfma_f32_16x16x32_bf16 v[136:139], v[72:75], v[48:51], v[136:139]
  ds_read_b64_tr_b16 v[48:49], v16 offset:25088
  s_waitcnt lgkmcnt(13)
  v_mfma_f32_16x16x32_bf16 v[140:143], v[68:71], v[52:55], v[140:143]
  ds_read_b64_tr_b16 v[50:51], v16 offset:26112
  s_cmp_eq_u32 s24, s36
  s_cselect_b32 s24, 0, s24
  v_mfma_f32_16x16x32_bf16 v[144:147], v[72:75], v[52:55], v[144:147]
  ds_read_b64_tr_b16 v[52:53], v17 offset:25088
  ds_read_b64_tr_b16 v[54:55], v17 offset:26112
  v_mfma_f32_16x16x32_bf16 v[148:151], v[68:71], v[56:59], v[148:151]
  s_mov_b32 m0, s73
  s_nop 0
  buffer_load_dwordx4 v5, s[4:7], s25 offen offset:0 lds
  v_mfma_f32_16x16x32_bf16 v[152:155], v[72:75], v[56:59], v[152:155]
  ds_read_b64_tr_b16 v[56:57], v16 offset:25344
  s_waitcnt lgkmcnt(13)
  v_mfma_f32_16x16x32_bf16 v[156:159], v[68:71], v[60:63], v[156:159]
  ds_read_b64_tr_b16 v[58:59], v16 offset:26368
  v_mfma_f32_16x16x32_bf16 v[160:163], v[72:75], v[60:63], v[160:163]
  ds_read_b64_tr_b16 v[60:61], v17 offset:25344
  ds_read_b64_tr_b16 v[62:63], v17 offset:26368
  v_mfma_f32_16x16x32_bf16 v[164:167], v[68:71], v[64:67], v[164:167]
  buffer_load_dwordx4 v6, s[4:7], s25 offen offset:1024 lds
  v_mfma_f32_16x16x32_bf16 v[168:171], v[72:75], v[64:67], v[168:171]
  ds_read_b64_tr_b16 v[64:65], v18 offset:41984
  ds_read_b64_tr_b16 v[66:67], v18 offset:42240
  s_waitcnt vmcnt(8)
  s_barrier
  s_waitcnt lgkmcnt(15)
  v_mfma_f32_16x16x32_bf16 v[100:103], v[76:79], v[32:35], v[100:103]
  ds_read_b64_tr_b16 v[196:197], v245 offset:32768
  v_mfma_f32_16x16x32_bf16 v[104:107], v[80:83], v[32:35], v[104:107]
  ds_read_b64_tr_b16 v[198:199], v245 offset:33024
  s_waitcnt lgkmcnt(14)
  v_mfma_f32_16x16x32_bf16 v[108:111], v[76:79], v[36:39], v[108:111]
  ds_read_b64_tr_b16 v[200:201], v245 offset:32776
  ds_read_b64_tr_b16 v[202:203], v245 offset:33032
  v_mfma_f32_16x16x32_bf16 v[112:115], v[80:83], v[36:39], v[112:115]
  s_mov_b32 m0, s68
  ds_read_b64_tr_b16 v[204:205], v246 offset:32768
  v_mfma_f32_16x16x32_bf16 v[116:119], v[76:79], v[40:43], v[116:119]
  buffer_load_dwordx4 v20, s[40:43], s59 offen lds
  v_mfma_f32_16x16x32_bf16 v[120:123], v[80:83], v[40:43], v[120:123]
  ds_read_b64_tr_b16 v[206:207], v246 offset:32896
  ds_read_b64_tr_b16 v[208:209], v245 offset:33792
  s_waitcnt lgkmcnt(15)
  v_mfma_f32_16x16x32_bf16 v[124:127], v[76:79], v[44:47], v[124:127]
  buffer_load_dwordx4 v244, s[40:43], s59 offen offset:1024 lds
  v_mfma_f32_16x16x32_bf16 v[128:131], v[80:83], v[44:47], v[128:131]
  s_add_u32 s59, s59, s58
  s_cmp_eq_u32 s59, s42
  s_cselect_b32 s59, 0, s59
  v_mfma_f32_16x16x32_bf16 v[132:135], v[76:79], v[48:51], v[132:135]
  s_waitcnt vmcnt(8)
  ds_read_b128 v[84:87], v21 offset:16384
  v_mfma_f32_16x16x32_bf16 v[136:139], v[80:83], v[48:51], v[136:139]
  ds_read_b64_tr_b16 v[210:211], v245 offset:34048
  s_waitcnt lgkmcnt(13)
  v_mfma_f32_16x16x32_bf16 v[140:143], v[76:79], v[52:55], v[140:143]
  ds_read_b128 v[88:91], v21 offset:18432
  ds_read_b64_tr_b16 v[212:213], v245 offset:33800
  v_mfma_f32_16x16x32_bf16 v[144:147], v[80:83], v[52:55], v[144:147]
  ds_read_b128 v[92:95], v22 offset:16384
  ds_read_b64_tr_b16 v[214:215], v245 offset:34056
  v_mfma_f32_16x16x32_bf16 v[148:151], v[76:79], v[56:59], v[148:151]
  ds_read_b128 v[96:99], v22 offset:18432
  s_mov_b32 m0, s73
  v_mfma_f32_16x16x32_bf16 v[152:155], v[80:83], v[56:59], v[152:155]
  ds_read_b64_tr_b16 v[216:217], v246 offset:33792
  s_waitcnt lgkmcnt(15)
  v_mfma_f32_16x16x32_bf16 v[156:159], v[76:79], v[60:63], v[156:159]
  buffer_load_dwordx4 v7, s[4:7], s25 offen offset:2048 lds
  v_mfma_f32_16x16x32_bf16 v[160:163], v[80:83], v[60:63], v[160:163]
  buffer_load_dwordx4 v8, s[4:7], s25 offen offset:3072 lds
  v_mfma_f32_16x16x32_bf16 v[164:167], v[76:79], v[64:67], v[164:167]
  s_addk_i32 s25, 128
  s_cmp_eq_u32 s25, s3
  s_cselect_b32 s25, 0, s25
  v_mfma_f32_16x16x32_bf16 v[168:171], v[80:83], v[64:67], v[168:171]
  ds_read_b64_tr_b16 v[218:219], v246 offset:33920
  s_waitcnt vmcnt(8)
  s_barrier
  s_waitcnt lgkmcnt(14)
  v_mfma_f32_16x16x32_bf16 v[172:175], v[196:199], v[68:71], v[172:175]
  ds_read_b64_tr_b16 v[32:33], v16 offset:0
  ds_read_b64_tr_b16 v[34:35], v16 offset:1024
  v_mfma_f32_16x16x32_bf16 v[176:179], v[196:199], v[72:75], v[176:179]
  ds_read_b64_tr_b16 v[36:37], v17 offset:0
  s_waitcnt lgkmcnt(13)
  v_mfma_f32_16x16x32_bf16 v[180:183], v[200:203], v[68:71], v[180:183]
  ds_read_b64_tr_b16 v[38:39], v17 offset:1024
  ds_read_b64_tr_b16 v[40:41], v16 offset:256
  v_mfma_f32_16x16x32_bf16 v[184:187], v[200:203], v[72:75], v[184:187]
  ds_read_b64_tr_b16 v[42:43], v16 offset:1280
  ds_read_b64_tr_b16 v[44:45], v17 offset:256
  v_mfma_f32_16x16x32_bf16 v[188:191], v[204:207], v[68:71], v[188:191]
  ds_read_b64_tr_b16 v[46:47], v17 offset:1280
  ds_read_b64_tr_b16 v[48:49], v16 offset:512
  v_mfma_f32_16x16x32_bf16 v[192:195], v[204:207], v[72:75], v[192:195]
  ds_read_b64_tr_b16 v[50:51], v16 offset:1536
  ds_read_b64_tr_b16 v[52:53], v17 offset:512
  s_waitcnt lgkmcnt(14)
  v_mfma_f32_16x16x32_bf16 v[172:175], v[208:211], v[76:79], v[172:175]
  s_mov_b32 m0, s69
  ds_read_b64_tr_b16 v[54:55], v17 offset:1536
  v_mfma_f32_16x16x32_bf16 v[176:179], v[208:211], v[80:83], v[176:179]
  buffer_load_dwordx4 v2, s[8:11], s24 offen lds
  ds_read_b64_tr_b16 v[56:57], v16 offset:768
  v_mfma_f32_16x16x32_bf16 v[180:183], v[212:215], v[76:79], v[180:183]
  buffer_load_dwordx4 v3, s[8:11], s24 offen offset:1024 lds
  ds_read_b64_tr_b16 v[58:59], v16 offset:1792
  v_mfma_f32_16x16x32_bf16 v[184:187], v[212:215], v[80:83], v[184:187]
  s_add_u32 s24, s24, s33
  s_mov_b32 m0, s72
  s_waitcnt lgkmcnt(14)
  v_mfma_f32_16x16x32_bf16 v[188:191], v[216:219], v[76:79], v[188:191]
  buffer_load_dwordx4 v4, s[8:11], s28 offen lds
  s_add_u32 s28, s28, 1179648
  v_mfma_f32_16x16x32_bf16 v[192:195], v[216:219], v[80:83], v[192:195]
  s_cmp_ge_u32 s28, s36
  s_cselect_b32 s29, s36, 0
  s_sub_u32 s28, s28, s29
  s_waitcnt vmcnt(9)
  s_barrier
  s_waitcnt lgkmcnt(12)
  v_mfma_f32_16x16x32_bf16 v[100:103], v[84:87], v[32:35], v[100:103]
  ds_read_b64_tr_b16 v[60:61], v17 offset:768
  v_mfma_f32_16x16x32_bf16 v[104:107], v[88:91], v[32:35], v[104:107]
  ds_read_b64_tr_b16 v[62:63], v17 offset:1792
  ds_read_b64_tr_b16 v[64:65], v18 offset:43008
  s_waitcnt lgkmcnt(11)
  v_mfma_f32_16x16x32_bf16 v[108:111], v[84:87], v[36:39], v[108:111]
  ds_read_b64_tr_b16 v[66:67], v18 offset:43264
  ds_read_b64_tr_b16 v[32:33], v16 offset:8192
  v_mfma_f32_16x16x32_bf16 v[112:115], v[88:91], v[36:39], v[112:115]
  ds_read_b64_tr_b16 v[34:35], v16 offset:9216
  ds_read_b64_tr_b16 v[36:37], v17 offset:8192
  v_mfma_f32_16x16x32_bf16 v[116:119], v[84:87], v[40:43], v[116:119]
  ds_read_b64_tr_b16 v[38:39], v17 offset:9216
  s_mov_b32 m0, s70
  v_mfma_f32_16x16x32_bf16 v[120:123], v[88:91], v[40:43], v[120:123]
  ds_read_b64_tr_b16 v[40:41], v16 offset:8448
  s_waitcnt lgkmcnt(13)
  v_mfma_f32_16x16x32_bf16 v[124:127], v[84:87], v[44:47], v[124:127]
  ds_read_b64_tr_b16 v[42:43], v16 offset:9472
  buffer_load_dwordx4 v2, s[8:11], s24 offen lds
  v_mfma_f32_16x16x32_bf16 v[128:131], v[88:91], v[44:47], v[128:131]
  ds_read_b64_tr_b16 v[44:45], v17 offset:8448
  ds_read_b64_tr_b16 v[46:47], v17 offset:9472
  v_mfma_f32_16x16x32_bf16 v[132:135], v[84:87], v[48:51], v[132:135]
  buffer_load_dwordx4 v3, s[8:11], s24 offen offset:1024 lds
  s_add_u32 s24, s24, s33
  v_mfma_f32_16x16x32_bf16 v[136:139], v[88:91], v[48:51], v[136:139]
  ds_read_b64_tr_b16 v[48:49], v16 offset:8704
  s_waitcnt lgkmcnt(13)
  v_mfma_f32_16x16x32_bf16 v[140:143], v[84:87], v[52:55], v[140:143]
  ds_read_b64_tr_b16 v[50:51], v16 offset:9728
  s_cmp_eq_u32 s24, s36
  s_cselect_b32 s24, 0, s24
  v_mfma_f32_16x16x32_bf16 v[144:147], v[88:91], v[52:55], v[144:147]
  ds_read_b64_tr_b16 v[52:53], v17 offset:8704
  ds_read_b64_tr_b16 v[54:55], v17 offset:9728
  v_mfma_f32_16x16x32_bf16 v[148:151], v[84:87], v[56:59], v[148:151]
  s_mov_b32 m0, s63
  s_nop 0
  buffer_load_dwordx4 v5, s[4:7], s25 offen offset:0 lds
  v_mfma_f32_16x16x32_bf16 v[152:155], v[88:91], v[56:59], v[152:155]
  ds_read_b64_tr_b16 v[56:57], v16 offset:8960
  s_waitcnt lgkmcnt(13)
  v_mfma_f32_16x16x32_bf16 v[156:159], v[84:87], v[60:63], v[156:159]
  ds_read_b64_tr_b16 v[58:59], v16 offset:9984
  v_mfma_f32_16x16x32_bf16 v[160:163], v[88:91], v[60:63], v[160:163]
  ds_read_b64_tr_b16 v[60:61], v17 offset:8960
  ds_read_b64_tr_b16 v[62:63], v17 offset:9984
  v_mfma_f32_16x16x32_bf16 v[164:167], v[84:87], v[64:67], v[164:167]
  buffer_load_dwordx4 v6, s[4:7], s25 offen offset:1024 lds
  v_mfma_f32_16x16x32_bf16 v[168:171], v[88:91], v[64:67], v[168:171]
  ds_read_b64_tr_b16 v[64:65], v18 offset:44032
  ds_read_b64_tr_b16 v[66:67], v18 offset:44288
  s_waitcnt vmcnt(9)
  s_barrier
  s_waitcnt lgkmcnt(15)
  v_mfma_f32_16x16x32_bf16 v[100:103], v[92:95], v[32:35], v[100:103]
  ds_read_b64_tr_b16 v[196:197], v245 offset:16384
  v_mfma_f32_16x16x32_bf16 v[104:107], v[96:99], v[32:35], v[104:107]
  ds_read_b64_tr_b16 v[198:199], v245 offset:16640
  s_waitcnt lgkmcnt(14)
  v_mfma_f32_16x16x32_bf16 v[108:111], v[92:95], v[36:39], v[108:111]
  ds_read_b64_tr_b16 v[200:201], v245 offset:16392
  ds_read_b64_tr_b16 v[202:203], v245 offset:16648
  v_mfma_f32_16x16x32_bf16 v[112:115], v[96:99], v[36:39], v[112:115]
  s_mov_b32 m0, s66
  ds_read_b64_tr_b16 v[204:205], v246 offset:16384
  v_mfma_f32_16x16x32_bf16 v[116:119], v[92:95], v[40:43], v[116:119]
  buffer_load_dwordx4 v20, s[40:43], s59 offen lds
  v_mfma_f32_16x16x32_bf16 v[120:123], v[96:99], v[40:43], v[120:123]
  ds_read_b64_tr_b16 v[206:207], v246 offset:16512
  ds_read_b64_tr_b16 v[208:209], v245 offset:17408
  s_waitcnt lgkmcnt(15)
  v_mfma_f32_16x16x32_bf16 v[124:127], v[92:95], v[44:47], v[124:127]
  buffer_load_dwordx4 v244, s[40:43], s59 offen offset:1024 lds
  v_mfma_f32_16x16x32_bf16 v[128:131], v[96:99], v[44:47], v[128:131]
  s_add_u32 s59, s59, s58
  s_cmp_eq_u32 s59, s42
  s_cselect_b32 s59, 0, s59
  v_mfma_f32_16x16x32_bf16 v[132:135], v[92:95], v[48:51], v[132:135]
  s_waitcnt vmcnt(9)
  ds_read_b128 v[68:71], v21 offset:0
  v_mfma_f32_16x16x32_bf16 v[136:139], v[96:99], v[48:51], v[136:139]
  ds_read_b64_tr_b16 v[210:211], v245 offset:17664
  s_waitcnt lgkmcnt(13)
  v_mfma_f32_16x16x32_bf16 v[140:143], v[92:95], v[52:55], v[140:143]
  ds_read_b128 v[72:75], v21 offset:2048
  ds_read_b64_tr_b16 v[212:213], v245 offset:17416
  v_mfma_f32_16x16x32_bf16 v[144:147], v[96:99], v[52:55], v[144:147]
  ds_read_b128 v[76:79], v22 offset:0
  ds_read_b64_tr_b16 v[214:215], v245 offset:17672
  v_mfma_f32_16x16x32_bf16 v[148:151], v[92:95], v[56:59], v[148:151]
  ds_read_b128 v[80:83], v22 offset:2048
  s_mov_b32 m0, s63
  v_mfma_f32_16x16x32_bf16 v[152:155], v[96:99], v[56:59], v[152:155]
  ds_read_b64_tr_b16 v[216:217], v246 offset:17408
  s_waitcnt lgkmcnt(15)
  v_mfma_f32_16x16x32_bf16 v[156:159], v[92:95], v[60:63], v[156:159]
  buffer_load_dwordx4 v7, s[4:7], s25 offen offset:2048 lds
  v_mfma_f32_16x16x32_bf16 v[160:163], v[96:99], v[60:63], v[160:163]
  buffer_load_dwordx4 v8, s[4:7], s25 offen offset:3072 lds
  v_mfma_f32_16x16x32_bf16 v[164:167], v[92:95], v[64:67], v[164:167]
  s_addk_i32 s25, 128
  s_cmp_eq_u32 s25, s3
  s_cselect_b32 s25, 0, s25
  v_mfma_f32_16x16x32_bf16 v[168:171], v[96:99], v[64:67], v[168:171]
  ds_read_b64_tr_b16 v[218:219], v246 offset:17536
  s_waitcnt vmcnt(8)
  s_barrier
  s_waitcnt lgkmcnt(14)
  v_mfma_f32_16x16x32_bf16 v[172:175], v[196:199], v[84:87], v[172:175]
  ds_read_b64_tr_b16 v[32:33], v16 offset:24576
  v_mfma_f32_16x16x32_bf16 v[176:179], v[196:199], v[88:91], v[176:179]
  ds_read_b64_tr_b16 v[34:35], v16 offset:25600
  s_waitcnt lgkmcnt(12)
  v_mfma_f32_16x16x32_bf16 v[180:183], v[200:203], v[84:87], v[180:183]
  ds_read_b64_tr_b16 v[36:37], v17 offset:24576
  ds_read_b64_tr_b16 v[38:39], v17 offset:25600
  v_mfma_f32_16x16x32_bf16 v[184:187], v[200:203], v[88:91], v[184:187]
  ds_read_b64_tr_b16 v[40:41], v16 offset:24832
  ds_read_b64_tr_b16 v[42:43], v16 offset:25856
  v_mfma_f32_16x16x32_bf16 v[188:191], v[204:207], v[84:87], v[188:191]
  ds_read_b64_tr_b16 v[44:45], v17 offset:24832
  ds_read_b64_tr_b16 v[46:47], v17 offset:25856
  v_mfma_f32_16x16x32_bf16 v[192:195], v[204:207], v[88:91], v[192:195]
  ds_read_b64_tr_b16 v[48:49], v16 offset:25088
  s_waitcnt lgkmcnt(12)
  v_mfma_f32_16x16x32_bf16 v[172:175], v[208:211], v[92:95], v[172:175]
  ds_read_b64_tr_b16 v[50:51], v16 offset:26112
  v_mfma_f32_16x16x32_bf16 v[176:179], v[208:211], v[96:99], v[176:179]
  ds_read_b64_tr_b16 v[52:53], v17 offset:25088
  ds_read_b64_tr_b16 v[54:55], v17 offset:26112
  v_mfma_f32_16x16x32_bf16 v[180:183], v[212:215], v[92:95], v[180:183]
  s_mov_b32 m0, s67
  ds_read_b64_tr_b16 v[56:57], v16 offset:25344
  v_mfma_f32_16x16x32_bf16 v[184:187], v[212:215], v[96:99], v[184:187]
  ds_read_b64_tr_b16 v[58:59], v16 offset:26368
  s_waitcnt lgkmcnt(14)
  v_mfma_f32_16x16x32_bf16 v[188:191], v[216:219], v[92:95], v[188:191]
  buffer_load_dwordx4 v2, s[8:11], s24 offen lds
  v_mfma_f32_16x16x32_bf16 v[192:195], v[216:219], v[96:99], v[192:195]
  buffer_load_dwordx4 v3, s[8:11], s24 offen offset:1024 lds
  s_add_u32 s24, s24, s33
  s_waitcnt vmcnt(8)
  s_barrier
  s_waitcnt lgkmcnt(12)
  v_mfma_f32_16x16x32_bf16 v[100:103], v[68:71], v[32:35], v[100:103]
  ds_read_b64_tr_b16 v[60:61], v17 offset:25344
  v_mfma_f32_16x16x32_bf16 v[104:107], v[72:75], v[32:35], v[104:107]
  ds_read_b64_tr_b16 v[62:63], v17 offset:26368
  ds_read_b64_tr_b16 v[64:65], v18 offset:45056
  s_waitcnt lgkmcnt(11)
  v_mfma_f32_16x16x32_bf16 v[108:111], v[68:71], v[36:39], v[108:111]
  ds_read_b64_tr_b16 v[66:67], v18 offset:45312
  ds_read_b64_tr_b16 v[32:33], v16 offset:32768
  v_mfma_f32_16x16x32_bf16 v[112:115], v[72:75], v[36:39], v[112:115]
  ds_read_b64_tr_b16 v[34:35], v16 offset:33792
  ds_read_b64_tr_b16 v[36:37], v17 offset:32768
  v_mfma_f32_16x16x32_bf16 v[116:119], v[68:71], v[40:43], v[116:119]
  ds_read_b64_tr_b16 v[38:39], v17 offset:33792
  s_mov_b32 m0, s68
  v_mfma_f32_16x16x32_bf16 v[120:123], v[72:75], v[40:43], v[120:123]
  ds_read_b64_tr_b16 v[40:41], v16 offset:33024
  s_waitcnt lgkmcnt(13)
  v_mfma_f32_16x16x32_bf16 v[124:127], v[68:71], v[44:47], v[124:127]
  ds_read_b64_tr_b16 v[42:43], v16 offset:34048
  buffer_load_dwordx4 v2, s[8:11], s24 offen lds
  v_mfma_f32_16x16x32_bf16 v[128:131], v[72:75], v[44:47], v[128:131]
  ds_read_b64_tr_b16 v[44:45], v17 offset:33024
  ds_read_b64_tr_b16 v[46:47], v17 offset:34048
  v_mfma_f32_16x16x32_bf16 v[132:135], v[68:71], v[48:51], v[132:135]
  buffer_load_dwordx4 v3, s[8:11], s24 offen offset:1024 lds
  s_add_u32 s24, s24, s33
  v_mfma_f32_16x16x32_bf16 v[136:139], v[72:75], v[48:51], v[136:139]
  ds_read_b64_tr_b16 v[48:49], v16 offset:33280
  s_waitcnt lgkmcnt(13)
  v_mfma_f32_16x16x32_bf16 v[140:143], v[68:71], v[52:55], v[140:143]
  ds_read_b64_tr_b16 v[50:51], v16 offset:34304
  s_cmp_eq_u32 s24, s36
  s_cselect_b32 s24, 0, s24
  v_mfma_f32_16x16x32_bf16 v[144:147], v[72:75], v[52:55], v[144:147]
  ds_read_b64_tr_b16 v[52:53], v17 offset:33280
  ds_read_b64_tr_b16 v[54:55], v17 offset:34304
  v_mfma_f32_16x16x32_bf16 v[148:151], v[68:71], v[56:59], v[148:151]
  s_mov_b32 m0, s73
  s_nop 0
  buffer_load_dwordx4 v5, s[4:7], s25 offen offset:0 lds
  v_mfma_f32_16x16x32_bf16 v[152:155], v[72:75], v[56:59], v[152:155]
  ds_read_b64_tr_b16 v[56:57], v16 offset:33536
  s_waitcnt lgkmcnt(13)
  v_mfma_f32_16x16x32_bf16 v[156:159], v[68:71], v[60:63], v[156:159]
  ds_read_b64_tr_b16 v[58:59], v16 offset:34560
  v_mfma_f32_16x16x32_bf16 v[160:163], v[72:75], v[60:63], v[160:163]
  ds_read_b64_tr_b16 v[60:61], v17 offset:33536
  ds_read_b64_tr_b16 v[62:63], v17 offset:34560
  v_mfma_f32_16x16x32_bf16 v[164:167], v[68:71], v[64:67], v[164:167]
  buffer_load_dwordx4 v6, s[4:7], s25 offen offset:1024 lds
  v_mfma_f32_16x16x32_bf16 v[168:171], v[72:75], v[64:67], v[168:171]
  ds_read_b64_tr_b16 v[64:65], v18 offset:46080
  ds_read_b64_tr_b16 v[66:67], v18 offset:46336
  s_waitcnt vmcnt(8)
  s_barrier
  s_waitcnt lgkmcnt(15)
  v_mfma_f32_16x16x32_bf16 v[100:103], v[76:79], v[32:35], v[100:103]
  ds_read_b64_tr_b16 v[196:197], v245 offset:0
  v_mfma_f32_16x16x32_bf16 v[104:107], v[80:83], v[32:35], v[104:107]
  ds_read_b64_tr_b16 v[198:199], v245 offset:256
  s_waitcnt lgkmcnt(14)
  v_mfma_f32_16x16x32_bf16 v[108:111], v[76:79], v[36:39], v[108:111]
  ds_read_b64_tr_b16 v[200:201], v245 offset:8
  ds_read_b64_tr_b16 v[202:203], v245 offset:264
  v_mfma_f32_16x16x32_bf16 v[112:115], v[80:83], v[36:39], v[112:115]
  s_mov_b32 m0, s69
  ds_read_b64_tr_b16 v[204:205], v246 offset:0
  v_mfma_f32_16x16x32_bf16 v[116:119], v[76:79], v[40:43], v[116:119]
  buffer_load_dwordx4 v20, s[40:43], s59 offen lds
  v_mfma_f32_16x16x32_bf16 v[120:123], v[80:83], v[40:43], v[120:123]
  ds_read_b64_tr_b16 v[206:207], v246 offset:128
  ds_read_b64_tr_b16 v[208:209], v245 offset:1024
  s_waitcnt lgkmcnt(15)
  v_mfma_f32_16x16x32_bf16 v[124:127], v[76:79], v[44:47], v[124:127]
  buffer_load_dwordx4 v244, s[40:43], s59 offen offset:1024 lds
  v_mfma_f32_16x16x32_bf16 v[128:131], v[80:83], v[44:47], v[128:131]
  s_add_u32 s59, s59, s58
  s_cmp_eq_u32 s59, s42
  s_cselect_b32 s59, 0, s59
  v_mfma_f32_16x16x32_bf16 v[132:135], v[76:79], v[48:51], v[132:135]
  s_waitcnt vmcnt(8)
  ds_read_b128 v[84:87], v21 offset:16384
  v_mfma_f32_16x16x32_bf16 v[136:139], v[80:83], v[48:51], v[136:139]
  ds_read_b64_tr_b16 v[210:211], v245 offset:1280
  s_waitcnt lgkmcnt(13)
  v_mfma_f32_16x16x32_bf16 v[140:143], v[76:79], v[52:55], v[140:143]
  ds_read_b128 v[88:91], v21 offset:18432
  ds_read_b64_tr_b16 v[212:213], v245 offset:1032
  v_mfma_f32_16x16x32_bf16 v[144:147], v[80:83], v[52:55], v[144:147]
  ds_read_b128 v[92:95], v22 offset:16384
  ds_read_b64_tr_b16 v[214:215], v245 offset:1288
  v_mfma_f32_16x16x32_bf16 v[148:151], v[76:79], v[56:59], v[148:151]
  ds_read_b128 v[96:99], v22 offset:18432
  s_mov_b32 m0, s73
  v_mfma_f32_16x16x32_bf16 v[152:155], v[80:83], v[56:59], v[152:155]
  ds_read_b64_tr_b16 v[216:217], v246 offset:1024
  s_waitcnt lgkmcnt(15)
  v_mfma_f32_16x16x32_bf16 v[156:159], v[76:79], v[60:63], v[156:159]
  buffer_load_dwordx4 v7, s[4:7], s25 offen offset:2048 lds
  v_mfma_f32_16x16x32_bf16 v[160:163], v[80:83], v[60:63], v[160:163]
  buffer_load_dwordx4 v8, s[4:7], s25 offen offset:3072 lds
  v_mfma_f32_16x16x32_bf16 v[164:167], v[76:79], v[64:67], v[164:167]
  s_addk_i32 s25, 128
  s_cmp_eq_u32 s25, s3
  s_cselect_b32 s25, 0, s25
  v_mfma_f32_16x16x32_bf16 v[168:171], v[80:83], v[64:67], v[168:171]
  ds_read_b64_tr_b16 v[218:219], v246 offset:1152
  s_waitcnt vmcnt(8)
  s_barrier
  s_waitcnt lgkmcnt(14)
  v_mfma_f32_16x16x32_bf16 v[172:175], v[196:199], v[68:71], v[172:175]
  ds_read_b64_tr_b16 v[32:33], v16 offset:8192
  ds_read_b64_tr_b16 v[34:35], v16 offset:9216
  v_mfma_f32_16x16x32_bf16 v[176:179], v[196:199], v[72:75], v[176:179]
  ds_read_b64_tr_b16 v[36:37], v17 offset:8192
  s_waitcnt lgkmcnt(13)
  v_mfma_f32_16x16x32_bf16 v[180:183], v[200:203], v[68:71], v[180:183]
  ds_read_b64_tr_b16 v[38:39], v17 offset:9216
  ds_read_b64_tr_b16 v[40:41], v16 offset:8448
  ds_read_b64_tr_b16 v[42:43], v16 offset:9472
  v_mfma_f32_16x16x32_bf16 v[184:187], v[200:203], v[72:75], v[184:187]
  ds_read_b64_tr_b16 v[44:45], v17 offset:8448
  ds_read_b64_tr_b16 v[46:47], v17 offset:9472
  v_mfma_f32_16x16x32_bf16 v[188:191], v[204:207], v[68:71], v[188:191]
  ds_read_b64_tr_b16 v[48:49], v16 offset:8704
  ds_read_b64_tr_b16 v[50:51], v16 offset:9728
  v_mfma_f32_16x16x32_bf16 v[192:195], v[204:207], v[72:75], v[192:195]
  ds_read_b64_tr_b16 v[52:53], v17 offset:8704
  ds_read_b64_tr_b16 v[54:55], v17 offset:9728
  s_waitcnt lgkmcnt(15)
  v_mfma_f32_16x16x32_bf16 v[172:175], v[208:211], v[76:79], v[172:175]
  s_mov_b32 m0, s70
  ds_read_b64_tr_b16 v[56:57], v16 offset:8960
  v_mfma_f32_16x16x32_bf16 v[176:179], v[208:211], v[80:83], v[176:179]
  buffer_load_dwordx4 v2, s[8:11], s24 offen lds
  ds_read_b64_tr_b16 v[58:59], v16 offset:9984
  v_mfma_f32_16x16x32_bf16 v[180:183], v[212:215], v[76:79], v[180:183]
  buffer_load_dwordx4 v3, s[8:11], s24 offen offset:1024 lds
  s_add_u32 s24, s24, s33
  v_mfma_f32_16x16x32_bf16 v[184:187], v[212:215], v[80:83], v[184:187]
  s_cmp_lt_u32 s20, 2
  s_cselect_b32 s29, 0, 4608
  v_subrev_u32 v4, s29, v4
  s_mov_b32 m0, s71
  s_waitcnt lgkmcnt(14)
  v_mfma_f32_16x16x32_bf16 v[188:191], v[216:219], v[76:79], v[188:191]
  buffer_load_dwordx4 v4, s[8:11], s28 offen lds
  s_add_u32 s28, s28, 1179648
  v_mfma_f32_16x16x32_bf16 v[192:195], v[216:219], v[80:83], v[192:195]
  s_cmp_ge_u32 s28, s36
  s_cselect_b32 s29, s36, 0
  s_sub_u32 s28, s28, s29
  s_waitcnt vmcnt(9)
  s_barrier
  s_waitcnt lgkmcnt(12)
  v_mfma_f32_16x16x32_bf16 v[100:103], v[84:87], v[32:35], v[100:103]
  ds_read_b64_tr_b16 v[60:61], v17 offset:8960
  v_mfma_f32_16x16x32_bf16 v[104:107], v[88:91], v[32:35], v[104:107]
  ds_read_b64_tr_b16 v[62:63], v17 offset:9984
  ds_read_b64_tr_b16 v[64:65], v18 offset:47104
  s_waitcnt lgkmcnt(11)
  v_mfma_f32_16x16x32_bf16 v[108:111], v[84:87], v[36:39], v[108:111]
  ds_read_b64_tr_b16 v[66:67], v18 offset:47360
  ds_read_b64_tr_b16 v[32:33], v16 offset:16384
  v_mfma_f32_16x16x32_bf16 v[112:115], v[88:91], v[36:39], v[112:115]
  ds_read_b64_tr_b16 v[34:35], v16 offset:17408
  ds_read_b64_tr_b16 v[36:37], v17 offset:16384
  v_mfma_f32_16x16x32_bf16 v[116:119], v[84:87], v[40:43], v[116:119]
  ds_read_b64_tr_b16 v[38:39], v17 offset:17408
  s_mov_b32 m0, s66
  v_mfma_f32_16x16x32_bf16 v[120:123], v[88:91], v[40:43], v[120:123]
  ds_read_b64_tr_b16 v[40:41], v16 offset:16640
  s_waitcnt lgkmcnt(13)
  v_mfma_f32_16x16x32_bf16 v[124:127], v[84:87], v[44:47], v[124:127]
  ds_read_b64_tr_b16 v[42:43], v16 offset:17664
  buffer_load_dwordx4 v2, s[8:11], s24 offen lds
  v_mfma_f32_16x16x32_bf16 v[128:131], v[88:91], v[44:47], v[128:131]
  ds_read_b64_tr_b16 v[44:45], v17 offset:16640
  ds_read_b64_tr_b16 v[46:47], v17 offset:17664
  v_mfma_f32_16x16x32_bf16 v[132:135], v[84:87], v[48:51], v[132:135]
  buffer_load_dwordx4 v3, s[8:11], s24 offen offset:1024 lds
  s_add_u32 s24, s24, s33
  v_mfma_f32_16x16x32_bf16 v[136:139], v[88:91], v[48:51], v[136:139]
  ds_read_b64_tr_b16 v[48:49], v16 offset:16896
  s_waitcnt lgkmcnt(13)
  v_mfma_f32_16x16x32_bf16 v[140:143], v[84:87], v[52:55], v[140:143]
  ds_read_b64_tr_b16 v[50:51], v16 offset:17920
  s_cmp_eq_u32 s24, s36
  s_cselect_b32 s24, 0, s24
  v_mfma_f32_16x16x32_bf16 v[144:147], v[88:91], v[52:55], v[144:147]
  ds_read_b64_tr_b16 v[52:53], v17 offset:16896
  ds_read_b64_tr_b16 v[54:55], v17 offset:17920
  v_mfma_f32_16x16x32_bf16 v[148:151], v[84:87], v[56:59], v[148:151]
  s_mov_b32 m0, s63
  s_nop 0
  buffer_load_dwordx4 v5, s[4:7], s25 offen offset:0 lds
  v_mfma_f32_16x16x32_bf16 v[152:155], v[88:91], v[56:59], v[152:155]
  ds_read_b64_tr_b16 v[56:57], v16 offset:17152
  s_waitcnt lgkmcnt(13)
  v_mfma_f32_16x16x32_bf16 v[156:159], v[84:87], v[60:63], v[156:159]
  ds_read_b64_tr_b16 v[58:59], v16 offset:18176
  v_mfma_f32_16x16x32_bf16 v[160:163], v[88:91], v[60:63], v[160:163]
  ds_read_b64_tr_b16 v[60:61], v17 offset:17152
  ds_read_b64_tr_b16 v[62:63], v17 offset:18176
  v_mfma_f32_16x16x32_bf16 v[164:167], v[84:87], v[64:67], v[164:167]
  buffer_load_dwordx4 v6, s[4:7], s25 offen offset:1024 lds
  v_mfma_f32_16x16x32_bf16 v[168:171], v[88:91], v[64:67], v[168:171]
  ds_read_b64_tr_b16 v[64:65], v18 offset:48128
  ds_read_b64_tr_b16 v[66:67], v18 offset:48384
  s_waitcnt vmcnt(9)
  s_barrier
  v_mov_b32 v23, 0
  global_load_dword v24, v23, s[16:17] sc0 sc1
  buffer_load_dwordx2 v[26:27], v23, s[12:15], s47 offen sc0 sc1
  s_waitcnt lgkmcnt(15)
  v_mfma_f32_16x16x32_bf16 v[100:103], v[92:95], v[32:35], v[100:103]
  ds_read_b64_tr_b16 v[196:197], v245 offset:24576
  v_mfma_f32_16x16x32_bf16 v[104:107], v[96:99], v[32:35], v[104:107]
  ds_read_b64_tr_b16 v[198:199], v245 offset:24832
  s_waitcnt lgkmcnt(14)
  v_mfma_f32_16x16x32_bf16 v[108:111], v[92:95], v[36:39], v[108:111]
  ds_read_b64_tr_b16 v[200:201], v245 offset:24584
  ds_read_b64_tr_b16 v[202:203], v245 offset:24840
  v_mfma_f32_16x16x32_bf16 v[112:115], v[96:99], v[36:39], v[112:115]
  s_mov_b32 m0, s67
  ds_read_b64_tr_b16 v[204:205], v246 offset:24576
  v_mfma_f32_16x16x32_bf16 v[116:119], v[92:95], v[40:43], v[116:119]
  buffer_load_dwordx4 v20, s[40:43], s59 offen lds
  v_mfma_f32_16x16x32_bf16 v[120:123], v[96:99], v[40:43], v[120:123]
  ds_read_b64_tr_b16 v[206:207], v246 offset:24704
  ds_read_b64_tr_b16 v[208:209], v245 offset:25600
  s_waitcnt lgkmcnt(15)
  v_mfma_f32_16x16x32_bf16 v[124:127], v[92:95], v[44:47], v[124:127]
  buffer_load_dwordx4 v244, s[40:43], s59 offen offset:1024 lds
  v_mfma_f32_16x16x32_bf16 v[128:131], v[96:99], v[44:47], v[128:131]
  s_add_u32 s59, s59, s58
  s_cmp_eq_u32 s59, s42
  s_cselect_b32 s59, 0, s59
  v_mfma_f32_16x16x32_bf16 v[132:135], v[92:95], v[48:51], v[132:135]
  s_waitcnt vmcnt(11)
  ds_read_b128 v[68:71], v21 offset:0
  v_mfma_f32_16x16x32_bf16 v[136:139], v[96:99], v[48:51], v[136:139]
  ds_read_b64_tr_b16 v[210:211], v245 offset:25856
  s_waitcnt lgkmcnt(13)
  v_mfma_f32_16x16x32_bf16 v[140:143], v[92:95], v[52:55], v[140:143]
  ds_read_b128 v[72:75], v21 offset:2048
  ds_read_b64_tr_b16 v[212:213], v245 offset:25608
  v_mfma_f32_16x16x32_bf16 v[144:147], v[96:99], v[52:55], v[144:147]
  ds_read_b128 v[76:79], v22 offset:0
  ds_read_b64_tr_b16 v[214:215], v245 offset:25864
  v_mfma_f32_16x16x32_bf16 v[148:151], v[92:95], v[56:59], v[148:151]
  ds_read_b128 v[80:83], v22 offset:2048
  s_mov_b32 m0, s63
  v_mfma_f32_16x16x32_bf16 v[152:155], v[96:99], v[56:59], v[152:155]
  ds_read_b64_tr_b16 v[216:217], v246 offset:25600
  s_waitcnt lgkmcnt(15)
  v_mfma_f32_16x16x32_bf16 v[156:159], v[92:95], v[60:63], v[156:159]
  buffer_load_dwordx4 v7, s[4:7], s25 offen offset:2048 lds
  v_mfma_f32_16x16x32_bf16 v[160:163], v[96:99], v[60:63], v[160:163]
  buffer_load_dwordx4 v8, s[4:7], s25 offen offset:3072 lds
  v_mfma_f32_16x16x32_bf16 v[164:167], v[92:95], v[64:67], v[164:167]
  s_addk_i32 s25, 128
  s_cmp_eq_u32 s25, s3
  s_cselect_b32 s25, 0, s25
  v_mfma_f32_16x16x32_bf16 v[168:171], v[96:99], v[64:67], v[168:171]
  ds_read_b64_tr_b16 v[218:219], v246 offset:25728
  s_waitcnt vmcnt(10)
  s_barrier
  s_waitcnt lgkmcnt(14)
  v_mfma_f32_16x16x32_bf16 v[172:175], v[196:199], v[84:87], v[172:175]
  ds_read_b64_tr_b16 v[32:33], v16 offset:32768
  v_mfma_f32_16x16x32_bf16 v[176:179], v[196:199], v[88:91], v[176:179]
  ds_read_b64_tr_b16 v[34:35], v16 offset:33792
  s_waitcnt lgkmcnt(12)
  v_mfma_f32_16x16x32_bf16 v[180:183], v[200:203], v[84:87], v[180:183]
  ds_read_b64_tr_b16 v[36:37], v17 offset:32768
  v_mfma_f32_16x16x32_bf16 v[184:187], v[200:203], v[88:91], v[184:187]
  ds_read_b64_tr_b16 v[38:39], v17 offset:33792
  ds_read_b64_tr_b16 v[40:41], v16 offset:33024
  v_mfma_f32_16x16x32_bf16 v[188:191], v[204:207], v[84:87], v[188:191]
  ds_read_b64_tr_b16 v[42:43], v16 offset:34048
  v_mfma_f32_16x16x32_bf16 v[192:195], v[204:207], v[88:91], v[192:195]
  ds_read_b64_tr_b16 v[44:45], v17 offset:33024
  s_waitcnt lgkmcnt(10)
  v_mfma_f32_16x16x32_bf16 v[172:175], v[208:211], v[92:95], v[172:175]
  ds_read_b64_tr_b16 v[46:47], v17 offset:34048
  v_mfma_f32_16x16x32_bf16 v[176:179], v[208:211], v[96:99], v[176:179]
  ds_read_b64_tr_b16 v[48:49], v16 offset:33280
  ds_read_b64_tr_b16 v[50:51], v16 offset:34304
  v_mfma_f32_16x16x32_bf16 v[180:183], v[212:215], v[92:95], v[180:183]
  ds_read_b64_tr_b16 v[52:53], v17 offset:33280
  v_mfma_f32_16x16x32_bf16 v[184:187], v[212:215], v[96:99], v[184:187]
  ds_read_b64_tr_b16 v[54:55], v17 offset:34304
  s_waitcnt lgkmcnt(12)
  v_mfma_f32_16x16x32_bf16 v[188:191], v[216:219], v[92:95], v[188:191]
  ds_read_b64_tr_b16 v[56:57], v16 offset:33536
  v_mfma_f32_16x16x32_bf16 v[192:195], v[216:219], v[96:99], v[192:195]
  ds_read_b64_tr_b16 v[58:59], v16 offset:34560
  s_waitcnt vmcnt(8)
  s_barrier
  s_waitcnt lgkmcnt(12)
  v_mfma_f32_16x16x32_bf16 v[100:103], v[68:71], v[32:35], v[100:103]
  ds_read_b64_tr_b16 v[60:61], v17 offset:33536
  v_mfma_f32_16x16x32_bf16 v[104:107], v[72:75], v[32:35], v[104:107]
  ds_read_b64_tr_b16 v[62:63], v17 offset:34560
  s_waitcnt lgkmcnt(10)
  v_mfma_f32_16x16x32_bf16 v[108:111], v[68:71], v[36:39], v[108:111]
  ds_read_b64_tr_b16 v[64:65], v18 offset:40960
  ds_read_b64_tr_b16 v[66:67], v18 offset:41216
  v_mfma_f32_16x16x32_bf16 v[112:115], v[72:75], v[36:39], v[112:115]
  ds_read_b64_tr_b16 v[32:33], v16 offset:0
  v_mfma_f32_16x16x32_bf16 v[116:119], v[68:71], v[40:43], v[116:119]
  ds_read_b64_tr_b16 v[34:35], v16 offset:1024
  ds_read_b64_tr_b16 v[36:37], v17 offset:0
  v_mfma_f32_16x16x32_bf16 v[120:123], v[72:75], v[40:43], v[120:123]
  ds_read_b64_tr_b16 v[38:39], v17 offset:1024
  s_waitcnt lgkmcnt(12)
  v_mfma_f32_16x16x32_bf16 v[124:127], v[68:71], v[44:47], v[124:127]
  ds_read_b64_tr_b16 v[40:41], v16 offset:256
  ds_read_b64_tr_b16 v[42:43], v16 offset:1280
  v_mfma_f32_16x16x32_bf16 v[128:131], v[72:75], v[44:47], v[128:131]
  ds_read_b64_tr_b16 v[44:45], v17 offset:256
  v_mfma_f32_16x16x32_bf16 v[132:135], v[68:71], v[48:51], v[132:135]
  ds_read_b64_tr_b16 v[46:47], v17 offset:1280
  s_mov_b32 m0, s73
  v_mfma_f32_16x16x32_bf16 v[136:139], v[72:75], v[48:51], v[136:139]
  ds_read_b64_tr_b16 v[48:49], v16 offset:512
  ds_read_b64_tr_b16 v[50:51], v16 offset:1536
  s_waitcnt lgkmcnt(14)
  v_mfma_f32_16x16x32_bf16 v[140:143], v[68:71], v[52:55], v[140:143]
  buffer_load_dwordx4 v5, s[4:7], s25 offen offset:0 lds
  v_mfma_f32_16x16x32_bf16 v[144:147], v[72:75], v[52:55], v[144:147]
  ds_read_b64_tr_b16 v[52:53], v17 offset:512
  v_mfma_f32_16x16x32_bf16 v[148:151], v[68:71], v[56:59], v[148:151]
  ds_read_b64_tr_b16 v[54:55], v17 offset:1536
  v_mfma_f32_16x16x32_bf16 v[152:155], v[72:75], v[56:59], v[152:155]
  ds_read_b64_tr_b16 v[56:57], v16 offset:768
  ds_read_b64_tr_b16 v[58:59], v16 offset:1792
  s_waitcnt lgkmcnt(14)
  v_mfma_f32_16x16x32_bf16 v[156:159], v[68:71], v[60:63], v[156:159]
  buffer_load_dwordx4 v6, s[4:7], s25 offen offset:1024 lds
  v_mfma_f32_16x16x32_bf16 v[160:163], v[72:75], v[60:63], v[160:163]
  ds_read_b64_tr_b16 v[60:61], v17 offset:768
  ds_read_b64_tr_b16 v[62:63], v17 offset:1792
  v_mfma_f32_16x16x32_bf16 v[164:167], v[68:71], v[64:67], v[164:167]
  v_mfma_f32_16x16x32_bf16 v[168:171], v[72:75], v[64:67], v[168:171]
  ds_read_b64_tr_b16 v[64:65], v18 offset:41984
  ds_read_b64_tr_b16 v[66:67], v18 offset:42240
  s_waitcnt vmcnt(4)
  s_barrier
  s_waitcnt lgkmcnt(15)
  v_mfma_f32_16x16x32_bf16 v[100:103], v[76:79], v[32:35], v[100:103]
  ds_read_b64_tr_b16 v[196:197], v245 offset:8192
  v_mfma_f32_16x16x32_bf16 v[104:107], v[80:83], v[32:35], v[104:107]
  ds_read_b64_tr_b16 v[198:199], v245 offset:8448
  s_waitcnt lgkmcnt(14)
  v_mfma_f32_16x16x32_bf16 v[108:111], v[76:79], v[36:39], v[108:111]
  ds_read_b64_tr_b16 v[200:201], v245 offset:8200
  v_mfma_f32_16x16x32_bf16 v[112:115], v[80:83], v[36:39], v[112:115]
  ds_read_b64_tr_b16 v[202:203], v245 offset:8456
  s_mov_b32 m0, s73
  v_mfma_f32_16x16x32_bf16 v[116:119], v[76:79], v[40:43], v[116:119]
  ds_read_b64_tr_b16 v[204:205], v246 offset:8192
  v_mfma_f32_16x16x32_bf16 v[120:123], v[80:83], v[40:43], v[120:123]
  ds_read_b64_tr_b16 v[206:207], v246 offset:8320
  s_waitcnt lgkmcnt(14)
  v_mfma_f32_16x16x32_bf16 v[124:127], v[76:79], v[44:47], v[124:127]
  buffer_load_dwordx4 v7, s[4:7], s25 offen offset:2048 lds
  v_mfma_f32_16x16x32_bf16 v[128:131], v[80:83], v[44:47], v[128:131]
  buffer_load_dwordx4 v8, s[4:7], s25 offen offset:3072 lds
  v_mfma_f32_16x16x32_bf16 v[132:135], v[76:79], v[48:51], v[132:135]
  ds_read_b64_tr_b16 v[208:209], v245 offset:9216
  s_addk_i32 s25, 128
  v_mfma_f32_16x16x32_bf16 v[136:139], v[80:83], v[48:51], v[136:139]
  ds_read_b64_tr_b16 v[210:211], v245 offset:9472
  s_waitcnt lgkmcnt(12)
  v_mfma_f32_16x16x32_bf16 v[140:143], v[76:79], v[52:55], v[140:143]
  s_cmp_eq_u32 s25, s3
  s_cselect_b32 s25, 0, s25
  v_mfma_f32_16x16x32_bf16 v[144:147], v[80:83], v[52:55], v[144:147]
  ds_read_b64_tr_b16 v[212:213], v245 offset:9224
  v_mfma_f32_16x16x32_bf16 v[148:151], v[76:79], v[56:59], v[148:151]
  ds_read_b64_tr_b16 v[214:215], v245 offset:9480
  v_mfma_f32_16x16x32_bf16 v[152:155], v[80:83], v[56:59], v[152:155]
  ds_read_b64_tr_b16 v[216:217], v246 offset:9216
  s_waitcnt lgkmcnt(11)
  v_mfma_f32_16x16x32_bf16 v[156:159], v[76:79], v[60:63], v[156:159]
  ds_read_b64_tr_b16 v[218:219], v246 offset:9344
  v_mfma_f32_16x16x32_bf16 v[160:163], v[80:83], v[60:63], v[160:163]
  v_mfma_f32_16x16x32_bf16 v[164:167], v[76:79], v[64:67], v[164:167]
  v_mfma_f32_16x16x32_bf16 v[168:171], v[80:83], v[64:67], v[168:171]
  s_waitcnt lgkmcnt(10)
  v_mfma_f32_16x16x32_bf16 v[172:175], v[196:199], v[68:71], v[172:175]
  v_mfma_f32_16x16x32_bf16 v[176:179], v[196:199], v[72:75], v[176:179]
  s_waitcnt lgkmcnt(6)
  v_mfma_f32_16x16x32_bf16 v[180:183], v[200:203], v[68:71], v[180:183]
  v_mfma_f32_16x16x32_bf16 v[184:187], v[200:203], v[72:75], v[184:187]
  v_mfma_f32_16x16x32_bf16 v[188:191], v[204:207], v[68:71], v[188:191]
  v_mfma_f32_16x16x32_bf16 v[192:195], v[204:207], v[72:75], v[192:195]
  s_waitcnt lgkmcnt(2)
  v_mfma_f32_16x16x32_bf16 v[172:175], v[208:211], v[76:79], v[172:175]
  v_mfma_f32_16x16x32_bf16 v[176:179], v[208:211], v[80:83], v[176:179]
  v_mfma_f32_16x16x32_bf16 v[180:183], v[212:215], v[76:79], v[180:183]
  v_mfma_f32_16x16x32_bf16 v[184:187], v[212:215], v[80:83], v[184:187]
  s_waitcnt lgkmcnt(0)
  v_mfma_f32_16x16x32_bf16 v[188:191], v[216:219], v[76:79], v[188:191]
  v_mfma_f32_16x16x32_bf16 v[192:195], v[216:219], v[80:83], v[192:195]
  s_setprio 2
  s_mov_b32 s51, 300000
NONCE_1:
  v_readfirstlane_b32 s62, v24
  s_nop 1
  s_cmp_lg_u32 s62, 0
  s_cbranch_scc1 NONCE_OK_2
  s_sleep 32
  global_load_dword v24, v23, s[16:17] sc0 sc1
  s_waitcnt vmcnt(0)
  s_sub_u32 s51, s51, 1
  s_cmp_lg_u32 s51, 0
  s_cbranch_scc1 NONCE_1
NONCE_OK_2:
  s_mov_b32 s51, 300000
  s_branch POLLC_4
POLL_3:
  buffer_load_dwordx2 v[26:27], v23, s[12:15], s47 offen sc0 sc1
  s_waitcnt vmcnt(0)
POLLC_4:
  v_xor_b32 v28, s62, v26
  v_xor_b32 v29, s62, v27
  v_or_b32 v28, v28, v29
  v_cmp_ne_u32 vcc, 0, v28
  s_nop 4
  s_cbranch_vccz POLLOK_5
  s_sleep 4
  s_sub_u32 s51, s51, 1
  s_cmp_lg_u32 s51, 0
  s_cbranch_scc1 POLL_3
POLLOK_5:
  s_mov_b32 s44, 0x3eae1a93
  s_mov_b32 s45, 0x3eae1a93
  v_mov_b32 v24, s44
  s_bitcmp1_b32 0x2c, s22
  s_cselect_b32 s46, 0x4f800000, 1.0
  v_mov_b32 v25, s46
  v_cmp_gt_u32 vcc, 32, v1
  s_nop 1
  v_cndmask_b32 v24, v25, v24, vcc
  s_lshl_b32 s46, s23, 5
  s_add_u32 s46, s46, s22
  s_mul_i32 s46, s46, 1152
  s_add_u32 s46, s46, 25452544
  s_add_u32 s47, s46, 18432
  v_lshlrev_b32 v25, 2, v1
  v_pk_mul_f32 v[172:173], v[172:173], s[44:45]
  v_pk_mul_f32 v[174:175], v[174:175], s[44:45]
  v_pk_mul_f32 v[180:181], v[180:181], s[44:45]
  v_pk_mul_f32 v[182:183], v[182:183], s[44:45]
  v_pk_mul_f32 v[188:189], v[188:189], v[24:25] op_sel_hi:[1,0]
  v_pk_mul_f32 v[190:191], v[190:191], v[24:25] op_sel_hi:[1,0]
  v_cvt_pk_bf16_f32 v32, v172, v173
  v_cvt_pk_bf16_f32 v33, v174, v175
  v_cvt_pk_bf16_f32 v34, v180, v181
  v_cvt_pk_bf16_f32 v35, v182, v183
  v_cvt_pk_bf16_f32 v36, v188, v189
  v_cvt_pk_bf16_f32 v37, v190, v191
  v_min_u32 v32, -2, v32
  v_min_u32 v33, -2, v33
  v_min_u32 v34, -2, v34
  v_min_u32 v35, -2, v35
  v_min_u32 v36, -2, v36
  v_min_u32 v37, -2, v37
  buffer_store_dwordx4 v[32:35], v19, s[12:15], s46 offen sc0 sc1
  v_pk_mul_f32 v[176:177], v[176:177], s[44:45]
  v_pk_mul_f32 v[178:179], v[178:179], s[44:45]
  v_pk_mul_f32 v[184:185], v[184:185], s[44:45]
  v_pk_mul_f32 v[186:187], v[186:187], s[44:45]
  v_pk_mul_f32 v[192:193], v[192:193], v[24:25] op_sel_hi:[1,0]
  v_pk_mul_f32 v[194:195], v[194:195], v[24:25] op_sel_hi:[1,0]
  v_cvt_pk_bf16_f32 v40, v176, v177
  v_cvt_pk_bf16_f32 v41, v178, v179
  v_cvt_pk_bf16_f32 v42, v184, v185
  v_cvt_pk_bf16_f32 v43, v186, v187
  v_cvt_pk_bf16_f32 v44, v192, v193
  v_cvt_pk_bf16_f32 v45, v194, v195
  v_min_u32 v40, -2, v40
  v_min_u32 v41, -2, v41
  v_min_u32 v42, -2, v42
  v_min_u32 v43, -2, v43
  v_min_u32 v44, -2, v44
  v_min_u32 v45, -2, v45
  buffer_store_dwordx4 v[40:43], v19, s[12:15], s47 offen sc0 sc1
  s_mov_b32 exec_hi, 0
  buffer_store_dword v36, v25, s[12:15], s46 offen offset:1024 sc0 sc1
  buffer_store_dword v44, v25, s[12:15], s47 offen offset:1024 sc0 sc1
  s_mov_b64 exec, -1
  s_cmp_ge_u32 s22, 6
  s_cbranch_scc1 PJ_E_6
  s_mul_i32 s44, s23, 2496
  s_add_u32 s44, s44, 24616960
  v_and_b32 v24, 15, v1
  v_bfe_u32 v25, v1, 4, 1
  v_lshrrev_b32 v26, 2, v24
  v_mul_u32_u24 v26, 168, v26
  v_add_u32 v26, 1152, v26
  v_and_b32 v27, 3, v1
  s_mov_b32 exec_lo, 0
  s_cmp_ge_u32 s22, 4
  s_cbranch_scc1 PJ_T_8
  s_cmp_ge_u32 s22, 2
  s_cbranch_scc1 PJ_V_7
  v_lshlrev_b32 v28, 4, v24
  v_lshl_add_u32 v28, v25, 3, v28
  s_lshl_b32 s45, s22, 9
  s_add_u32 s44, s44, s45
  s_add_u32 s45, s44, 256
  s_branch PJ_S_9
PJ_V_7:
  v_lshl_add_u32 v28, v27, 5, v26
  v_lshl_add_u32 v28, v25, 3, v28
  s_and_b32 s45, s22, 1
  s_lshl_b32 s45, s45, 4
  s_add_u32 s44, s44, s45
  s_add_u32 s45, s44, 672
  s_branch PJ_S_9
PJ_T_8:
  s_cmp_eq_u32 s22, 5
  s_cbranch_scc1 PJ_VT_10
  v_lshlrev_b32 v28, 2, v24
  s_mov_b32 exec_hi, 0xffff
  buffer_store_dword v36, v28, s[12:15], s44 offen offset:1024 sc0 sc1
  buffer_store_dword v44, v28, s[12:15], s44 offen offset:1088 sc0 sc1
  s_branch PJ_E_6
PJ_VT_10:
  v_lshl_add_u32 v28, v27, 3, v26
  v_add_u32 v28, 128, v28
  v_add_u32 v29, 160, v26
  v_cmp_eq_u32 vcc, 0, v25
  s_nop 1
  v_cndmask_b32 v28, v29, v28, vcc
  v_mov_b32 v29, 20352
  v_cndmask_b32 v36, 0, v36, vcc
  v_cndmask_b32 v37, 0, v29, vcc
  v_cndmask_b32 v44, 0, v44, vcc
  v_cndmask_b32 v45, 0, v29, vcc
  s_add_u32 s45, s44, 672
PJ_S_9:
  buffer_store_dwordx2 v[36:37], v28, s[12:15], s44 offen sc0 sc1
  buffer_store_dwordx2 v[44:45], v28, s[12:15], s45 offen sc0 sc1
PJ_E_6:
  s_mov_b64 exec, -1
  s_barrier
  v_subrev_u32 v2, 4608, v2
  v_subrev_u32 v3, 4608, v3
  s_mov_b32 m0, s68
  s_nop 0
  buffer_load_dwordx4 v2, s[8:11], s24 offen lds
  buffer_load_dwordx4 v3, s[8:11], s24 offen offset:1024 lds
  s_add_u32 s24, s24, s33
  s_mov_b32 m0, s69
  s_nop 0
  buffer_load_dwordx4 v2, s[8:11], s24 offen lds
  buffer_load_dwordx4 v3, s[8:11], s24 offen offset:1024 lds
  s_add_u32 s24, s24, s33
  s_cmp_eq_u32 s24, s36
  s_cselect_b32 s24, 0, s24
  s_mov_b32 m0, s70
  s_nop 0
  buffer_load_dwordx4 v2, s[8:11], s24 offen lds
  buffer_load_dwordx4 v3, s[8:11], s24 offen offset:1024 lds
  s_add_u32 s24, s24, s33
  s_cmp_lt_u32 s20, 2
  s_cselect_b32 s29, 4608, 0
  v_subrev_u32 v4, s29, v4
  s_mov_b32 m0, s72
  s_nop 0
  buffer_load_dwordx4 v4, s[8:11], s28 offen lds
  s_add_u32 s28, s28, 1179648
  s_cmp_ge_u32 s28, s36
  s_cselect_b32 s29, s36, 0
  s_sub_u32 s28, s28, s29
  s_mov_b32 m0, s66
  s_nop 0
  buffer_load_dwordx4 v2, s[8:11], s24 offen lds
  buffer_load_dwordx4 v3, s[8:11], s24 offen offset:1024 lds
  s_add_u32 s24, s24, s33
  s_cmp_eq_u32 s24, s36
  s_cselect_b32 s24, 0, s24
  v_pk_mul_f32 v[48:49], v[100:101], v[100:101]
  v_pk_mul_f32 v[50:51], v[102:103], v[102:103]
  v_pk_mul_f32 v[52:53], v[104:105], v[104:105]
  v_pk_mul_f32 v[54:55], v[106:107], v[106:107]
  v_pk_fma_f32 v[48:49], v[48:49], s[60:61], v[30:31]
  v_pk_fma_f32 v[50:51], v[50:51], s[60:61], v[30:31]
  v_pk_fma_f32 v[52:53], v[52:53], s[60:61], v[30:31]
  v_pk_fma_f32 v[54:55], v[54:55], s[60:61], v[30:31]
  v_pk_mul_f32 v[48:49], v[48:49], v[100:101]
  v_pk_mul_f32 v[50:51], v[50:51], v[102:103]
  v_pk_mul_f32 v[52:53], v[52:53], v[104:105]
  v_pk_mul_f32 v[54:55], v[54:55], v[106:107]
  v_exp_f32 v48, v48
  v_exp_f32 v49, v49
  v_exp_f32 v50, v50
  v_exp_f32 v51, v51
  v_exp_f32 v52, v52
  v_exp_f32 v53, v53
  v_exp_f32 v54, v54
  v_exp_f32 v55, v55
  v_pk_add_f32 v[48:49], v[48:49], 1.0 op_sel_hi:[1,0]
  v_pk_add_f32 v[50:51], v[50:51], 1.0 op_sel_hi:[1,0]
  v_pk_add_f32 v[52:53], v[52:53], 1.0 op_sel_hi:[1,0]
  v_pk_add_f32 v[54:55], v[54:55], 1.0 op_sel_hi:[1,0]
  v_rcp_f32 v48, v48
  v_rcp_f32 v49, v49
  v_rcp_f32 v50, v50
  v_rcp_f32 v51, v51
  v_rcp_f32 v52, v52
  v_rcp_f32 v53, v53
  v_rcp_f32 v54, v54
  v_rcp_f32 v55, v55
  v_pk_mul_f32 v[100:101], v[48:49], v[100:101]
  v_pk_mul_f32 v[102:103], v[50:51], v[102:103]
  v_pk_mul_f32 v[104:105], v[52:53], v[104:105]
  v_pk_mul_f32 v[106:107], v[54:55], v[106:107]
  v_pk_add_f32 v[68:69], v[100:101], 0 op_sel_hi:[1,0]
  v_pk_mul_f32 v[76:77], v[100:101], v[100:101]
  v_pk_add_f32 v[70:71], v[102:103], 0 op_sel_hi:[1,0]
  v_pk_mul_f32 v[78:79], v[102:103], v[102:103]
  v_pk_add_f32 v[72:73], v[104:105], 0 op_sel_hi:[1,0]
  v_pk_mul_f32 v[80:81], v[104:105], v[104:105]
  v_pk_add_f32 v[74:75], v[106:107], 0 op_sel_hi:[1,0]
  v_pk_mul_f32 v[82:83], v[106:107], v[106:107]
  v_pk_mul_f32 v[56:57], v[108:109], v[108:109]
  v_pk_mul_f32 v[58:59], v[110:111], v[110:111]
  v_pk_mul_f32 v[60:61], v[112:113], v[112:113]
  v_pk_mul_f32 v[62:63], v[114:115], v[114:115]
  v_pk_fma_f32 v[56:57], v[56:57], s[60:61], v[30:31]
  v_pk_fma_f32 v[58:59], v[58:59], s[60:61], v[30:31]
  v_pk_fma_f32 v[60:61], v[60:61], s[60:61], v[30:31]
  v_pk_fma_f32 v[62:63], v[62:63], s[60:61], v[30:31]
  v_pk_mul_f32 v[56:57], v[56:57], v[108:109]
  v_pk_mul_f32 v[58:59], v[58:59], v[110:111]
  v_pk_mul_f32 v[60:61], v[60:61], v[112:113]
  v_pk_mul_f32 v[62:63], v[62:63], v[114:115]
  v_exp_f32 v56, v56
  v_exp_f32 v57, v57
  v_exp_f32 v58, v58
  v_exp_f32 v59, v59
  v_exp_f32 v60, v60
  v_exp_f32 v61, v61
  v_exp_f32 v62, v62
  v_exp_f32 v63, v63
  v_pk_add_f32 v[56:57], v[56:57], 1.0 op_sel_hi:[1,0]
  v_pk_add_f32 v[58:59], v[58:59], 1.0 op_sel_hi:[1,0]
  v_pk_add_f32 v[60:61], v[60:61], 1.0 op_sel_hi:[1,0]
  v_pk_add_f32 v[62:63], v[62:63], 1.0 op_sel_hi:[1,0]
  v_rcp_f32 v56, v56
  v_rcp_f32 v57, v57
  v_rcp_f32 v58, v58
  v_rcp_f32 v59, v59
  v_rcp_f32 v60, v60
  v_rcp_f32 v61, v61
  v_rcp_f32 v62, v62
  v_rcp_f32 v63, v63
  v_pk_mul_f32 v[108:109], v[56:57], v[108:109]
  v_pk_mul_f32 v[110:111], v[58:59], v[110:111]
  v_pk_mul_f32 v[112:113], v[60:61], v[112:113]
  v_pk_mul_f32 v[114:115], v[62:63], v[114:115]
  v_pk_add_f32 v[68:69], v[68:69], v[108:109]
  v_pk_fma_f32 v[76:77], v[108:109], v[108:109], v[76:77]
  v_pk_add_f32 v[70:71], v[70:71], v[110:111]
  v_pk_fma_f32 v[78:79], v[110:111], v[110:111], v[78:79]
  v_pk_add_f32 v[72:73], v[72:73], v[112:113]
  v_pk_fma_f32 v[80:81], v[112:113], v[112:113], v[80:81]
  v_pk_add_f32 v[74:75], v[74:75], v[114:115]
  v_pk_fma_f32 v[82:83], v[114:115], v[114:115], v[82:83]
  v_pk_mul_f32 v[48:49], v[116:117], v[116:117]
  v_pk_mul_f32 v[50:51], v[118:119], v[118:119]
  v_pk_mul_f32 v[52:53], v[120:121], v[120:121]
  v_pk_mul_f32 v[54:55], v[122:123], v[122:123]
  v_pk_fma_f32 v[48:49], v[48:49], s[60:61], v[30:31]
  v_pk_fma_f32 v[50:51], v[50:51], s[60:61], v[30:31]
  v_pk_fma_f32 v[52:53], v[52:53], s[60:61], v[30:31]
  v_pk_fma_f32 v[54:55], v[54:55], s[60:61], v[30:31]
  v_pk_mul_f32 v[48:49], v[48:49], v[116:117]
  v_pk_mul_f32 v[50:51], v[50:51], v[118:119]
  v_pk_mul_f32 v[52:53], v[52:53], v[120:121]
  v_pk_mul_f32 v[54:55], v[54:55], v[122:123]
  v_exp_f32 v48, v48
  v_exp_f32 v49, v49
  v_exp_f32 v50, v50
  v_exp_f32 v51, v51
  v_exp_f32 v52, v52
  v_exp_f32 v53, v53
  v_exp_f32 v54, v54
  v_exp_f32 v55, v55
  v_pk_add_f32 v[48:49], v[48:49], 1.0 op_sel_hi:[1,0]
  v_pk_add_f32 v[50:51], v[50:51], 1.0 op_sel_hi:[1,0]
  v_pk_add_f32 v[52:53], v[52:53], 1.0 op_sel_hi:[1,0]
  v_pk_add_f32 v[54:55], v[54:55], 1.0 op_sel_hi:[1,0]
  v_rcp_f32 v48, v48
  v_rcp_f32 v49, v49
  v_rcp_f32 v50, v50
  v_rcp_f32 v51, v51
  v_rcp_f32 v52, v52
  v_rcp_f32 v53, v53
  v_rcp_f32 v54, v54
  v_rcp_f32 v55, v55
  v_pk_mul_f32 v[116:117], v[48:49], v[116:117]
  v_pk_mul_f32 v[118:119], v[50:51], v[118:119]
  v_pk_mul_f32 v[120:121], v[52:53], v[120:121]
  v_pk_mul_f32 v[122:123], v[54:55], v[122:123]
  v_pk_add_f32 v[68:69], v[68:69], v[116:117]
  v_pk_fma_f32 v[76:77], v[116:117], v[116:117], v[76:77]
  v_pk_add_f32 v[70:71], v[70:71], v[118:119]
  v_pk_fma_f32 v[78:79], v[118:119], v[118:119], v[78:79]
  v_pk_add_f32 v[72:73], v[72:73], v[120:121]
  v_pk_fma_f32 v[80:81], v[120:121], v[120:121], v[80:81]
  v_pk_add_f32 v[74:75], v[74:75], v[122:123]
  v_pk_fma_f32 v[82:83], v[122:123], v[122:123], v[82:83]
  v_pk_mul_f32 v[56:57], v[124:125], v[124:125]
  v_pk_mul_f32 v[58:59], v[126:127], v[126:127]
  v_pk_mul_f32 v[60:61], v[128:129], v[128:129]
  v_pk_mul_f32 v[62:63], v[130:131], v[130:131]
  v_pk_fma_f32 v[56:57], v[56:57], s[60:61], v[30:31]
  v_pk_fma_f32 v[58:59], v[58:59], s[60:61], v[30:31]
  v_pk_fma_f32 v[60:61], v[60:61], s[60:61], v[30:31]
  v_pk_fma_f32 v[62:63], v[62:63], s[60:61], v[30:31]
  v_pk_mul_f32 v[56:57], v[56:57], v[124:125]
  v_pk_mul_f32 v[58:59], v[58:59], v[126:127]
  v_pk_mul_f32 v[60:61], v[60:61], v[128:129]
  v_pk_mul_f32 v[62:63], v[62:63], v[130:131]
  v_exp_f32 v56, v56
  v_exp_f32 v57, v57
  v_exp_f32 v58, v58
  v_exp_f32 v59, v59
  v_exp_f32 v60, v60
  v_exp_f32 v61, v61
  v_exp_f32 v62, v62
  v_exp_f32 v63, v63
  v_pk_add_f32 v[56:57], v[56:57], 1.0 op_sel_hi:[1,0]
  v_pk_add_f32 v[58:59], v[58:59], 1.0 op_sel_hi:[1,0]
  v_pk_add_f32 v[60:61], v[60:61], 1.0 op_sel_hi:[1,0]
  v_pk_add_f32 v[62:63], v[62:63], 1.0 op_sel_hi:[1,0]
  v_rcp_f32 v56, v56
  v_rcp_f32 v57, v57
  v_rcp_f32 v58, v58
  v_rcp_f32 v59, v59
  v_rcp_f32 v60, v60
  v_rcp_f32 v61, v61
  v_rcp_f32 v62, v62
  v_rcp_f32 v63, v63
  v_pk_mul_f32 v[124:125], v[56:57], v[124:125]
  v_pk_mul_f32 v[126:127], v[58:59], v[126:127]
  v_pk_mul_f32 v[128:129], v[60:61], v[128:129]
  v_pk_mul_f32 v[130:131], v[62:63], v[130:131]
  v_pk_add_f32 v[68:69], v[68:69], v[124:125]
  v_pk_fma_f32 v[76:77], v[124:125], v[124:125], v[76:77]
  v_pk_add_f32 v[70:71], v[70:71], v[126:127]
  v_pk_fma_f32 v[78:79], v[126:127], v[126:127], v[78:79]
  v_pk_add_f32 v[72:73], v[72:73], v[128:129]
  v_pk_fma_f32 v[80:81], v[128:129], v[128:129], v[80:81]
  v_pk_add_f32 v[74:75], v[74:75], v[130:131]
  v_pk_fma_f32 v[82:83], v[130:131], v[130:131], v[82:83]
  v_pk_mul_f32 v[48:49], v[132:133], v[132:133]
  v_pk_mul_f32 v[50:51], v[134:135], v[134:135]
  v_pk_mul_f32 v[52:53], v[136:137], v[136:137]
  v_pk_mul_f32 v[54:55], v[138:139], v[138:139]
  v_pk_fma_f32 v[48:49], v[48:49], s[60:61], v[30:31]
  v_pk_fma_f32 v[50:51], v[50:51], s[60:61], v[30:31]
  v_pk_fma_f32 v[52:53], v[52:53], s[60:61], v[30:31]
  v_pk_fma_f32 v[54:55], v[54:55], s[60:61], v[30:31]
  v_pk_mul_f32 v[48:49], v[48:49], v[132:133]
  v_pk_mul_f32 v[50:51], v[50:51], v[134:135]
  v_pk_mul_f32 v[52:53], v[52:53], v[136:137]
  v_pk_mul_f32 v[54:55], v[54:55], v[138:139]
  v_exp_f32 v48, v48
  v_exp_f32 v49, v49
  v_exp_f32 v50, v50
  v_exp_f32 v51, v51
  v_exp_f32 v52, v52
  v_exp_f32 v53, v53
  v_exp_f32 v54, v54
  v_exp_f32 v55, v55
  v_pk_add_f32 v[48:49], v[48:49], 1.0 op_sel_hi:[1,0]
  v_pk_add_f32 v[50:51], v[50:51], 1.0 op_sel_hi:[1,0]
  v_pk_add_f32 v[52:53], v[52:53], 1.0 op_sel_hi:[1,0]
  v_pk_add_f32 v[54:55], v[54:55], 1.0 op_sel_hi:[1,0]
  v_rcp_f32 v48, v48
  v_rcp_f32 v49, v49
  v_rcp_f32 v50, v50
  v_rcp_f32 v51, v51
  v_rcp_f32 v52, v52
  v_rcp_f32 v53, v53
  v_rcp_f32 v54, v54
  v_rcp_f32 v55, v55
  v_pk_mul_f32 v[132:133], v[48:49], v[132:133]
  v_pk_mul_f32 v[134:135], v[50:51], v[134:135]
  v_pk_mul_f32 v[136:137], v[52:53], v[136:137]
  v_pk_mul_f32 v[138:139], v[54:55], v[138:139]
  v_pk_add_f32 v[68:69], v[68:69], v[132:133]
  v_pk_fma_f32 v[76:77], v[132:133], v[132:133], v[76:77]
  v_pk_add_f32 v[70:71], v[70:71], v[134:135]
  v_pk_fma_f32 v[78:79], v[134:135], v[134:135], v[78:79]
  v_pk_add_f32 v[72:73], v[72:73], v[136:137]
  v_pk_fma_f32 v[80:81], v[136:137], v[136:137], v[80:81]
  v_pk_add_f32 v[74:75], v[74:75], v[138:139]
  v_pk_fma_f32 v[82:83], v[138:139], v[138:139], v[82:83]
  s_waitcnt vmcnt(9)
  v_mov_b32 v28, s62
  s_barrier
  s_cmp_ge_u32 s22, 6
  s_cbranch_scc1 PS_11
  s_cmp_lg_u32 s20, 0
  s_cbranch_scc1 PS_11
  s_mul_i32 s44, s21, 6
  s_add_u32 s44, s44, s22
  s_lshl_b32 s44, s44, 2
  s_add_u32 s44, s44, 25321472
  v_lshlrev_b32 v27, 9, v1
  s_mov_b64 exec, 0xff
  buffer_store_dword v28, v27, s[12:15], s44 offen sc0 sc1
  s_mov_b64 exec, -1
PS_11:
  v_pk_mul_f32 v[56:57], v[140:141], v[140:141]
  v_pk_mul_f32 v[58:59], v[142:143], v[142:143]
  v_pk_mul_f32 v[60:61], v[144:145], v[144:145]
  v_pk_mul_f32 v[62:63], v[146:147], v[146:147]
  v_pk_fma_f32 v[56:57], v[56:57], s[60:61], v[30:31]
  v_pk_fma_f32 v[58:59], v[58:59], s[60:61], v[30:31]
  v_pk_fma_f32 v[60:61], v[60:61], s[60:61], v[30:31]
  v_pk_fma_f32 v[62:63], v[62:63], s[60:61], v[30:31]
  v_pk_mul_f32 v[56:57], v[56:57], v[140:141]
  v_pk_mul_f32 v[58:59], v[58:59], v[142:143]
  v_pk_mul_f32 v[60:61], v[60:61], v[144:145]
  v_pk_mul_f32 v[62:63], v[62:63], v[146:147]
  v_exp_f32 v56, v56
  v_exp_f32 v57, v57
  v_exp_f32 v58, v58
  v_exp_f32 v59, v59
  v_exp_f32 v60, v60
  v_exp_f32 v61, v61
  v_exp_f32 v62, v62
  v_exp_f32 v63, v63
  v_pk_add_f32 v[56:57], v[56:57], 1.0 op_sel_hi:[1,0]
  v_pk_add_f32 v[58:59], v[58:59], 1.0 op_sel_hi:[1,0]
  v_pk_add_f32 v[60:61], v[60:61], 1.0 op_sel_hi:[1,0]
  v_pk_add_f32 v[62:63], v[62:63], 1.0 op_sel_hi:[1,0]
  v_rcp_f32 v56, v56
  v_rcp_f32 v57, v57
  v_rcp_f32 v58, v58
  v_rcp_f32 v59, v59
  v_rcp_f32 v60, v60
  v_rcp_f32 v61, v61
  v_rcp_f32 v62, v62
  v_rcp_f32 v63, v63
  v_pk_mul_f32 v[140:141], v[56:57], v[140:141]
  v_pk_mul_f32 v[142:143], v[58:59], v[142:143]
  v_pk_mul_f32 v[144:145], v[60:61], v[144:145]
  v_pk_mul_f32 v[146:147], v[62:63], v[146:147]
  v_pk_add_f32 v[68:69], v[68:69], v[140:141]
  v_pk_fma_f32 v[76:77], v[140:141], v[140:141], v[76:77]
  v_pk_add_f32 v[70:71], v[70:71], v[142:143]
  v_pk_fma_f32 v[78:79], v[142:143], v[142:143], v[78:79]
  v_pk_add_f32 v[72:73], v[72:73], v[144:145]
  v_pk_fma_f32 v[80:81], v[144:145], v[144:145], v[80:81]
  v_pk_add_f32 v[74:75], v[74:75], v[146:147]
  v_pk_fma_f32 v[82:83], v[146:147], v[146:147], v[82:83]
  v_pk_mul_f32 v[48:49], v[148:149], v[148:149]
  v_pk_mul_f32 v[50:51], v[150:151], v[150:151]
  v_pk_mul_f32 v[52:53], v[152:153], v[152:153]
  v_pk_mul_f32 v[54:55], v[154:155], v[154:155]
  v_pk_fma_f32 v[48:49], v[48:49], s[60:61], v[30:31]
  v_pk_fma_f32 v[50:51], v[50:51], s[60:61], v[30:31]
  v_pk_fma_f32 v[52:53], v[52:53], s[60:61], v[30:31]
  v_pk_fma_f32 v[54:55], v[54:55], s[60:61], v[30:31]
  v_pk_mul_f32 v[48:49], v[48:49], v[148:149]
  v_pk_mul_f32 v[50:51], v[50:51], v[150:151]
  v_pk_mul_f32 v[52:53], v[52:53], v[152:153]
  v_pk_mul_f32 v[54:55], v[54:55], v[154:155]
  v_exp_f32 v48, v48
  v_exp_f32 v49, v49
  v_exp_f32 v50, v50
  v_exp_f32 v51, v51
  v_exp_f32 v52, v52
  v_exp_f32 v53, v53
  v_exp_f32 v54, v54
  v_exp_f32 v55, v55
  v_pk_add_f32 v[48:49], v[48:49], 1.0 op_sel_hi:[1,0]
  v_pk_add_f32 v[50:51], v[50:51], 1.0 op_sel_hi:[1,0]
  v_pk_add_f32 v[52:53], v[52:53], 1.0 op_sel_hi:[1,0]
  v_pk_add_f32 v[54:55], v[54:55], 1.0 op_sel_hi:[1,0]
  v_rcp_f32 v48, v48
  v_rcp_f32 v49, v49
  v_rcp_f32 v50, v50
  v_rcp_f32 v51, v51
  v_rcp_f32 v52, v52
  v_rcp_f32 v53, v53
  v_rcp_f32 v54, v54
  v_rcp_f32 v55, v55
  v_pk_mul_f32 v[148:149], v[48:49], v[148:149]
  v_pk_mul_f32 v[150:151], v[50:51], v[150:151]
  v_pk_mul_f32 v[152:153], v[52:53], v[152:153]
  v_pk_mul_f32 v[154:155], v[54:55], v[154:155]
  v_pk_add_f32 v[68:69], v[68:69], v[148:149]
  v_pk_fma_f32 v[76:77], v[148:149], v[148:149], v[76:77]
  v_pk_add_f32 v[70:71], v[70:71], v[150:151]
  v_pk_fma_f32 v[78:79], v[150:151], v[150:151], v[78:79]
  v_pk_add_f32 v[72:73], v[72:73], v[152:153]
  v_pk_fma_f32 v[80:81], v[152:153], v[152:153], v[80:81]
  v_pk_add_f32 v[74:75], v[74:75], v[154:155]
  v_pk_fma_f32 v[82:83], v[154:155], v[154:155], v[82:83]
  v_pk_mul_f32 v[56:57], v[156:157], v[156:157]
  v_pk_mul_f32 v[58:59], v[158:159], v[158:159]
  v_pk_mul_f32 v[60:61], v[160:161], v[160:161]
  v_pk_mul_f32 v[62:63], v[162:163], v[162:163]
  v_pk_fma_f32 v[56:57], v[56:57], s[60:61], v[30:31]
  v_pk_fma_f32 v[58:59], v[58:59], s[60:61], v[30:31]
  v_pk_fma_f32 v[60:61], v[60:61], s[60:61], v[30:31]
  v_pk_fma_f32 v[62:63], v[62:63], s[60:61], v[30:31]
  v_pk_mul_f32 v[56:57], v[56:57], v[156:157]
  v_pk_mul_f32 v[58:59], v[58:59], v[158:159]
  v_pk_mul_f32 v[60:61], v[60:61], v[160:161]
  v_pk_mul_f32 v[62:63], v[62:63], v[162:163]
  v_exp_f32 v56, v56
  v_exp_f32 v57, v57
  v_exp_f32 v58, v58
  v_exp_f32 v59, v59
  v_exp_f32 v60, v60
  v_exp_f32 v61, v61
  v_exp_f32 v62, v62
  v_exp_f32 v63, v63
  v_pk_add_f32 v[56:57], v[56:57], 1.0 op_sel_hi:[1,0]
  v_pk_add_f32 v[58:59], v[58:59], 1.0 op_sel_hi:[1,0]
  v_pk_add_f32 v[60:61], v[60:61], 1.0 op_sel_hi:[1,0]
  v_pk_add_f32 v[62:63], v[62:63], 1.0 op_sel_hi:[1,0]
  v_rcp_f32 v56, v56
  v_rcp_f32 v57, v57
  v_rcp_f32 v58, v58
  v_rcp_f32 v59, v59
  v_rcp_f32 v60, v60
  v_rcp_f32 v61, v61
  v_rcp_f32 v62, v62
  v_rcp_f32 v63, v63
  v_pk_mul_f32 v[156:157], v[56:57], v[156:157]
  v_pk_mul_f32 v[158:159], v[58:59], v[158:159]
  v_pk_mul_f32 v[160:161], v[60:61], v[160:161]
  v_pk_mul_f32 v[162:163], v[62:63], v[162:163]
  v_pk_add_f32 v[68:69], v[68:69], v[156:157]
  v_pk_fma_f32 v[76:77], v[156:157], v[156:157], v[76:77]
  v_pk_add_f32 v[70:71], v[70:71], v[158:159]
  v_pk_fma_f32 v[78:79], v[158:159], v[158:159], v[78:79]
  v_pk_add_f32 v[72:73], v[72:73], v[160:161]
  v_pk_fma_f32 v[80:81], v[160:161], v[160:161], v[80:81]
  v_pk_add_f32 v[74:75], v[74:75], v[162:163]
  v_pk_fma_f32 v[82:83], v[162:163], v[162:163], v[82:83]
  v_pk_mul_f32 v[48:49], v[164:165], v[164:165]
  v_pk_mul_f32 v[50:51], v[166:167], v[166:167]
  v_pk_mul_f32 v[52:53], v[168:169], v[168:169]
  v_pk_mul_f32 v[54:55], v[170:171], v[170:171]
  v_pk_fma_f32 v[48:49], v[48:49], s[60:61], v[30:31]
  v_pk_fma_f32 v[50:51], v[50:51], s[60:61], v[30:31]
  v_pk_fma_f32 v[52:53], v[52:53], s[60:61], v[30:31]
  v_pk_fma_f32 v[54:55], v[54:55], s[60:61], v[30:31]
  v_pk_mul_f32 v[48:49], v[48:49], v[164:165]
  v_pk_mul_f32 v[50:51], v[50:51], v[166:167]
  v_pk_mul_f32 v[52:53], v[52:53], v[168:169]
  v_pk_mul_f32 v[54:55], v[54:55], v[170:171]
  v_exp_f32 v48, v48
  v_exp_f32 v49, v49
  v_exp_f32 v50, v50
  v_exp_f32 v51, v51
  v_exp_f32 v52, v52
  v_exp_f32 v53, v53
  v_exp_f32 v54, v54
  v_exp_f32 v55, v55
  v_pk_add_f32 v[48:49], v[48:49], 1.0 op_sel_hi:[1,0]
  v_pk_add_f32 v[50:51], v[50:51], 1.0 op_sel_hi:[1,0]
  v_pk_add_f32 v[52:53], v[52:53], 1.0 op_sel_hi:[1,0]
  v_pk_add_f32 v[54:55], v[54:55], 1.0 op_sel_hi:[1,0]
  v_rcp_f32 v48, v48
  v_rcp_f32 v49, v49
  v_rcp_f32 v50, v50
  v_rcp_f32 v51, v51
  v_rcp_f32 v52, v52
  v_rcp_f32 v53, v53
  v_rcp_f32 v54, v54
  v_rcp_f32 v55, v55
  v_pk_mul_f32 v[164:165], v[48:49], v[164:165]
  v_pk_mul_f32 v[166:167], v[50:51], v[166:167]
  v_pk_mul_f32 v[168:169], v[52:53], v[168:169]
  v_pk_mul_f32 v[170:171], v[54:55], v[170:171]
  v_pk_add_f32 v[68:69], v[68:69], v[164:165]
  v_pk_fma_f32 v[76:77], v[164:165], v[164:165], v[76:77]
  v_pk_add_f32 v[70:71], v[70:71], v[166:167]
  v_pk_fma_f32 v[78:79], v[166:167], v[166:167], v[78:79]
  v_pk_add_f32 v[72:73], v[72:73], v[168:169]
  v_pk_fma_f32 v[80:81], v[168:169], v[168:169], v[80:81]
  v_pk_add_f32 v[74:75], v[74:75], v[170:171]
  v_pk_fma_f32 v[82:83], v[170:171], v[170:171], v[82:83]
  v_add_f32_dpp v68, v68, v68 row_ror:8 row_mask:0xf bank_mask:0x3
  v_add_f32_dpp v69, v69, v69 row_ror:8 row_mask:0xf bank_mask:0x3
  v_add_f32_dpp v70, v70, v70 row_ror:8 row_mask:0xf bank_mask:0x3
  v_add_f32_dpp v71, v71, v71 row_ror:8 row_mask:0xf bank_mask:0x3
  v_add_f32_dpp v68, v72, v72 row_ror:8 row_mask:0xf bank_mask:0xc
  v_add_f32_dpp v69, v73, v73 row_ror:8 row_mask:0xf bank_mask:0xc
  v_add_f32_dpp v70, v74, v74 row_ror:8 row_mask:0xf bank_mask:0xc
  v_add_f32_dpp v71, v75, v75 row_ror:8 row_mask:0xf bank_mask:0xc
  v_add_f32_dpp v76, v76, v76 row_ror:8 row_mask:0xf bank_mask:0x3
  v_add_f32_dpp v77, v77, v77 row_ror:8 row_mask:0xf bank_mask:0x3
  v_add_f32_dpp v78, v78, v78 row_ror:8 row_mask:0xf bank_mask:0x3
  v_add_f32_dpp v79, v79, v79 row_ror:8 row_mask:0xf bank_mask:0x3
  v_add_f32_dpp v76, v80, v80 row_ror:8 row_mask:0xf bank_mask:0xc
  v_add_f32_dpp v77, v81, v81 row_ror:8 row_mask:0xf bank_mask:0xc
  v_add_f32_dpp v78, v82, v82 row_ror:8 row_mask:0xf bank_mask:0xc
  v_add_f32_dpp v79, v83, v83 row_ror:8 row_mask:0xf bank_mask:0xc
  v_add_f32_dpp v68, v68, v68 row_shl:4 row_mask:0xf bank_mask:0x5
  v_add_f32_dpp v69, v69, v69 row_shl:4 row_mask:0xf bank_mask:0x5
  s_nop 0
  v_add_f32_dpp v68, v70, v70 row_shr:4 row_mask:0xf bank_mask:0xa
  v_add_f32_dpp v69, v71, v71 row_shr:4 row_mask:0xf bank_mask:0xa
  v_add_f32_dpp v76, v76, v76 row_shl:4 row_mask:0xf bank_mask:0x5
  v_add_f32_dpp v77, v77, v77 row_shl:4 row_mask:0xf bank_mask:0x5
  s_nop 0
  v_add_f32_dpp v76, v78, v78 row_shr:4 row_mask:0xf bank_mask:0xa
  v_add_f32_dpp v77, v79, v79 row_shr:4 row_mask:0xf bank_mask:0xa
  v_add_f32_dpp v68, v68, v68 quad_perm:[1,0,3,2] row_mask:0xf bank_mask:0xf
  v_add_f32_dpp v69, v69, v69 quad_perm:[1,0,3,2] row_mask:0xf bank_mask:0xf
  v_add_f32_dpp v76, v76, v76 quad_perm:[1,0,3,2] row_mask:0xf bank_mask:0xf
  v_add_f32_dpp v77, v77, v77 quad_perm:[1,0,3,2] row_mask:0xf bank_mask:0xf
  v_add_f32_dpp v68, v68, v68 quad_perm:[2,3,0,1] row_mask:0xf bank_mask:0xf
  v_add_f32_dpp v69, v69, v69 quad_perm:[2,3,0,1] row_mask:0xf bank_mask:0xf
  v_add_f32_dpp v76, v76, v76 quad_perm:[2,3,0,1] row_mask:0xf bank_mask:0xf
  v_add_f32_dpp v77, v77, v77 quad_perm:[2,3,0,1] row_mask:0xf bank_mask:0xf
  v_and_b32 v25, 1, v1
  v_cmp_eq_u32 vcc, 1, v25
  s_nop 1
  v_cndmask_b32 v80, v68, v69, vcc
  v_cndmask_b32 v82, v76, v77, vcc
  v_lshrrev_b32 v27, 2, v1
  v_lshl_add_u32 v27, v27, 1, v25
  v_lshlrev_b32 v27, 4, v27
  s_lshl_b32 s48, s23, 13
  s_add_u32 s48, s48, 24797184
  s_lshl_b32 s49, s22, 9
  s_add_u32 s49, s49, s48
  v_mov_b32 v81, s62
  v_mov_b32 v83, s62
  s_mov_b32 exec_lo, 0x33333333
  s_mov_b32 exec_hi, 0x33333333
  buffer_store_dwordx4 v[80:83], v27, s[12:15], s49 offen sc0 sc1
  s_mov_b64 exec, -1
  s_setprio 2
  ds_read_b128 v[84:87], v21 offset:16384
  ds_read_b128 v[88:91], v21 offset:18432
  ds_read_b128 v[92:95], v22 offset:16384
  ds_read_b128 v[96:99], v22 offset:18432
  s_waitcnt vmcnt(8)
  s_barrier
  ds_read_b64_tr_b16 v[32:33], v16 offset:16384
  ds_read_b64_tr_b16 v[34:35], v16 offset:17408
  ds_read_b64_tr_b16 v[36:37], v17 offset:16384
  ds_read_b64_tr_b16 v[38:39], v17 offset:17408
  ds_read_b64_tr_b16 v[40:41], v16 offset:16640
  ds_read_b64_tr_b16 v[42:43], v16 offset:17664
  ds_read_b64_tr_b16 v[44:45], v17 offset:16640
  ds_read_b64_tr_b16 v[46:47], v17 offset:17664
  ds_read_b64_tr_b16 v[48:49], v16 offset:16896
  ds_read_b64_tr_b16 v[50:51], v16 offset:17920
  ds_read_b64_tr_b16 v[52:53], v17 offset:16896
  ds_read_b64_tr_b16 v[54:55], v17 offset:17920
  ds_read_b64_tr_b16 v[56:57], v16 offset:17152
  ds_read_b64_tr_b16 v[58:59], v16 offset:18176
  ds_read_b64_tr_b16 v[60:61], v17 offset:17152
  ds_read_b64_tr_b16 v[62:63], v17 offset:18176
  ds_read_b64_tr_b16 v[64:65], v18 offset:43008
  ds_read_b64_tr_b16 v[66:67], v18 offset:43264
  s_waitcnt vmcnt(6)
  s_barrier
  s_waitcnt lgkmcnt(15)
  v_mfma_f32_16x16x32_bf16 v[172:175], v[32:35], v[84:87], 0
  s_mov_b32 m0, s67
  v_mfma_f32_16x16x32_bf16 v[176:179], v[32:35], v[88:91], 0
  ds_read_b64_tr_b16 v[32:33], v16 offset:24576
  ds_read_b64_tr_b16 v[34:35], v16 offset:25600
  s_waitcnt lgkmcnt(14)
  v_mfma_f32_16x16x32_bf16 v[180:183], v[36:39], v[84:87], 0
  buffer_load_dwordx4 v2, s[8:11], s24 offen lds
  v_mfma_f32_16x16x32_bf16 v[184:187], v[36:39], v[88:91], 0
  ds_read_b64_tr_b16 v[36:37], v17 offset:24576
  v_mfma_f32_16x16x32_bf16 v[188:191], v[40:43], v[84:87], 0
  ds_read_b64_tr_b16 v[38:39], v17 offset:25600
  buffer_load_dwordx4 v3, s[8:11], s24 offen offset:1024 lds
  v_mfma_f32_16x16x32_bf16 v[192:195], v[40:43], v[88:91], 0
  ds_read_b64_tr_b16 v[40:41], v16 offset:24832
  s_waitcnt lgkmcnt(13)
  v_mfma_f32_16x16x32_bf16 v[196:199], v[44:47], v[84:87], 0
  ds_read_b64_tr_b16 v[42:43], v16 offset:25856
  s_add_u32 s24, s24, s33
  v_mfma_f32_16x16x32_bf16 v[200:203], v[44:47], v[88:91], 0
  ds_read_b64_tr_b16 v[44:45], v17 offset:24832
  v_mfma_f32_16x16x32_bf16 v[204:207], v[48:51], v[84:87], 0
  ds_read_b64_tr_b16 v[46:47], v17 offset:25856
  s_mov_b32 m0, s63
  v_mfma_f32_16x16x32_bf16 v[208:211], v[48:51], v[88:91], 0
  ds_read_b64_tr_b16 v[48:49], v16 offset:25088
  ds_read_b64_tr_b16 v[50:51], v16 offset:26112
  s_waitcnt lgkmcnt(14)
  v_mfma_f32_16x16x32_bf16 v[212:215], v[52:55], v[84:87], 0
  buffer_load_dwordx4 v5, s[4:7], s25 offen offset:0 lds
  v_mfma_f32_16x16x32_bf16 v[216:219], v[52:55], v[88:91], 0
  ds_read_b64_tr_b16 v[52:53], v17 offset:25088
  v_mfma_f32_16x16x32_bf16 v[220:223], v[56:59], v[84:87], 0
  ds_read_b64_tr_b16 v[54:55], v17 offset:26112
  v_mfma_f32_16x16x32_bf16 v[224:227], v[56:59], v[88:91], 0
  ds_read_b64_tr_b16 v[56:57], v16 offset:25344
  ds_read_b64_tr_b16 v[58:59], v16 offset:26368
  s_waitcnt lgkmcnt(14)
  v_mfma_f32_16x16x32_bf16 v[228:231], v[60:63], v[84:87], 0
  buffer_load_dwordx4 v6, s[4:7], s25 offen offset:1024 lds
  v_mfma_f32_16x16x32_bf16 v[232:235], v[60:63], v[88:91], 0
  ds_read_b64_tr_b16 v[60:61], v17 offset:25344
  ds_read_b64_tr_b16 v[62:63], v17 offset:26368
  v_mfma_f32_16x16x32_bf16 v[236:239], v[64:67], v[84:87], 0
  v_mfma_f32_16x16x32_bf16 v[240:243], v[64:67], v[88:91], 0
  ds_read_b64_tr_b16 v[64:65], v18 offset:44032
  ds_read_b64_tr_b16 v[66:67], v18 offset:44288
  s_waitcnt vmcnt(7)
  s_barrier
  s_waitcnt lgkmcnt(15)
  v_mfma_f32_16x16x32_bf16 v[172:175], v[32:35], v[92:95], v[172:175]
  s_mov_b32 m0, s68
  s_nop 0
  buffer_load_dwordx4 v2, s[8:11], s24 offen lds
  v_mfma_f32_16x16x32_bf16 v[176:179], v[32:35], v[96:99], v[176:179]
  ds_read_b64_tr_b16 v[32:33], v16 offset:32768
  s_waitcnt lgkmcnt(13)
  v_mfma_f32_16x16x32_bf16 v[180:183], v[36:39], v[92:95], v[180:183]
  ds_read_b64_tr_b16 v[34:35], v16 offset:33792
  buffer_load_dwordx4 v3, s[8:11], s24 offen offset:1024 lds
  v_mfma_f32_16x16x32_bf16 v[184:187], v[36:39], v[96:99], v[184:187]
  ds_read_b64_tr_b16 v[36:37], v17 offset:32768
  ds_read_b64_tr_b16 v[38:39], v17 offset:33792
  v_mfma_f32_16x16x32_bf16 v[188:191], v[40:43], v[92:95], v[188:191]
  s_add_u32 s24, s24, s33
  s_cmp_eq_u32 s24, s36
  s_cselect_b32 s24, 0, s24
  v_mfma_f32_16x16x32_bf16 v[192:195], v[40:43], v[96:99], v[192:195]
  ds_read_b64_tr_b16 v[40:41], v16 offset:33024
  s_waitcnt lgkmcnt(13)
  v_mfma_f32_16x16x32_bf16 v[196:199], v[44:47], v[92:95], v[196:199]
  ds_read_b64_tr_b16 v[42:43], v16 offset:34048
  ds_read_b128 v[68:71], v21 offset:0
  v_mfma_f32_16x16x32_bf16 v[200:203], v[44:47], v[96:99], v[200:203]
  ds_read_b64_tr_b16 v[44:45], v17 offset:33024
  ds_read_b64_tr_b16 v[46:47], v17 offset:34048
  v_mfma_f32_16x16x32_bf16 v[204:207], v[48:51], v[92:95], v[204:207]
  ds_read_b128 v[72:75], v21 offset:2048
  ds_read_b128 v[76:79], v22 offset:0
  v_mfma_f32_16x16x32_bf16 v[208:211], v[48:51], v[96:99], v[208:211]
  ds_read_b64_tr_b16 v[48:49], v16 offset:33280
  ds_read_b64_tr_b16 v[50:51], v16 offset:34304
  s_waitcnt lgkmcnt(15)
  v_mfma_f32_16x16x32_bf16 v[212:215], v[52:55], v[92:95], v[212:215]
  ds_read_b128 v[80:83], v22 offset:2048
  s_mov_b32 m0, s63
  v_mfma_f32_16x16x32_bf16 v[216:219], v[52:55], v[96:99], v[216:219]
  ds_read_b64_tr_b16 v[52:53], v17 offset:33280
  ds_read_b64_tr_b16 v[54:55], v17 offset:34304
  v_mfma_f32_16x16x32_bf16 v[220:223], v[56:59], v[92:95], v[220:223]
  buffer_load_dwordx4 v7, s[4:7], s25 offen offset:2048 lds
  v_mfma_f32_16x16x32_bf16 v[224:227], v[56:59], v[96:99], v[224:227]
  ds_read_b64_tr_b16 v[56:57], v16 offset:33536
  ds_read_b64_tr_b16 v[58:59], v16 offset:34560
  s_waitcnt lgkmcnt(15)
  v_mfma_f32_16x16x32_bf16 v[228:231], v[60:63], v[92:95], v[228:231]
  buffer_load_dwordx4 v8, s[4:7], s25 offen offset:3072 lds
  s_addk_i32 s25, 128
  v_mfma_f32_16x16x32_bf16 v[232:235], v[60:63], v[96:99], v[232:235]
  ds_read_b64_tr_b16 v[60:61], v17 offset:33536
  ds_read_b64_tr_b16 v[62:63], v17 offset:34560
  v_mfma_f32_16x16x32_bf16 v[236:239], v[64:67], v[92:95], v[236:239]
  s_cmp_eq_u32 s25, s3
  s_cselect_b32 s25, 0, s25
  v_mfma_f32_16x16x32_bf16 v[240:243], v[64:67], v[96:99], v[240:243]
  ds_read_b64_tr_b16 v[64:65], v18 offset:45056
  ds_read_b64_tr_b16 v[66:67], v18 offset:45312
  s_waitcnt vmcnt(9)
  s_barrier
  s_waitcnt lgkmcnt(8)
  v_mfma_f32_16x16x32_bf16 v[172:175], v[32:35], v[68:71], v[172:175]
  s_mov_b32 m0, s69
  v_mfma_f32_16x16x32_bf16 v[176:179], v[32:35], v[72:75], v[176:179]
  ds_read_b64_tr_b16 v[32:33], v16 offset:0
  ds_read_b64_tr_b16 v[34:35], v16 offset:1024
  v_mfma_f32_16x16x32_bf16 v[180:183], v[36:39], v[68:71], v[180:183]
  buffer_load_dwordx4 v2, s[8:11], s24 offen lds
  v_mfma_f32_16x16x32_bf16 v[184:187], v[36:39], v[72:75], v[184:187]
  ds_read_b64_tr_b16 v[36:37], v17 offset:0
  ds_read_b64_tr_b16 v[38:39], v17 offset:1024
  v_mfma_f32_16x16x32_bf16 v[188:191], v[40:43], v[68:71], v[188:191]
  buffer_load_dwordx4 v3, s[8:11], s24 offen offset:1024 lds
  s_add_u32 s24, s24, s33
  s_mov_b32 m0, s71
  v_mfma_f32_16x16x32_bf16 v[192:195], v[40:43], v[72:75], v[192:195]
  ds_read_b64_tr_b16 v[40:41], v16 offset:256
  v_mfma_f32_16x16x32_bf16 v[196:199], v[44:47], v[68:71], v[196:199]
  ds_read_b64_tr_b16 v[42:43], v16 offset:1280
  v_mfma_f32_16x16x32_bf16 v[200:203], v[44:47], v[72:75], v[200:203]
  ds_read_b64_tr_b16 v[44:45], v17 offset:256
  ds_read_b64_tr_b16 v[46:47], v17 offset:1280
  v_mfma_f32_16x16x32_bf16 v[204:207], v[48:51], v[68:71], v[204:207]
  buffer_load_dwordx4 v4, s[8:11], s28 offen lds
  s_add_u32 s28, s28, 1179648
  v_mfma_f32_16x16x32_bf16 v[208:211], v[48:51], v[72:75], v[208:211]
  ds_read_b64_tr_b16 v[48:49], v16 offset:512
  ds_read_b64_tr_b16 v[50:51], v16 offset:1536
  s_waitcnt lgkmcnt(14)
  v_mfma_f32_16x16x32_bf16 v[212:215], v[52:55], v[68:71], v[212:215]
  s_cmp_ge_u32 s28, s36
  s_cselect_b32 s29, s36, 0
  s_sub_u32 s28, s28, s29
  s_mov_b32 m0, s73
  v_mfma_f32_16x16x32_bf16 v[216:219], v[52:55], v[72:75], v[216:219]
  ds_read_b64_tr_b16 v[52:53], v17 offset:512
  v_mfma_f32_16x16x32_bf16 v[220:223], v[56:59], v[68:71], v[220:223]
  ds_read_b64_tr_b16 v[54:55], v17 offset:1536
  buffer_load_dwordx4 v5, s[4:7], s25 offen offset:0 lds
  v_mfma_f32_16x16x32_bf16 v[224:227], v[56:59], v[72:75], v[224:227]
  ds_read_b64_tr_b16 v[56:57], v16 offset:768
  s_waitcnt lgkmcnt(13)
  v_mfma_f32_16x16x32_bf16 v[228:231], v[60:63], v[68:71], v[228:231]
  ds_read_b64_tr_b16 v[58:59], v16 offset:1792
  v_mfma_f32_16x16x32_bf16 v[232:235], v[60:63], v[72:75], v[232:235]
  ds_read_b64_tr_b16 v[60:61], v17 offset:768
  ds_read_b64_tr_b16 v[62:63], v17 offset:1792
  v_mfma_f32_16x16x32_bf16 v[236:239], v[64:67], v[68:71], v[236:239]
  buffer_load_dwordx4 v6, s[4:7], s25 offen offset:1024 lds
  v_mfma_f32_16x16x32_bf16 v[240:243], v[64:67], v[72:75], v[240:243]
  ds_read_b64_tr_b16 v[64:65], v18 offset:46080
  ds_read_b64_tr_b16 v[66:67], v18 offset:46336
  s_waitcnt vmcnt(11)
  s_barrier
  s_waitcnt lgkmcnt(15)
  v_mfma_f32_16x16x32_bf16 v[172:175], v[32:35], v[76:79], v[172:175]
  s_mov_b32 m0, s70
  s_nop 0
  buffer_load_dwordx4 v2, s[8:11], s24 offen lds
  v_mfma_f32_16x16x32_bf16 v[176:179], v[32:35], v[80:83], v[176:179]
  ds_read_b64_tr_b16 v[32:33], v16 offset:8192
  s_waitcnt lgkmcnt(13)
  v_mfma_f32_16x16x32_bf16 v[180:183], v[36:39], v[76:79], v[180:183]
  ds_read_b64_tr_b16 v[34:35], v16 offset:9216
  buffer_load_dwordx4 v3, s[8:11], s24 offen offset:1024 lds
  v_mfma_f32_16x16x32_bf16 v[184:187], v[36:39], v[80:83], v[184:187]
  ds_read_b64_tr_b16 v[36:37], v17 offset:8192
  ds_read_b64_tr_b16 v[38:39], v17 offset:9216
  v_mfma_f32_16x16x32_bf16 v[188:191], v[40:43], v[76:79], v[188:191]
  s_add_u32 s24, s24, s33
  s_cmp_eq_u32 s24, s36
  s_cselect_b32 s24, 0, s24
  s_waitcnt vmcnt(7)
  v_mfma_f32_16x16x32_bf16 v[192:195], v[40:43], v[80:83], v[192:195]
  ds_read_b64_tr_b16 v[40:41], v16 offset:8448
  s_waitcnt lgkmcnt(13)
  v_mfma_f32_16x16x32_bf16 v[196:199], v[44:47], v[76:79], v[196:199]
  ds_read_b64_tr_b16 v[42:43], v16 offset:9472
  ds_read_b128 v[84:87], v21 offset:16384
  v_mfma_f32_16x16x32_bf16 v[200:203], v[44:47], v[80:83], v[200:203]
  ds_read_b64_tr_b16 v[44:45], v17 offset:8448
  ds_read_b64_tr_b16 v[46:47], v17 offset:9472
  v_mfma_f32_16x16x32_bf16 v[204:207], v[48:51], v[76:79], v[204:207]
  ds_read_b128 v[88:91], v21 offset:18432
  ds_read_b128 v[92:95], v22 offset:16384
  v_mfma_f32_16x16x32_bf16 v[208:211], v[48:51], v[80:83], v[208:211]
  ds_read_b64_tr_b16 v[48:49], v16 offset:8704
  ds_read_b64_tr_b16 v[50:51], v16 offset:9728
  s_waitcnt lgkmcnt(15)
  v_mfma_f32_16x16x32_bf16 v[212:215], v[52:55], v[76:79], v[212:215]
  ds_read_b128 v[96:99], v22 offset:18432
  s_mov_b32 m0, s73
  v_mfma_f32_16x16x32_bf16 v[216:219], v[52:55], v[80:83], v[216:219]
  ds_read_b64_tr_b16 v[52:53], v17 offset:8704
  ds_read_b64_tr_b16 v[54:55], v17 offset:9728
  v_mfma_f32_16x16x32_bf16 v[220:223], v[56:59], v[76:79], v[220:223]
  buffer_load_dwordx4 v7, s[4:7], s25 offen offset:2048 lds
  v_mfma_f32_16x16x32_bf16 v[224:227], v[56:59], v[80:83], v[224:227]
  ds_read_b64_tr_b16 v[56:57], v16 offset:8960
  ds_read_b64_tr_b16 v[58:59], v16 offset:9984
  s_waitcnt lgkmcnt(15)
  v_mfma_f32_16x16x32_bf16 v[228:231], v[60:63], v[76:79], v[228:231]
  buffer_load_dwordx4 v8, s[4:7], s25 offen offset:3072 lds
  s_addk_i32 s25, 128
  v_mfma_f32_16x16x32_bf16 v[232:235], v[60:63], v[80:83], v[232:235]
  ds_read_b64_tr_b16 v[60:61], v17 offset:8960
  ds_read_b64_tr_b16 v[62:63], v17 offset:9984
  v_mfma_f32_16x16x32_bf16 v[236:239], v[64:67], v[76:79], v[236:239]
  s_cmp_eq_u32 s25, s3
  s_cselect_b32 s25, 0, s25
  v_mfma_f32_16x16x32_bf16 v[240:243], v[64:67], v[80:83], v[240:243]
  ds_read_b64_tr_b16 v[64:65], v18 offset:47104
  ds_read_b64_tr_b16 v[66:67], v18 offset:47360
  s_barrier
  s_waitcnt lgkmcnt(8)
  v_mfma_f32_16x16x32_bf16 v[172:175], v[32:35], v[84:87], v[172:175]
  s_mov_b32 m0, s66
  v_mfma_f32_16x16x32_bf16 v[176:179], v[32:35], v[88:91], v[176:179]
  ds_read_b64_tr_b16 v[32:33], v16 offset:16384
  ds_read_b64_tr_b16 v[34:35], v16 offset:17408
  v_mfma_f32_16x16x32_bf16 v[180:183], v[36:39], v[84:87], v[180:183]
  buffer_load_dwordx4 v2, s[8:11], s24 offen lds
  v_mfma_f32_16x16x32_bf16 v[184:187], v[36:39], v[88:91], v[184:187]
  ds_read_b64_tr_b16 v[36:37], v17 offset:16384
  v_mfma_f32_16x16x32_bf16 v[188:191], v[40:43], v[84:87], v[188:191]
  ds_read_b64_tr_b16 v[38:39], v17 offset:17408
  buffer_load_dwordx4 v3, s[8:11], s24 offen offset:1024 lds
  v_mfma_f32_16x16x32_bf16 v[192:195], v[40:43], v[88:91], v[192:195]
  ds_read_b64_tr_b16 v[40:41], v16 offset:16640
  v_mfma_f32_16x16x32_bf16 v[196:199], v[44:47], v[84:87], v[196:199]
  ds_read_b64_tr_b16 v[42:43], v16 offset:17664
  s_add_u32 s24, s24, s33
  v_mfma_f32_16x16x32_bf16 v[200:203], v[44:47], v[88:91], v[200:203]
  ds_read_b64_tr_b16 v[44:45], v17 offset:16640
  v_mfma_f32_16x16x32_bf16 v[204:207], v[48:51], v[84:87], v[204:207]
  ds_read_b64_tr_b16 v[46:47], v17 offset:17664
  s_mov_b32 m0, s63
  v_mfma_f32_16x16x32_bf16 v[208:211], v[48:51], v[88:91], v[208:211]
  ds_read_b64_tr_b16 v[48:49], v16 offset:16896
  ds_read_b64_tr_b16 v[50:51], v16 offset:17920
  s_waitcnt lgkmcnt(14)
  v_mfma_f32_16x16x32_bf16 v[212:215], v[52:55], v[84:87], v[212:215]
  buffer_load_dwordx4 v5, s[4:7], s25 offen offset:0 lds
  v_mfma_f32_16x16x32_bf16 v[216:219], v[52:55], v[88:91], v[216:219]
  ds_read_b64_tr_b16 v[52:53], v17 offset:16896
  v_mfma_f32_16x16x32_bf16 v[220:223], v[56:59], v[84:87], v[220:223]
  ds_read_b64_tr_b16 v[54:55], v17 offset:17920
  v_mfma_f32_16x16x32_bf16 v[224:227], v[56:59], v[88:91], v[224:227]
  ds_read_b64_tr_b16 v[56:57], v16 offset:17152
  ds_read_b64_tr_b16 v[58:59], v16 offset:18176
  s_waitcnt lgkmcnt(14)
  v_mfma_f32_16x16x32_bf16 v[228:231], v[60:63], v[84:87], v[228:231]
  buffer_load_dwordx4 v6, s[4:7], s25 offen offset:1024 lds
  v_mfma_f32_16x16x32_bf16 v[232:235], v[60:63], v[88:91], v[232:235]
  ds_read_b64_tr_b16 v[60:61], v17 offset:17152
  ds_read_b64_tr_b16 v[62:63], v17 offset:18176
  v_mfma_f32_16x16x32_bf16 v[236:239], v[64:67], v[84:87], v[236:239]
  v_mfma_f32_16x16x32_bf16 v[240:243], v[64:67], v[88:91], v[240:243]
  ds_read_b64_tr_b16 v[64:65], v18 offset:48128
  ds_read_b64_tr_b16 v[66:67], v18 offset:48384
  s_waitcnt vmcnt(10)
  s_barrier
  s_waitcnt lgkmcnt(15)
  v_mfma_f32_16x16x32_bf16 v[172:175], v[32:35], v[92:95], v[172:175]
  s_mov_b32 m0, s67
  s_nop 0
  buffer_load_dwordx4 v2, s[8:11], s24 offen lds
  v_mfma_f32_16x16x32_bf16 v[176:179], v[32:35], v[96:99], v[176:179]
  ds_read_b64_tr_b16 v[32:33], v16 offset:24576
  s_waitcnt lgkmcnt(13)
  v_mfma_f32_16x16x32_bf16 v[180:183], v[36:39], v[92:95], v[180:183]
  ds_read_b64_tr_b16 v[34:35], v16 offset:25600
  buffer_load_dwordx4 v3, s[8:11], s24 offen offset:1024 lds
  v_mfma_f32_16x16x32_bf16 v[184:187], v[36:39], v[96:99], v[184:187]
  ds_read_b64_tr_b16 v[36:37], v17 offset:24576
  ds_read_b64_tr_b16 v[38:39], v17 offset:25600
  v_mfma_f32_16x16x32_bf16 v[188:191], v[40:43], v[92:95], v[188:191]
  s_add_u32 s24, s24, s33
  s_cmp_eq_u32 s24, s36
  s_cselect_b32 s24, 0, s24
  s_waitcnt vmcnt(6)
  v_mfma_f32_16x16x32_bf16 v[192:195], v[40:43], v[96:99], v[192:195]
  ds_read_b64_tr_b16 v[40:41], v16 offset:24832
  s_waitcnt lgkmcnt(13)
  v_mfma_f32_16x16x32_bf16 v[196:199], v[44:47], v[92:95], v[196:199]
  ds_read_b64_tr_b16 v[42:43], v16 offset:25856
  ds_read_b128 v[68:71], v21 offset:0
  v_mfma_f32_16x16x32_bf16 v[200:203], v[44:47], v[96:99], v[200:203]
  ds_read_b64_tr_b16 v[44:45], v17 offset:24832
  ds_read_b64_tr_b16 v[46:47], v17 offset:25856
  v_mfma_f32_16x16x32_bf16 v[204:207], v[48:51], v[92:95], v[204:207]
  ds_read_b128 v[72:75], v21 offset:2048
  ds_read_b128 v[76:79], v22 offset:0
  v_mfma_f32_16x16x32_bf16 v[208:211], v[48:51], v[96:99], v[208:211]
  ds_read_b64_tr_b16 v[48:49], v16 offset:25088
  ds_read_b64_tr_b16 v[50:51], v16 offset:26112
  s_waitcnt lgkmcnt(15)
  v_mfma_f32_16x16x32_bf16 v[212:215], v[52:55], v[92:95], v[212:215]
  ds_read_b128 v[80:83], v22 offset:2048
  s_mov_b32 m0, s63
  v_mfma_f32_16x16x32_bf16 v[216:219], v[52:55], v[96:99], v[216:219]
  ds_read_b64_tr_b16 v[52:53], v17 offset:25088
  ds_read_b64_tr_b16 v[54:55], v17 offset:26112
  v_mfma_f32_16x16x32_bf16 v[220:223], v[56:59], v[92:95], v[220:223]
  buffer_load_dwordx4 v7, s[4:7], s25 offen offset:2048 lds
  v_mfma_f32_16x16x32_bf16 v[224:227], v[56:59], v[96:99], v[224:227]
  ds_read_b64_tr_b16 v[56:57], v16 offset:25344
  ds_read_b64_tr_b16 v[58:59], v16 offset:26368
  s_waitcnt lgkmcnt(15)
  v_mfma_f32_16x16x32_bf16 v[228:231], v[60:63], v[92:95], v[228:231]
  buffer_load_dwordx4 v8, s[4:7], s25 offen offset:3072 lds
  s_addk_i32 s25, 128
  v_mfma_f32_16x16x32_bf16 v[232:235], v[60:63], v[96:99], v[232:235]
  ds_read_b64_tr_b16 v[60:61], v17 offset:25344
  ds_read_b64_tr_b16 v[62:63], v17 offset:26368
  v_mfma_f32_16x16x32_bf16 v[236:239], v[64:67], v[92:95], v[236:239]
  s_cmp_eq_u32 s25, s3
  s_cselect_b32 s25, 0, s25
  v_mfma_f32_16x16x32_bf16 v[240:243], v[64:67], v[96:99], v[240:243]
  ds_read_b64_tr_b16 v[64:65], v18 offset:40960
  ds_read_b64_tr_b16 v[66:67], v18 offset:41216
  s_barrier
  s_waitcnt lgkmcnt(8)
  v_mfma_f32_16x16x32_bf16 v[172:175], v[32:35], v[68:71], v[172:175]
  s_mov_b32 m0, s68
  v_mfma_f32_16x16x32_bf16 v[176:179], v[32:35], v[72:75], v[176:179]
  ds_read_b64_tr_b16 v[32:33], v16 offset:32768
  ds_read_b64_tr_b16 v[34:35], v16 offset:33792
  v_mfma_f32_16x16x32_bf16 v[180:183], v[36:39], v[68:71], v[180:183]
  buffer_load_dwordx4 v2, s[8:11], s24 offen lds
  v_mfma_f32_16x16x32_bf16 v[184:187], v[36:39], v[72:75], v[184:187]
  ds_read_b64_tr_b16 v[36:37], v17 offset:32768
  ds_read_b64_tr_b16 v[38:39], v17 offset:33792
  v_mfma_f32_16x16x32_bf16 v[188:191], v[40:43], v[68:71], v[188:191]
  buffer_load_dwordx4 v3, s[8:11], s24 offen offset:1024 lds
  s_add_u32 s24, s24, s33
  s_mov_b32 m0, s72
  v_mfma_f32_16x16x32_bf16 v[192:195], v[40:43], v[72:75], v[192:195]
  ds_read_b64_tr_b16 v[40:41], v16 offset:33024
  v_mfma_f32_16x16x32_bf16 v[196:199], v[44:47], v[68:71], v[196:199]
  ds_read_b64_tr_b16 v[42:43], v16 offset:34048
  v_mfma_f32_16x16x32_bf16 v[200:203], v[44:47], v[72:75], v[200:203]
  ds_read_b64_tr_b16 v[44:45], v17 offset:33024
  ds_read_b64_tr_b16 v[46:47], v17 offset:34048
  v_mfma_f32_16x16x32_bf16 v[204:207], v[48:51], v[68:71], v[204:207]
  buffer_load_dwordx4 v4, s[8:11], s28 offen lds
  s_add_u32 s28, s28, 1179648
  v_mfma_f32_16x16x32_bf16 v[208:211], v[48:51], v[72:75], v[208:211]
  ds_read_b64_tr_b16 v[48:49], v16 offset:33280
  ds_read_b64_tr_b16 v[50:51], v16 offset:34304
  s_waitcnt lgkmcnt(14)
  v_mfma_f32_16x16x32_bf16 v[212:215], v[52:55], v[68:71], v[212:215]
  s_cmp_ge_u32 s28, s36
  s_cselect_b32 s29, s36, 0
  s_sub_u32 s28, s28, s29
  s_mov_b32 m0, s73
  v_mfma_f32_16x16x32_bf16 v[216:219], v[52:55], v[72:75], v[216:219]
  ds_read_b64_tr_b16 v[52:53], v17 offset:33280
  v_mfma_f32_16x16x32_bf16 v[220:223], v[56:59], v[68:71], v[220:223]
  ds_read_b64_tr_b16 v[54:55], v17 offset:34304
  buffer_load_dwordx4 v5, s[4:7], s25 offen offset:0 lds
  v_mfma_f32_16x16x32_bf16 v[224:227], v[56:59], v[72:75], v[224:227]
  ds_read_b64_tr_b16 v[56:57], v16 offset:33536
  s_waitcnt lgkmcnt(13)
  v_mfma_f32_16x16x32_bf16 v[228:231], v[60:63], v[68:71], v[228:231]
  ds_read_b64_tr_b16 v[58:59], v16 offset:34560
  v_mfma_f32_16x16x32_bf16 v[232:235], v[60:63], v[72:75], v[232:235]
  ds_read_b64_tr_b16 v[60:61], v17 offset:33536
  ds_read_b64_tr_b16 v[62:63], v17 offset:34560
  v_mfma_f32_16x16x32_bf16 v[236:239], v[64:67], v[68:71], v[236:239]
  buffer_load_dwordx4 v6, s[4:7], s25 offen offset:1024 lds
  v_mfma_f32_16x16x32_bf16 v[240:243], v[64:67], v[72:75], v[240:243]
  ds_read_b64_tr_b16 v[64:65], v18 offset:41984
  ds_read_b64_tr_b16 v[66:67], v18 offset:42240
  s_barrier
  s_waitcnt lgkmcnt(15)
  v_mfma_f32_16x16x32_bf16 v[172:175], v[32:35], v[76:79], v[172:175]
  s_mov_b32 m0, s69
  v_mfma_f32_16x16x32_bf16 v[176:179], v[32:35], v[80:83], v[176:179]
  s_waitcnt lgkmcnt(12)
  v_mfma_f32_16x16x32_bf16 v[180:183], v[36:39], v[76:79], v[180:183]
  buffer_load_dwordx4 v2, s[8:11], s24 offen lds
  v_mfma_f32_16x16x32_bf16 v[184:187], v[36:39], v[80:83], v[184:187]
  buffer_load_dwordx4 v3, s[8:11], s24 offen offset:1024 lds
  v_mfma_f32_16x16x32_bf16 v[188:191], v[40:43], v[76:79], v[188:191]
  s_add_u32 s24, s24, s33
  s_cmp_eq_u32 s24, s36
  s_cselect_b32 s24, 0, s24
  v_mfma_f32_16x16x32_bf16 v[192:195], v[40:43], v[80:83], v[192:195]
  s_mov_b32 m0, s73
  s_waitcnt lgkmcnt(8)
  v_mfma_f32_16x16x32_bf16 v[196:199], v[44:47], v[76:79], v[196:199]
  buffer_load_dwordx4 v7, s[4:7], s25 offen offset:2048 lds
  v_mfma_f32_16x16x32_bf16 v[200:203], v[44:47], v[80:83], v[200:203]
  buffer_load_dwordx4 v8, s[4:7], s25 offen offset:3072 lds
  v_mfma_f32_16x16x32_bf16 v[204:207], v[48:51], v[76:79], v[204:207]
  s_addk_i32 s25, 128
  s_cmp_eq_u32 s25, s3
  s_cselect_b32 s25, 0, s25
  v_mfma_f32_16x16x32_bf16 v[208:211], v[48:51], v[80:83], v[208:211]
  s_waitcnt lgkmcnt(4)
  v_mfma_f32_16x16x32_bf16 v[212:215], v[52:55], v[76:79], v[212:215]
  v_mfma_f32_16x16x32_bf16 v[216:219], v[52:55], v[80:83], v[216:219]
  v_mfma_f32_16x16x32_bf16 v[220:223], v[56:59], v[76:79], v[220:223]
  v_mfma_f32_16x16x32_bf16 v[224:227], v[56:59], v[80:83], v[224:227]
  s_waitcnt lgkmcnt(0)
  v_mfma_f32_16x16x32_bf16 v[228:231], v[60:63], v[76:79], v[228:231]
  v_mfma_f32_16x16x32_bf16 v[232:235], v[60:63], v[80:83], v[232:235]
  v_mfma_f32_16x16x32_bf16 v[236:239], v[64:67], v[76:79], v[236:239]
  v_mfma_f32_16x16x32_bf16 v[240:243], v[64:67], v[80:83], v[240:243]
  s_setprio 2
  s_add_u32 s49, s48, 4096
  s_mov_b32 s51, 300000
POLL_12:
  buffer_load_dwordx4 v[32:35], v19, s[12:15], s48 offen offset:0 sc0 sc1
  buffer_load_dwordx4 v[36:39], v19, s[12:15], s48 offen offset:1024 sc0 sc1
  buffer_load_dwordx4 v[40:43], v19, s[12:15], s48 offen offset:2048 sc0 sc1
  buffer_load_dwordx4 v[44:47], v19, s[12:15], s48 offen offset:3072 sc0 sc1
  buffer_load_dwordx4 v[48:51], v19, s[12:15], s49 offen offset:0 sc0 sc1
  buffer_load_dwordx4 v[52:55], v19, s[12:15], s49 offen offset:1024 sc0 sc1
  buffer_load_dwordx4 v[56:59], v19, s[12:15], s49 offen offset:2048 sc0 sc1
  buffer_load_dwordx4 v[60:63], v19, s[12:15], s49 offen offset:3072 sc0 sc1
  s_waitcnt vmcnt(0)
POLLC_13:
  v_max3_u32 v27, v33, v35, s62
  v_min3_u32 v28, v33, v35, s62
  v_max3_u32 v27, v37, v39, v27
  v_min3_u32 v28, v37, v39, v28
  v_max3_u32 v27, v41, v43, v27
  v_min3_u32 v28, v41, v43, v28
  v_max3_u32 v27, v45, v47, v27
  v_min3_u32 v28, v45, v47, v28
  v_max3_u32 v27, v49, v51, v27
  v_min3_u32 v28, v49, v51, v28
  v_max3_u32 v27, v53, v55, v27
  v_min3_u32 v28, v53, v55, v28
  v_max3_u32 v27, v57, v59, v27
  v_min3_u32 v28, v57, v59, v28
  v_max3_u32 v27, v61, v63, v27
  v_min3_u32 v28, v61, v63, v28
  v_xor_b32 v27, v27, v28
  v_cmp_ne_u32 vcc, 0, v27
  s_nop 4
  s_cbranch_vccz POLLOK_14
  s_sleep 1
  s_sub_u32 s51, s51, 1
  s_cmp_lg_u32 s51, 0
  s_cbranch_scc1 POLL_12
POLLOK_14:
  v_add_f32 v32, v32, v36
  v_add_f32 v40, v40, v44
  v_add_f32 v48, v48, v52
  v_add_f32 v56, v56, v60
  v_add_f32 v34, v34, v38
  v_add_f32 v42, v42, v46
  v_add_f32 v50, v50, v54
  v_add_f32 v58, v58, v62
  v_add_f32 v32, v32, v40
  v_add_f32 v48, v48, v56
  v_add_f32 v34, v34, v42
  v_add_f32 v50, v50, v58
  v_add_f32 v32, v32, v48
  v_add_f32 v33, v34, v50
  v_mov_b32 v34, v32
  v_mov_b32 v35, v33
  s_nop 0
  v_permlane32_swap_b32 v32, v34
  v_permlane32_swap_b32 v33, v35
  v_pk_add_f32 v[32:33], v[32:33], v[34:35]
  v_mul_f32 v32, 0x39e38e39, v32
  v_mul_f32 v33, 0x39e38e39, v33
  v_fma_f32 v33, -v32, v32, v33
  v_max_f32 v33, 0, v33
  v_add_f32 v33, 0x3727c5ac, v33
  v_rsq_f32 v33, v33
  s_nop 0
  v_mul_f32 v32, v32, v33
  v_sub_f32 v32, 0, v32
  v_lshrrev_b32 v28, 4, v1
  v_lshlrev_b32 v28, 5, v28
  ds_bpermute_b32 v68, v28, v33 offset:0
  ds_bpermute_b32 v76, v28, v32 offset:0
  ds_bpermute_b32 v69, v28, v33 offset:4
  ds_bpermute_b32 v77, v28, v32 offset:4
  ds_bpermute_b32 v70, v28, v33 offset:8
  ds_bpermute_b32 v78, v28, v32 offset:8
  ds_bpermute_b32 v71, v28, v33 offset:12
  ds_bpermute_b32 v79, v28, v32 offset:12
  ds_bpermute_b32 v72, v28, v33 offset:16
  ds_bpermute_b32 v80, v28, v32 offset:16
  ds_bpermute_b32 v73, v28, v33 offset:20
  ds_bpermute_b32 v81, v28, v32 offset:20
  ds_bpermute_b32 v74, v28, v33 offset:24
  ds_bpermute_b32 v82, v28, v32 offset:24
  ds_bpermute_b32 v75, v28, v33 offset:28
  ds_bpermute_b32 v83, v28, v32 offset:28
  s_mul_i32 s44, s23, 147456
  s_add_u32 s44, s44, 65536
  s_lshl_b32 s45, s22, 13
  s_add_u32 s45, s45, s44
  s_add_u32 s47, s45, 4096
  s_lshl_b32 s46, s22, 10
  s_add_u32 s46, s46, s44
  s_add_u32 s46, s46, 131072
  s_waitcnt lgkmcnt(0)
  v_pk_fma_f32 v[100:101], v[100:101], v[68:69], v[76:77]
  v_pk_fma_f32 v[102:103], v[102:103], v[70:71], v[78:79]
  v_pk_fma_f32 v[104:105], v[104:105], v[72:73], v[80:81]
  v_pk_fma_f32 v[106:107], v[106:107], v[74:75], v[82:83]
  v_cvt_pk_bf16_f32 v100, v100, v101
  v_cvt_pk_bf16_f32 v101, v102, v103
  v_cvt_pk_bf16_f32 v102, v104, v105
  v_cvt_pk_bf16_f32 v103, v106, v107
  buffer_store_dwordx4 v[100:103], v19, s[12:15], s45 offen offset:0 sc0 sc1
  v_pk_fma_f32 v[108:109], v[108:109], v[68:69], v[76:77]
  v_pk_fma_f32 v[110:111], v[110:111], v[70:71], v[78:79]
  v_pk_fma_f32 v[112:113], v[112:113], v[72:73], v[80:81]
  v_pk_fma_f32 v[114:115], v[114:115], v[74:75], v[82:83]
  v_cvt_pk_bf16_f32 v104, v108, v109
  v_cvt_pk_bf16_f32 v105, v110, v111
  v_cvt_pk_bf16_f32 v106, v112, v113
  v_cvt_pk_bf16_f32 v107, v114, v115
  buffer_store_dwordx4 v[104:107], v19, s[12:15], s45 offen offset:1024 sc0 sc1
  v_pk_fma_f32 v[116:117], v[116:117], v[68:69], v[76:77]
  v_pk_fma_f32 v[118:119], v[118:119], v[70:71], v[78:79]
  v_pk_fma_f32 v[120:121], v[120:121], v[72:73], v[80:81]
  v_pk_fma_f32 v[122:123], v[122:123], v[74:75], v[82:83]
  v_cvt_pk_bf16_f32 v108, v116, v117
  v_cvt_pk_bf16_f32 v109, v118, v119
  v_cvt_pk_bf16_f32 v110, v120, v121
  v_cvt_pk_bf16_f32 v111, v122, v123
  buffer_store_dwordx4 v[108:111], v19, s[12:15], s45 offen offset:2048 sc0 sc1
  v_pk_fma_f32 v[124:125], v[124:125], v[68:69], v[76:77]
  v_pk_fma_f32 v[126:127], v[126:127], v[70:71], v[78:79]
  v_pk_fma_f32 v[128:129], v[128:129], v[72:73], v[80:81]
  v_pk_fma_f32 v[130:131], v[130:131], v[74:75], v[82:83]
  v_cvt_pk_bf16_f32 v112, v124, v125
  v_cvt_pk_bf16_f32 v113, v126, v127
  v_cvt_pk_bf16_f32 v114, v128, v129
  v_cvt_pk_bf16_f32 v115, v130, v131
  buffer_store_dwordx4 v[112:115], v19, s[12:15], s45 offen offset:3072 sc0 sc1
  v_pk_fma_f32 v[132:133], v[132:133], v[68:69], v[76:77]
  v_pk_fma_f32 v[134:135], v[134:135], v[70:71], v[78:79]
  v_pk_fma_f32 v[136:137], v[136:137], v[72:73], v[80:81]
  v_pk_fma_f32 v[138:139], v[138:139], v[74:75], v[82:83]
  v_cvt_pk_bf16_f32 v116, v132, v133
  v_cvt_pk_bf16_f32 v117, v134, v135
  v_cvt_pk_bf16_f32 v118, v136, v137
  v_cvt_pk_bf16_f32 v119, v138, v139
  buffer_store_dwordx4 v[116:119], v19, s[12:15], s47 offen offset:0 sc0 sc1
  v_pk_fma_f32 v[140:141], v[140:141], v[68:69], v[76:77]
  v_pk_fma_f32 v[142:143], v[142:143], v[70:71], v[78:79]
  v_pk_fma_f32 v[144:145], v[144:145], v[72:73], v[80:81]
  v_pk_fma_f32 v[146:147], v[146:147], v[74:75], v[82:83]
  v_cvt_pk_bf16_f32 v120, v140, v141
  v_cvt_pk_bf16_f32 v121, v142, v143
  v_cvt_pk_bf16_f32 v122, v144, v145
  v_cvt_pk_bf16_f32 v123, v146, v147
  buffer_store_dwordx4 v[120:123], v19, s[12:15], s47 offen offset:1024 sc0 sc1
  v_pk_fma_f32 v[148:149], v[148:149], v[68:69], v[76:77]
  v_pk_fma_f32 v[150:151], v[150:151], v[70:71], v[78:79]
  v_pk_fma_f32 v[152:153], v[152:153], v[72:73], v[80:81]
  v_pk_fma_f32 v[154:155], v[154:155], v[74:75], v[82:83]
  v_cvt_pk_bf16_f32 v124, v148, v149
  v_cvt_pk_bf16_f32 v125, v150, v151
  v_cvt_pk_bf16_f32 v126, v152, v153
  v_cvt_pk_bf16_f32 v127, v154, v155
  buffer_store_dwordx4 v[124:127], v19, s[12:15], s47 offen offset:2048 sc0 sc1
  v_pk_fma_f32 v[156:157], v[156:157], v[68:69], v[76:77]
  v_pk_fma_f32 v[158:159], v[158:159], v[70:71], v[78:79]
  v_pk_fma_f32 v[160:161], v[160:161], v[72:73], v[80:81]
  v_pk_fma_f32 v[162:163], v[162:163], v[74:75], v[82:83]
  v_cvt_pk_bf16_f32 v128, v156, v157
  v_cvt_pk_bf16_f32 v129, v158, v159
  v_cvt_pk_bf16_f32 v130, v160, v161
  v_cvt_pk_bf16_f32 v131, v162, v163
  buffer_store_dwordx4 v[128:131], v19, s[12:15], s47 offen offset:3072 sc0 sc1
  v_pk_fma_f32 v[164:165], v[164:165], v[68:69], v[76:77]
  v_pk_fma_f32 v[166:167], v[166:167], v[70:71], v[78:79]
  v_pk_fma_f32 v[168:169], v[168:169], v[72:73], v[80:81]
  v_pk_fma_f32 v[170:171], v[170:171], v[74:75], v[82:83]
  v_cvt_pk_bf16_f32 v132, v164, v165
  v_cvt_pk_bf16_f32 v133, v166, v167
  v_cvt_pk_bf16_f32 v134, v168, v169
  v_cvt_pk_bf16_f32 v135, v170, v171
  buffer_store_dwordx4 v[132:135], v19, s[12:15], s46 offen offset:0 sc0 sc1
  s_lshl_b32 s49, s22, 9
  s_add_u32 s49, s49, 25325568
  s_lshl_b32 s48, s32, 7
  s_add_u32 s48, s48, s49
  s_and_b32 s50, s23, 15
  s_lshl_b32 s50, s50, 2
  s_add_u32 s48, s48, s50
  s_and_b32 s50, s32, 2
  s_lshl_b32 s50, s50, 7
  s_add_u32 s50, s50, s49
  v_and_b32 v29, 15, v1
  v_lshlrev_b32 v29, 2, v29
  v_lshrrev_b32 v23, 4, v1
  v_lshl_add_u32 v23, v23, 7, v29
  v_and_b32 v29, 0xff, v23
  s_setprio 2
  ds_read_b128 v[84:87], v21 offset:16384
  ds_read_b128 v[88:91], v21 offset:18432
  ds_read_b128 v[92:95], v22 offset:16384
  ds_read_b128 v[96:99], v22 offset:18432
  s_barrier
  ds_read_b64_tr_b16 v[32:33], v16 offset:0
  ds_read_b64_tr_b16 v[34:35], v16 offset:1024
  ds_read_b64_tr_b16 v[36:37], v17 offset:0
  ds_read_b64_tr_b16 v[38:39], v17 offset:1024
  ds_read_b64_tr_b16 v[40:41], v16 offset:256
  ds_read_b64_tr_b16 v[42:43], v16 offset:1280
  ds_read_b64_tr_b16 v[44:45], v17 offset:256
  ds_read_b64_tr_b16 v[46:47], v17 offset:1280
  ds_read_b64_tr_b16 v[48:49], v16 offset:512
  ds_read_b64_tr_b16 v[50:51], v16 offset:1536
  ds_read_b64_tr_b16 v[52:53], v17 offset:512
  ds_read_b64_tr_b16 v[54:55], v17 offset:1536
  ds_read_b64_tr_b16 v[56:57], v16 offset:768
  ds_read_b64_tr_b16 v[58:59], v16 offset:1792
  ds_read_b64_tr_b16 v[60:61], v17 offset:768
  ds_read_b64_tr_b16 v[62:63], v17 offset:1792
  ds_read_b64_tr_b16 v[64:65], v18 offset:43008
  ds_read_b64_tr_b16 v[66:67], v18 offset:43264
  s_barrier
  s_waitcnt lgkmcnt(15)
  v_mfma_f32_16x16x32_bf16 v[172:175], v[32:35], v[84:87], v[172:175]
  s_mov_b32 m0, s70
  v_mfma_f32_16x16x32_bf16 v[176:179], v[32:35], v[88:91], v[176:179]
  ds_read_b64_tr_b16 v[32:33], v16 offset:8192
  ds_read_b64_tr_b16 v[34:35], v16 offset:9216
  s_waitcnt lgkmcnt(14)
  v_mfma_f32_16x16x32_bf16 v[180:183], v[36:39], v[84:87], v[180:183]
  buffer_load_dwordx4 v2, s[8:11], s24 offen lds
  v_mfma_f32_16x16x32_bf16 v[184:187], v[36:39], v[88:91], v[184:187]
  ds_read_b64_tr_b16 v[36:37], v17 offset:8192
  v_mfma_f32_16x16x32_bf16 v[188:191], v[40:43], v[84:87], v[188:191]
  ds_read_b64_tr_b16 v[38:39], v17 offset:9216
  buffer_load_dwordx4 v3, s[8:11], s24 offen offset:1024 lds
  v_mfma_f32_16x16x32_bf16 v[192:195], v[40:43], v[88:91], v[192:195]
  ds_read_b64_tr_b16 v[40:41], v16 offset:8448
  s_waitcnt lgkmcnt(13)
  v_mfma_f32_16x16x32_bf16 v[196:199], v[44:47], v[84:87], v[196:199]
  ds_read_b64_tr_b16 v[42:43], v16 offset:9472
  s_add_u32 s24, s24, s33
  v_mfma_f32_16x16x32_bf16 v[200:203], v[44:47], v[88:91], v[200:203]
  ds_read_b64_tr_b16 v[44:45], v17 offset:8448
  v_mfma_f32_16x16x32_bf16 v[204:207], v[48:51], v[84:87], v[204:207]
  ds_read_b64_tr_b16 v[46:47], v17 offset:9472
  s_mov_b32 m0, s63
  v_mfma_f32_16x16x32_bf16 v[208:211], v[48:51], v[88:91], v[208:211]
  ds_read_b64_tr_b16 v[48:49], v16 offset:8704
  ds_read_b64_tr_b16 v[50:51], v16 offset:9728
  s_waitcnt lgkmcnt(14)
  v_mfma_f32_16x16x32_bf16 v[212:215], v[52:55], v[84:87], v[212:215]
  buffer_load_dwordx4 v5, s[4:7], s25 offen offset:0 lds
  v_mfma_f32_16x16x32_bf16 v[216:219], v[52:55], v[88:91], v[216:219]
  ds_read_b64_tr_b16 v[52:53], v17 offset:8704
  v_mfma_f32_16x16x32_bf16 v[220:223], v[56:59], v[84:87], v[220:223]
  ds_read_b64_tr_b16 v[54:55], v17 offset:9728
  v_mfma_f32_16x16x32_bf16 v[224:227], v[56:59], v[88:91], v[224:227]
  ds_read_b64_tr_b16 v[56:57], v16 offset:8960
  ds_read_b64_tr_b16 v[58:59], v16 offset:9984
  s_waitcnt lgkmcnt(14)
  v_mfma_f32_16x16x32_bf16 v[228:231], v[60:63], v[84:87], v[228:231]
  buffer_load_dwordx4 v6, s[4:7], s25 offen offset:1024 lds
  v_mfma_f32_16x16x32_bf16 v[232:235], v[60:63], v[88:91], v[232:235]
  ds_read_b64_tr_b16 v[60:61], v17 offset:8960
  ds_read_b64_tr_b16 v[62:63], v17 offset:9984
  v_mfma_f32_16x16x32_bf16 v[236:239], v[64:67], v[84:87], v[236:239]
  v_mfma_f32_16x16x32_bf16 v[240:243], v[64:67], v[88:91], v[240:243]
  ds_read_b64_tr_b16 v[64:65], v18 offset:44032
  ds_read_b64_tr_b16 v[66:67], v18 offset:44288
  s_barrier
  s_waitcnt lgkmcnt(15)
  v_mfma_f32_16x16x32_bf16 v[172:175], v[32:35], v[92:95], v[172:175]
  s_mov_b32 m0, s66
  s_nop 0
  buffer_load_dwordx4 v2, s[8:11], s24 offen lds
  v_mfma_f32_16x16x32_bf16 v[176:179], v[32:35], v[96:99], v[176:179]
  ds_read_b64_tr_b16 v[32:33], v16 offset:16384
  s_waitcnt lgkmcnt(13)
  v_mfma_f32_16x16x32_bf16 v[180:183], v[36:39], v[92:95], v[180:183]
  ds_read_b64_tr_b16 v[34:35], v16 offset:17408
  buffer_load_dwordx4 v3, s[8:11], s24 offen offset:1024 lds
  v_mfma_f32_16x16x32_bf16 v[184:187], v[36:39], v[96:99], v[184:187]
  ds_read_b64_tr_b16 v[36:37], v17 offset:16384
  ds_read_b64_tr_b16 v[38:39], v17 offset:17408
  v_mfma_f32_16x16x32_bf16 v[188:191], v[40:43], v[92:95], v[188:191]
  s_add_u32 s24, s24, s33
  s_cmp_eq_u32 s24, s36
  s_cselect_b32 s24, 0, s24
  v_mfma_f32_16x16x32_bf16 v[192:195], v[40:43], v[96:99], v[192:195]
  ds_read_b64_tr_b16 v[40:41], v16 offset:16640
  s_waitcnt lgkmcnt(13)
  v_mfma_f32_16x16x32_bf16 v[196:199], v[44:47], v[92:95], v[196:199]
  ds_read_b64_tr_b16 v[42:43], v16 offset:17664
  ds_read_b128 v[68:71], v21 offset:0
  v_mfma_f32_16x16x32_bf16 v[200:203], v[44:47], v[96:99], v[200:203]
  ds_read_b64_tr_b16 v[44:45], v17 offset:16640
  ds_read_b64_tr_b16 v[46:47], v17 offset:17664
  v_mfma_f32_16x16x32_bf16 v[204:207], v[48:51], v[92:95], v[204:207]
  ds_read_b128 v[72:75], v21 offset:2048
  ds_read_b128 v[76:79], v22 offset:0
  v_mfma_f32_16x16x32_bf16 v[208:211], v[48:51], v[96:99], v[208:211]
  ds_read_b64_tr_b16 v[48:49], v16 offset:16896
  ds_read_b64_tr_b16 v[50:51], v16 offset:17920
  s_waitcnt lgkmcnt(15)
  v_mfma_f32_16x16x32_bf16 v[212:215], v[52:55], v[92:95], v[212:215]
  ds_read_b128 v[80:83], v22 offset:2048
  s_mov_b32 m0, s63
  v_mfma_f32_16x16x32_bf16 v[216:219], v[52:55], v[96:99], v[216:219]
  ds_read_b64_tr_b16 v[52:53], v17 offset:16896
  ds_read_b64_tr_b16 v[54:55], v17 offset:17920
  v_mfma_f32_16x16x32_bf16 v[220:223], v[56:59], v[92:95], v[220:223]
  buffer_load_dwordx4 v7, s[4:7], s25 offen offset:2048 lds
  v_mfma_f32_16x16x32_bf16 v[224:227], v[56:59], v[96:99], v[224:227]
  ds_read_b64_tr_b16 v[56:57], v16 offset:17152
  ds_read_b64_tr_b16 v[58:59], v16 offset:18176
  s_waitcnt lgkmcnt(15)
  v_mfma_f32_16x16x32_bf16 v[228:231], v[60:63], v[92:95], v[228:231]
  buffer_load_dwordx4 v8, s[4:7], s25 offen offset:3072 lds
  s_addk_i32 s25, 128
  v_mfma_f32_16x16x32_bf16 v[232:235], v[60:63], v[96:99], v[232:235]
  ds_read_b64_tr_b16 v[60:61], v17 offset:17152
  ds_read_b64_tr_b16 v[62:63], v17 offset:18176
  v_mfma_f32_16x16x32_bf16 v[236:239], v[64:67], v[92:95], v[236:239]
  s_cmp_eq_u32 s25, s3
  s_cselect_b32 s25, 0, s25
  v_mfma_f32_16x16x32_bf16 v[240:243], v[64:67], v[96:99], v[240:243]
  ds_read_b64_tr_b16 v[64:65], v18 offset:45056
  ds_read_b64_tr_b16 v[66:67], v18 offset:45312
  s_barrier
  s_waitcnt lgkmcnt(8)
  v_mfma_f32_16x16x32_bf16 v[172:175], v[32:35], v[68:71], v[172:175]
  s_mov_b32 m0, s67
  v_mfma_f32_16x16x32_bf16 v[176:179], v[32:35], v[72:75], v[176:179]
  ds_read_b64_tr_b16 v[32:33], v16 offset:24576
  ds_read_b64_tr_b16 v[34:35], v16 offset:25600
  v_mfma_f32_16x16x32_bf16 v[180:183], v[36:39], v[68:71], v[180:183]
  buffer_load_dwordx4 v2, s[8:11], s24 offen lds
  v_mfma_f32_16x16x32_bf16 v[184:187], v[36:39], v[72:75], v[184:187]
  ds_read_b64_tr_b16 v[36:37], v17 offset:24576
  ds_read_b64_tr_b16 v[38:39], v17 offset:25600
  v_mfma_f32_16x16x32_bf16 v[188:191], v[40:43], v[68:71], v[188:191]
  buffer_load_dwordx4 v3, s[8:11], s24 offen offset:1024 lds
  s_add_u32 s24, s24, s33
  s_mov_b32 m0, s71
  v_mfma_f32_16x16x32_bf16 v[192:195], v[40:43], v[72:75], v[192:195]
  ds_read_b64_tr_b16 v[40:41], v16 offset:24832
  v_mfma_f32_16x16x32_bf16 v[196:199], v[44:47], v[68:71], v[196:199]
  ds_read_b64_tr_b16 v[42:43], v16 offset:25856
  v_mfma_f32_16x16x32_bf16 v[200:203], v[44:47], v[72:75], v[200:203]
  ds_read_b64_tr_b16 v[44:45], v17 offset:24832
  ds_read_b64_tr_b16 v[46:47], v17 offset:25856
  v_mfma_f32_16x16x32_bf16 v[204:207], v[48:51], v[68:71], v[204:207]
  buffer_load_dwordx4 v4, s[8:11], s28 offen lds
  s_add_u32 s28, s28, 1179648
  v_mfma_f32_16x16x32_bf16 v[208:211], v[48:51], v[72:75], v[208:211]
  ds_read_b64_tr_b16 v[48:49], v16 offset:25088
  ds_read_b64_tr_b16 v[50:51], v16 offset:26112
  s_waitcnt lgkmcnt(14)
  v_mfma_f32_16x16x32_bf16 v[212:215], v[52:55], v[68:71], v[212:215]
  s_cmp_ge_u32 s28, s36
  s_cselect_b32 s29, s36, 0
  s_sub_u32 s28, s28, s29
  s_mov_b32 m0, s73
  v_mfma_f32_16x16x32_bf16 v[216:219], v[52:55], v[72:75], v[216:219]
  ds_read_b64_tr_b16 v[52:53], v17 offset:25088
  v_mfma_f32_16x16x32_bf16 v[220:223], v[56:59], v[68:71], v[220:223]
  ds_read_b64_tr_b16 v[54:55], v17 offset:26112
  buffer_load_dwordx4 v5, s[4:7], s25 offen offset:0 lds
  v_mfma_f32_16x16x32_bf16 v[224:227], v[56:59], v[72:75], v[224:227]
  ds_read_b64_tr_b16 v[56:57], v16 offset:25344
  s_waitcnt lgkmcnt(13)
  v_mfma_f32_16x16x32_bf16 v[228:231], v[60:63], v[68:71], v[228:231]
  ds_read_b64_tr_b16 v[58:59], v16 offset:26368
  v_mfma_f32_16x16x32_bf16 v[232:235], v[60:63], v[72:75], v[232:235]
  ds_read_b64_tr_b16 v[60:61], v17 offset:25344
  ds_read_b64_tr_b16 v[62:63], v17 offset:26368
  v_mfma_f32_16x16x32_bf16 v[236:239], v[64:67], v[68:71], v[236:239]
  buffer_load_dwordx4 v6, s[4:7], s25 offen offset:1024 lds
  v_mfma_f32_16x16x32_bf16 v[240:243], v[64:67], v[72:75], v[240:243]
  ds_read_b64_tr_b16 v[64:65], v18 offset:46080
  ds_read_b64_tr_b16 v[66:67], v18 offset:46336
  s_waitcnt vmcnt(11)
  s_barrier
  s_waitcnt lgkmcnt(15)
  v_mfma_f32_16x16x32_bf16 v[172:175], v[32:35], v[76:79], v[172:175]
  s_mov_b32 m0, s68
  s_nop 0
  buffer_load_dwordx4 v2, s[8:11], s24 offen lds
  v_mfma_f32_16x16x32_bf16 v[176:179], v[32:35], v[80:83], v[176:179]
  ds_read_b64_tr_b16 v[32:33], v16 offset:32768
  s_waitcnt lgkmcnt(13)
  v_mfma_f32_16x16x32_bf16 v[180:183], v[36:39], v[76:79], v[180:183]
  ds_read_b64_tr_b16 v[34:35], v16 offset:33792
  buffer_load_dwordx4 v3, s[8:11], s24 offen offset:1024 lds
  v_mfma_f32_16x16x32_bf16 v[184:187], v[36:39], v[80:83], v[184:187]
  ds_read_b64_tr_b16 v[36:37], v17 offset:32768
  ds_read_b64_tr_b16 v[38:39], v17 offset:33792
  v_mfma_f32_16x16x32_bf16 v[188:191], v[40:43], v[76:79], v[188:191]
  s_add_u32 s24, s24, s33
  s_cmp_eq_u32 s24, s36
  s_cselect_b32 s24, 0, s24
  s_waitcnt vmcnt(7)
  v_mfma_f32_16x16x32_bf16 v[192:195], v[40:43], v[80:83], v[192:195]
  ds_read_b64_tr_b16 v[40:41], v16 offset:33024
  s_waitcnt lgkmcnt(13)
  v_mfma_f32_16x16x32_bf16 v[196:199], v[44:47], v[76:79], v[196:199]
  ds_read_b64_tr_b16 v[42:43], v16 offset:34048
  ds_read_b128 v[84:87], v21 offset:16384
  v_mfma_f32_16x16x32_bf16 v[200:203], v[44:47], v[80:83], v[200:203]
  ds_read_b64_tr_b16 v[44:45], v17 offset:33024
  ds_read_b64_tr_b16 v[46:47], v17 offset:34048
  v_mfma_f32_16x16x32_bf16 v[204:207], v[48:51], v[76:79], v[204:207]
  ds_read_b128 v[88:91], v21 offset:18432
  ds_read_b128 v[92:95], v22 offset:16384
  v_mfma_f32_16x16x32_bf16 v[208:211], v[48:51], v[80:83], v[208:211]
  ds_read_b64_tr_b16 v[48:49], v16 offset:33280
  ds_read_b64_tr_b16 v[50:51], v16 offset:34304
  s_waitcnt lgkmcnt(15)
  v_mfma_f32_16x16x32_bf16 v[212:215], v[52:55], v[76:79], v[212:215]
  ds_read_b128 v[96:99], v22 offset:18432
  s_mov_b32 m0, s73
  v_mfma_f32_16x16x32_bf16 v[216:219], v[52:55], v[80:83], v[216:219]
  ds_read_b64_tr_b16 v[52:53], v17 offset:33280
  ds_read_b64_tr_b16 v[54:55], v17 offset:34304
  v_mfma_f32_16x16x32_bf16 v[220:223], v[56:59], v[76:79], v[220:223]
  buffer_load_dwordx4 v7, s[4:7], s25 offen offset:2048 lds
  v_mfma_f32_16x16x32_bf16 v[224:227], v[56:59], v[80:83], v[224:227]
  ds_read_b64_tr_b16 v[56:57], v16 offset:33536
  ds_read_b64_tr_b16 v[58:59], v16 offset:34560
  s_waitcnt lgkmcnt(15)
  v_mfma_f32_16x16x32_bf16 v[228:231], v[60:63], v[76:79], v[228:231]
  buffer_load_dwordx4 v8, s[4:7], s25 offen offset:3072 lds
  s_addk_i32 s25, 128
  v_mfma_f32_16x16x32_bf16 v[232:235], v[60:63], v[80:83], v[232:235]
  ds_read_b64_tr_b16 v[60:61], v17 offset:33536
  ds_read_b64_tr_b16 v[62:63], v17 offset:34560
  v_mfma_f32_16x16x32_bf16 v[236:239], v[64:67], v[76:79], v[236:239]
  s_cmp_eq_u32 s25, s3
  s_cselect_b32 s25, 0, s25
  v_mfma_f32_16x16x32_bf16 v[240:243], v[64:67], v[80:83], v[240:243]
  ds_read_b64_tr_b16 v[64:65], v18 offset:47104
  ds_read_b64_tr_b16 v[66:67], v18 offset:47360
  s_barrier
  v_mov_b32 v27, 0
  v_mov_b32 v28, s62
  s_mov_b64 exec, 1
  buffer_store_dword v28, v27, s[12:15], s48 offen sc0 sc1
  s_mov_b64 exec, -1
  s_waitcnt lgkmcnt(8)
  v_mfma_f32_16x16x32_bf16 v[172:175], v[32:35], v[84:87], v[172:175]
  s_mov_b32 m0, s69
  v_mfma_f32_16x16x32_bf16 v[176:179], v[32:35], v[88:91], v[176:179]
  ds_read_b64_tr_b16 v[32:33], v16 offset:0
  ds_read_b64_tr_b16 v[34:35], v16 offset:1024
  v_mfma_f32_16x16x32_bf16 v[180:183], v[36:39], v[84:87], v[180:183]
  buffer_load_dwordx4 v2, s[8:11], s24 offen lds
  v_mfma_f32_16x16x32_bf16 v[184:187], v[36:39], v[88:91], v[184:187]
  ds_read_b64_tr_b16 v[36:37], v17 offset:0
  v_mfma_f32_16x16x32_bf16 v[188:191], v[40:43], v[84:87], v[188:191]
  ds_read_b64_tr_b16 v[38:39], v17 offset:1024
  buffer_load_dwordx4 v3, s[8:11], s24 offen offset:1024 lds
  v_mfma_f32_16x16x32_bf16 v[192:195], v[40:43], v[88:91], v[192:195]
  ds_read_b64_tr_b16 v[40:41], v16 offset:256
  v_mfma_f32_16x16x32_bf16 v[196:199], v[44:47], v[84:87], v[196:199]
  ds_read_b64_tr_b16 v[42:43], v16 offset:1280
  s_add_u32 s24, s24, s33
  v_mfma_f32_16x16x32_bf16 v[200:203], v[44:47], v[88:91], v[200:203]
  ds_read_b64_tr_b16 v[44:45], v17 offset:256
  v_mfma_f32_16x16x32_bf16 v[204:207], v[48:51], v[84:87], v[204:207]
  ds_read_b64_tr_b16 v[46:47], v17 offset:1280
  s_mov_b32 m0, s63
  v_mfma_f32_16x16x32_bf16 v[208:211], v[48:51], v[88:91], v[208:211]
  ds_read_b64_tr_b16 v[48:49], v16 offset:512
  ds_read_b64_tr_b16 v[50:51], v16 offset:1536
  s_waitcnt lgkmcnt(14)
  v_mfma_f32_16x16x32_bf16 v[212:215], v[52:55], v[84:87], v[212:215]
  buffer_load_dwordx4 v5, s[4:7], s25 offen offset:0 lds
  v_mfma_f32_16x16x32_bf16 v[216:219], v[52:55], v[88:91], v[216:219]
  ds_read_b64_tr_b16 v[52:53], v17 offset:512
  v_mfma_f32_16x16x32_bf16 v[220:223], v[56:59], v[84:87], v[220:223]
  ds_read_b64_tr_b16 v[54:55], v17 offset:1536
  v_mfma_f32_16x16x32_bf16 v[224:227], v[56:59], v[88:91], v[224:227]
  ds_read_b64_tr_b16 v[56:57], v16 offset:768
  ds_read_b64_tr_b16 v[58:59], v16 offset:1792
  s_waitcnt lgkmcnt(14)
  v_mfma_f32_16x16x32_bf16 v[228:231], v[60:63], v[84:87], v[228:231]
  buffer_load_dwordx4 v6, s[4:7], s25 offen offset:1024 lds
  v_mfma_f32_16x16x32_bf16 v[232:235], v[60:63], v[88:91], v[232:235]
  ds_read_b64_tr_b16 v[60:61], v17 offset:768
  ds_read_b64_tr_b16 v[62:63], v17 offset:1792
  v_mfma_f32_16x16x32_bf16 v[236:239], v[64:67], v[84:87], v[236:239]
  v_mfma_f32_16x16x32_bf16 v[240:243], v[64:67], v[88:91], v[240:243]
  ds_read_b64_tr_b16 v[64:65], v18 offset:48128
  ds_read_b64_tr_b16 v[66:67], v18 offset:48384
  s_waitcnt vmcnt(11)
  s_barrier
  s_waitcnt lgkmcnt(15)
  v_mfma_f32_16x16x32_bf16 v[172:175], v[32:35], v[92:95], v[172:175]
  s_mov_b32 m0, s70
  s_nop 0
  buffer_load_dwordx4 v2, s[8:11], s24 offen lds
  v_mfma_f32_16x16x32_bf16 v[176:179], v[32:35], v[96:99], v[176:179]
  ds_read_b64_tr_b16 v[32:33], v16 offset:8192
  s_waitcnt lgkmcnt(13)
  v_mfma_f32_16x16x32_bf16 v[180:183], v[36:39], v[92:95], v[180:183]
  ds_read_b64_tr_b16 v[34:35], v16 offset:9216
  buffer_load_dwordx4 v3, s[8:11], s24 offen offset:1024 lds
  v_mfma_f32_16x16x32_bf16 v[184:187], v[36:39], v[96:99], v[184:187]
  ds_read_b64_tr_b16 v[36:37], v17 offset:8192
  ds_read_b64_tr_b16 v[38:39], v17 offset:9216
  v_mfma_f32_16x16x32_bf16 v[188:191], v[40:43], v[92:95], v[188:191]
  s_add_u32 s24, s24, s33
  s_cmp_eq_u32 s24, s36
  s_cselect_b32 s24, 0, s24
  s_waitcnt vmcnt(7)
  v_mfma_f32_16x16x32_bf16 v[192:195], v[40:43], v[96:99], v[192:195]
  ds_read_b64_tr_b16 v[40:41], v16 offset:8448
  s_waitcnt lgkmcnt(13)
  v_mfma_f32_16x16x32_bf16 v[196:199], v[44:47], v[92:95], v[196:199]
  ds_read_b64_tr_b16 v[42:43], v16 offset:9472
  ds_read_b128 v[68:71], v21 offset:0
  v_mfma_f32_16x16x32_bf16 v[200:203], v[44:47], v[96:99], v[200:203]
  ds_read_b64_tr_b16 v[44:45], v17 offset:8448
  ds_read_b64_tr_b16 v[46:47], v17 offset:9472
  v_mfma_f32_16x16x32_bf16 v[204:207], v[48:51], v[92:95], v[204:207]
  ds_read_b128 v[72:75], v21 offset:2048
  ds_read_b128 v[76:79], v22 offset:0
  v_mfma_f32_16x16x32_bf16 v[208:211], v[48:51], v[96:99], v[208:211]
  ds_read_b64_tr_b16 v[48:49], v16 offset:8704
  ds_read_b64_tr_b16 v[50:51], v16 offset:9728
  s_waitcnt lgkmcnt(15)
  v_mfma_f32_16x16x32_bf16 v[212:215], v[52:55], v[92:95], v[212:215]
  ds_read_b128 v[80:83], v22 offset:2048
  s_mov_b32 m0, s63
  v_mfma_f32_16x16x32_bf16 v[216:219], v[52:55], v[96:99], v[216:219]
  ds_read_b64_tr_b16 v[52:53], v17 offset:8704
  ds_read_b64_tr_b16 v[54:55], v17 offset:9728
  v_mfma_f32_16x16x32_bf16 v[220:223], v[56:59], v[92:95], v[220:223]
  buffer_load_dwordx4 v7, s[4:7], s25 offen offset:2048 lds
  v_mfma_f32_16x16x32_bf16 v[224:227], v[56:59], v[96:99], v[224:227]
  ds_read_b64_tr_b16 v[56:57], v16 offset:8960
  ds_read_b64_tr_b16 v[58:59], v16 offset:9984
  s_waitcnt lgkmcnt(15)
  v_mfma_f32_16x16x32_bf16 v[228:231], v[60:63], v[92:95], v[228:231]
  buffer_load_dwordx4 v8, s[4:7], s25 offen offset:3072 lds
  s_addk_i32 s25, 128
  v_mfma_f32_16x16x32_bf16 v[232:235], v[60:63], v[96:99], v[232:235]
  ds_read_b64_tr_b16 v[60:61], v17 offset:8960
  ds_read_b64_tr_b16 v[62:63], v17 offset:9984
  v_mfma_f32_16x16x32_bf16 v[236:239], v[64:67], v[92:95], v[236:239]
  s_cmp_eq_u32 s25, s3
  s_cselect_b32 s25, 0, s25
  v_mfma_f32_16x16x32_bf16 v[240:243], v[64:67], v[96:99], v[240:243]
  ds_read_b64_tr_b16 v[64:65], v18 offset:40960
  ds_read_b64_tr_b16 v[66:67], v18 offset:41216
  s_barrier
  s_waitcnt lgkmcnt(8)
  v_mfma_f32_16x16x32_bf16 v[172:175], v[32:35], v[68:71], v[172:175]
  s_mov_b32 s25, s21
  s_lshl_b32 s25, s25, 8
  s_mov_b32 m0, s73
  v_mfma_f32_16x16x32_bf16 v[176:179], v[32:35], v[72:75], v[176:179]
  ds_read_b64_tr_b16 v[32:33], v16 offset:16384
  v_mfma_f32_16x16x32_bf16 v[180:183], v[36:39], v[68:71], v[180:183]
  ds_read_b64_tr_b16 v[34:35], v16 offset:17408
  v_mfma_f32_16x16x32_bf16 v[184:187], v[36:39], v[72:75], v[184:187]
  ds_read_b64_tr_b16 v[36:37], v17 offset:16384
  v_mfma_f32_16x16x32_bf16 v[188:191], v[40:43], v[68:71], v[188:191]
  ds_read_b64_tr_b16 v[38:39], v17 offset:17408
  v_mfma_f32_16x16x32_bf16 v[192:195], v[40:43], v[72:75], v[192:195]
  ds_read_b64_tr_b16 v[40:41], v16 offset:16640
  ds_read_b64_tr_b16 v[42:43], v16 offset:17664
  v_mfma_f32_16x16x32_bf16 v[196:199], v[44:47], v[68:71], v[196:199]
  buffer_load_dwordx4 v12, s[52:55], s25 offen offset:0 lds
  v_mfma_f32_16x16x32_bf16 v[200:203], v[44:47], v[72:75], v[200:203]
  ds_read_b64_tr_b16 v[44:45], v17 offset:16640
  v_mfma_f32_16x16x32_bf16 v[204:207], v[48:51], v[68:71], v[204:207]
  ds_read_b64_tr_b16 v[46:47], v17 offset:17664
  v_mfma_f32_16x16x32_bf16 v[208:211], v[48:51], v[72:75], v[208:211]
  ds_read_b64_tr_b16 v[48:49], v16 offset:16896
  s_waitcnt lgkmcnt(13)
  v_mfma_f32_16x16x32_bf16 v[212:215], v[52:55], v[68:71], v[212:215]
  ds_read_b64_tr_b16 v[50:51], v16 offset:17920
  v_mfma_f32_16x16x32_bf16 v[216:219], v[52:55], v[72:75], v[216:219]
  ds_read_b64_tr_b16 v[52:53], v17 offset:16896
  ds_read_b64_tr_b16 v[54:55], v17 offset:17920
  v_mfma_f32_16x16x32_bf16 v[220:223], v[56:59], v[68:71], v[220:223]
  buffer_load_dwordx4 v13, s[52:55], s25 offen offset:1024 lds
  v_mfma_f32_16x16x32_bf16 v[224:227], v[56:59], v[72:75], v[224:227]
  ds_read_b64_tr_b16 v[56:57], v16 offset:17152
  s_waitcnt lgkmcnt(13)
  v_mfma_f32_16x16x32_bf16 v[228:231], v[60:63], v[68:71], v[228:231]
  ds_read_b64_tr_b16 v[58:59], v16 offset:18176
  v_mfma_f32_16x16x32_bf16 v[232:235], v[60:63], v[72:75], v[232:235]
  ds_read_b64_tr_b16 v[60:61], v17 offset:17152
  ds_read_b64_tr_b16 v[62:63], v17 offset:18176
  v_mfma_f32_16x16x32_bf16 v[236:239], v[64:67], v[68:71], v[236:239]
  v_mfma_f32_16x16x32_bf16 v[240:243], v[64:67], v[72:75], v[240:243]
  ds_read_b64_tr_b16 v[64:65], v18 offset:41984
  ds_read_b64_tr_b16 v[66:67], v18 offset:42240
  s_waitcnt vmcnt(8)
  s_barrier
  s_waitcnt lgkmcnt(15)
  v_mfma_f32_16x16x32_bf16 v[172:175], v[32:35], v[76:79], v[172:175]
  s_waitcnt vmcnt(2)
  ds_read_b128 v[84:87], v21 offset:16384
  v_mfma_f32_16x16x32_bf16 v[176:179], v[32:35], v[80:83], v[176:179]
  ds_read_b64_tr_b16 v[32:33], v16 offset:24576
  s_waitcnt lgkmcnt(14)
  v_mfma_f32_16x16x32_bf16 v[180:183], v[36:39], v[76:79], v[180:183]
  ds_read_b64_tr_b16 v[34:35], v16 offset:25600
  v_mfma_f32_16x16x32_bf16 v[184:187], v[36:39], v[80:83], v[184:187]
  ds_read_b64_tr_b16 v[36:37], v17 offset:24576
  ds_read_b64_tr_b16 v[38:39], v17 offset:25600
  v_mfma_f32_16x16x32_bf16 v[188:191], v[40:43], v[76:79], v[188:191]
  ds_read_b128 v[88:91], v21 offset:18432
  ds_read_b128 v[92:95], v22 offset:16384
  v_mfma_f32_16x16x32_bf16 v[192:195], v[40:43], v[80:83], v[192:195]
  ds_read_b64_tr_b16 v[40:41], v16 offset:24832
  s_waitcnt lgkmcnt(15)
  v_mfma_f32_16x16x32_bf16 v[196:199], v[44:47], v[76:79], v[196:199]
  ds_read_b64_tr_b16 v[42:43], v16 offset:25856
  v_mfma_f32_16x16x32_bf16 v[200:203], v[44:47], v[80:83], v[200:203]
  ds_read_b64_tr_b16 v[44:45], v17 offset:24832
  ds_read_b64_tr_b16 v[46:47], v17 offset:25856
  v_mfma_f32_16x16x32_bf16 v[204:207], v[48:51], v[76:79], v[204:207]
  ds_read_b128 v[96:99], v22 offset:18432
  s_mov_b32 m0, s73
  v_mfma_f32_16x16x32_bf16 v[208:211], v[48:51], v[80:83], v[208:211]
  ds_read_b64_tr_b16 v[48:49], v16 offset:25088
  s_waitcnt lgkmcnt(15)
  v_mfma_f32_16x16x32_bf16 v[212:215], v[52:55], v[76:79], v[212:215]
  ds_read_b64_tr_b16 v[50:51], v16 offset:26112
  buffer_load_dwordx4 v14, s[52:55], s25 offen offset:2048 lds
  v_mfma_f32_16x16x32_bf16 v[216:219], v[52:55], v[80:83], v[216:219]
  ds_read_b64_tr_b16 v[52:53], v17 offset:25088
  v_mfma_f32_16x16x32_bf16 v[220:223], v[56:59], v[76:79], v[220:223]
  ds_read_b64_tr_b16 v[54:55], v17 offset:26112
  v_mfma_f32_16x16x32_bf16 v[224:227], v[56:59], v[80:83], v[224:227]
  ds_read_b64_tr_b16 v[56:57], v16 offset:25344
  ds_read_b64_tr_b16 v[58:59], v16 offset:26368
  s_waitcnt lgkmcnt(15)
  v_mfma_f32_16x16x32_bf16 v[228:231], v[60:63], v[76:79], v[228:231]
  buffer_load_dwordx4 v15, s[52:55], s25 offen offset:3072 lds
  v_mfma_f32_16x16x32_bf16 v[232:235], v[60:63], v[80:83], v[232:235]
  ds_read_b64_tr_b16 v[60:61], v17 offset:25344
  ds_read_b64_tr_b16 v[62:63], v17 offset:26368
  v_mfma_f32_16x16x32_bf16 v[236:239], v[64:67], v[76:79], v[236:239]
  v_mfma_f32_16x16x32_bf16 v[240:243], v[64:67], v[80:83], v[240:243]
  ds_read_b64_tr_b16 v[64:65], v18 offset:43008
  ds_read_b64_tr_b16 v[66:67], v18 offset:43264
  s_barrier
  s_waitcnt lgkmcnt(10)
  v_mfma_f32_16x16x32_bf16 v[172:175], v[32:35], v[84:87], v[172:175]
  s_addk_i32 s25, 128
  s_mov_b32 m0, s63
  v_mfma_f32_16x16x32_bf16 v[176:179], v[32:35], v[88:91], v[176:179]
  ds_read_b64_tr_b16 v[32:33], v16 offset:32768
  v_mfma_f32_16x16x32_bf16 v[180:183], v[36:39], v[84:87], v[180:183]
  ds_read_b64_tr_b16 v[34:35], v16 offset:33792
  v_mfma_f32_16x16x32_bf16 v[184:187], v[36:39], v[88:91], v[184:187]
  ds_read_b64_tr_b16 v[36:37], v17 offset:32768
  ds_read_b64_tr_b16 v[38:39], v17 offset:33792
  v_mfma_f32_16x16x32_bf16 v[188:191], v[40:43], v[84:87], v[188:191]
  buffer_load_dwordx4 v12, s[52:55], s25 offen offset:0 lds
  v_mfma_f32_16x16x32_bf16 v[192:195], v[40:43], v[88:91], v[192:195]
  ds_read_b64_tr_b16 v[40:41], v16 offset:33024
  s_waitcnt lgkmcnt(13)
  v_mfma_f32_16x16x32_bf16 v[196:199], v[44:47], v[84:87], v[196:199]
  ds_read_b64_tr_b16 v[42:43], v16 offset:34048
  v_mfma_f32_16x16x32_bf16 v[200:203], v[44:47], v[88:91], v[200:203]
  ds_read_b64_tr_b16 v[44:45], v17 offset:33024
  v_mfma_f32_16x16x32_bf16 v[204:207], v[48:51], v[84:87], v[204:207]
  ds_read_b64_tr_b16 v[46:47], v17 offset:34048
  v_mfma_f32_16x16x32_bf16 v[208:211], v[48:51], v[88:91], v[208:211]
  ds_read_b64_tr_b16 v[48:49], v16 offset:33280
  ds_read_b64_tr_b16 v[50:51], v16 offset:34304
  s_waitcnt lgkmcnt(14)
  v_mfma_f32_16x16x32_bf16 v[212:215], v[52:55], v[84:87], v[212:215]
  buffer_load_dwordx4 v13, s[52:55], s25 offen offset:1024 lds
  v_mfma_f32_16x16x32_bf16 v[216:219], v[52:55], v[88:91], v[216:219]
  ds_read_b64_tr_b16 v[52:53], v17 offset:33280
  v_mfma_f32_16x16x32_bf16 v[220:223], v[56:59], v[84:87], v[220:223]
  ds_read_b64_tr_b16 v[54:55], v17 offset:34304
  v_mfma_f32_16x16x32_bf16 v[224:227], v[56:59], v[88:91], v[224:227]
  ds_read_b64_tr_b16 v[56:57], v16 offset:33536
  s_waitcnt lgkmcnt(13)
  v_mfma_f32_16x16x32_bf16 v[228:231], v[60:63], v[84:87], v[228:231]
  ds_read_b64_tr_b16 v[58:59], v16 offset:34560
  v_mfma_f32_16x16x32_bf16 v[232:235], v[60:63], v[88:91], v[232:235]
  ds_read_b64_tr_b16 v[60:61], v17 offset:33536
  ds_read_b64_tr_b16 v[62:63], v17 offset:34560
  v_mfma_f32_16x16x32_bf16 v[236:239], v[64:67], v[84:87], v[236:239]
  v_mfma_f32_16x16x32_bf16 v[240:243], v[64:67], v[88:91], v[240:243]
  ds_read_b64_tr_b16 v[64:65], v18 offset:44032
  ds_read_b64_tr_b16 v[66:67], v18 offset:44288
  s_waitcnt lgkmcnt(15)
  v_mfma_f32_16x16x32_bf16 v[172:175], v[32:35], v[92:95], v[172:175]
  s_mov_b32 m0, s63
  v_mfma_f32_16x16x32_bf16 v[176:179], v[32:35], v[96:99], v[176:179]
  s_waitcnt lgkmcnt(12)
  v_mfma_f32_16x16x32_bf16 v[180:183], v[36:39], v[92:95], v[180:183]
  buffer_load_dwordx4 v14, s[52:55], s25 offen offset:2048 lds
  v_mfma_f32_16x16x32_bf16 v[184:187], v[36:39], v[96:99], v[184:187]
  buffer_load_dwordx4 v15, s[52:55], s25 offen offset:3072 lds
  v_mfma_f32_16x16x32_bf16 v[188:191], v[40:43], v[92:95], v[188:191]
  v_mfma_f32_16x16x32_bf16 v[192:195], v[40:43], v[96:99], v[192:195]
  s_waitcnt lgkmcnt(8)
  v_mfma_f32_16x16x32_bf16 v[196:199], v[44:47], v[92:95], v[196:199]
  v_mfma_f32_16x16x32_bf16 v[200:203], v[44:47], v[96:99], v[200:203]
  v_mfma_f32_16x16x32_bf16 v[204:207], v[48:51], v[92:95], v[204:207]
  v_mfma_f32_16x16x32_bf16 v[208:211], v[48:51], v[96:99], v[208:211]
  s_waitcnt lgkmcnt(4)
  v_mfma_f32_16x16x32_bf16 v[212:215], v[52:55], v[92:95], v[212:215]
  v_mfma_f32_16x16x32_bf16 v[216:219], v[52:55], v[96:99], v[216:219]
  v_mfma_f32_16x16x32_bf16 v[220:223], v[56:59], v[92:95], v[220:223]
  v_mfma_f32_16x16x32_bf16 v[224:227], v[56:59], v[96:99], v[224:227]
  s_waitcnt lgkmcnt(0)
  v_mfma_f32_16x16x32_bf16 v[228:231], v[60:63], v[92:95], v[228:231]
  v_mfma_f32_16x16x32_bf16 v[232:235], v[60:63], v[96:99], v[232:235]
  v_mfma_f32_16x16x32_bf16 v[236:239], v[64:67], v[92:95], v[236:239]
  v_mfma_f32_16x16x32_bf16 v[240:243], v[64:67], v[96:99], v[240:243]
  s_setprio 2
  s_lshl_b32 s44, s20, 13
  v_add_u32 v27, s44, v19
  v_add_u32 v28, s30, v19
  s_barrier
  ds_write_b128 v27, v[100:103] offset:0
  ds_write_b128 v27, v[104:107] offset:1024
  ds_write_b128 v27, v[108:111] offset:2048
  ds_write_b128 v27, v[112:115] offset:3072
  ds_write_b128 v27, v[116:119] offset:4096
  ds_write_b128 v27, v[120:123] offset:5120
  ds_write_b128 v27, v[124:127] offset:6144
  ds_write_b128 v27, v[128:131] offset:7168
  ds_write_b128 v28, v[132:135] offset:4096
  v_pk_mul_f32 v[84:85], v[172:173], v[172:173]
  v_pk_mul_f32 v[86:87], v[174:175], v[174:175]
  v_pk_mul_f32 v[88:89], v[176:177], v[176:177]
  v_pk_mul_f32 v[90:91], v[178:179], v[178:179]
  v_pk_fma_f32 v[84:85], v[84:85], s[60:61], v[30:31]
  v_pk_fma_f32 v[86:87], v[86:87], s[60:61], v[30:31]
  v_pk_fma_f32 v[88:89], v[88:89], s[60:61], v[30:31]
  v_pk_fma_f32 v[90:91], v[90:91], s[60:61], v[30:31]
  v_pk_mul_f32 v[84:85], v[84:85], v[172:173]
  v_pk_mul_f32 v[86:87], v[86:87], v[174:175]
  v_pk_mul_f32 v[88:89], v[88:89], v[176:177]
  v_pk_mul_f32 v[90:91], v[90:91], v[178:179]
  v_exp_f32 v84, v84
  v_exp_f32 v85, v85
  v_exp_f32 v86, v86
  v_exp_f32 v87, v87
  v_exp_f32 v88, v88
  v_exp_f32 v89, v89
  v_exp_f32 v90, v90
  v_exp_f32 v91, v91
  v_pk_add_f32 v[84:85], v[84:85], 1.0 op_sel_hi:[1,0]
  v_pk_add_f32 v[86:87], v[86:87], 1.0 op_sel_hi:[1,0]
  v_pk_add_f32 v[88:89], v[88:89], 1.0 op_sel_hi:[1,0]
  v_pk_add_f32 v[90:91], v[90:91], 1.0 op_sel_hi:[1,0]
  v_rcp_f32 v84, v84
  v_rcp_f32 v85, v85
  v_rcp_f32 v86, v86
  v_rcp_f32 v87, v87
  v_rcp_f32 v88, v88
  v_rcp_f32 v89, v89
  v_rcp_f32 v90, v90
  v_rcp_f32 v91, v91
  v_pk_mul_f32 v[172:173], v[84:85], v[172:173]
  v_pk_mul_f32 v[174:175], v[86:87], v[174:175]
  v_pk_mul_f32 v[176:177], v[88:89], v[176:177]
  v_pk_mul_f32 v[178:179], v[90:91], v[178:179]
  s_setprio 2
  s_waitcnt vmcnt(4)
  ds_read_b128 v[68:71], v21 offset:0
  ds_read_b128 v[72:75], v21 offset:2048
  ds_read_b128 v[76:79], v22 offset:0
  ds_read_b128 v[80:83], v22 offset:2048
  s_waitcnt lgkmcnt(4)
  s_barrier
  ds_read_b128 v[32:35], v19 offset:0
  ds_read_b128 v[36:39], v19 offset:1024
  ds_read_b128 v[40:43], v19 offset:2048
  ds_read_b128 v[44:47], v19 offset:3072
  ds_read_b128 v[48:51], v19 offset:4096
  ds_read_b128 v[52:55], v19 offset:5120
  ds_read_b128 v[56:59], v19 offset:6144
  ds_read_b128 v[60:63], v19 offset:7168
  ds_read_b128 v[64:67], v19 offset:45056
  s_waitcnt lgkmcnt(8)
  v_mfma_f32_16x16x32_bf16 v[100:103], v[32:35], v[68:71], 0
  s_add_u32 s25, s35, 1
  s_cmp_ge_u32 s25, 8
  s_cselect_b32 s44, 7, 0
  v_mfma_f32_16x16x32_bf16 v[104:107], v[32:35], v[72:75], 0
  s_sub_u32 s25, s25, s44
  s_xor_b32 s25, s25, s21
  s_waitcnt lgkmcnt(6)
  v_mfma_f32_16x16x32_bf16 v[108:111], v[36:39], v[68:71], 0
  ds_read_b128 v[32:35], v19 offset:8192
  s_lshl_b32 s25, s25, 8
  v_mfma_f32_16x16x32_bf16 v[112:115], v[36:39], v[72:75], 0
  s_mov_b32 m0, s73
  ds_read_b128 v[36:39], v19 offset:9216
  v_mfma_f32_16x16x32_bf16 v[116:119], v[40:43], v[68:71], 0
  buffer_load_dwordx4 v12, s[52:55], s25 offen offset:0 lds
  v_mfma_f32_16x16x32_bf16 v[120:123], v[40:43], v[72:75], 0
  ds_read_b128 v[40:43], v19 offset:10240
  s_waitcnt lgkmcnt(7)
  v_mfma_f32_16x16x32_bf16 v[124:127], v[44:47], v[68:71], 0
  buffer_load_dwordx4 v13, s[52:55], s25 offen offset:1024 lds
  v_mfma_f32_16x16x32_bf16 v[128:131], v[44:47], v[72:75], 0
  ds_read_b128 v[44:47], v19 offset:11264
  v_mfma_f32_16x16x32_bf16 v[132:135], v[48:51], v[68:71], 0
  v_mfma_f32_16x16x32_bf16 v[136:139], v[48:51], v[72:75], 0
  ds_read_b128 v[48:51], v19 offset:12288
  s_waitcnt lgkmcnt(7)
  v_mfma_f32_16x16x32_bf16 v[140:143], v[52:55], v[68:71], 0
  v_mfma_f32_16x16x32_bf16 v[144:147], v[52:55], v[72:75], 0
  ds_read_b128 v[52:55], v19 offset:13312
  v_mfma_f32_16x16x32_bf16 v[148:151], v[56:59], v[68:71], 0
  v_mfma_f32_16x16x32_bf16 v[152:155], v[56:59], v[72:75], 0
  ds_read_b128 v[56:59], v19 offset:14336
  s_waitcnt lgkmcnt(7)
  v_mfma_f32_16x16x32_bf16 v[156:159], v[60:63], v[68:71], 0
  v_mfma_f32_16x16x32_bf16 v[160:163], v[60:63], v[72:75], 0
  ds_read_b128 v[60:63], v19 offset:15360
  v_mfma_f32_16x16x32_bf16 v[164:167], v[64:67], v[68:71], 0
  v_mfma_f32_16x16x32_bf16 v[168:171], v[64:67], v[72:75], 0
  ds_read_b128 v[64:67], v19 offset:46080
  s_waitcnt lgkmcnt(8)
  v_mfma_f32_16x16x32_bf16 v[100:103], v[32:35], v[76:79], v[100:103]
  s_waitcnt vmcnt(2)
  ds_read_b128 v[84:87], v21 offset:16384
  v_mfma_f32_16x16x32_bf16 v[104:107], v[32:35], v[80:83], v[104:107]
  ds_read_b128 v[88:91], v21 offset:18432
  s_waitcnt lgkmcnt(8)
  v_mfma_f32_16x16x32_bf16 v[108:111], v[36:39], v[76:79], v[108:111]
  ds_read_b128 v[32:35], v19 offset:16384
  v_mfma_f32_16x16x32_bf16 v[112:115], v[36:39], v[80:83], v[112:115]
  ds_read_b128 v[92:95], v22 offset:16384
  v_mfma_f32_16x16x32_bf16 v[116:119], v[40:43], v[76:79], v[116:119]
  ds_read_b128 v[36:39], v19 offset:17408
  v_mfma_f32_16x16x32_bf16 v[120:123], v[40:43], v[80:83], v[120:123]
  ds_read_b128 v[96:99], v22 offset:18432
  s_waitcnt lgkmcnt(10)
  v_mfma_f32_16x16x32_bf16 v[124:127], v[44:47], v[76:79], v[124:127]
  ds_read_b128 v[40:43], v19 offset:18432
  s_mov_b32 m0, s73
  v_mfma_f32_16x16x32_bf16 v[128:131], v[44:47], v[80:83], v[128:131]
  buffer_load_dwordx4 v14, s[52:55], s25 offen offset:2048 lds
  v_mfma_f32_16x16x32_bf16 v[132:135], v[48:51], v[76:79], v[132:135]
  ds_read_b128 v[44:47], v19 offset:19456
  v_mfma_f32_16x16x32_bf16 v[136:139], v[48:51], v[80:83], v[136:139]
  ds_read_b128 v[48:51], v19 offset:20480
  s_waitcnt lgkmcnt(11)
  v_mfma_f32_16x16x32_bf16 v[140:143], v[52:55], v[76:79], v[140:143]
  buffer_load_dwordx4 v15, s[52:55], s25 offen offset:3072 lds
  v_mfma_f32_16x16x32_bf16 v[144:147], v[52:55], v[80:83], v[144:147]
  ds_read_b128 v[52:55], v19 offset:21504
  v_mfma_f32_16x16x32_bf16 v[148:151], v[56:59], v[76:79], v[148:151]
  v_mfma_f32_16x16x32_bf16 v[152:155], v[56:59], v[80:83], v[152:155]
  ds_read_b128 v[56:59], v19 offset:22528
  s_waitcnt lgkmcnt(11)
  v_mfma_f32_16x16x32_bf16 v[156:159], v[60:63], v[76:79], v[156:159]
  v_mfma_f32_16x16x32_bf16 v[160:163], v[60:63], v[80:83], v[160:163]
  ds_read_b128 v[60:63], v19 offset:23552
  v_mfma_f32_16x16x32_bf16 v[164:167], v[64:67], v[76:79], v[164:167]
  v_mfma_f32_16x16x32_bf16 v[168:171], v[64:67], v[80:83], v[168:171]
  ds_read_b128 v[64:67], v19 offset:47104
  s_waitcnt lgkmcnt(10)
  s_waitcnt lgkmcnt(7)
  v_mfma_f32_16x16x32_bf16 v[100:103], v[32:35], v[84:87], v[100:103]
  s_addk_i32 s25, 128
  s_mov_b32 m0, s63
  v_mfma_f32_16x16x32_bf16 v[104:107], v[32:35], v[88:91], v[104:107]
  ds_read_b128 v[32:35], v19 offset:24576
  s_waitcnt lgkmcnt(7)
  v_mfma_f32_16x16x32_bf16 v[108:111], v[36:39], v[84:87], v[108:111]
  buffer_load_dwordx4 v12, s[52:55], s25 offen offset:0 lds
  v_mfma_f32_16x16x32_bf16 v[112:115], v[36:39], v[88:91], v[112:115]
  buffer_load_dwordx4 v13, s[52:55], s25 offen offset:1024 lds
  v_mfma_f32_16x16x32_bf16 v[116:119], v[40:43], v[84:87], v[116:119]
  ds_read_b128 v[36:39], v19 offset:25600
  v_mfma_f32_16x16x32_bf16 v[120:123], v[40:43], v[88:91], v[120:123]
  ds_read_b128 v[40:43], v19 offset:26624
  s_waitcnt lgkmcnt(7)
  v_mfma_f32_16x16x32_bf16 v[124:127], v[44:47], v[84:87], v[124:127]
  v_mfma_f32_16x16x32_bf16 v[128:131], v[44:47], v[88:91], v[128:131]
  ds_read_b128 v[44:47], v19 offset:27648
  v_mfma_f32_16x16x32_bf16 v[132:135], v[48:51], v[84:87], v[132:135]
  v_mfma_f32_16x16x32_bf16 v[136:139], v[48:51], v[88:91], v[136:139]
  ds_read_b128 v[48:51], v19 offset:28672
  s_waitcnt lgkmcnt(7)
  v_mfma_f32_16x16x32_bf16 v[140:143], v[52:55], v[84:87], v[140:143]
  v_mfma_f32_16x16x32_bf16 v[144:147], v[52:55], v[88:91], v[144:147]
  ds_read_b128 v[52:55], v19 offset:29696
  v_mfma_f32_16x16x32_bf16 v[148:151], v[56:59], v[84:87], v[148:151]
  v_mfma_f32_16x16x32_bf16 v[152:155], v[56:59], v[88:91], v[152:155]
  ds_read_b128 v[56:59], v19 offset:30720
  s_waitcnt lgkmcnt(7)
  v_mfma_f32_16x16x32_bf16 v[156:159], v[60:63], v[84:87], v[156:159]
  v_mfma_f32_16x16x32_bf16 v[160:163], v[60:63], v[88:91], v[160:163]
  ds_read_b128 v[60:63], v19 offset:31744
  v_mfma_f32_16x16x32_bf16 v[164:167], v[64:67], v[84:87], v[164:167]
  v_mfma_f32_16x16x32_bf16 v[168:171], v[64:67], v[88:91], v[168:171]
  ds_read_b128 v[64:67], v19 offset:48128
  s_waitcnt lgkmcnt(8)
  v_mfma_f32_16x16x32_bf16 v[100:103], v[32:35], v[92:95], v[100:103]
  s_mov_b32 m0, s63
  v_mfma_f32_16x16x32_bf16 v[104:107], v[32:35], v[96:99], v[104:107]
  s_waitcnt lgkmcnt(6)
  v_mfma_f32_16x16x32_bf16 v[108:111], v[36:39], v[92:95], v[108:111]
  buffer_load_dwordx4 v14, s[52:55], s25 offen offset:2048 lds
  v_mfma_f32_16x16x32_bf16 v[112:115], v[36:39], v[96:99], v[112:115]
  buffer_load_dwordx4 v15, s[52:55], s25 offen offset:3072 lds
  v_mfma_f32_16x16x32_bf16 v[116:119], v[40:43], v[92:95], v[116:119]
  v_mfma_f32_16x16x32_bf16 v[120:123], v[40:43], v[96:99], v[120:123]
  s_waitcnt lgkmcnt(4)
  v_mfma_f32_16x16x32_bf16 v[124:127], v[44:47], v[92:95], v[124:127]
  v_mfma_f32_16x16x32_bf16 v[128:131], v[44:47], v[96:99], v[128:131]
  v_mfma_f32_16x16x32_bf16 v[132:135], v[48:51], v[92:95], v[132:135]
  v_mfma_f32_16x16x32_bf16 v[136:139], v[48:51], v[96:99], v[136:139]
  s_waitcnt lgkmcnt(2)
  v_mfma_f32_16x16x32_bf16 v[140:143], v[52:55], v[92:95], v[140:143]
  v_mfma_f32_16x16x32_bf16 v[144:147], v[52:55], v[96:99], v[144:147]
  v_mfma_f32_16x16x32_bf16 v[148:151], v[56:59], v[92:95], v[148:151]
  v_mfma_f32_16x16x32_bf16 v[152:155], v[56:59], v[96:99], v[152:155]
  s_waitcnt lgkmcnt(0)
  v_mfma_f32_16x16x32_bf16 v[156:159], v[60:63], v[92:95], v[156:159]
  v_mfma_f32_16x16x32_bf16 v[160:163], v[60:63], v[96:99], v[160:163]
  v_mfma_f32_16x16x32_bf16 v[164:167], v[64:67], v[92:95], v[164:167]
  v_mfma_f32_16x16x32_bf16 v[168:171], v[64:67], v[96:99], v[168:171]
  s_setprio 2
  v_pk_mul_f32 v[92:93], v[180:181], v[180:181]
  v_pk_mul_f32 v[94:95], v[182:183], v[182:183]
  v_pk_mul_f32 v[96:97], v[184:185], v[184:185]
  v_pk_mul_f32 v[98:99], v[186:187], v[186:187]
  v_pk_fma_f32 v[92:93], v[92:93], s[60:61], v[30:31]
  v_pk_fma_f32 v[94:95], v[94:95], s[60:61], v[30:31]
  v_pk_fma_f32 v[96:97], v[96:97], s[60:61], v[30:31]
  v_pk_fma_f32 v[98:99], v[98:99], s[60:61], v[30:31]
  v_pk_mul_f32 v[92:93], v[92:93], v[180:181]
  v_pk_mul_f32 v[94:95], v[94:95], v[182:183]
  v_pk_mul_f32 v[96:97], v[96:97], v[184:185]
  v_pk_mul_f32 v[98:99], v[98:99], v[186:187]
  v_exp_f32 v92, v92
  v_exp_f32 v93, v93
  v_exp_f32 v94, v94
  v_exp_f32 v95, v95
  v_exp_f32 v96, v96
  v_exp_f32 v97, v97
  v_exp_f32 v98, v98
  v_exp_f32 v99, v99
  v_pk_add_f32 v[92:93], v[92:93], 1.0 op_sel_hi:[1,0]
  v_pk_add_f32 v[94:95], v[94:95], 1.0 op_sel_hi:[1,0]
  v_pk_add_f32 v[96:97], v[96:97], 1.0 op_sel_hi:[1,0]
  v_pk_add_f32 v[98:99], v[98:99], 1.0 op_sel_hi:[1,0]
  v_rcp_f32 v92, v92
  v_rcp_f32 v93, v93
  v_rcp_f32 v94, v94
  v_rcp_f32 v95, v95
  v_rcp_f32 v96, v96
  v_rcp_f32 v97, v97
  v_rcp_f32 v98, v98
  v_rcp_f32 v99, v99
  v_pk_mul_f32 v[180:181], v[92:93], v[180:181]
  v_pk_mul_f32 v[182:183], v[94:95], v[182:183]
  v_pk_mul_f32 v[184:185], v[96:97], v[184:185]
  v_pk_mul_f32 v[186:187], v[98:99], v[186:187]
  v_pk_mul_f32 v[84:85], v[188:189], v[188:189]
  v_pk_mul_f32 v[86:87], v[190:191], v[190:191]
  v_pk_mul_f32 v[88:89], v[192:193], v[192:193]
  v_pk_mul_f32 v[90:91], v[194:195], v[194:195]
  v_pk_fma_f32 v[84:85], v[84:85], s[60:61], v[30:31]
  v_pk_fma_f32 v[86:87], v[86:87], s[60:61], v[30:31]
  v_pk_fma_f32 v[88:89], v[88:89], s[60:61], v[30:31]
  v_pk_fma_f32 v[90:91], v[90:91], s[60:61], v[30:31]
  v_pk_mul_f32 v[84:85], v[84:85], v[188:189]
  v_pk_mul_f32 v[86:87], v[86:87], v[190:191]
  v_pk_mul_f32 v[88:89], v[88:89], v[192:193]
  v_pk_mul_f32 v[90:91], v[90:91], v[194:195]
  v_exp_f32 v84, v84
  v_exp_f32 v85, v85
  v_exp_f32 v86, v86
  v_exp_f32 v87, v87
  v_exp_f32 v88, v88
  v_exp_f32 v89, v89
  v_exp_f32 v90, v90
  v_exp_f32 v91, v91
  v_pk_add_f32 v[84:85], v[84:85], 1.0 op_sel_hi:[1,0]
  v_pk_add_f32 v[86:87], v[86:87], 1.0 op_sel_hi:[1,0]
  v_pk_add_f32 v[88:89], v[88:89], 1.0 op_sel_hi:[1,0]
  v_pk_add_f32 v[90:91], v[90:91], 1.0 op_sel_hi:[1,0]
  v_rcp_f32 v84, v84
  v_rcp_f32 v85, v85
  v_rcp_f32 v86, v86
  v_rcp_f32 v87, v87
  v_rcp_f32 v88, v88
  v_rcp_f32 v89, v89
  v_rcp_f32 v90, v90
  v_rcp_f32 v91, v91
  v_pk_mul_f32 v[188:189], v[84:85], v[188:189]
  v_pk_mul_f32 v[190:191], v[86:87], v[190:191]
  v_pk_mul_f32 v[192:193], v[88:89], v[192:193]
  v_pk_mul_f32 v[194:195], v[90:91], v[194:195]
  s_mov_b32 s51, 300000
POLL_15:
  buffer_load_dword v26, v29, s[12:15], s50 offen sc0 sc1
  s_waitcnt vmcnt(0)
POLLC_16:
  v_xor_b32 v27, s62, v26
  v_cmp_ne_u32 vcc, 0, v27
  s_nop 4
  s_cbranch_vccz POLLOK_17
  s_sleep 1
  s_sub_u32 s51, s51, 1
  s_cmp_lg_u32 s51, 0
  s_cbranch_scc1 POLL_15
POLLOK_17:
  s_barrier
  s_add_u32 s24, s35, 1
  s_cmp_ge_u32 s24, 8
  s_cselect_b32 s29, 7, 0
  s_sub_u32 s24, s24, s29
  s_xor_b32 s24, s24, s21
  s_mul_i32 s24, s24, 589824
  s_mov_b32 m0, s70
  s_nop 0
  buffer_load_dwordx4 v9, s[12:15], s24 offen sc1 lds
  buffer_load_dwordx4 v9, s[12:15], s24 offen offset:1024 sc1 lds
  s_mov_b32 m0, s71
  s_nop 0
  buffer_load_dwordx4 v10, s[12:15], s24 offen sc1 lds
  s_add_u32 s24, s24, s38
  s_mov_b32 m0, s66
  s_nop 0
  buffer_load_dwordx4 v9, s[12:15], s24 offen sc1 lds
  buffer_load_dwordx4 v9, s[12:15], s24 offen offset:1024 sc1 lds
  s_add_u32 s24, s24, s38
  s_mov_b32 m0, s67
  s_nop 0
  buffer_load_dwordx4 v9, s[12:15], s24 offen sc1 lds
  buffer_load_dwordx4 v9, s[12:15], s24 offen offset:1024 sc1 lds
  s_add_u32 s24, s24, s38
  s_mov_b32 m0, s68
  s_nop 0
  buffer_load_dwordx4 v9, s[12:15], s24 offen sc1 lds
  buffer_load_dwordx4 v9, s[12:15], s24 offen offset:1024 sc1 lds
  v_pk_mul_f32 v[92:93], v[196:197], v[196:197]
  v_pk_mul_f32 v[94:95], v[198:199], v[198:199]
  v_pk_mul_f32 v[96:97], v[200:201], v[200:201]
  v_pk_mul_f32 v[98:99], v[202:203], v[202:203]
  v_pk_fma_f32 v[92:93], v[92:93], s[60:61], v[30:31]
  v_pk_fma_f32 v[94:95], v[94:95], s[60:61], v[30:31]
  v_pk_fma_f32 v[96:97], v[96:97], s[60:61], v[30:31]
  v_pk_fma_f32 v[98:99], v[98:99], s[60:61], v[30:31]
  v_pk_mul_f32 v[92:93], v[92:93], v[196:197]
  v_pk_mul_f32 v[94:95], v[94:95], v[198:199]
  v_pk_mul_f32 v[96:97], v[96:97], v[200:201]
  v_pk_mul_f32 v[98:99], v[98:99], v[202:203]
  v_exp_f32 v92, v92
  v_exp_f32 v93, v93
  v_exp_f32 v94, v94
  v_exp_f32 v95, v95
  v_exp_f32 v96, v96
  v_exp_f32 v97, v97
  v_exp_f32 v98, v98
  v_exp_f32 v99, v99
  v_pk_add_f32 v[92:93], v[92:93], 1.0 op_sel_hi:[1,0]
  v_pk_add_f32 v[94:95], v[94:95], 1.0 op_sel_hi:[1,0]
  v_pk_add_f32 v[96:97], v[96:97], 1.0 op_sel_hi:[1,0]
  v_pk_add_f32 v[98:99], v[98:99], 1.0 op_sel_hi:[1,0]
  v_rcp_f32 v92, v92
  v_rcp_f32 v93, v93
  v_rcp_f32 v94, v94
  v_rcp_f32 v95, v95
  v_rcp_f32 v96, v96
  v_rcp_f32 v97, v97
  v_rcp_f32 v98, v98
  v_rcp_f32 v99, v99
  v_pk_mul_f32 v[196:197], v[92:93], v[196:197]
  v_pk_mul_f32 v[198:199], v[94:95], v[198:199]
  v_pk_mul_f32 v[200:201], v[96:97], v[200:201]
  v_pk_mul_f32 v[202:203], v[98:99], v[202:203]
  v_pk_mul_f32 v[84:85], v[204:205], v[204:205]
  v_pk_mul_f32 v[86:87], v[206:207], v[206:207]
  v_pk_mul_f32 v[88:89], v[208:209], v[208:209]
  v_pk_mul_f32 v[90:91], v[210:211], v[210:211]
  v_pk_fma_f32 v[84:85], v[84:85], s[60:61], v[30:31]
  v_pk_fma_f32 v[86:87], v[86:87], s[60:61], v[30:31]
  v_pk_fma_f32 v[88:89], v[88:89], s[60:61], v[30:31]
  v_pk_fma_f32 v[90:91], v[90:91], s[60:61], v[30:31]
  v_pk_mul_f32 v[84:85], v[84:85], v[204:205]
  v_pk_mul_f32 v[86:87], v[86:87], v[206:207]
  v_pk_mul_f32 v[88:89], v[88:89], v[208:209]
  v_pk_mul_f32 v[90:91], v[90:91], v[210:211]
  v_exp_f32 v84, v84
  v_exp_f32 v85, v85
  v_exp_f32 v86, v86
  v_exp_f32 v87, v87
  v_exp_f32 v88, v88
  v_exp_f32 v89, v89
  v_exp_f32 v90, v90
  v_exp_f32 v91, v91
  v_pk_add_f32 v[84:85], v[84:85], 1.0 op_sel_hi:[1,0]
  v_pk_add_f32 v[86:87], v[86:87], 1.0 op_sel_hi:[1,0]
  v_pk_add_f32 v[88:89], v[88:89], 1.0 op_sel_hi:[1,0]
  v_pk_add_f32 v[90:91], v[90:91], 1.0 op_sel_hi:[1,0]
  v_rcp_f32 v84, v84
  v_rcp_f32 v85, v85
  v_rcp_f32 v86, v86
  v_rcp_f32 v87, v87
  v_rcp_f32 v88, v88
  v_rcp_f32 v89, v89
  v_rcp_f32 v90, v90
  v_rcp_f32 v91, v91
  v_pk_mul_f32 v[204:205], v[84:85], v[204:205]
  v_pk_mul_f32 v[206:207], v[86:87], v[206:207]
  v_pk_mul_f32 v[208:209], v[88:89], v[208:209]
  v_pk_mul_f32 v[210:211], v[90:91], v[210:211]
  v_pk_mul_f32 v[92:93], v[212:213], v[212:213]
  v_pk_mul_f32 v[94:95], v[214:215], v[214:215]
  v_pk_mul_f32 v[96:97], v[216:217], v[216:217]
  v_pk_mul_f32 v[98:99], v[218:219], v[218:219]
  v_pk_fma_f32 v[92:93], v[92:93], s[60:61], v[30:31]
  v_pk_fma_f32 v[94:95], v[94:95], s[60:61], v[30:31]
  v_pk_fma_f32 v[96:97], v[96:97], s[60:61], v[30:31]
  v_pk_fma_f32 v[98:99], v[98:99], s[60:61], v[30:31]
  v_pk_mul_f32 v[92:93], v[92:93], v[212:213]
  v_pk_mul_f32 v[94:95], v[94:95], v[214:215]
  v_pk_mul_f32 v[96:97], v[96:97], v[216:217]
  v_pk_mul_f32 v[98:99], v[98:99], v[218:219]
  v_exp_f32 v92, v92
  v_exp_f32 v93, v93
  v_exp_f32 v94, v94
  v_exp_f32 v95, v95
  v_exp_f32 v96, v96
  v_exp_f32 v97, v97
  v_exp_f32 v98, v98
  v_exp_f32 v99, v99
  v_pk_add_f32 v[92:93], v[92:93], 1.0 op_sel_hi:[1,0]
  v_pk_add_f32 v[94:95], v[94:95], 1.0 op_sel_hi:[1,0]
  v_pk_add_f32 v[96:97], v[96:97], 1.0 op_sel_hi:[1,0]
  v_pk_add_f32 v[98:99], v[98:99], 1.0 op_sel_hi:[1,0]
  v_rcp_f32 v92, v92
  v_rcp_f32 v93, v93
  v_rcp_f32 v94, v94
  v_rcp_f32 v95, v95
  v_rcp_f32 v96, v96
  v_rcp_f32 v97, v97
  v_rcp_f32 v98, v98
  v_rcp_f32 v99, v99
  v_pk_mul_f32 v[212:213], v[92:93], v[212:213]
  v_pk_mul_f32 v[214:215], v[94:95], v[214:215]
  v_pk_mul_f32 v[216:217], v[96:97], v[216:217]
  v_pk_mul_f32 v[218:219], v[98:99], v[218:219]
  v_pk_mul_f32 v[84:85], v[220:221], v[220:221]
  v_pk_mul_f32 v[86:87], v[222:223], v[222:223]
  v_pk_mul_f32 v[88:89], v[224:225], v[224:225]
  v_pk_mul_f32 v[90:91], v[226:227], v[226:227]
  v_pk_fma_f32 v[84:85], v[84:85], s[60:61], v[30:31]
  v_pk_fma_f32 v[86:87], v[86:87], s[60:61], v[30:31]
  v_pk_fma_f32 v[88:89], v[88:89], s[60:61], v[30:31]
  v_pk_fma_f32 v[90:91], v[90:91], s[60:61], v[30:31]
  v_pk_mul_f32 v[84:85], v[84:85], v[220:221]
  v_pk_mul_f32 v[86:87], v[86:87], v[222:223]
  v_pk_mul_f32 v[88:89], v[88:89], v[224:225]
  v_pk_mul_f32 v[90:91], v[90:91], v[226:227]
  v_exp_f32 v84, v84
  v_exp_f32 v85, v85
  v_exp_f32 v86, v86
  v_exp_f32 v87, v87
  v_exp_f32 v88, v88
  v_exp_f32 v89, v89
  v_exp_f32 v90, v90
  v_exp_f32 v91, v91
  v_pk_add_f32 v[84:85], v[84:85], 1.0 op_sel_hi:[1,0]
  v_pk_add_f32 v[86:87], v[86:87], 1.0 op_sel_hi:[1,0]
  v_pk_add_f32 v[88:89], v[88:89], 1.0 op_sel_hi:[1,0]
  v_pk_add_f32 v[90:91], v[90:91], 1.0 op_sel_hi:[1,0]
  v_rcp_f32 v84, v84
  v_rcp_f32 v85, v85
  v_rcp_f32 v86, v86
  v_rcp_f32 v87, v87
  v_rcp_f32 v88, v88
  v_rcp_f32 v89, v89
  v_rcp_f32 v90, v90
  v_rcp_f32 v91, v91
  v_pk_mul_f32 v[220:221], v[84:85], v[220:221]
  v_pk_mul_f32 v[222:223], v[86:87], v[222:223]
  v_pk_mul_f32 v[224:225], v[88:89], v[224:225]
  v_pk_mul_f32 v[226:227], v[90:91], v[226:227]
  v_pk_mul_f32 v[92:93], v[228:229], v[228:229]
  v_pk_mul_f32 v[94:95], v[230:231], v[230:231]
  v_pk_mul_f32 v[96:97], v[232:233], v[232:233]
  v_pk_mul_f32 v[98:99], v[234:235], v[234:235]
  v_pk_fma_f32 v[92:93], v[92:93], s[60:61], v[30:31]
  v_pk_fma_f32 v[94:95], v[94:95], s[60:61], v[30:31]
  v_pk_fma_f32 v[96:97], v[96:97], s[60:61], v[30:31]
  v_pk_fma_f32 v[98:99], v[98:99], s[60:61], v[30:31]
  v_pk_mul_f32 v[92:93], v[92:93], v[228:229]
  v_pk_mul_f32 v[94:95], v[94:95], v[230:231]
  v_pk_mul_f32 v[96:97], v[96:97], v[232:233]
  v_pk_mul_f32 v[98:99], v[98:99], v[234:235]
  v_exp_f32 v92, v92
  v_exp_f32 v93, v93
  v_exp_f32 v94, v94
  v_exp_f32 v95, v95
  v_exp_f32 v96, v96
  v_exp_f32 v97, v97
  v_exp_f32 v98, v98
  v_exp_f32 v99, v99
  v_pk_add_f32 v[92:93], v[92:93], 1.0 op_sel_hi:[1,0]
  v_pk_add_f32 v[94:95], v[94:95], 1.0 op_sel_hi:[1,0]
  v_pk_add_f32 v[96:97], v[96:97], 1.0 op_sel_hi:[1,0]
  v_pk_add_f32 v[98:99], v[98:99], 1.0 op_sel_hi:[1,0]
  v_rcp_f32 v92, v92
  v_rcp_f32 v93, v93
  v_rcp_f32 v94, v94
  v_rcp_f32 v95, v95
  v_rcp_f32 v96, v96
  v_rcp_f32 v97, v97
  v_rcp_f32 v98, v98
  v_rcp_f32 v99, v99
  v_pk_mul_f32 v[228:229], v[92:93], v[228:229]
  v_pk_mul_f32 v[230:231], v[94:95], v[230:231]
  v_pk_mul_f32 v[232:233], v[96:97], v[232:233]
  v_pk_mul_f32 v[234:235], v[98:99], v[234:235]
  v_pk_mul_f32 v[84:85], v[236:237], v[236:237]
  v_pk_mul_f32 v[86:87], v[238:239], v[238:239]
  v_pk_mul_f32 v[88:89], v[240:241], v[240:241]
  v_pk_mul_f32 v[90:91], v[242:243], v[242:243]
  v_pk_fma_f32 v[84:85], v[84:85], s[60:61], v[30:31]
  v_pk_fma_f32 v[86:87], v[86:87], s[60:61], v[30:31]
  v_pk_fma_f32 v[88:89], v[88:89], s[60:61], v[30:31]
  v_pk_fma_f32 v[90:91], v[90:91], s[60:61], v[30:31]
  v_pk_mul_f32 v[84:85], v[84:85], v[236:237]
  v_pk_mul_f32 v[86:87], v[86:87], v[238:239]
  v_pk_mul_f32 v[88:89], v[88:89], v[240:241]
  v_pk_mul_f32 v[90:91], v[90:91], v[242:243]
  v_exp_f32 v84, v84
  v_exp_f32 v85, v85
  v_exp_f32 v86, v86
  v_exp_f32 v87, v87
  v_exp_f32 v88, v88
  v_exp_f32 v89, v89
  v_exp_f32 v90, v90
  v_exp_f32 v91, v91
  v_pk_add_f32 v[84:85], v[84:85], 1.0 op_sel_hi:[1,0]
  v_pk_add_f32 v[86:87], v[86:87], 1.0 op_sel_hi:[1,0]
  v_pk_add_f32 v[88:89], v[88:89], 1.0 op_sel_hi:[1,0]
  v_pk_add_f32 v[90:91], v[90:91], 1.0 op_sel_hi:[1,0]
  v_rcp_f32 v84, v84
  v_rcp_f32 v85, v85
  v_rcp_f32 v86, v86
  v_rcp_f32 v87, v87
  v_rcp_f32 v88, v88
  v_rcp_f32 v89, v89
  v_rcp_f32 v90, v90
  v_rcp_f32 v91, v91
  v_pk_mul_f32 v[236:237], v[84:85], v[236:237]
  v_pk_mul_f32 v[238:239], v[86:87], v[238:239]
  v_pk_mul_f32 v[240:241], v[88:89], v[240:241]
  v_pk_mul_f32 v[242:243], v[90:91], v[242:243]
  s_setprio 2
  ds_read_b128 v[68:71], v21 offset:0
  ds_read_b128 v[72:75], v21 offset:2048
  ds_read_b128 v[76:79], v22 offset:0
  ds_read_b128 v[80:83], v22 offset:2048
  s_waitcnt vmcnt(6)
  s_barrier
  ds_read_b128 v[32:35], v19 offset:32768
  ds_read_b128 v[36:39], v19 offset:33792
  ds_read_b128 v[40:43], v19 offset:34816
  ds_read_b128 v[44:47], v19 offset:35840
  ds_read_b128 v[48:51], v19 offset:36864
  ds_read_b128 v[52:55], v19 offset:37888
  ds_read_b128 v[56:59], v19 offset:38912
  ds_read_b128 v[60:63], v19 offset:39936
  ds_read_b128 v[64:67], v19 offset:40960
  s_waitcnt vmcnt(4)
  s_barrier
  s_waitcnt lgkmcnt(8)
  v_mfma_f32_16x16x32_bf16 v[100:103], v[32:35], v[68:71], v[100:103]
  s_add_u32 s24, s35, 2
  s_cmp_ge_u32 s24, 8
  s_cselect_b32 s29, 7, 0
  v_mfma_f32_16x16x32_bf16 v[104:107], v[32:35], v[72:75], v[104:107]
  s_sub_u32 s24, s24, s29
  s_xor_b32 s24, s24, s21
  s_waitcnt lgkmcnt(6)
  v_mfma_f32_16x16x32_bf16 v[108:111], v[36:39], v[68:71], v[108:111]
  ds_read_b128 v[32:35], v19 offset:0
  v_mfma_f32_16x16x32_bf16 v[112:115], v[36:39], v[72:75], v[112:115]
  s_mul_i32 s24, s24, 589824
  s_mov_b32 m0, s69
  ds_read_b128 v[36:39], v19 offset:1024
  v_mfma_f32_16x16x32_bf16 v[116:119], v[40:43], v[68:71], v[116:119]
  buffer_load_dwordx4 v9, s[12:15], s24 offen sc1 lds
  v_mfma_f32_16x16x32_bf16 v[120:123], v[40:43], v[72:75], v[120:123]
  ds_read_b128 v[40:43], v19 offset:2048
  s_waitcnt lgkmcnt(7)
  v_mfma_f32_16x16x32_bf16 v[124:127], v[44:47], v[68:71], v[124:127]
  buffer_load_dwordx4 v9, s[12:15], s24 offen offset:1024 sc1 lds
  v_mfma_f32_16x16x32_bf16 v[128:131], v[44:47], v[72:75], v[128:131]
  s_mov_b32 m0, s72
  ds_read_b128 v[44:47], v19 offset:3072
  v_mfma_f32_16x16x32_bf16 v[132:135], v[48:51], v[68:71], v[132:135]
  buffer_load_dwordx4 v10, s[12:15], s24 offen sc1 lds
  v_mfma_f32_16x16x32_bf16 v[136:139], v[48:51], v[72:75], v[136:139]
  ds_read_b128 v[48:51], v19 offset:4096
  s_waitcnt lgkmcnt(7)
  v_mfma_f32_16x16x32_bf16 v[140:143], v[52:55], v[68:71], v[140:143]
  s_add_u32 s24, s24, s38
  s_add_u32 s25, s35, 2
  s_cmp_ge_u32 s25, 8
  s_cselect_b32 s44, 7, 0
  v_mfma_f32_16x16x32_bf16 v[144:147], v[52:55], v[72:75], v[144:147]
  ds_read_b128 v[52:55], v19 offset:5120
  s_sub_u32 s25, s25, s44
  v_mfma_f32_16x16x32_bf16 v[148:151], v[56:59], v[68:71], v[148:151]
  s_xor_b32 s25, s25, s21
  s_lshl_b32 s25, s25, 8
  s_mov_b32 m0, s73
  v_mfma_f32_16x16x32_bf16 v[152:155], v[56:59], v[72:75], v[152:155]
  ds_read_b128 v[56:59], v19 offset:6144
  s_waitcnt lgkmcnt(7)
  v_mfma_f32_16x16x32_bf16 v[156:159], v[60:63], v[68:71], v[156:159]
  buffer_load_dwordx4 v12, s[52:55], s25 offen offset:0 lds
  v_mfma_f32_16x16x32_bf16 v[160:163], v[60:63], v[72:75], v[160:163]
  ds_read_b128 v[60:63], v19 offset:7168
  v_mfma_f32_16x16x32_bf16 v[164:167], v[64:67], v[68:71], v[164:167]
  buffer_load_dwordx4 v13, s[52:55], s25 offen offset:1024 lds
  v_mfma_f32_16x16x32_bf16 v[168:171], v[64:67], v[72:75], v[168:171]
  ds_read_b128 v[64:67], v19 offset:41984
  s_waitcnt vmcnt(7)
  s_barrier
  s_waitcnt lgkmcnt(8)
  v_mfma_f32_16x16x32_bf16 v[100:103], v[32:35], v[76:79], v[100:103]
  s_mov_b32 m0, s70
  v_mfma_f32_16x16x32_bf16 v[104:107], v[32:35], v[80:83], v[104:107]
  ds_read_b128 v[32:35], v19 offset:8192
  s_waitcnt lgkmcnt(7)
  v_mfma_f32_16x16x32_bf16 v[108:111], v[36:39], v[76:79], v[108:111]
  buffer_load_dwordx4 v9, s[12:15], s24 offen sc1 lds
  v_mfma_f32_16x16x32_bf16 v[112:115], v[36:39], v[80:83], v[112:115]
  buffer_load_dwordx4 v9, s[12:15], s24 offen offset:1024 sc1 lds
  v_mfma_f32_16x16x32_bf16 v[116:119], v[40:43], v[76:79], v[116:119]
  ds_read_b128 v[36:39], v19 offset:9216
  s_add_u32 s24, s24, s38
  v_mfma_f32_16x16x32_bf16 v[120:123], v[40:43], v[80:83], v[120:123]
  s_waitcnt lgkmcnt(6)
  v_mfma_f32_16x16x32_bf16 v[124:127], v[44:47], v[76:79], v[124:127]
  ds_read_b128 v[40:43], v19 offset:10240
  ds_read_b128 v[84:87], v21 offset:16384
  v_mfma_f32_16x16x32_bf16 v[128:131], v[44:47], v[80:83], v[128:131]
  ds_read_b128 v[88:91], v21 offset:18432
  v_mfma_f32_16x16x32_bf16 v[132:135], v[48:51], v[76:79], v[132:135]
  ds_read_b128 v[44:47], v19 offset:11264
  v_mfma_f32_16x16x32_bf16 v[136:139], v[48:51], v[80:83], v[136:139]
  ds_read_b128 v[48:51], v19 offset:12288
  s_waitcnt lgkmcnt(9)
  v_mfma_f32_16x16x32_bf16 v[140:143], v[52:55], v[76:79], v[140:143]
  ds_read_b128 v[92:95], v22 offset:16384
  v_mfma_f32_16x16x32_bf16 v[144:147], v[52:55], v[80:83], v[144:147]
  ds_read_b128 v[52:55], v19 offset:13312
  ds_read_b128 v[96:99], v22 offset:18432
  v_mfma_f32_16x16x32_bf16 v[148:151], v[56:59], v[76:79], v[148:151]
  s_mov_b32 m0, s73
  v_mfma_f32_16x16x32_bf16 v[152:155], v[56:59], v[80:83], v[152:155]
  ds_read_b128 v[56:59], v19 offset:14336
  s_waitcnt lgkmcnt(11)
  v_mfma_f32_16x16x32_bf16 v[156:159], v[60:63], v[76:79], v[156:159]
  buffer_load_dwordx4 v14, s[52:55], s25 offen offset:2048 lds
  v_mfma_f32_16x16x32_bf16 v[160:163], v[60:63], v[80:83], v[160:163]
  ds_read_b128 v[60:63], v19 offset:15360
  v_mfma_f32_16x16x32_bf16 v[164:167], v[64:67], v[76:79], v[164:167]
  buffer_load_dwordx4 v15, s[52:55], s25 offen offset:3072 lds
  v_mfma_f32_16x16x32_bf16 v[168:171], v[64:67], v[80:83], v[168:171]
  ds_read_b128 v[64:67], v19 offset:43008
  s_waitcnt vmcnt(9)
  s_barrier
  s_waitcnt lgkmcnt(12)
  s_waitcnt lgkmcnt(3)
  v_mfma_f32_16x16x32_bf16 v[100:103], v[32:35], v[84:87], v[100:103]
  s_mov_b32 m0, s66
  v_mfma_f32_16x16x32_bf16 v[104:107], v[32:35], v[88:91], v[104:107]
  ds_read_b128 v[32:35], v19 offset:16384
  v_mfma_f32_16x16x32_bf16 v[108:111], v[36:39], v[84:87], v[108:111]
  buffer_load_dwordx4 v9, s[12:15], s24 offen sc1 lds
  v_mfma_f32_16x16x32_bf16 v[112:115], v[36:39], v[88:91], v[112:115]
  buffer_load_dwordx4 v9, s[12:15], s24 offen offset:1024 sc1 lds
  v_mfma_f32_16x16x32_bf16 v[116:119], v[40:43], v[84:87], v[116:119]
  ds_read_b128 v[36:39], v19 offset:17408
  s_add_u32 s24, s24, s38
  v_mfma_f32_16x16x32_bf16 v[120:123], v[40:43], v[88:91], v[120:123]
  s_addk_i32 s25, 128
  s_mov_b32 m0, s63
  v_mfma_f32_16x16x32_bf16 v[124:127], v[44:47], v[84:87], v[124:127]
  ds_read_b128 v[40:43], v19 offset:18432
  v_mfma_f32_16x16x32_bf16 v[128:131], v[44:47], v[88:91], v[128:131]
  buffer_load_dwordx4 v12, s[52:55], s25 offen offset:0 lds
  v_mfma_f32_16x16x32_bf16 v[132:135], v[48:51], v[84:87], v[132:135]
  ds_read_b128 v[44:47], v19 offset:19456
  v_mfma_f32_16x16x32_bf16 v[136:139], v[48:51], v[88:91], v[136:139]
  ds_read_b128 v[48:51], v19 offset:20480
  s_waitcnt lgkmcnt(7)
  v_mfma_f32_16x16x32_bf16 v[140:143], v[52:55], v[84:87], v[140:143]
  buffer_load_dwordx4 v13, s[52:55], s25 offen offset:1024 lds
  v_mfma_f32_16x16x32_bf16 v[144:147], v[52:55], v[88:91], v[144:147]
  ds_read_b128 v[52:55], v19 offset:21504
  v_mfma_f32_16x16x32_bf16 v[148:151], v[56:59], v[84:87], v[148:151]
  v_mfma_f32_16x16x32_bf16 v[152:155], v[56:59], v[88:91], v[152:155]
  ds_read_b128 v[56:59], v19 offset:22528
  s_waitcnt lgkmcnt(7)
  v_mfma_f32_16x16x32_bf16 v[156:159], v[60:63], v[84:87], v[156:159]
  v_mfma_f32_16x16x32_bf16 v[160:163], v[60:63], v[88:91], v[160:163]
  ds_read_b128 v[60:63], v19 offset:23552
  v_mfma_f32_16x16x32_bf16 v[164:167], v[64:67], v[84:87], v[164:167]
  v_mfma_f32_16x16x32_bf16 v[168:171], v[64:67], v[88:91], v[168:171]
  ds_read_b128 v[64:67], v19 offset:44032
  s_waitcnt vmcnt(10)
  s_barrier
  s_waitcnt lgkmcnt(8)
  v_mfma_f32_16x16x32_bf16 v[100:103], v[32:35], v[92:95], v[100:103]
  s_mov_b32 m0, s67
  v_mfma_f32_16x16x32_bf16 v[104:107], v[32:35], v[96:99], v[104:107]
  ds_read_b128 v[32:35], v19 offset:24576
  s_waitcnt lgkmcnt(7)
  v_mfma_f32_16x16x32_bf16 v[108:111], v[36:39], v[92:95], v[108:111]
  buffer_load_dwordx4 v9, s[12:15], s24 offen sc1 lds
  v_mfma_f32_16x16x32_bf16 v[112:115], v[36:39], v[96:99], v[112:115]
  buffer_load_dwordx4 v9, s[12:15], s24 offen offset:1024 sc1 lds
  v_mfma_f32_16x16x32_bf16 v[116:119], v[40:43], v[92:95], v[116:119]
  ds_read_b128 v[36:39], v19 offset:25600
  s_waitcnt vmcnt(6)
  v_mfma_f32_16x16x32_bf16 v[120:123], v[40:43], v[96:99], v[120:123]
  ds_read_b128 v[68:71], v21 offset:0
  s_waitcnt lgkmcnt(7)
  v_mfma_f32_16x16x32_bf16 v[124:127], v[44:47], v[92:95], v[124:127]
  ds_read_b128 v[40:43], v19 offset:26624
  v_mfma_f32_16x16x32_bf16 v[128:131], v[44:47], v[96:99], v[128:131]
  ds_read_b128 v[72:75], v21 offset:2048
  v_mfma_f32_16x16x32_bf16 v[132:135], v[48:51], v[92:95], v[132:135]
  ds_read_b128 v[44:47], v19 offset:27648
  ds_read_b128 v[76:79], v22 offset:0
  v_mfma_f32_16x16x32_bf16 v[136:139], v[48:51], v[96:99], v[136:139]
  ds_read_b128 v[48:51], v19 offset:28672
  s_waitcnt lgkmcnt(10)
  v_mfma_f32_16x16x32_bf16 v[140:143], v[52:55], v[92:95], v[140:143]
  ds_read_b128 v[80:83], v22 offset:2048
  s_mov_b32 m0, s63
  v_mfma_f32_16x16x32_bf16 v[144:147], v[52:55], v[96:99], v[144:147]
  ds_read_b128 v[52:55], v19 offset:29696
  v_mfma_f32_16x16x32_bf16 v[148:151], v[56:59], v[92:95], v[148:151]
  buffer_load_dwordx4 v14, s[52:55], s25 offen offset:2048 lds
  v_mfma_f32_16x16x32_bf16 v[152:155], v[56:59], v[96:99], v[152:155]
  ds_read_b128 v[56:59], v19 offset:30720
  s_waitcnt lgkmcnt(11)
  v_mfma_f32_16x16x32_bf16 v[156:159], v[60:63], v[92:95], v[156:159]
  buffer_load_dwordx4 v15, s[52:55], s25 offen offset:3072 lds
  v_mfma_f32_16x16x32_bf16 v[160:163], v[60:63], v[96:99], v[160:163]
  ds_read_b128 v[60:63], v19 offset:31744
  v_mfma_f32_16x16x32_bf16 v[164:167], v[64:67], v[92:95], v[164:167]
  v_mfma_f32_16x16x32_bf16 v[168:171], v[64:67], v[96:99], v[168:171]
  ds_read_b128 v[64:67], v19 offset:45056
  s_barrier
  s_waitcnt lgkmcnt(12)
  s_waitcnt lgkmcnt(4)
  v_mfma_f32_16x16x32_bf16 v[100:103], v[32:35], v[68:71], v[100:103]
  s_add_u32 s24, s35, 3
  s_cmp_ge_u32 s24, 8
  s_cselect_b32 s29, 7, 0
  v_mfma_f32_16x16x32_bf16 v[104:107], v[32:35], v[72:75], v[104:107]
  s_sub_u32 s24, s24, s29
  s_xor_b32 s24, s24, s21
  v_mfma_f32_16x16x32_bf16 v[108:111], v[36:39], v[68:71], v[108:111]
  ds_read_b128 v[32:35], v19 offset:32768
  v_mfma_f32_16x16x32_bf16 v[112:115], v[36:39], v[72:75], v[112:115]
  s_mul_i32 s24, s24, 589824
  s_mov_b32 m0, s68
  ds_read_b128 v[36:39], v19 offset:33792
  v_mfma_f32_16x16x32_bf16 v[116:119], v[40:43], v[68:71], v[116:119]
  buffer_load_dwordx4 v9, s[12:15], s24 offen sc1 lds
  v_mfma_f32_16x16x32_bf16 v[120:123], v[40:43], v[72:75], v[120:123]
  ds_read_b128 v[40:43], v19 offset:34816
  v_mfma_f32_16x16x32_bf16 v[124:127], v[44:47], v[68:71], v[124:127]
  buffer_load_dwordx4 v9, s[12:15], s24 offen offset:1024 sc1 lds
  v_mfma_f32_16x16x32_bf16 v[128:131], v[44:47], v[72:75], v[128:131]
  s_mov_b32 m0, s71
  ds_read_b128 v[44:47], v19 offset:35840
  v_mfma_f32_16x16x32_bf16 v[132:135], v[48:51], v[68:71], v[132:135]
  buffer_load_dwordx4 v10, s[12:15], s24 offen sc1 lds
  v_mfma_f32_16x16x32_bf16 v[136:139], v[48:51], v[72:75], v[136:139]
  ds_read_b128 v[48:51], v19 offset:36864
  s_waitcnt lgkmcnt(7)
  v_mfma_f32_16x16x32_bf16 v[140:143], v[52:55], v[68:71], v[140:143]
  s_add_u32 s24, s24, s38
  s_add_u32 s25, s35, 3
  s_cmp_ge_u32 s25, 8
  s_cselect_b32 s44, 7, 0
  v_mfma_f32_16x16x32_bf16 v[144:147], v[52:55], v[72:75], v[144:147]
  ds_read_b128 v[52:55], v19 offset:37888
  s_sub_u32 s25, s25, s44
  v_mfma_f32_16x16x32_bf16 v[148:151], v[56:59], v[68:71], v[148:151]
  s_xor_b32 s25, s25, s21
  s_lshl_b32 s25, s25, 8
  s_mov_b32 m0, s73
  v_mfma_f32_16x16x32_bf16 v[152:155], v[56:59], v[72:75], v[152:155]
  ds_read_b128 v[56:59], v19 offset:38912
  s_waitcnt lgkmcnt(7)
  v_mfma_f32_16x16x32_bf16 v[156:159], v[60:63], v[68:71], v[156:159]
  buffer_load_dwordx4 v12, s[52:55], s25 offen offset:0 lds
  v_mfma_f32_16x16x32_bf16 v[160:163], v[60:63], v[72:75], v[160:163]
  ds_read_b128 v[60:63], v19 offset:39936
  v_mfma_f32_16x16x32_bf16 v[164:167], v[64:67], v[68:71], v[164:167]
  buffer_load_dwordx4 v13, s[52:55], s25 offen offset:1024 lds
  v_mfma_f32_16x16x32_bf16 v[168:171], v[64:67], v[72:75], v[168:171]
  ds_read_b128 v[64:67], v19 offset:46080
  s_waitcnt vmcnt(11)
  s_barrier
  s_waitcnt lgkmcnt(8)
  v_mfma_f32_16x16x32_bf16 v[100:103], v[32:35], v[76:79], v[100:103]
  s_mov_b32 m0, s69
  v_mfma_f32_16x16x32_bf16 v[104:107], v[32:35], v[80:83], v[104:107]
  ds_read_b128 v[32:35], v19 offset:0
  s_waitcnt lgkmcnt(7)
  v_mfma_f32_16x16x32_bf16 v[108:111], v[36:39], v[76:79], v[108:111]
  buffer_load_dwordx4 v9, s[12:15], s24 offen sc1 lds
  v_mfma_f32_16x16x32_bf16 v[112:115], v[36:39], v[80:83], v[112:115]
  buffer_load_dwordx4 v9, s[12:15], s24 offen offset:1024 sc1 lds
  v_mfma_f32_16x16x32_bf16 v[116:119], v[40:43], v[76:79], v[116:119]
  ds_read_b128 v[36:39], v19 offset:1024
  s_add_u32 s24, s24, s38
  v_mfma_f32_16x16x32_bf16 v[120:123], v[40:43], v[80:83], v[120:123]
  s_waitcnt vmcnt(7)
  s_waitcnt lgkmcnt(6)
  v_mfma_f32_16x16x32_bf16 v[124:127], v[44:47], v[76:79], v[124:127]
  ds_read_b128 v[40:43], v19 offset:2048
  ds_read_b128 v[84:87], v21 offset:16384
  v_mfma_f32_16x16x32_bf16 v[128:131], v[44:47], v[80:83], v[128:131]
  ds_read_b128 v[88:91], v21 offset:18432
  v_mfma_f32_16x16x32_bf16 v[132:135], v[48:51], v[76:79], v[132:135]
  ds_read_b128 v[44:47], v19 offset:3072
  v_mfma_f32_16x16x32_bf16 v[136:139], v[48:51], v[80:83], v[136:139]
  ds_read_b128 v[48:51], v19 offset:4096
  s_waitcnt lgkmcnt(9)
  v_mfma_f32_16x16x32_bf16 v[140:143], v[52:55], v[76:79], v[140:143]
  ds_read_b128 v[92:95], v22 offset:16384
  v_mfma_f32_16x16x32_bf16 v[144:147], v[52:55], v[80:83], v[144:147]
  ds_read_b128 v[52:55], v19 offset:5120
  ds_read_b128 v[96:99], v22 offset:18432
  v_mfma_f32_16x16x32_bf16 v[148:151], v[56:59], v[76:79], v[148:151]
  s_mov_b32 m0, s73
  v_mfma_f32_16x16x32_bf16 v[152:155], v[56:59], v[80:83], v[152:155]
  ds_read_b128 v[56:59], v19 offset:6144
  s_waitcnt lgkmcnt(11)
  v_mfma_f32_16x16x32_bf16 v[156:159], v[60:63], v[76:79], v[156:159]
  buffer_load_dwordx4 v14, s[52:55], s25 offen offset:2048 lds
  v_mfma_f32_16x16x32_bf16 v[160:163], v[60:63], v[80:83], v[160:163]
  ds_read_b128 v[60:63], v19 offset:7168
  v_mfma_f32_16x16x32_bf16 v[164:167], v[64:67], v[76:79], v[164:167]
  buffer_load_dwordx4 v15, s[52:55], s25 offen offset:3072 lds
  v_mfma_f32_16x16x32_bf16 v[168:171], v[64:67], v[80:83], v[168:171]
  ds_read_b128 v[64:67], v19 offset:47104
  s_barrier
  buffer_load_dword v26, v23, s[12:15], s49 offen sc0 sc1
  s_waitcnt lgkmcnt(12)
  s_waitcnt lgkmcnt(3)
  v_mfma_f32_16x16x32_bf16 v[100:103], v[32:35], v[84:87], v[100:103]
  s_mov_b32 m0, s70
  v_mfma_f32_16x16x32_bf16 v[104:107], v[32:35], v[88:91], v[104:107]
  ds_read_b128 v[32:35], v19 offset:8192
  v_mfma_f32_16x16x32_bf16 v[108:111], v[36:39], v[84:87], v[108:111]
  buffer_load_dwordx4 v9, s[12:15], s24 offen sc1 lds
  v_mfma_f32_16x16x32_bf16 v[112:115], v[36:39], v[88:91], v[112:115]
  buffer_load_dwordx4 v9, s[12:15], s24 offen offset:1024 sc1 lds
  v_mfma_f32_16x16x32_bf16 v[116:119], v[40:43], v[84:87], v[116:119]
  ds_read_b128 v[36:39], v19 offset:9216
  s_add_u32 s24, s24, s38
  v_mfma_f32_16x16x32_bf16 v[120:123], v[40:43], v[88:91], v[120:123]
  s_addk_i32 s25, 128
  s_mov_b32 m0, s63
  v_mfma_f32_16x16x32_bf16 v[124:127], v[44:47], v[84:87], v[124:127]
  ds_read_b128 v[40:43], v19 offset:10240
  v_mfma_f32_16x16x32_bf16 v[128:131], v[44:47], v[88:91], v[128:131]
  buffer_load_dwordx4 v12, s[52:55], s25 offen offset:0 lds
  v_mfma_f32_16x16x32_bf16 v[132:135], v[48:51], v[84:87], v[132:135]
  ds_read_b128 v[44:47], v19 offset:11264
  v_mfma_f32_16x16x32_bf16 v[136:139], v[48:51], v[88:91], v[136:139]
  ds_read_b128 v[48:51], v19 offset:12288
  s_waitcnt lgkmcnt(7)
  v_mfma_f32_16x16x32_bf16 v[140:143], v[52:55], v[84:87], v[140:143]
  buffer_load_dwordx4 v13, s[52:55], s25 offen offset:1024 lds
  v_mfma_f32_16x16x32_bf16 v[144:147], v[52:55], v[88:91], v[144:147]
  ds_read_b128 v[52:55], v19 offset:13312
  v_mfma_f32_16x16x32_bf16 v[148:151], v[56:59], v[84:87], v[148:151]
  v_mfma_f32_16x16x32_bf16 v[152:155], v[56:59], v[88:91], v[152:155]
  ds_read_b128 v[56:59], v19 offset:14336
  s_waitcnt lgkmcnt(7)
  v_mfma_f32_16x16x32_bf16 v[156:159], v[60:63], v[84:87], v[156:159]
  v_mfma_f32_16x16x32_bf16 v[160:163], v[60:63], v[88:91], v[160:163]
  ds_read_b128 v[60:63], v19 offset:15360
  v_mfma_f32_16x16x32_bf16 v[164:167], v[64:67], v[84:87], v[164:167]
  v_mfma_f32_16x16x32_bf16 v[168:171], v[64:67], v[88:91], v[168:171]
  ds_read_b128 v[64:67], v19 offset:48128
  s_waitcnt vmcnt(11)
  s_barrier
  s_waitcnt lgkmcnt(8)
  v_mfma_f32_16x16x32_bf16 v[100:103], v[32:35], v[92:95], v[100:103]
  s_mov_b32 m0, s66
  v_mfma_f32_16x16x32_bf16 v[104:107], v[32:35], v[96:99], v[104:107]
  ds_read_b128 v[32:35], v19 offset:16384
  s_waitcnt lgkmcnt(7)
  v_mfma_f32_16x16x32_bf16 v[108:111], v[36:39], v[92:95], v[108:111]
  buffer_load_dwordx4 v9, s[12:15], s24 offen sc1 lds
  v_mfma_f32_16x16x32_bf16 v[112:115], v[36:39], v[96:99], v[112:115]
  buffer_load_dwordx4 v9, s[12:15], s24 offen offset:1024 sc1 lds
  v_mfma_f32_16x16x32_bf16 v[116:119], v[40:43], v[92:95], v[116:119]
  ds_read_b128 v[36:39], v19 offset:17408
  s_waitcnt vmcnt(7)
  v_mfma_f32_16x16x32_bf16 v[120:123], v[40:43], v[96:99], v[120:123]
  ds_read_b128 v[68:71], v21 offset:0
  s_waitcnt lgkmcnt(7)
  v_mfma_f32_16x16x32_bf16 v[124:127], v[44:47], v[92:95], v[124:127]
  ds_read_b128 v[40:43], v19 offset:18432
  v_mfma_f32_16x16x32_bf16 v[128:131], v[44:47], v[96:99], v[128:131]
  ds_read_b128 v[72:75], v21 offset:2048
  v_mfma_f32_16x16x32_bf16 v[132:135], v[48:51], v[92:95], v[132:135]
  ds_read_b128 v[44:47], v19 offset:19456
  ds_read_b128 v[76:79], v22 offset:0
  v_mfma_f32_16x16x32_bf16 v[136:139], v[48:51], v[96:99], v[136:139]
  ds_read_b128 v[48:51], v19 offset:20480
  s_waitcnt lgkmcnt(10)
  v_mfma_f32_16x16x32_bf16 v[140:143], v[52:55], v[92:95], v[140:143]
  ds_read_b128 v[80:83], v22 offset:2048
  s_mov_b32 m0, s63
  v_mfma_f32_16x16x32_bf16 v[144:147], v[52:55], v[96:99], v[144:147]
  ds_read_b128 v[52:55], v19 offset:21504
  v_mfma_f32_16x16x32_bf16 v[148:151], v[56:59], v[92:95], v[148:151]
  buffer_load_dwordx4 v14, s[52:55], s25 offen offset:2048 lds
  v_mfma_f32_16x16x32_bf16 v[152:155], v[56:59], v[96:99], v[152:155]
  ds_read_b128 v[56:59], v19 offset:22528
  s_waitcnt lgkmcnt(11)
  v_mfma_f32_16x16x32_bf16 v[156:159], v[60:63], v[92:95], v[156:159]
  buffer_load_dwordx4 v15, s[52:55], s25 offen offset:3072 lds
  v_mfma_f32_16x16x32_bf16 v[160:163], v[60:63], v[96:99], v[160:163]
  ds_read_b128 v[60:63], v19 offset:23552
  v_mfma_f32_16x16x32_bf16 v[164:167], v[64:67], v[92:95], v[164:167]
  v_mfma_f32_16x16x32_bf16 v[168:171], v[64:67], v[96:99], v[168:171]
  ds_read_b128 v[64:67], v19 offset:40960
  s_barrier
  s_waitcnt lgkmcnt(12)
  s_waitcnt lgkmcnt(4)
  v_mfma_f32_16x16x32_bf16 v[100:103], v[32:35], v[68:71], v[100:103]
  s_add_u32 s24, s35, 4
  s_cmp_ge_u32 s24, 8
  s_cselect_b32 s29, 7, 0
  v_mfma_f32_16x16x32_bf16 v[104:107], v[32:35], v[72:75], v[104:107]
  s_sub_u32 s24, s24, s29
  s_xor_b32 s24, s24, s21
  v_mfma_f32_16x16x32_bf16 v[108:111], v[36:39], v[68:71], v[108:111]
  ds_read_b128 v[32:35], v19 offset:24576
  v_mfma_f32_16x16x32_bf16 v[112:115], v[36:39], v[72:75], v[112:115]
  s_mul_i32 s24, s24, 589824
  s_mov_b32 m0, s67
  ds_read_b128 v[36:39], v19 offset:25600
  v_mfma_f32_16x16x32_bf16 v[116:119], v[40:43], v[68:71], v[116:119]
  buffer_load_dwordx4 v9, s[12:15], s24 offen sc1 lds
  v_mfma_f32_16x16x32_bf16 v[120:123], v[40:43], v[72:75], v[120:123]
  ds_read_b128 v[40:43], v19 offset:26624
  v_mfma_f32_16x16x32_bf16 v[124:127], v[44:47], v[68:71], v[124:127]
  buffer_load_dwordx4 v9, s[12:15], s24 offen offset:1024 sc1 lds
  v_mfma_f32_16x16x32_bf16 v[128:131], v[44:47], v[72:75], v[128:131]
  s_mov_b32 m0, s72
  ds_read_b128 v[44:47], v19 offset:27648
  v_mfma_f32_16x16x32_bf16 v[132:135], v[48:51], v[68:71], v[132:135]
  buffer_load_dwordx4 v10, s[12:15], s24 offen sc1 lds
  v_mfma_f32_16x16x32_bf16 v[136:139], v[48:51], v[72:75], v[136:139]
  ds_read_b128 v[48:51], v19 offset:28672
  s_waitcnt lgkmcnt(7)
  v_mfma_f32_16x16x32_bf16 v[140:143], v[52:55], v[68:71], v[140:143]
  s_add_u32 s24, s24, s38
  s_add_u32 s25, s35, 4
  s_cmp_ge_u32 s25, 8
  s_cselect_b32 s44, 7, 0
  v_mfma_f32_16x16x32_bf16 v[144:147], v[52:55], v[72:75], v[144:147]
  ds_read_b128 v[52:55], v19 offset:29696
  s_sub_u32 s25, s25, s44
  v_mfma_f32_16x16x32_bf16 v[148:151], v[56:59], v[68:71], v[148:151]
  s_xor_b32 s25, s25, s21
  s_lshl_b32 s25, s25, 8
  s_mov_b32 m0, s73
  v_mfma_f32_16x16x32_bf16 v[152:155], v[56:59], v[72:75], v[152:155]
  ds_read_b128 v[56:59], v19 offset:30720
  s_waitcnt lgkmcnt(7)
  v_mfma_f32_16x16x32_bf16 v[156:159], v[60:63], v[68:71], v[156:159]
  buffer_load_dwordx4 v12, s[52:55], s25 offen offset:0 lds
  v_mfma_f32_16x16x32_bf16 v[160:163], v[60:63], v[72:75], v[160:163]
  ds_read_b128 v[60:63], v19 offset:31744
  v_mfma_f32_16x16x32_bf16 v[164:167], v[64:67], v[68:71], v[164:167]
  buffer_load_dwordx4 v13, s[52:55], s25 offen offset:1024 lds
  v_mfma_f32_16x16x32_bf16 v[168:171], v[64:67], v[72:75], v[168:171]
  ds_read_b128 v[64:67], v19 offset:41984
  s_waitcnt vmcnt(11)
  s_barrier
  s_waitcnt lgkmcnt(8)
  v_mfma_f32_16x16x32_bf16 v[100:103], v[32:35], v[76:79], v[100:103]
  s_mov_b32 m0, s68
  v_mfma_f32_16x16x32_bf16 v[104:107], v[32:35], v[80:83], v[104:107]
  ds_read_b128 v[32:35], v19 offset:32768
  s_waitcnt lgkmcnt(7)
  v_mfma_f32_16x16x32_bf16 v[108:111], v[36:39], v[76:79], v[108:111]
  buffer_load_dwordx4 v9, s[12:15], s24 offen sc1 lds
  v_mfma_f32_16x16x32_bf16 v[112:115], v[36:39], v[80:83], v[112:115]
  buffer_load_dwordx4 v9, s[12:15], s24 offen offset:1024 sc1 lds
  v_mfma_f32_16x16x32_bf16 v[116:119], v[40:43], v[76:79], v[116:119]
  ds_read_b128 v[36:39], v19 offset:33792
  s_add_u32 s24, s24, s38
  v_mfma_f32_16x16x32_bf16 v[120:123], v[40:43], v[80:83], v[120:123]
  s_waitcnt vmcnt(7)
  s_waitcnt lgkmcnt(6)
  v_mfma_f32_16x16x32_bf16 v[124:127], v[44:47], v[76:79], v[124:127]
  ds_read_b128 v[40:43], v19 offset:34816
  ds_read_b128 v[84:87], v21 offset:16384
  v_mfma_f32_16x16x32_bf16 v[128:131], v[44:47], v[80:83], v[128:131]
  ds_read_b128 v[88:91], v21 offset:18432
  v_mfma_f32_16x16x32_bf16 v[132:135], v[48:51], v[76:79], v[132:135]
  ds_read_b128 v[44:47], v19 offset:35840
  v_mfma_f32_16x16x32_bf16 v[136:139], v[48:51], v[80:83], v[136:139]
  ds_read_b128 v[48:51], v19 offset:36864
  s_waitcnt lgkmcnt(9)
  v_mfma_f32_16x16x32_bf16 v[140:143], v[52:55], v[76:79], v[140:143]
  ds_read_b128 v[92:95], v22 offset:16384
  v_mfma_f32_16x16x32_bf16 v[144:147], v[52:55], v[80:83], v[144:147]
  ds_read_b128 v[52:55], v19 offset:37888
  ds_read_b128 v[96:99], v22 offset:18432
  v_mfma_f32_16x16x32_bf16 v[148:151], v[56:59], v[76:79], v[148:151]
  s_mov_b32 m0, s73
  v_mfma_f32_16x16x32_bf16 v[152:155], v[56:59], v[80:83], v[152:155]
  ds_read_b128 v[56:59], v19 offset:38912
  s_waitcnt lgkmcnt(11)
  v_mfma_f32_16x16x32_bf16 v[156:159], v[60:63], v[76:79], v[156:159]
  buffer_load_dwordx4 v14, s[52:55], s25 offen offset:2048 lds
  v_mfma_f32_16x16x32_bf16 v[160:163], v[60:63], v[80:83], v[160:163]
  ds_read_b128 v[60:63], v19 offset:39936
  v_mfma_f32_16x16x32_bf16 v[164:167], v[64:67], v[76:79], v[164:167]
  buffer_load_dwordx4 v15, s[52:55], s25 offen offset:3072 lds
  v_mfma_f32_16x16x32_bf16 v[168:171], v[64:67], v[80:83], v[168:171]
  ds_read_b128 v[64:67], v19 offset:43008
  s_barrier
  s_waitcnt lgkmcnt(12)
  s_waitcnt lgkmcnt(3)
  v_mfma_f32_16x16x32_bf16 v[100:103], v[32:35], v[84:87], v[100:103]
  s_mov_b32 m0, s69
  v_mfma_f32_16x16x32_bf16 v[104:107], v[32:35], v[88:91], v[104:107]
  ds_read_b128 v[32:35], v19 offset:0
  v_mfma_f32_16x16x32_bf16 v[108:111], v[36:39], v[84:87], v[108:111]
  buffer_load_dwordx4 v9, s[12:15], s24 offen sc1 lds
  v_mfma_f32_16x16x32_bf16 v[112:115], v[36:39], v[88:91], v[112:115]
  buffer_load_dwordx4 v9, s[12:15], s24 offen offset:1024 sc1 lds
  v_mfma_f32_16x16x32_bf16 v[116:119], v[40:43], v[84:87], v[116:119]
  ds_read_b128 v[36:39], v19 offset:1024
  s_add_u32 s24, s24, s38
  v_mfma_f32_16x16x32_bf16 v[120:123], v[40:43], v[88:91], v[120:123]
  s_addk_i32 s25, 128
  s_mov_b32 m0, s63
  v_mfma_f32_16x16x32_bf16 v[124:127], v[44:47], v[84:87], v[124:127]
  ds_read_b128 v[40:43], v19 offset:2048
  v_mfma_f32_16x16x32_bf16 v[128:131], v[44:47], v[88:91], v[128:131]
  buffer_load_dwordx4 v12, s[52:55], s25 offen offset:0 lds
  v_mfma_f32_16x16x32_bf16 v[132:135], v[48:51], v[84:87], v[132:135]
  ds_read_b128 v[44:47], v19 offset:3072
  v_mfma_f32_16x16x32_bf16 v[136:139], v[48:51], v[88:91], v[136:139]
  ds_read_b128 v[48:51], v19 offset:4096
  s_waitcnt lgkmcnt(7)
  v_mfma_f32_16x16x32_bf16 v[140:143], v[52:55], v[84:87], v[140:143]
  buffer_load_dwordx4 v13, s[52:55], s25 offen offset:1024 lds
  v_mfma_f32_16x16x32_bf16 v[144:147], v[52:55], v[88:91], v[144:147]
  ds_read_b128 v[52:55], v19 offset:5120
  v_mfma_f32_16x16x32_bf16 v[148:151], v[56:59], v[84:87], v[148:151]
  v_mfma_f32_16x16x32_bf16 v[152:155], v[56:59], v[88:91], v[152:155]
  ds_read_b128 v[56:59], v19 offset:6144
  s_waitcnt lgkmcnt(7)
  v_mfma_f32_16x16x32_bf16 v[156:159], v[60:63], v[84:87], v[156:159]
  v_mfma_f32_16x16x32_bf16 v[160:163], v[60:63], v[88:91], v[160:163]
  ds_read_b128 v[60:63], v19 offset:7168
  v_mfma_f32_16x16x32_bf16 v[164:167], v[64:67], v[84:87], v[164:167]
  v_mfma_f32_16x16x32_bf16 v[168:171], v[64:67], v[88:91], v[168:171]
  ds_read_b128 v[64:67], v19 offset:44032
  s_waitcnt vmcnt(10)
  s_barrier
  s_mov_b32 s51, 300000
  s_branch POLLC_19
POLL_18:
  buffer_load_dword v26, v23, s[12:15], s49 offen sc0 sc1
  s_waitcnt vmcnt(0)
POLLC_19:
  v_xor_b32 v27, s62, v26
  v_cmp_ne_u32 vcc, 0, v27
  s_nop 4
  s_cbranch_vccz POLLOK_20
  s_sleep 1
  s_sub_u32 s51, s51, 1
  s_cmp_lg_u32 s51, 0
  s_cbranch_scc1 POLL_18
POLLOK_20:
  s_waitcnt lgkmcnt(8)
  v_mfma_f32_16x16x32_bf16 v[100:103], v[32:35], v[92:95], v[100:103]
  s_mov_b32 m0, s70
  v_mfma_f32_16x16x32_bf16 v[104:107], v[32:35], v[96:99], v[104:107]
  ds_read_b128 v[32:35], v19 offset:8192
  s_waitcnt lgkmcnt(7)
  v_mfma_f32_16x16x32_bf16 v[108:111], v[36:39], v[92:95], v[108:111]
  buffer_load_dwordx4 v9, s[12:15], s24 offen sc1 lds
  v_mfma_f32_16x16x32_bf16 v[112:115], v[36:39], v[96:99], v[112:115]
  buffer_load_dwordx4 v9, s[12:15], s24 offen offset:1024 sc1 lds
  v_mfma_f32_16x16x32_bf16 v[116:119], v[40:43], v[92:95], v[116:119]
  ds_read_b128 v[36:39], v19 offset:9216
  s_waitcnt vmcnt(6)
  v_mfma_f32_16x16x32_bf16 v[120:123], v[40:43], v[96:99], v[120:123]
  ds_read_b128 v[68:71], v21 offset:0
  s_waitcnt lgkmcnt(7)
  v_mfma_f32_16x16x32_bf16 v[124:127], v[44:47], v[92:95], v[124:127]
  ds_read_b128 v[40:43], v19 offset:10240
  v_mfma_f32_16x16x32_bf16 v[128:131], v[44:47], v[96:99], v[128:131]
  ds_read_b128 v[72:75], v21 offset:2048
  v_mfma_f32_16x16x32_bf16 v[132:135], v[48:51], v[92:95], v[132:135]
  ds_read_b128 v[44:47], v19 offset:11264
  ds_read_b128 v[76:79], v22 offset:0
  v_mfma_f32_16x16x32_bf16 v[136:139], v[48:51], v[96:99], v[136:139]
  ds_read_b128 v[48:51], v19 offset:12288
  s_waitcnt lgkmcnt(10)
  v_mfma_f32_16x16x32_bf16 v[140:143], v[52:55], v[92:95], v[140:143]
  ds_read_b128 v[80:83], v22 offset:2048
  s_mov_b32 m0, s63
  v_mfma_f32_16x16x32_bf16 v[144:147], v[52:55], v[96:99], v[144:147]
  ds_read_b128 v[52:55], v19 offset:13312
  v_mfma_f32_16x16x32_bf16 v[148:151], v[56:59], v[92:95], v[148:151]
  buffer_load_dwordx4 v14, s[52:55], s25 offen offset:2048 lds
  v_mfma_f32_16x16x32_bf16 v[152:155], v[56:59], v[96:99], v[152:155]
  ds_read_b128 v[56:59], v19 offset:14336
  s_waitcnt lgkmcnt(11)
  v_mfma_f32_16x16x32_bf16 v[156:159], v[60:63], v[92:95], v[156:159]
  buffer_load_dwordx4 v15, s[52:55], s25 offen offset:3072 lds
  v_mfma_f32_16x16x32_bf16 v[160:163], v[60:63], v[96:99], v[160:163]
  ds_read_b128 v[60:63], v19 offset:15360
  v_mfma_f32_16x16x32_bf16 v[164:167], v[64:67], v[92:95], v[164:167]
  v_mfma_f32_16x16x32_bf16 v[168:171], v[64:67], v[96:99], v[168:171]
  ds_read_b128 v[64:67], v19 offset:45056
  s_barrier
  s_waitcnt lgkmcnt(12)
  s_waitcnt lgkmcnt(4)
  v_mfma_f32_16x16x32_bf16 v[100:103], v[32:35], v[68:71], v[100:103]
  s_add_u32 s24, s35, 5
  s_cmp_ge_u32 s24, 8
  s_cselect_b32 s29, 7, 0
  v_mfma_f32_16x16x32_bf16 v[104:107], v[32:35], v[72:75], v[104:107]
  s_sub_u32 s24, s24, s29
  s_xor_b32 s24, s24, s21
  v_mfma_f32_16x16x32_bf16 v[108:111], v[36:39], v[68:71], v[108:111]
  ds_read_b128 v[32:35], v19 offset:16384
  v_mfma_f32_16x16x32_bf16 v[112:115], v[36:39], v[72:75], v[112:115]
  s_mul_i32 s24, s24, 589824
  s_mov_b32 m0, s66
  ds_read_b128 v[36:39], v19 offset:17408
  v_mfma_f32_16x16x32_bf16 v[116:119], v[40:43], v[68:71], v[116:119]
  buffer_load_dwordx4 v9, s[12:15], s24 offen sc1 lds
  v_mfma_f32_16x16x32_bf16 v[120:123], v[40:43], v[72:75], v[120:123]
  ds_read_b128 v[40:43], v19 offset:18432
  v_mfma_f32_16x16x32_bf16 v[124:127], v[44:47], v[68:71], v[124:127]
  buffer_load_dwordx4 v9, s[12:15], s24 offen offset:1024 sc1 lds
  v_mfma_f32_16x16x32_bf16 v[128:131], v[44:47], v[72:75], v[128:131]
  s_mov_b32 m0, s71
  ds_read_b128 v[44:47], v19 offset:19456
  v_mfma_f32_16x16x32_bf16 v[132:135], v[48:51], v[68:71], v[132:135]
  buffer_load_dwordx4 v10, s[12:15], s24 offen sc1 lds
  v_mfma_f32_16x16x32_bf16 v[136:139], v[48:51], v[72:75], v[136:139]
  ds_read_b128 v[48:51], v19 offset:20480
  s_waitcnt lgkmcnt(7)
  v_mfma_f32_16x16x32_bf16 v[140:143], v[52:55], v[68:71], v[140:143]
  s_add_u32 s24, s24, s38
  s_add_u32 s25, s35, 5
  s_cmp_ge_u32 s25, 8
  s_cselect_b32 s44, 7, 0
  v_mfma_f32_16x16x32_bf16 v[144:147], v[52:55], v[72:75], v[144:147]
  ds_read_b128 v[52:55], v19 offset:21504
  s_sub_u32 s25, s25, s44
  v_mfma_f32_16x16x32_bf16 v[148:151], v[56:59], v[68:71], v[148:151]
  s_xor_b32 s25, s25, s21
  s_lshl_b32 s25, s25, 8
  s_mov_b32 m0, s73
  v_mfma_f32_16x16x32_bf16 v[152:155], v[56:59], v[72:75], v[152:155]
  ds_read_b128 v[56:59], v19 offset:22528
  s_waitcnt lgkmcnt(7)
  v_mfma_f32_16x16x32_bf16 v[156:159], v[60:63], v[68:71], v[156:159]
  buffer_load_dwordx4 v12, s[52:55], s25 offen offset:0 lds
  v_mfma_f32_16x16x32_bf16 v[160:163], v[60:63], v[72:75], v[160:163]
  ds_read_b128 v[60:63], v19 offset:23552
  v_mfma_f32_16x16x32_bf16 v[164:167], v[64:67], v[68:71], v[164:167]
  buffer_load_dwordx4 v13, s[52:55], s25 offen offset:1024 lds
  v_mfma_f32_16x16x32_bf16 v[168:171], v[64:67], v[72:75], v[168:171]
  ds_read_b128 v[64:67], v19 offset:46080
  s_waitcnt vmcnt(11)
  s_barrier
  s_waitcnt lgkmcnt(8)
  v_mfma_f32_16x16x32_bf16 v[100:103], v[32:35], v[76:79], v[100:103]
  s_mov_b32 m0, s67
  v_mfma_f32_16x16x32_bf16 v[104:107], v[32:35], v[80:83], v[104:107]
  ds_read_b128 v[32:35], v19 offset:24576
  s_waitcnt lgkmcnt(7)
  v_mfma_f32_16x16x32_bf16 v[108:111], v[36:39], v[76:79], v[108:111]
  buffer_load_dwordx4 v9, s[12:15], s24 offen sc1 lds
  v_mfma_f32_16x16x32_bf16 v[112:115], v[36:39], v[80:83], v[112:115]
  buffer_load_dwordx4 v9, s[12:15], s24 offen offset:1024 sc1 lds
  v_mfma_f32_16x16x32_bf16 v[116:119], v[40:43], v[76:79], v[116:119]
  ds_read_b128 v[36:39], v19 offset:25600
  s_add_u32 s24, s24, s38
  v_mfma_f32_16x16x32_bf16 v[120:123], v[40:43], v[80:83], v[120:123]
  s_waitcnt vmcnt(7)
  s_waitcnt lgkmcnt(6)
  v_mfma_f32_16x16x32_bf16 v[124:127], v[44:47], v[76:79], v[124:127]
  ds_read_b128 v[40:43], v19 offset:26624
  ds_read_b128 v[84:87], v21 offset:16384
  v_mfma_f32_16x16x32_bf16 v[128:131], v[44:47], v[80:83], v[128:131]
  ds_read_b128 v[88:91], v21 offset:18432
  v_mfma_f32_16x16x32_bf16 v[132:135], v[48:51], v[76:79], v[132:135]
  ds_read_b128 v[44:47], v19 offset:27648
  v_mfma_f32_16x16x32_bf16 v[136:139], v[48:51], v[80:83], v[136:139]
  ds_read_b128 v[48:51], v19 offset:28672
  s_waitcnt lgkmcnt(9)
  v_mfma_f32_16x16x32_bf16 v[140:143], v[52:55], v[76:79], v[140:143]
  ds_read_b128 v[92:95], v22 offset:16384
  v_mfma_f32_16x16x32_bf16 v[144:147], v[52:55], v[80:83], v[144:147]
  ds_read_b128 v[52:55], v19 offset:29696
  ds_read_b128 v[96:99], v22 offset:18432
  v_mfma_f32_16x16x32_bf16 v[148:151], v[56:59], v[76:79], v[148:151]
  s_mov_b32 m0, s73
  v_mfma_f32_16x16x32_bf16 v[152:155], v[56:59], v[80:83], v[152:155]
  ds_read_b128 v[56:59], v19 offset:30720
  s_waitcnt lgkmcnt(11)
  v_mfma_f32_16x16x32_bf16 v[156:159], v[60:63], v[76:79], v[156:159]
  buffer_load_dwordx4 v14, s[52:55], s25 offen offset:2048 lds
  v_mfma_f32_16x16x32_bf16 v[160:163], v[60:63], v[80:83], v[160:163]
  ds_read_b128 v[60:63], v19 offset:31744
  v_mfma_f32_16x16x32_bf16 v[164:167], v[64:67], v[76:79], v[164:167]
  buffer_load_dwordx4 v15, s[52:55], s25 offen offset:3072 lds
  v_mfma_f32_16x16x32_bf16 v[168:171], v[64:67], v[80:83], v[168:171]
  ds_read_b128 v[64:67], v19 offset:47104
  s_barrier
  s_waitcnt lgkmcnt(12)
  s_waitcnt lgkmcnt(3)
  v_mfma_f32_16x16x32_bf16 v[100:103], v[32:35], v[84:87], v[100:103]
  s_mov_b32 m0, s68
  v_mfma_f32_16x16x32_bf16 v[104:107], v[32:35], v[88:91], v[104:107]
  ds_read_b128 v[32:35], v19 offset:32768
  v_mfma_f32_16x16x32_bf16 v[108:111], v[36:39], v[84:87], v[108:111]
  buffer_load_dwordx4 v9, s[12:15], s24 offen sc1 lds
  v_mfma_f32_16x16x32_bf16 v[112:115], v[36:39], v[88:91], v[112:115]
  buffer_load_dwordx4 v9, s[12:15], s24 offen offset:1024 sc1 lds
  v_mfma_f32_16x16x32_bf16 v[116:119], v[40:43], v[84:87], v[116:119]
  ds_read_b128 v[36:39], v19 offset:33792
  s_add_u32 s24, s24, s38
  v_mfma_f32_16x16x32_bf16 v[120:123], v[40:43], v[88:91], v[120:123]
  s_addk_i32 s25, 128
  s_mov_b32 m0, s63
  v_mfma_f32_16x16x32_bf16 v[124:127], v[44:47], v[84:87], v[124:127]
  ds_read_b128 v[40:43], v19 offset:34816
  v_mfma_f32_16x16x32_bf16 v[128:131], v[44:47], v[88:91], v[128:131]
  buffer_load_dwordx4 v12, s[52:55], s25 offen offset:0 lds
  v_mfma_f32_16x16x32_bf16 v[132:135], v[48:51], v[84:87], v[132:135]
  ds_read_b128 v[44:47], v19 offset:35840
  v_mfma_f32_16x16x32_bf16 v[136:139], v[48:51], v[88:91], v[136:139]
  ds_read_b128 v[48:51], v19 offset:36864
  s_waitcnt lgkmcnt(7)
  v_mfma_f32_16x16x32_bf16 v[140:143], v[52:55], v[84:87], v[140:143]
  buffer_load_dwordx4 v13, s[52:55], s25 offen offset:1024 lds
  v_mfma_f32_16x16x32_bf16 v[144:147], v[52:55], v[88:91], v[144:147]
  ds_read_b128 v[52:55], v19 offset:37888
  v_mfma_f32_16x16x32_bf16 v[148:151], v[56:59], v[84:87], v[148:151]
  v_mfma_f32_16x16x32_bf16 v[152:155], v[56:59], v[88:91], v[152:155]
  ds_read_b128 v[56:59], v19 offset:38912
  s_waitcnt lgkmcnt(7)
  v_mfma_f32_16x16x32_bf16 v[156:159], v[60:63], v[84:87], v[156:159]
  v_mfma_f32_16x16x32_bf16 v[160:163], v[60:63], v[88:91], v[160:163]
  ds_read_b128 v[60:63], v19 offset:39936
  v_mfma_f32_16x16x32_bf16 v[164:167], v[64:67], v[84:87], v[164:167]
  v_mfma_f32_16x16x32_bf16 v[168:171], v[64:67], v[88:91], v[168:171]
  ds_read_b128 v[64:67], v19 offset:48128
  s_waitcnt vmcnt(10)
  s_barrier
  s_waitcnt lgkmcnt(8)
  v_mfma_f32_16x16x32_bf16 v[100:103], v[32:35], v[92:95], v[100:103]
  s_mov_b32 m0, s69
  v_mfma_f32_16x16x32_bf16 v[104:107], v[32:35], v[96:99], v[104:107]
  ds_read_b128 v[32:35], v19 offset:0
  s_waitcnt lgkmcnt(7)
  v_mfma_f32_16x16x32_bf16 v[108:111], v[36:39], v[92:95], v[108:111]
  buffer_load_dwordx4 v9, s[12:15], s24 offen sc1 lds
  v_mfma_f32_16x16x32_bf16 v[112:115], v[36:39], v[96:99], v[112:115]
  buffer_load_dwordx4 v9, s[12:15], s24 offen offset:1024 sc1 lds
  v_mfma_f32_16x16x32_bf16 v[116:119], v[40:43], v[92:95], v[116:119]
  ds_read_b128 v[36:39], v19 offset:1024
  s_waitcnt vmcnt(6)
  v_mfma_f32_16x16x32_bf16 v[120:123], v[40:43], v[96:99], v[120:123]
  ds_read_b128 v[68:71], v21 offset:0
  s_waitcnt lgkmcnt(7)
  v_mfma_f32_16x16x32_bf16 v[124:127], v[44:47], v[92:95], v[124:127]
  ds_read_b128 v[40:43], v19 offset:2048
  v_mfma_f32_16x16x32_bf16 v[128:131], v[44:47], v[96:99], v[128:131]
  ds_read_b128 v[72:75], v21 offset:2048
  v_mfma_f32_16x16x32_bf16 v[132:135], v[48:51], v[92:95], v[132:135]
  ds_read_b128 v[44:47], v19 offset:3072
  ds_read_b128 v[76:79], v22 offset:0
  v_mfma_f32_16x16x32_bf16 v[136:139], v[48:51], v[96:99], v[136:139]
  ds_read_b128 v[48:51], v19 offset:4096
  s_waitcnt lgkmcnt(10)
  v_mfma_f32_16x16x32_bf16 v[140:143], v[52:55], v[92:95], v[140:143]
  ds_read_b128 v[80:83], v22 offset:2048
  s_mov_b32 m0, s63
  v_mfma_f32_16x16x32_bf16 v[144:147], v[52:55], v[96:99], v[144:147]
  ds_read_b128 v[52:55], v19 offset:5120
  v_mfma_f32_16x16x32_bf16 v[148:151], v[56:59], v[92:95], v[148:151]
  buffer_load_dwordx4 v14, s[52:55], s25 offen offset:2048 lds
  v_mfma_f32_16x16x32_bf16 v[152:155], v[56:59], v[96:99], v[152:155]
  ds_read_b128 v[56:59], v19 offset:6144
  s_waitcnt lgkmcnt(11)
  v_mfma_f32_16x16x32_bf16 v[156:159], v[60:63], v[92:95], v[156:159]
  buffer_load_dwordx4 v15, s[52:55], s25 offen offset:3072 lds
  v_mfma_f32_16x16x32_bf16 v[160:163], v[60:63], v[96:99], v[160:163]
  ds_read_b128 v[60:63], v19 offset:7168
  v_mfma_f32_16x16x32_bf16 v[164:167], v[64:67], v[92:95], v[164:167]
  v_mfma_f32_16x16x32_bf16 v[168:171], v[64:67], v[96:99], v[168:171]
  ds_read_b128 v[64:67], v19 offset:40960
  s_barrier
  s_waitcnt lgkmcnt(12)
  s_waitcnt lgkmcnt(4)
  v_mfma_f32_16x16x32_bf16 v[100:103], v[32:35], v[68:71], v[100:103]
  s_add_u32 s24, s35, 6
  s_cmp_ge_u32 s24, 8
  s_cselect_b32 s29, 7, 0
  v_mfma_f32_16x16x32_bf16 v[104:107], v[32:35], v[72:75], v[104:107]
  s_sub_u32 s24, s24, s29
  s_xor_b32 s24, s24, s21
  v_mfma_f32_16x16x32_bf16 v[108:111], v[36:39], v[68:71], v[108:111]
  ds_read_b128 v[32:35], v19 offset:8192
  v_mfma_f32_16x16x32_bf16 v[112:115], v[36:39], v[72:75], v[112:115]
  s_mul_i32 s24, s24, 589824
  s_mov_b32 m0, s70
  ds_read_b128 v[36:39], v19 offset:9216
  v_mfma_f32_16x16x32_bf16 v[116:119], v[40:43], v[68:71], v[116:119]
  buffer_load_dwordx4 v9, s[12:15], s24 offen sc1 lds
  v_mfma_f32_16x16x32_bf16 v[120:123], v[40:43], v[72:75], v[120:123]
  ds_read_b128 v[40:43], v19 offset:10240
  v_mfma_f32_16x16x32_bf16 v[124:127], v[44:47], v[68:71], v[124:127]
  buffer_load_dwordx4 v9, s[12:15], s24 offen offset:1024 sc1 lds
  v_mfma_f32_16x16x32_bf16 v[128:131], v[44:47], v[72:75], v[128:131]
  s_mov_b32 m0, s72
  ds_read_b128 v[44:47], v19 offset:11264
  v_mfma_f32_16x16x32_bf16 v[132:135], v[48:51], v[68:71], v[132:135]
  buffer_load_dwordx4 v10, s[12:15], s24 offen sc1 lds
  v_mfma_f32_16x16x32_bf16 v[136:139], v[48:51], v[72:75], v[136:139]
  ds_read_b128 v[48:51], v19 offset:12288
  s_waitcnt lgkmcnt(7)
  v_mfma_f32_16x16x32_bf16 v[140:143], v[52:55], v[68:71], v[140:143]
  s_add_u32 s24, s24, s38
  s_add_u32 s25, s35, 6
  s_cmp_ge_u32 s25, 8
  s_cselect_b32 s44, 7, 0
  v_mfma_f32_16x16x32_bf16 v[144:147], v[52:55], v[72:75], v[144:147]
  ds_read_b128 v[52:55], v19 offset:13312
  s_sub_u32 s25, s25, s44
  v_mfma_f32_16x16x32_bf16 v[148:151], v[56:59], v[68:71], v[148:151]
  s_xor_b32 s25, s25, s21
  s_lshl_b32 s25, s25, 8
  s_mov_b32 m0, s73
  v_mfma_f32_16x16x32_bf16 v[152:155], v[56:59], v[72:75], v[152:155]
  ds_read_b128 v[56:59], v19 offset:14336
  s_waitcnt lgkmcnt(7)
  v_mfma_f32_16x16x32_bf16 v[156:159], v[60:63], v[68:71], v[156:159]
  buffer_load_dwordx4 v12, s[52:55], s25 offen offset:0 lds
  v_mfma_f32_16x16x32_bf16 v[160:163], v[60:63], v[72:75], v[160:163]
  ds_read_b128 v[60:63], v19 offset:15360
  v_mfma_f32_16x16x32_bf16 v[164:167], v[64:67], v[68:71], v[164:167]
  buffer_load_dwordx4 v13, s[52:55], s25 offen offset:1024 lds
  v_mfma_f32_16x16x32_bf16 v[168:171], v[64:67], v[72:75], v[168:171]
  ds_read_b128 v[64:67], v19 offset:41984
  s_waitcnt vmcnt(11)
  s_barrier
  s_waitcnt lgkmcnt(8)
  v_mfma_f32_16x16x32_bf16 v[100:103], v[32:35], v[76:79], v[100:103]
  s_mov_b32 m0, s66
  v_mfma_f32_16x16x32_bf16 v[104:107], v[32:35], v[80:83], v[104:107]
  ds_read_b128 v[32:35], v19 offset:16384
  s_waitcnt lgkmcnt(7)
  v_mfma_f32_16x16x32_bf16 v[108:111], v[36:39], v[76:79], v[108:111]
  buffer_load_dwordx4 v9, s[12:15], s24 offen sc1 lds
  v_mfma_f32_16x16x32_bf16 v[112:115], v[36:39], v[80:83], v[112:115]
  buffer_load_dwordx4 v9, s[12:15], s24 offen offset:1024 sc1 lds
  v_mfma_f32_16x16x32_bf16 v[116:119], v[40:43], v[76:79], v[116:119]
  ds_read_b128 v[36:39], v19 offset:17408
  s_add_u32 s24, s24, s38
  v_mfma_f32_16x16x32_bf16 v[120:123], v[40:43], v[80:83], v[120:123]
  s_waitcnt vmcnt(7)
  s_waitcnt lgkmcnt(6)
  v_mfma_f32_16x16x32_bf16 v[124:127], v[44:47], v[76:79], v[124:127]
  ds_read_b128 v[40:43], v19 offset:18432
  ds_read_b128 v[84:87], v21 offset:16384
  v_mfma_f32_16x16x32_bf16 v[128:131], v[44:47], v[80:83], v[128:131]
  ds_read_b128 v[88:91], v21 offset:18432
  v_mfma_f32_16x16x32_bf16 v[132:135], v[48:51], v[76:79], v[132:135]
  ds_read_b128 v[44:47], v19 offset:19456
  v_mfma_f32_16x16x32_bf16 v[136:139], v[48:51], v[80:83], v[136:139]
  ds_read_b128 v[48:51], v19 offset:20480
  s_waitcnt lgkmcnt(9)
  v_mfma_f32_16x16x32_bf16 v[140:143], v[52:55], v[76:79], v[140:143]
  ds_read_b128 v[92:95], v22 offset:16384
  v_mfma_f32_16x16x32_bf16 v[144:147], v[52:55], v[80:83], v[144:147]
  ds_read_b128 v[52:55], v19 offset:21504
  ds_read_b128 v[96:99], v22 offset:18432
  v_mfma_f32_16x16x32_bf16 v[148:151], v[56:59], v[76:79], v[148:151]
  s_mov_b32 m0, s73
  v_mfma_f32_16x16x32_bf16 v[152:155], v[56:59], v[80:83], v[152:155]
  ds_read_b128 v[56:59], v19 offset:22528
  s_waitcnt lgkmcnt(11)
  v_mfma_f32_16x16x32_bf16 v[156:159], v[60:63], v[76:79], v[156:159]
  buffer_load_dwordx4 v14, s[52:55], s25 offen offset:2048 lds
  v_mfma_f32_16x16x32_bf16 v[160:163], v[60:63], v[80:83], v[160:163]
  ds_read_b128 v[60:63], v19 offset:23552
  v_mfma_f32_16x16x32_bf16 v[164:167], v[64:67], v[76:79], v[164:167]
  buffer_load_dwordx4 v15, s[52:55], s25 offen offset:3072 lds
  v_mfma_f32_16x16x32_bf16 v[168:171], v[64:67], v[80:83], v[168:171]
  ds_read_b128 v[64:67], v19 offset:43008
  s_barrier
  s_waitcnt lgkmcnt(12)
  s_waitcnt lgkmcnt(3)
  v_mfma_f32_16x16x32_bf16 v[100:103], v[32:35], v[84:87], v[100:103]
  s_mov_b32 m0, s67
  v_mfma_f32_16x16x32_bf16 v[104:107], v[32:35], v[88:91], v[104:107]
  ds_read_b128 v[32:35], v19 offset:24576
  v_mfma_f32_16x16x32_bf16 v[108:111], v[36:39], v[84:87], v[108:111]
  buffer_load_dwordx4 v9, s[12:15], s24 offen sc1 lds
  v_mfma_f32_16x16x32_bf16 v[112:115], v[36:39], v[88:91], v[112:115]
  buffer_load_dwordx4 v9, s[12:15], s24 offen offset:1024 sc1 lds
  v_mfma_f32_16x16x32_bf16 v[116:119], v[40:43], v[84:87], v[116:119]
  ds_read_b128 v[36:39], v19 offset:25600
  s_add_u32 s24, s24, s38
  v_mfma_f32_16x16x32_bf16 v[120:123], v[40:43], v[88:91], v[120:123]
  s_addk_i32 s25, 128
  s_mov_b32 m0, s63
  v_mfma_f32_16x16x32_bf16 v[124:127], v[44:47], v[84:87], v[124:127]
  ds_read_b128 v[40:43], v19 offset:26624
  v_mfma_f32_16x16x32_bf16 v[128:131], v[44:47], v[88:91], v[128:131]
  buffer_load_dwordx4 v12, s[52:55], s25 offen offset:0 lds
  v_mfma_f32_16x16x32_bf16 v[132:135], v[48:51], v[84:87], v[132:135]
  ds_read_b128 v[44:47], v19 offset:27648
  v_mfma_f32_16x16x32_bf16 v[136:139], v[48:51], v[88:91], v[136:139]
  ds_read_b128 v[48:51], v19 offset:28672
  s_waitcnt lgkmcnt(7)
  v_mfma_f32_16x16x32_bf16 v[140:143], v[52:55], v[84:87], v[140:143]
  buffer_load_dwordx4 v13, s[52:55], s25 offen offset:1024 lds
  v_mfma_f32_16x16x32_bf16 v[144:147], v[52:55], v[88:91], v[144:147]
  ds_read_b128 v[52:55], v19 offset:29696
  v_mfma_f32_16x16x32_bf16 v[148:151], v[56:59], v[84:87], v[148:151]
  v_mfma_f32_16x16x32_bf16 v[152:155], v[56:59], v[88:91], v[152:155]
  ds_read_b128 v[56:59], v19 offset:30720
  s_waitcnt lgkmcnt(7)
  v_mfma_f32_16x16x32_bf16 v[156:159], v[60:63], v[84:87], v[156:159]
  v_mfma_f32_16x16x32_bf16 v[160:163], v[60:63], v[88:91], v[160:163]
  ds_read_b128 v[60:63], v19 offset:31744
  v_mfma_f32_16x16x32_bf16 v[164:167], v[64:67], v[84:87], v[164:167]
  v_mfma_f32_16x16x32_bf16 v[168:171], v[64:67], v[88:91], v[168:171]
  ds_read_b128 v[64:67], v19 offset:44032
  s_waitcnt vmcnt(10)
  s_barrier
  s_waitcnt lgkmcnt(8)
  v_mfma_f32_16x16x32_bf16 v[100:103], v[32:35], v[92:95], v[100:103]
  s_mov_b32 m0, s68
  v_mfma_f32_16x16x32_bf16 v[104:107], v[32:35], v[96:99], v[104:107]
  ds_read_b128 v[32:35], v19 offset:32768
  s_waitcnt lgkmcnt(7)
  v_mfma_f32_16x16x32_bf16 v[108:111], v[36:39], v[92:95], v[108:111]
  buffer_load_dwordx4 v9, s[12:15], s24 offen sc1 lds
  v_mfma_f32_16x16x32_bf16 v[112:115], v[36:39], v[96:99], v[112:115]
  buffer_load_dwordx4 v9, s[12:15], s24 offen offset:1024 sc1 lds
  v_mfma_f32_16x16x32_bf16 v[116:119], v[40:43], v[92:95], v[116:119]
  ds_read_b128 v[36:39], v19 offset:33792
  s_waitcnt vmcnt(6)
  v_mfma_f32_16x16x32_bf16 v[120:123], v[40:43], v[96:99], v[120:123]
  ds_read_b128 v[68:71], v21 offset:0
  s_waitcnt lgkmcnt(7)
  v_mfma_f32_16x16x32_bf16 v[124:127], v[44:47], v[92:95], v[124:127]
  ds_read_b128 v[40:43], v19 offset:34816
  v_mfma_f32_16x16x32_bf16 v[128:131], v[44:47], v[96:99], v[128:131]
  ds_read_b128 v[72:75], v21 offset:2048
  v_mfma_f32_16x16x32_bf16 v[132:135], v[48:51], v[92:95], v[132:135]
  ds_read_b128 v[44:47], v19 offset:35840
  ds_read_b128 v[76:79], v22 offset:0
  v_mfma_f32_16x16x32_bf16 v[136:139], v[48:51], v[96:99], v[136:139]
  ds_read_b128 v[48:51], v19 offset:36864
  s_waitcnt lgkmcnt(10)
  v_mfma_f32_16x16x32_bf16 v[140:143], v[52:55], v[92:95], v[140:143]
  ds_read_b128 v[80:83], v22 offset:2048
  s_mov_b32 m0, s63
  v_mfma_f32_16x16x32_bf16 v[144:147], v[52:55], v[96:99], v[144:147]
  ds_read_b128 v[52:55], v19 offset:37888
  v_mfma_f32_16x16x32_bf16 v[148:151], v[56:59], v[92:95], v[148:151]
  buffer_load_dwordx4 v14, s[52:55], s25 offen offset:2048 lds
  v_mfma_f32_16x16x32_bf16 v[152:155], v[56:59], v[96:99], v[152:155]
  ds_read_b128 v[56:59], v19 offset:38912
  s_waitcnt lgkmcnt(11)
  v_mfma_f32_16x16x32_bf16 v[156:159], v[60:63], v[92:95], v[156:159]
  buffer_load_dwordx4 v15, s[52:55], s25 offen offset:3072 lds
  v_mfma_f32_16x16x32_bf16 v[160:163], v[60:63], v[96:99], v[160:163]
  ds_read_b128 v[60:63], v19 offset:39936
  v_mfma_f32_16x16x32_bf16 v[164:167], v[64:67], v[92:95], v[164:167]
  v_mfma_f32_16x16x32_bf16 v[168:171], v[64:67], v[96:99], v[168:171]
  ds_read_b128 v[64:67], v19 offset:45056
  s_barrier
  s_waitcnt lgkmcnt(12)
  s_waitcnt lgkmcnt(4)
  v_mfma_f32_16x16x32_bf16 v[100:103], v[32:35], v[68:71], v[100:103]
  s_add_u32 s24, s35, 7
  s_cmp_ge_u32 s24, 8
  s_cselect_b32 s29, 7, 0
  v_mfma_f32_16x16x32_bf16 v[104:107], v[32:35], v[72:75], v[104:107]
  s_sub_u32 s24, s24, s29
  s_xor_b32 s24, s24, s21
  v_mfma_f32_16x16x32_bf16 v[108:111], v[36:39], v[68:71], v[108:111]
  ds_read_b128 v[32:35], v19 offset:0
  v_mfma_f32_16x16x32_bf16 v[112:115], v[36:39], v[72:75], v[112:115]
  s_mul_i32 s24, s24, 589824
  s_mov_b32 m0, s69
  ds_read_b128 v[36:39], v19 offset:1024
  v_mfma_f32_16x16x32_bf16 v[116:119], v[40:43], v[68:71], v[116:119]
  buffer_load_dwordx4 v9, s[12:15], s24 offen sc1 lds
  v_mfma_f32_16x16x32_bf16 v[120:123], v[40:43], v[72:75], v[120:123]
  ds_read_b128 v[40:43], v19 offset:2048
  v_mfma_f32_16x16x32_bf16 v[124:127], v[44:47], v[68:71], v[124:127]
  buffer_load_dwordx4 v9, s[12:15], s24 offen offset:1024 sc1 lds
  v_mfma_f32_16x16x32_bf16 v[128:131], v[44:47], v[72:75], v[128:131]
  s_mov_b32 m0, s71
  ds_read_b128 v[44:47], v19 offset:3072
  v_mfma_f32_16x16x32_bf16 v[132:135], v[48:51], v[68:71], v[132:135]
  buffer_load_dwordx4 v10, s[12:15], s24 offen sc1 lds
  v_mfma_f32_16x16x32_bf16 v[136:139], v[48:51], v[72:75], v[136:139]
  ds_read_b128 v[48:51], v19 offset:4096
  s_waitcnt lgkmcnt(7)
  v_mfma_f32_16x16x32_bf16 v[140:143], v[52:55], v[68:71], v[140:143]
  s_add_u32 s24, s24, s38
  s_add_u32 s25, s35, 7
  s_cmp_ge_u32 s25, 8
  s_cselect_b32 s44, 7, 0
  v_mfma_f32_16x16x32_bf16 v[144:147], v[52:55], v[72:75], v[144:147]
  ds_read_b128 v[52:55], v19 offset:5120
  s_sub_u32 s25, s25, s44
  v_mfma_f32_16x16x32_bf16 v[148:151], v[56:59], v[68:71], v[148:151]
  s_xor_b32 s25, s25, s21
  s_lshl_b32 s25, s25, 8
  s_mov_b32 m0, s73
  v_mfma_f32_16x16x32_bf16 v[152:155], v[56:59], v[72:75], v[152:155]
  ds_read_b128 v[56:59], v19 offset:6144
  s_waitcnt lgkmcnt(7)
  v_mfma_f32_16x16x32_bf16 v[156:159], v[60:63], v[68:71], v[156:159]
  buffer_load_dwordx4 v12, s[52:55], s25 offen offset:0 lds
  v_mfma_f32_16x16x32_bf16 v[160:163], v[60:63], v[72:75], v[160:163]
  ds_read_b128 v[60:63], v19 offset:7168
  v_mfma_f32_16x16x32_bf16 v[164:167], v[64:67], v[68:71], v[164:167]
  buffer_load_dwordx4 v13, s[52:55], s25 offen offset:1024 lds
  v_mfma_f32_16x16x32_bf16 v[168:171], v[64:67], v[72:75], v[168:171]
  ds_read_b128 v[64:67], v19 offset:46080
  s_waitcnt vmcnt(11)
  s_barrier
  s_waitcnt lgkmcnt(8)
  v_mfma_f32_16x16x32_bf16 v[100:103], v[32:35], v[76:79], v[100:103]
  s_mov_b32 m0, s70
  v_mfma_f32_16x16x32_bf16 v[104:107], v[32:35], v[80:83], v[104:107]
  ds_read_b128 v[32:35], v19 offset:8192
  s_waitcnt lgkmcnt(7)
  v_mfma_f32_16x16x32_bf16 v[108:111], v[36:39], v[76:79], v[108:111]
  buffer_load_dwordx4 v9, s[12:15], s24 offen sc1 lds
  v_mfma_f32_16x16x32_bf16 v[112:115], v[36:39], v[80:83], v[112:115]
  buffer_load_dwordx4 v9, s[12:15], s24 offen offset:1024 sc1 lds
  v_mfma_f32_16x16x32_bf16 v[116:119], v[40:43], v[76:79], v[116:119]
  ds_read_b128 v[36:39], v19 offset:9216
  s_add_u32 s24, s24, s38
  v_mfma_f32_16x16x32_bf16 v[120:123], v[40:43], v[80:83], v[120:123]
  s_waitcnt vmcnt(7)
  s_waitcnt lgkmcnt(6)
  v_mfma_f32_16x16x32_bf16 v[124:127], v[44:47], v[76:79], v[124:127]
  ds_read_b128 v[40:43], v19 offset:10240
  ds_read_b128 v[84:87], v21 offset:16384
  v_mfma_f32_16x16x32_bf16 v[128:131], v[44:47], v[80:83], v[128:131]
  ds_read_b128 v[88:91], v21 offset:18432
  v_mfma_f32_16x16x32_bf16 v[132:135], v[48:51], v[76:79], v[132:135]
  ds_read_b128 v[44:47], v19 offset:11264
  v_mfma_f32_16x16x32_bf16 v[136:139], v[48:51], v[80:83], v[136:139]
  ds_read_b128 v[48:51], v19 offset:12288
  s_waitcnt lgkmcnt(9)
  v_mfma_f32_16x16x32_bf16 v[140:143], v[52:55], v[76:79], v[140:143]
  ds_read_b128 v[92:95], v22 offset:16384
  v_mfma_f32_16x16x32_bf16 v[144:147], v[52:55], v[80:83], v[144:147]
  ds_read_b128 v[52:55], v19 offset:13312
  ds_read_b128 v[96:99], v22 offset:18432
  v_mfma_f32_16x16x32_bf16 v[148:151], v[56:59], v[76:79], v[148:151]
  s_mov_b32 m0, s73
  v_mfma_f32_16x16x32_bf16 v[152:155], v[56:59], v[80:83], v[152:155]
  ds_read_b128 v[56:59], v19 offset:14336
  s_waitcnt lgkmcnt(11)
  v_mfma_f32_16x16x32_bf16 v[156:159], v[60:63], v[76:79], v[156:159]
  buffer_load_dwordx4 v14, s[52:55], s25 offen offset:2048 lds
  v_mfma_f32_16x16x32_bf16 v[160:163], v[60:63], v[80:83], v[160:163]
  ds_read_b128 v[60:63], v19 offset:15360
  v_mfma_f32_16x16x32_bf16 v[164:167], v[64:67], v[76:79], v[164:167]
  buffer_load_dwordx4 v15, s[52:55], s25 offen offset:3072 lds
  v_mfma_f32_16x16x32_bf16 v[168:171], v[64:67], v[80:83], v[168:171]
  ds_read_b128 v[64:67], v19 offset:47104
  s_barrier
  s_waitcnt lgkmcnt(12)
  s_waitcnt lgkmcnt(3)
  v_mfma_f32_16x16x32_bf16 v[100:103], v[32:35], v[84:87], v[100:103]
  s_mov_b32 m0, s66
  v_mfma_f32_16x16x32_bf16 v[104:107], v[32:35], v[88:91], v[104:107]
  ds_read_b128 v[32:35], v19 offset:16384
  v_mfma_f32_16x16x32_bf16 v[108:111], v[36:39], v[84:87], v[108:111]
  buffer_load_dwordx4 v9, s[12:15], s24 offen sc1 lds
  v_mfma_f32_16x16x32_bf16 v[112:115], v[36:39], v[88:91], v[112:115]
  buffer_load_dwordx4 v9, s[12:15], s24 offen offset:1024 sc1 lds
  v_mfma_f32_16x16x32_bf16 v[116:119], v[40:43], v[84:87], v[116:119]
  ds_read_b128 v[36:39], v19 offset:17408
  s_add_u32 s24, s24, s38
  v_mfma_f32_16x16x32_bf16 v[120:123], v[40:43], v[88:91], v[120:123]
  s_addk_i32 s25, 128
  s_mov_b32 m0, s63
  v_mfma_f32_16x16x32_bf16 v[124:127], v[44:47], v[84:87], v[124:127]
  ds_read_b128 v[40:43], v19 offset:18432
  v_mfma_f32_16x16x32_bf16 v[128:131], v[44:47], v[88:91], v[128:131]
  buffer_load_dwordx4 v12, s[52:55], s25 offen offset:0 lds
  v_mfma_f32_16x16x32_bf16 v[132:135], v[48:51], v[84:87], v[132:135]
  ds_read_b128 v[44:47], v19 offset:19456
  v_mfma_f32_16x16x32_bf16 v[136:139], v[48:51], v[88:91], v[136:139]
  ds_read_b128 v[48:51], v19 offset:20480
  s_waitcnt lgkmcnt(7)
  v_mfma_f32_16x16x32_bf16 v[140:143], v[52:55], v[84:87], v[140:143]
  buffer_load_dwordx4 v13, s[52:55], s25 offen offset:1024 lds
  v_mfma_f32_16x16x32_bf16 v[144:147], v[52:55], v[88:91], v[144:147]
  ds_read_b128 v[52:55], v19 offset:21504
  v_mfma_f32_16x16x32_bf16 v[148:151], v[56:59], v[84:87], v[148:151]
  v_mfma_f32_16x16x32_bf16 v[152:155], v[56:59], v[88:91], v[152:155]
  ds_read_b128 v[56:59], v19 offset:22528
  s_waitcnt lgkmcnt(7)
  v_mfma_f32_16x16x32_bf16 v[156:159], v[60:63], v[84:87], v[156:159]
  v_mfma_f32_16x16x32_bf16 v[160:163], v[60:63], v[88:91], v[160:163]
  ds_read_b128 v[60:63], v19 offset:23552
  v_mfma_f32_16x16x32_bf16 v[164:167], v[64:67], v[84:87], v[164:167]
  v_mfma_f32_16x16x32_bf16 v[168:171], v[64:67], v[88:91], v[168:171]
  ds_read_b128 v[64:67], v19 offset:48128
  s_waitcnt vmcnt(10)
  s_barrier
  s_waitcnt lgkmcnt(8)
  v_mfma_f32_16x16x32_bf16 v[100:103], v[32:35], v[92:95], v[100:103]
  s_mov_b32 m0, s67
  v_mfma_f32_16x16x32_bf16 v[104:107], v[32:35], v[96:99], v[104:107]
  ds_read_b128 v[32:35], v19 offset:24576
  s_waitcnt lgkmcnt(7)
  v_mfma_f32_16x16x32_bf16 v[108:111], v[36:39], v[92:95], v[108:111]
  buffer_load_dwordx4 v9, s[12:15], s24 offen sc1 lds
  v_mfma_f32_16x16x32_bf16 v[112:115], v[36:39], v[96:99], v[112:115]
  buffer_load_dwordx4 v9, s[12:15], s24 offen offset:1024 sc1 lds
  v_mfma_f32_16x16x32_bf16 v[116:119], v[40:43], v[92:95], v[116:119]
  ds_read_b128 v[36:39], v19 offset:25600
  s_waitcnt vmcnt(6)
  v_mfma_f32_16x16x32_bf16 v[120:123], v[40:43], v[96:99], v[120:123]
  ds_read_b128 v[68:71], v21 offset:0
  s_waitcnt lgkmcnt(7)
  v_mfma_f32_16x16x32_bf16 v[124:127], v[44:47], v[92:95], v[124:127]
  ds_read_b128 v[40:43], v19 offset:26624
  v_mfma_f32_16x16x32_bf16 v[128:131], v[44:47], v[96:99], v[128:131]
  ds_read_b128 v[72:75], v21 offset:2048
  v_mfma_f32_16x16x32_bf16 v[132:135], v[48:51], v[92:95], v[132:135]
  ds_read_b128 v[44:47], v19 offset:27648
  ds_read_b128 v[76:79], v22 offset:0
  v_mfma_f32_16x16x32_bf16 v[136:139], v[48:51], v[96:99], v[136:139]
  ds_read_b128 v[48:51], v19 offset:28672
  s_waitcnt lgkmcnt(10)
  v_mfma_f32_16x16x32_bf16 v[140:143], v[52:55], v[92:95], v[140:143]
  ds_read_b128 v[80:83], v22 offset:2048
  s_mov_b32 m0, s63
  v_mfma_f32_16x16x32_bf16 v[144:147], v[52:55], v[96:99], v[144:147]
  ds_read_b128 v[52:55], v19 offset:29696
  v_mfma_f32_16x16x32_bf16 v[148:151], v[56:59], v[92:95], v[148:151]
  buffer_load_dwordx4 v14, s[52:55], s25 offen offset:2048 lds
  v_mfma_f32_16x16x32_bf16 v[152:155], v[56:59], v[96:99], v[152:155]
  ds_read_b128 v[56:59], v19 offset:30720
  s_waitcnt lgkmcnt(11)
  v_mfma_f32_16x16x32_bf16 v[156:159], v[60:63], v[92:95], v[156:159]
  buffer_load_dwordx4 v15, s[52:55], s25 offen offset:3072 lds
  v_mfma_f32_16x16x32_bf16 v[160:163], v[60:63], v[96:99], v[160:163]
  ds_read_b128 v[60:63], v19 offset:31744
  v_mfma_f32_16x16x32_bf16 v[164:167], v[64:67], v[92:95], v[164:167]
  v_mfma_f32_16x16x32_bf16 v[168:171], v[64:67], v[96:99], v[168:171]
  ds_read_b128 v[64:67], v19 offset:40960
  s_barrier
  s_waitcnt lgkmcnt(12)
  s_waitcnt lgkmcnt(4)
  v_mfma_f32_16x16x32_bf16 v[100:103], v[32:35], v[68:71], v[100:103]
  s_xor_b32 s24, s37, 8
  s_mul_i32 s24, s24, 589824
  v_mfma_f32_16x16x32_bf16 v[104:107], v[32:35], v[72:75], v[104:107]
  s_mov_b32 m0, s68
  v_mfma_f32_16x16x32_bf16 v[108:111], v[36:39], v[68:71], v[108:111]
  ds_read_b128 v[32:35], v19 offset:32768
  v_mfma_f32_16x16x32_bf16 v[112:115], v[36:39], v[72:75], v[112:115]
  buffer_load_dwordx4 v9, s[12:15], s24 offen sc1 lds
  v_mfma_f32_16x16x32_bf16 v[116:119], v[40:43], v[68:71], v[116:119]
  ds_read_b128 v[36:39], v19 offset:33792
  v_mfma_f32_16x16x32_bf16 v[120:123], v[40:43], v[72:75], v[120:123]
  ds_read_b128 v[40:43], v19 offset:34816
  v_mfma_f32_16x16x32_bf16 v[124:127], v[44:47], v[68:71], v[124:127]
  buffer_load_dwordx4 v9, s[12:15], s24 offen offset:1024 sc1 lds
  s_mov_b32 m0, s72
  v_mfma_f32_16x16x32_bf16 v[128:131], v[44:47], v[72:75], v[128:131]
  buffer_load_dwordx4 v10, s[12:15], s24 offen sc1 lds
  v_mfma_f32_16x16x32_bf16 v[132:135], v[48:51], v[68:71], v[132:135]
  ds_read_b128 v[44:47], v19 offset:35840
  s_add_u32 s24, s24, s38
  v_mfma_f32_16x16x32_bf16 v[136:139], v[48:51], v[72:75], v[136:139]
  ds_read_b128 v[48:51], v19 offset:36864
  s_waitcnt lgkmcnt(7)
  v_mfma_f32_16x16x32_bf16 v[140:143], v[52:55], v[68:71], v[140:143]
  s_xor_b32 s25, s37, 8
  s_lshl_b32 s25, s25, 8
  s_mov_b32 m0, s73
  v_mfma_f32_16x16x32_bf16 v[144:147], v[52:55], v[72:75], v[144:147]
  ds_read_b128 v[52:55], v19 offset:37888
  v_mfma_f32_16x16x32_bf16 v[148:151], v[56:59], v[68:71], v[148:151]
  buffer_load_dwordx4 v12, s[52:55], s25 offen offset:0 lds
  v_mfma_f32_16x16x32_bf16 v[152:155], v[56:59], v[72:75], v[152:155]
  ds_read_b128 v[56:59], v19 offset:38912
  s_waitcnt lgkmcnt(7)
  v_mfma_f32_16x16x32_bf16 v[156:159], v[60:63], v[68:71], v[156:159]
  buffer_load_dwordx4 v13, s[52:55], s25 offen offset:1024 lds
  v_mfma_f32_16x16x32_bf16 v[160:163], v[60:63], v[72:75], v[160:163]
  ds_read_b128 v[60:63], v19 offset:39936
  v_mfma_f32_16x16x32_bf16 v[164:167], v[64:67], v[68:71], v[164:167]
  v_mfma_f32_16x16x32_bf16 v[168:171], v[64:67], v[72:75], v[168:171]
  ds_read_b128 v[64:67], v19 offset:41984
  s_waitcnt vmcnt(11)
  s_barrier
  s_waitcnt lgkmcnt(8)
  v_mfma_f32_16x16x32_bf16 v[100:103], v[32:35], v[76:79], v[100:103]
  s_mov_b32 m0, s69
  v_mfma_f32_16x16x32_bf16 v[104:107], v[32:35], v[80:83], v[104:107]
  ds_read_b128 v[32:35], v19 offset:0
  s_waitcnt lgkmcnt(7)
  v_mfma_f32_16x16x32_bf16 v[108:111], v[36:39], v[76:79], v[108:111]
  buffer_load_dwordx4 v9, s[12:15], s24 offen sc1 lds
  v_mfma_f32_16x16x32_bf16 v[112:115], v[36:39], v[80:83], v[112:115]
  buffer_load_dwordx4 v9, s[12:15], s24 offen offset:1024 sc1 lds
  v_mfma_f32_16x16x32_bf16 v[116:119], v[40:43], v[76:79], v[116:119]
  ds_read_b128 v[36:39], v19 offset:1024
  s_add_u32 s24, s24, s38
  v_mfma_f32_16x16x32_bf16 v[120:123], v[40:43], v[80:83], v[120:123]
  s_waitcnt vmcnt(7)
  s_waitcnt lgkmcnt(6)
  v_mfma_f32_16x16x32_bf16 v[124:127], v[44:47], v[76:79], v[124:127]
  ds_read_b128 v[40:43], v19 offset:2048
  ds_read_b128 v[84:87], v21 offset:16384
  v_mfma_f32_16x16x32_bf16 v[128:131], v[44:47], v[80:83], v[128:131]
  ds_read_b128 v[88:91], v21 offset:18432
  v_mfma_f32_16x16x32_bf16 v[132:135], v[48:51], v[76:79], v[132:135]
  ds_read_b128 v[44:47], v19 offset:3072
  v_mfma_f32_16x16x32_bf16 v[136:139], v[48:51], v[80:83], v[136:139]
  ds_read_b128 v[48:51], v19 offset:4096
  s_waitcnt lgkmcnt(9)
  v_mfma_f32_16x16x32_bf16 v[140:143], v[52:55], v[76:79], v[140:143]
  ds_read_b128 v[92:95], v22 offset:16384
  v_mfma_f32_16x16x32_bf16 v[144:147], v[52:55], v[80:83], v[144:147]
  ds_read_b128 v[52:55], v19 offset:5120
  ds_read_b128 v[96:99], v22 offset:18432
  v_mfma_f32_16x16x32_bf16 v[148:151], v[56:59], v[76:79], v[148:151]
  s_mov_b32 m0, s73
  v_mfma_f32_16x16x32_bf16 v[152:155], v[56:59], v[80:83], v[152:155]
  ds_read_b128 v[56:59], v19 offset:6144
  s_waitcnt lgkmcnt(11)
  v_mfma_f32_16x16x32_bf16 v[156:159], v[60:63], v[76:79], v[156:159]
  buffer_load_dwordx4 v14, s[52:55], s25 offen offset:2048 lds
  v_mfma_f32_16x16x32_bf16 v[160:163], v[60:63], v[80:83], v[160:163]
  ds_read_b128 v[60:63], v19 offset:7168
  v_mfma_f32_16x16x32_bf16 v[164:167], v[64:67], v[76:79], v[164:167]
  buffer_load_dwordx4 v15, s[52:55], s25 offen offset:3072 lds
  v_mfma_f32_16x16x32_bf16 v[168:171], v[64:67], v[80:83], v[168:171]
  ds_read_b128 v[64:67], v19 offset:43008
  s_barrier
  s_waitcnt lgkmcnt(12)
  s_waitcnt lgkmcnt(3)
  v_mfma_f32_16x16x32_bf16 v[100:103], v[32:35], v[84:87], v[100:103]
  s_mov_b32 m0, s70
  v_mfma_f32_16x16x32_bf16 v[104:107], v[32:35], v[88:91], v[104:107]
  ds_read_b128 v[32:35], v19 offset:8192
  v_mfma_f32_16x16x32_bf16 v[108:111], v[36:39], v[84:87], v[108:111]
  buffer_load_dwordx4 v9, s[12:15], s24 offen sc1 lds
  v_mfma_f32_16x16x32_bf16 v[112:115], v[36:39], v[88:91], v[112:115]
  buffer_load_dwordx4 v9, s[12:15], s24 offen offset:1024 sc1 lds
  v_mfma_f32_16x16x32_bf16 v[116:119], v[40:43], v[84:87], v[116:119]
  ds_read_b128 v[36:39], v19 offset:9216
  s_add_u32 s24, s24, s38
  v_mfma_f32_16x16x32_bf16 v[120:123], v[40:43], v[88:91], v[120:123]
  s_addk_i32 s25, 128
  s_mov_b32 m0, s63
  v_mfma_f32_16x16x32_bf16 v[124:127], v[44:47], v[84:87], v[124:127]
  ds_read_b128 v[40:43], v19 offset:10240
  v_mfma_f32_16x16x32_bf16 v[128:131], v[44:47], v[88:91], v[128:131]
  buffer_load_dwordx4 v12, s[52:55], s25 offen offset:0 lds
  v_mfma_f32_16x16x32_bf16 v[132:135], v[48:51], v[84:87], v[132:135]
  ds_read_b128 v[44:47], v19 offset:11264
  v_mfma_f32_16x16x32_bf16 v[136:139], v[48:51], v[88:91], v[136:139]
  ds_read_b128 v[48:51], v19 offset:12288
  s_waitcnt lgkmcnt(7)
  v_mfma_f32_16x16x32_bf16 v[140:143], v[52:55], v[84:87], v[140:143]
  buffer_load_dwordx4 v13, s[52:55], s25 offen offset:1024 lds
  v_mfma_f32_16x16x32_bf16 v[144:147], v[52:55], v[88:91], v[144:147]
  ds_read_b128 v[52:55], v19 offset:13312
  v_mfma_f32_16x16x32_bf16 v[148:151], v[56:59], v[84:87], v[148:151]
  v_mfma_f32_16x16x32_bf16 v[152:155], v[56:59], v[88:91], v[152:155]
  ds_read_b128 v[56:59], v19 offset:14336
  s_waitcnt lgkmcnt(7)
  v_mfma_f32_16x16x32_bf16 v[156:159], v[60:63], v[84:87], v[156:159]
  v_mfma_f32_16x16x32_bf16 v[160:163], v[60:63], v[88:91], v[160:163]
  ds_read_b128 v[60:63], v19 offset:15360
  v_mfma_f32_16x16x32_bf16 v[164:167], v[64:67], v[84:87], v[164:167]
  v_mfma_f32_16x16x32_bf16 v[168:171], v[64:67], v[88:91], v[168:171]
  ds_read_b128 v[64:67], v19 offset:44032
  s_waitcnt vmcnt(10)
  s_barrier
  s_waitcnt lgkmcnt(8)
  v_mfma_f32_16x16x32_bf16 v[100:103], v[32:35], v[92:95], v[100:103]
  s_mov_b32 m0, s66
  v_mfma_f32_16x16x32_bf16 v[104:107], v[32:35], v[96:99], v[104:107]
  ds_read_b128 v[32:35], v19 offset:16384
  s_waitcnt lgkmcnt(7)
  v_mfma_f32_16x16x32_bf16 v[108:111], v[36:39], v[92:95], v[108:111]
  buffer_load_dwordx4 v9, s[12:15], s24 offen sc1 lds
  v_mfma_f32_16x16x32_bf16 v[112:115], v[36:39], v[96:99], v[112:115]
  buffer_load_dwordx4 v9, s[12:15], s24 offen offset:1024 sc1 lds
  v_mfma_f32_16x16x32_bf16 v[116:119], v[40:43], v[92:95], v[116:119]
  ds_read_b128 v[36:39], v19 offset:17408
  s_waitcnt vmcnt(6)
  v_mfma_f32_16x16x32_bf16 v[120:123], v[40:43], v[96:99], v[120:123]
  ds_read_b128 v[68:71], v21 offset:0
  s_waitcnt lgkmcnt(7)
  v_mfma_f32_16x16x32_bf16 v[124:127], v[44:47], v[92:95], v[124:127]
  ds_read_b128 v[40:43], v19 offset:18432
  v_mfma_f32_16x16x32_bf16 v[128:131], v[44:47], v[96:99], v[128:131]
  ds_read_b128 v[72:75], v21 offset:2048
  v_mfma_f32_16x16x32_bf16 v[132:135], v[48:51], v[92:95], v[132:135]
  ds_read_b128 v[44:47], v19 offset:19456
  ds_read_b128 v[76:79], v22 offset:0
  v_mfma_f32_16x16x32_bf16 v[136:139], v[48:51], v[96:99], v[136:139]
  ds_read_b128 v[48:51], v19 offset:20480
  s_waitcnt lgkmcnt(10)
  v_mfma_f32_16x16x32_bf16 v[140:143], v[52:55], v[92:95], v[140:143]
  ds_read_b128 v[80:83], v22 offset:2048
  s_mov_b32 m0, s63
  v_mfma_f32_16x16x32_bf16 v[144:147], v[52:55], v[96:99], v[144:147]
  ds_read_b128 v[52:55], v19 offset:21504
  v_mfma_f32_16x16x32_bf16 v[148:151], v[56:59], v[92:95], v[148:151]
  buffer_load_dwordx4 v14, s[52:55], s25 offen offset:2048 lds
  v_mfma_f32_16x16x32_bf16 v[152:155], v[56:59], v[96:99], v[152:155]
  ds_read_b128 v[56:59], v19 offset:22528
  s_waitcnt lgkmcnt(11)
  v_mfma_f32_16x16x32_bf16 v[156:159], v[60:63], v[92:95], v[156:159]
  buffer_load_dwordx4 v15, s[52:55], s25 offen offset:3072 lds
  v_mfma_f32_16x16x32_bf16 v[160:163], v[60:63], v[96:99], v[160:163]
  ds_read_b128 v[60:63], v19 offset:23552
  v_mfma_f32_16x16x32_bf16 v[164:167], v[64:67], v[92:95], v[164:167]
  v_mfma_f32_16x16x32_bf16 v[168:171], v[64:67], v[96:99], v[168:171]
  ds_read_b128 v[64:67], v19 offset:45056
  s_barrier
  s_waitcnt lgkmcnt(12)
  s_waitcnt lgkmcnt(4)
  v_mfma_f32_16x16x32_bf16 v[100:103], v[32:35], v[68:71], v[100:103]
  s_xor_b32 s24, s37, 9
  s_mul_i32 s24, s24, 589824
  v_mfma_f32_16x16x32_bf16 v[104:107], v[32:35], v[72:75], v[104:107]
  s_mov_b32 m0, s67
  v_mfma_f32_16x16x32_bf16 v[108:111], v[36:39], v[68:71], v[108:111]
  ds_read_b128 v[32:35], v19 offset:24576
  v_mfma_f32_16x16x32_bf16 v[112:115], v[36:39], v[72:75], v[112:115]
  buffer_load_dwordx4 v9, s[12:15], s24 offen sc1 lds
  v_mfma_f32_16x16x32_bf16 v[116:119], v[40:43], v[68:71], v[116:119]
  ds_read_b128 v[36:39], v19 offset:25600
  v_mfma_f32_16x16x32_bf16 v[120:123], v[40:43], v[72:75], v[120:123]
  ds_read_b128 v[40:43], v19 offset:26624
  v_mfma_f32_16x16x32_bf16 v[124:127], v[44:47], v[68:71], v[124:127]
  buffer_load_dwordx4 v9, s[12:15], s24 offen offset:1024 sc1 lds
  s_mov_b32 m0, s71
  v_mfma_f32_16x16x32_bf16 v[128:131], v[44:47], v[72:75], v[128:131]
  buffer_load_dwordx4 v10, s[12:15], s24 offen sc1 lds
  v_mfma_f32_16x16x32_bf16 v[132:135], v[48:51], v[68:71], v[132:135]
  ds_read_b128 v[44:47], v19 offset:27648
  s_add_u32 s24, s24, s38
  v_mfma_f32_16x16x32_bf16 v[136:139], v[48:51], v[72:75], v[136:139]
  ds_read_b128 v[48:51], v19 offset:28672
  s_waitcnt lgkmcnt(7)
  v_mfma_f32_16x16x32_bf16 v[140:143], v[52:55], v[68:71], v[140:143]
  s_xor_b32 s25, s37, 9
  s_lshl_b32 s25, s25, 8
  s_mov_b32 m0, s73
  v_mfma_f32_16x16x32_bf16 v[144:147], v[52:55], v[72:75], v[144:147]
  ds_read_b128 v[52:55], v19 offset:29696
  v_mfma_f32_16x16x32_bf16 v[148:151], v[56:59], v[68:71], v[148:151]
  buffer_load_dwordx4 v12, s[52:55], s25 offen offset:0 lds
  v_mfma_f32_16x16x32_bf16 v[152:155], v[56:59], v[72:75], v[152:155]
  ds_read_b128 v[56:59], v19 offset:30720
  s_waitcnt lgkmcnt(7)
  v_mfma_f32_16x16x32_bf16 v[156:159], v[60:63], v[68:71], v[156:159]
  buffer_load_dwordx4 v13, s[52:55], s25 offen offset:1024 lds
  v_mfma_f32_16x16x32_bf16 v[160:163], v[60:63], v[72:75], v[160:163]
  ds_read_b128 v[60:63], v19 offset:31744
  v_mfma_f32_16x16x32_bf16 v[164:167], v[64:67], v[68:71], v[164:167]
  v_mfma_f32_16x16x32_bf16 v[168:171], v[64:67], v[72:75], v[168:171]
  ds_read_b128 v[64:67], v19 offset:46080
  s_waitcnt vmcnt(11)
  s_barrier
  s_waitcnt lgkmcnt(8)
  v_mfma_f32_16x16x32_bf16 v[100:103], v[32:35], v[76:79], v[100:103]
  s_mov_b32 m0, s68
  v_mfma_f32_16x16x32_bf16 v[104:107], v[32:35], v[80:83], v[104:107]
  ds_read_b128 v[32:35], v19 offset:32768
  s_waitcnt lgkmcnt(7)
  v_mfma_f32_16x16x32_bf16 v[108:111], v[36:39], v[76:79], v[108:111]
  buffer_load_dwordx4 v9, s[12:15], s24 offen sc1 lds
  v_mfma_f32_16x16x32_bf16 v[112:115], v[36:39], v[80:83], v[112:115]
  buffer_load_dwordx4 v9, s[12:15], s24 offen offset:1024 sc1 lds
  v_mfma_f32_16x16x32_bf16 v[116:119], v[40:43], v[76:79], v[116:119]
  ds_read_b128 v[36:39], v19 offset:33792
  s_add_u32 s24, s24, s38
  v_mfma_f32_16x16x32_bf16 v[120:123], v[40:43], v[80:83], v[120:123]
  s_waitcnt vmcnt(7)
  s_waitcnt lgkmcnt(6)
  v_mfma_f32_16x16x32_bf16 v[124:127], v[44:47], v[76:79], v[124:127]
  ds_read_b128 v[40:43], v19 offset:34816
  ds_read_b128 v[84:87], v21 offset:16384
  v_mfma_f32_16x16x32_bf16 v[128:131], v[44:47], v[80:83], v[128:131]
  ds_read_b128 v[88:91], v21 offset:18432
  v_mfma_f32_16x16x32_bf16 v[132:135], v[48:51], v[76:79], v[132:135]
  ds_read_b128 v[44:47], v19 offset:35840
  v_mfma_f32_16x16x32_bf16 v[136:139], v[48:51], v[80:83], v[136:139]
  ds_read_b128 v[48:51], v19 offset:36864
  s_waitcnt lgkmcnt(9)
  v_mfma_f32_16x16x32_bf16 v[140:143], v[52:55], v[76:79], v[140:143]
  ds_read_b128 v[92:95], v22 offset:16384
  v_mfma_f32_16x16x32_bf16 v[144:147], v[52:55], v[80:83], v[144:147]
  ds_read_b128 v[52:55], v19 offset:37888
  ds_read_b128 v[96:99], v22 offset:18432
  v_mfma_f32_16x16x32_bf16 v[148:151], v[56:59], v[76:79], v[148:151]
  s_mov_b32 m0, s73
  v_mfma_f32_16x16x32_bf16 v[152:155], v[56:59], v[80:83], v[152:155]
  ds_read_b128 v[56:59], v19 offset:38912
  s_waitcnt lgkmcnt(11)
  v_mfma_f32_16x16x32_bf16 v[156:159], v[60:63], v[76:79], v[156:159]
  buffer_load_dwordx4 v14, s[52:55], s25 offen offset:2048 lds
  v_mfma_f32_16x16x32_bf16 v[160:163], v[60:63], v[80:83], v[160:163]
  ds_read_b128 v[60:63], v19 offset:39936
  v_mfma_f32_16x16x32_bf16 v[164:167], v[64:67], v[76:79], v[164:167]
  buffer_load_dwordx4 v15, s[52:55], s25 offen offset:3072 lds
  v_mfma_f32_16x16x32_bf16 v[168:171], v[64:67], v[80:83], v[168:171]
  ds_read_b128 v[64:67], v19 offset:47104
  s_barrier
  s_waitcnt lgkmcnt(12)
  s_waitcnt lgkmcnt(3)
  v_mfma_f32_16x16x32_bf16 v[100:103], v[32:35], v[84:87], v[100:103]
  s_mov_b32 m0, s69
  v_mfma_f32_16x16x32_bf16 v[104:107], v[32:35], v[88:91], v[104:107]
  ds_read_b128 v[32:35], v19 offset:0
  v_mfma_f32_16x16x32_bf16 v[108:111], v[36:39], v[84:87], v[108:111]
  buffer_load_dwordx4 v9, s[12:15], s24 offen sc1 lds
  v_mfma_f32_16x16x32_bf16 v[112:115], v[36:39], v[88:91], v[112:115]
  buffer_load_dwordx4 v9, s[12:15], s24 offen offset:1024 sc1 lds
  v_mfma_f32_16x16x32_bf16 v[116:119], v[40:43], v[84:87], v[116:119]
  ds_read_b128 v[36:39], v19 offset:1024
  s_add_u32 s24, s24, s38
  v_mfma_f32_16x16x32_bf16 v[120:123], v[40:43], v[88:91], v[120:123]
  s_addk_i32 s25, 128
  s_mov_b32 m0, s63
  v_mfma_f32_16x16x32_bf16 v[124:127], v[44:47], v[84:87], v[124:127]
  ds_read_b128 v[40:43], v19 offset:2048
  v_mfma_f32_16x16x32_bf16 v[128:131], v[44:47], v[88:91], v[128:131]
  buffer_load_dwordx4 v12, s[52:55], s25 offen offset:0 lds
  v_mfma_f32_16x16x32_bf16 v[132:135], v[48:51], v[84:87], v[132:135]
  ds_read_b128 v[44:47], v19 offset:3072
  v_mfma_f32_16x16x32_bf16 v[136:139], v[48:51], v[88:91], v[136:139]
  ds_read_b128 v[48:51], v19 offset:4096
  s_waitcnt lgkmcnt(7)
  v_mfma_f32_16x16x32_bf16 v[140:143], v[52:55], v[84:87], v[140:143]
  buffer_load_dwordx4 v13, s[52:55], s25 offen offset:1024 lds
  v_mfma_f32_16x16x32_bf16 v[144:147], v[52:55], v[88:91], v[144:147]
  ds_read_b128 v[52:55], v19 offset:5120
  v_mfma_f32_16x16x32_bf16 v[148:151], v[56:59], v[84:87], v[148:151]
  v_mfma_f32_16x16x32_bf16 v[152:155], v[56:59], v[88:91], v[152:155]
  ds_read_b128 v[56:59], v19 offset:6144
  s_waitcnt lgkmcnt(7)
  v_mfma_f32_16x16x32_bf16 v[156:159], v[60:63], v[84:87], v[156:159]
  v_mfma_f32_16x16x32_bf16 v[160:163], v[60:63], v[88:91], v[160:163]
  ds_read_b128 v[60:63], v19 offset:7168
  v_mfma_f32_16x16x32_bf16 v[164:167], v[64:67], v[84:87], v[164:167]
  v_mfma_f32_16x16x32_bf16 v[168:171], v[64:67], v[88:91], v[168:171]
  ds_read_b128 v[64:67], v19 offset:48128
  s_waitcnt vmcnt(10)
  s_barrier
  s_waitcnt lgkmcnt(8)
  v_mfma_f32_16x16x32_bf16 v[100:103], v[32:35], v[92:95], v[100:103]
  s_mov_b32 m0, s70
  v_mfma_f32_16x16x32_bf16 v[104:107], v[32:35], v[96:99], v[104:107]
  ds_read_b128 v[32:35], v19 offset:8192
  s_waitcnt lgkmcnt(7)
  v_mfma_f32_16x16x32_bf16 v[108:111], v[36:39], v[92:95], v[108:111]
  buffer_load_dwordx4 v9, s[12:15], s24 offen sc1 lds
  v_mfma_f32_16x16x32_bf16 v[112:115], v[36:39], v[96:99], v[112:115]
  buffer_load_dwordx4 v9, s[12:15], s24 offen offset:1024 sc1 lds
  v_mfma_f32_16x16x32_bf16 v[116:119], v[40:43], v[92:95], v[116:119]
  ds_read_b128 v[36:39], v19 offset:9216
  s_waitcnt vmcnt(6)
  v_mfma_f32_16x16x32_bf16 v[120:123], v[40:43], v[96:99], v[120:123]
  ds_read_b128 v[68:71], v21 offset:0
  s_waitcnt lgkmcnt(7)
  v_mfma_f32_16x16x32_bf16 v[124:127], v[44:47], v[92:95], v[124:127]
  ds_read_b128 v[40:43], v19 offset:10240
  v_mfma_f32_16x16x32_bf16 v[128:131], v[44:47], v[96:99], v[128:131]
  ds_read_b128 v[72:75], v21 offset:2048
  v_mfma_f32_16x16x32_bf16 v[132:135], v[48:51], v[92:95], v[132:135]
  ds_read_b128 v[44:47], v19 offset:11264
  ds_read_b128 v[76:79], v22 offset:0
  v_mfma_f32_16x16x32_bf16 v[136:139], v[48:51], v[96:99], v[136:139]
  ds_read_b128 v[48:51], v19 offset:12288
  s_waitcnt lgkmcnt(10)
  v_mfma_f32_16x16x32_bf16 v[140:143], v[52:55], v[92:95], v[140:143]
  ds_read_b128 v[80:83], v22 offset:2048
  s_mov_b32 m0, s63
  v_mfma_f32_16x16x32_bf16 v[144:147], v[52:55], v[96:99], v[144:147]
  ds_read_b128 v[52:55], v19 offset:13312
  v_mfma_f32_16x16x32_bf16 v[148:151], v[56:59], v[92:95], v[148:151]
  buffer_load_dwordx4 v14, s[52:55], s25 offen offset:2048 lds
  v_mfma_f32_16x16x32_bf16 v[152:155], v[56:59], v[96:99], v[152:155]
  ds_read_b128 v[56:59], v19 offset:14336
  s_waitcnt lgkmcnt(11)
  v_mfma_f32_16x16x32_bf16 v[156:159], v[60:63], v[92:95], v[156:159]
  buffer_load_dwordx4 v15, s[52:55], s25 offen offset:3072 lds
  v_mfma_f32_16x16x32_bf16 v[160:163], v[60:63], v[96:99], v[160:163]
  ds_read_b128 v[60:63], v19 offset:15360
  v_mfma_f32_16x16x32_bf16 v[164:167], v[64:67], v[92:95], v[164:167]
  v_mfma_f32_16x16x32_bf16 v[168:171], v[64:67], v[96:99], v[168:171]
  ds_read_b128 v[64:67], v19 offset:40960
  s_barrier
  s_waitcnt lgkmcnt(12)
  s_waitcnt lgkmcnt(4)
  v_mfma_f32_16x16x32_bf16 v[100:103], v[32:35], v[68:71], v[100:103]
  s_xor_b32 s24, s37, 10
  s_mul_i32 s24, s24, 589824
  v_mfma_f32_16x16x32_bf16 v[104:107], v[32:35], v[72:75], v[104:107]
  s_mov_b32 m0, s66
  v_mfma_f32_16x16x32_bf16 v[108:111], v[36:39], v[68:71], v[108:111]
  ds_read_b128 v[32:35], v19 offset:16384
  v_mfma_f32_16x16x32_bf16 v[112:115], v[36:39], v[72:75], v[112:115]
  buffer_load_dwordx4 v9, s[12:15], s24 offen sc1 lds
  v_mfma_f32_16x16x32_bf16 v[116:119], v[40:43], v[68:71], v[116:119]
  ds_read_b128 v[36:39], v19 offset:17408
  v_mfma_f32_16x16x32_bf16 v[120:123], v[40:43], v[72:75], v[120:123]
  ds_read_b128 v[40:43], v19 offset:18432
  v_mfma_f32_16x16x32_bf16 v[124:127], v[44:47], v[68:71], v[124:127]
  buffer_load_dwordx4 v9, s[12:15], s24 offen offset:1024 sc1 lds
  s_mov_b32 m0, s72
  v_mfma_f32_16x16x32_bf16 v[128:131], v[44:47], v[72:75], v[128:131]
  buffer_load_dwordx4 v10, s[12:15], s24 offen sc1 lds
  v_mfma_f32_16x16x32_bf16 v[132:135], v[48:51], v[68:71], v[132:135]
  ds_read_b128 v[44:47], v19 offset:19456
  s_add_u32 s24, s24, s38
  v_mfma_f32_16x16x32_bf16 v[136:139], v[48:51], v[72:75], v[136:139]
  ds_read_b128 v[48:51], v19 offset:20480
  s_waitcnt lgkmcnt(7)
  v_mfma_f32_16x16x32_bf16 v[140:143], v[52:55], v[68:71], v[140:143]
  s_xor_b32 s25, s37, 10
  s_lshl_b32 s25, s25, 8
  s_mov_b32 m0, s73
  v_mfma_f32_16x16x32_bf16 v[144:147], v[52:55], v[72:75], v[144:147]
  ds_read_b128 v[52:55], v19 offset:21504
  v_mfma_f32_16x16x32_bf16 v[148:151], v[56:59], v[68:71], v[148:151]
  buffer_load_dwordx4 v12, s[52:55], s25 offen offset:0 lds
  v_mfma_f32_16x16x32_bf16 v[152:155], v[56:59], v[72:75], v[152:155]
  ds_read_b128 v[56:59], v19 offset:22528
  s_waitcnt lgkmcnt(7)
  v_mfma_f32_16x16x32_bf16 v[156:159], v[60:63], v[68:71], v[156:159]
  buffer_load_dwordx4 v13, s[52:55], s25 offen offset:1024 lds
  v_mfma_f32_16x16x32_bf16 v[160:163], v[60:63], v[72:75], v[160:163]
  ds_read_b128 v[60:63], v19 offset:23552
  v_mfma_f32_16x16x32_bf16 v[164:167], v[64:67], v[68:71], v[164:167]
  v_mfma_f32_16x16x32_bf16 v[168:171], v[64:67], v[72:75], v[168:171]
  ds_read_b128 v[64:67], v19 offset:41984
  s_waitcnt vmcnt(11)
  s_barrier
  s_waitcnt lgkmcnt(8)
  v_mfma_f32_16x16x32_bf16 v[100:103], v[32:35], v[76:79], v[100:103]
  s_mov_b32 m0, s67
  v_mfma_f32_16x16x32_bf16 v[104:107], v[32:35], v[80:83], v[104:107]
  ds_read_b128 v[32:35], v19 offset:24576
  s_waitcnt lgkmcnt(7)
  v_mfma_f32_16x16x32_bf16 v[108:111], v[36:39], v[76:79], v[108:111]
  buffer_load_dwordx4 v9, s[12:15], s24 offen sc1 lds
  v_mfma_f32_16x16x32_bf16 v[112:115], v[36:39], v[80:83], v[112:115]
  buffer_load_dwordx4 v9, s[12:15], s24 offen offset:1024 sc1 lds
  v_mfma_f32_16x16x32_bf16 v[116:119], v[40:43], v[76:79], v[116:119]
  ds_read_b128 v[36:39], v19 offset:25600
  s_add_u32 s24, s24, s38
  v_mfma_f32_16x16x32_bf16 v[120:123], v[40:43], v[80:83], v[120:123]
  s_waitcnt vmcnt(7)
  s_waitcnt lgkmcnt(6)
  v_mfma_f32_16x16x32_bf16 v[124:127], v[44:47], v[76:79], v[124:127]
  ds_read_b128 v[40:43], v19 offset:26624
  ds_read_b128 v[84:87], v21 offset:16384
  v_mfma_f32_16x16x32_bf16 v[128:131], v[44:47], v[80:83], v[128:131]
  ds_read_b128 v[88:91], v21 offset:18432
  v_mfma_f32_16x16x32_bf16 v[132:135], v[48:51], v[76:79], v[132:135]
  ds_read_b128 v[44:47], v19 offset:27648
  v_mfma_f32_16x16x32_bf16 v[136:139], v[48:51], v[80:83], v[136:139]
  ds_read_b128 v[48:51], v19 offset:28672
  s_waitcnt lgkmcnt(9)
  v_mfma_f32_16x16x32_bf16 v[140:143], v[52:55], v[76:79], v[140:143]
  ds_read_b128 v[92:95], v22 offset:16384
  v_mfma_f32_16x16x32_bf16 v[144:147], v[52:55], v[80:83], v[144:147]
  ds_read_b128 v[52:55], v19 offset:29696
  ds_read_b128 v[96:99], v22 offset:18432
  v_mfma_f32_16x16x32_bf16 v[148:151], v[56:59], v[76:79], v[148:151]
  s_mov_b32 m0, s73
  v_mfma_f32_16x16x32_bf16 v[152:155], v[56:59], v[80:83], v[152:155]
  ds_read_b128 v[56:59], v19 offset:30720
  s_waitcnt lgkmcnt(11)
  v_mfma_f32_16x16x32_bf16 v[156:159], v[60:63], v[76:79], v[156:159]
  buffer_load_dwordx4 v14, s[52:55], s25 offen offset:2048 lds
  v_mfma_f32_16x16x32_bf16 v[160:163], v[60:63], v[80:83], v[160:163]
  ds_read_b128 v[60:63], v19 offset:31744
  v_mfma_f32_16x16x32_bf16 v[164:167], v[64:67], v[76:79], v[164:167]
  buffer_load_dwordx4 v15, s[52:55], s25 offen offset:3072 lds
  v_mfma_f32_16x16x32_bf16 v[168:171], v[64:67], v[80:83], v[168:171]
  ds_read_b128 v[64:67], v19 offset:43008
  s_barrier
  s_waitcnt lgkmcnt(12)
  s_waitcnt lgkmcnt(3)
  v_mfma_f32_16x16x32_bf16 v[100:103], v[32:35], v[84:87], v[100:103]
  s_mov_b32 m0, s68
  v_mfma_f32_16x16x32_bf16 v[104:107], v[32:35], v[88:91], v[104:107]
  ds_read_b128 v[32:35], v19 offset:32768
  v_mfma_f32_16x16x32_bf16 v[108:111], v[36:39], v[84:87], v[108:111]
  buffer_load_dwordx4 v9, s[12:15], s24 offen sc1 lds
  v_mfma_f32_16x16x32_bf16 v[112:115], v[36:39], v[88:91], v[112:115]
  buffer_load_dwordx4 v9, s[12:15], s24 offen offset:1024 sc1 lds
  v_mfma_f32_16x16x32_bf16 v[116:119], v[40:43], v[84:87], v[116:119]
  ds_read_b128 v[36:39], v19 offset:33792
  s_add_u32 s24, s24, s38
  v_mfma_f32_16x16x32_bf16 v[120:123], v[40:43], v[88:91], v[120:123]
  s_addk_i32 s25, 128
  s_mov_b32 m0, s63
  v_mfma_f32_16x16x32_bf16 v[124:127], v[44:47], v[84:87], v[124:127]
  ds_read_b128 v[40:43], v19 offset:34816
  v_mfma_f32_16x16x32_bf16 v[128:131], v[44:47], v[88:91], v[128:131]
  buffer_load_dwordx4 v12, s[52:55], s25 offen offset:0 lds
  v_mfma_f32_16x16x32_bf16 v[132:135], v[48:51], v[84:87], v[132:135]
  ds_read_b128 v[44:47], v19 offset:35840
  v_mfma_f32_16x16x32_bf16 v[136:139], v[48:51], v[88:91], v[136:139]
  ds_read_b128 v[48:51], v19 offset:36864
  s_waitcnt lgkmcnt(7)
  v_mfma_f32_16x16x32_bf16 v[140:143], v[52:55], v[84:87], v[140:143]
  buffer_load_dwordx4 v13, s[52:55], s25 offen offset:1024 lds
  v_mfma_f32_16x16x32_bf16 v[144:147], v[52:55], v[88:91], v[144:147]
  ds_read_b128 v[52:55], v19 offset:37888
  v_mfma_f32_16x16x32_bf16 v[148:151], v[56:59], v[84:87], v[148:151]
  v_mfma_f32_16x16x32_bf16 v[152:155], v[56:59], v[88:91], v[152:155]
  ds_read_b128 v[56:59], v19 offset:38912
  s_waitcnt lgkmcnt(7)
  v_mfma_f32_16x16x32_bf16 v[156:159], v[60:63], v[84:87], v[156:159]
  v_mfma_f32_16x16x32_bf16 v[160:163], v[60:63], v[88:91], v[160:163]
  ds_read_b128 v[60:63], v19 offset:39936
  v_mfma_f32_16x16x32_bf16 v[164:167], v[64:67], v[84:87], v[164:167]
  v_mfma_f32_16x16x32_bf16 v[168:171], v[64:67], v[88:91], v[168:171]
  ds_read_b128 v[64:67], v19 offset:44032
  s_waitcnt vmcnt(10)
  s_barrier
  s_waitcnt lgkmcnt(8)
  v_mfma_f32_16x16x32_bf16 v[100:103], v[32:35], v[92:95], v[100:103]
  s_mov_b32 m0, s69
  v_mfma_f32_16x16x32_bf16 v[104:107], v[32:35], v[96:99], v[104:107]
  ds_read_b128 v[32:35], v19 offset:0
  s_waitcnt lgkmcnt(7)
  v_mfma_f32_16x16x32_bf16 v[108:111], v[36:39], v[92:95], v[108:111]
  buffer_load_dwordx4 v9, s[12:15], s24 offen sc1 lds
  v_mfma_f32_16x16x32_bf16 v[112:115], v[36:39], v[96:99], v[112:115]
  buffer_load_dwordx4 v9, s[12:15], s24 offen offset:1024 sc1 lds
  v_mfma_f32_16x16x32_bf16 v[116:119], v[40:43], v[92:95], v[116:119]
  ds_read_b128 v[36:39], v19 offset:1024
  s_waitcnt vmcnt(6)
  v_mfma_f32_16x16x32_bf16 v[120:123], v[40:43], v[96:99], v[120:123]
  ds_read_b128 v[68:71], v21 offset:0
  s_waitcnt lgkmcnt(7)
  v_mfma_f32_16x16x32_bf16 v[124:127], v[44:47], v[92:95], v[124:127]
  ds_read_b128 v[40:43], v19 offset:2048
  v_mfma_f32_16x16x32_bf16 v[128:131], v[44:47], v[96:99], v[128:131]
  ds_read_b128 v[72:75], v21 offset:2048
  v_mfma_f32_16x16x32_bf16 v[132:135], v[48:51], v[92:95], v[132:135]
  ds_read_b128 v[44:47], v19 offset:3072
  ds_read_b128 v[76:79], v22 offset:0
  v_mfma_f32_16x16x32_bf16 v[136:139], v[48:51], v[96:99], v[136:139]
  ds_read_b128 v[48:51], v19 offset:4096
  s_waitcnt lgkmcnt(10)
  v_mfma_f32_16x16x32_bf16 v[140:143], v[52:55], v[92:95], v[140:143]
  ds_read_b128 v[80:83], v22 offset:2048
  s_mov_b32 m0, s63
  v_mfma_f32_16x16x32_bf16 v[144:147], v[52:55], v[96:99], v[144:147]
  ds_read_b128 v[52:55], v19 offset:5120
  v_mfma_f32_16x16x32_bf16 v[148:151], v[56:59], v[92:95], v[148:151]
  buffer_load_dwordx4 v14, s[52:55], s25 offen offset:2048 lds
  v_mfma_f32_16x16x32_bf16 v[152:155], v[56:59], v[96:99], v[152:155]
  ds_read_b128 v[56:59], v19 offset:6144
  s_waitcnt lgkmcnt(11)
  v_mfma_f32_16x16x32_bf16 v[156:159], v[60:63], v[92:95], v[156:159]
  buffer_load_dwordx4 v15, s[52:55], s25 offen offset:3072 lds
  v_mfma_f32_16x16x32_bf16 v[160:163], v[60:63], v[96:99], v[160:163]
  ds_read_b128 v[60:63], v19 offset:7168
  v_mfma_f32_16x16x32_bf16 v[164:167], v[64:67], v[92:95], v[164:167]
  v_mfma_f32_16x16x32_bf16 v[168:171], v[64:67], v[96:99], v[168:171]
  ds_read_b128 v[64:67], v19 offset:45056
  s_barrier
  s_waitcnt lgkmcnt(12)
  s_waitcnt lgkmcnt(4)
  v_mfma_f32_16x16x32_bf16 v[100:103], v[32:35], v[68:71], v[100:103]
  s_xor_b32 s24, s37, 11
  s_mul_i32 s24, s24, 589824
  v_mfma_f32_16x16x32_bf16 v[104:107], v[32:35], v[72:75], v[104:107]
  s_mov_b32 m0, s70
  v_mfma_f32_16x16x32_bf16 v[108:111], v[36:39], v[68:71], v[108:111]
  ds_read_b128 v[32:35], v19 offset:8192
  v_mfma_f32_16x16x32_bf16 v[112:115], v[36:39], v[72:75], v[112:115]
  buffer_load_dwordx4 v9, s[12:15], s24 offen sc1 lds
  v_mfma_f32_16x16x32_bf16 v[116:119], v[40:43], v[68:71], v[116:119]
  ds_read_b128 v[36:39], v19 offset:9216
  v_mfma_f32_16x16x32_bf16 v[120:123], v[40:43], v[72:75], v[120:123]
  ds_read_b128 v[40:43], v19 offset:10240
  v_mfma_f32_16x16x32_bf16 v[124:127], v[44:47], v[68:71], v[124:127]
  buffer_load_dwordx4 v9, s[12:15], s24 offen offset:1024 sc1 lds
  s_mov_b32 m0, s71
  v_mfma_f32_16x16x32_bf16 v[128:131], v[44:47], v[72:75], v[128:131]
  buffer_load_dwordx4 v10, s[12:15], s24 offen sc1 lds
  v_mfma_f32_16x16x32_bf16 v[132:135], v[48:51], v[68:71], v[132:135]
  ds_read_b128 v[44:47], v19 offset:11264
  s_add_u32 s24, s24, s38
  v_mfma_f32_16x16x32_bf16 v[136:139], v[48:51], v[72:75], v[136:139]
  ds_read_b128 v[48:51], v19 offset:12288
  s_waitcnt lgkmcnt(7)
  v_mfma_f32_16x16x32_bf16 v[140:143], v[52:55], v[68:71], v[140:143]
  s_xor_b32 s25, s37, 11
  s_lshl_b32 s25, s25, 8
  s_mov_b32 m0, s73
  v_mfma_f32_16x16x32_bf16 v[144:147], v[52:55], v[72:75], v[144:147]
  ds_read_b128 v[52:55], v19 offset:13312
  v_mfma_f32_16x16x32_bf16 v[148:151], v[56:59], v[68:71], v[148:151]
  buffer_load_dwordx4 v12, s[52:55], s25 offen offset:0 lds
  v_mfma_f32_16x16x32_bf16 v[152:155], v[56:59], v[72:75], v[152:155]
  ds_read_b128 v[56:59], v19 offset:14336
  s_waitcnt lgkmcnt(7)
  v_mfma_f32_16x16x32_bf16 v[156:159], v[60:63], v[68:71], v[156:159]
  buffer_load_dwordx4 v13, s[52:55], s25 offen offset:1024 lds
  v_mfma_f32_16x16x32_bf16 v[160:163], v[60:63], v[72:75], v[160:163]
  ds_read_b128 v[60:63], v19 offset:15360
  v_mfma_f32_16x16x32_bf16 v[164:167], v[64:67], v[68:71], v[164:167]
  v_mfma_f32_16x16x32_bf16 v[168:171], v[64:67], v[72:75], v[168:171]
  ds_read_b128 v[64:67], v19 offset:46080
  s_waitcnt vmcnt(11)
  s_barrier
  s_waitcnt lgkmcnt(8)
  v_mfma_f32_16x16x32_bf16 v[100:103], v[32:35], v[76:79], v[100:103]
  s_mov_b32 m0, s66
  v_mfma_f32_16x16x32_bf16 v[104:107], v[32:35], v[80:83], v[104:107]
  ds_read_b128 v[32:35], v19 offset:16384
  s_waitcnt lgkmcnt(7)
  v_mfma_f32_16x16x32_bf16 v[108:111], v[36:39], v[76:79], v[108:111]
  buffer_load_dwordx4 v9, s[12:15], s24 offen sc1 lds
  v_mfma_f32_16x16x32_bf16 v[112:115], v[36:39], v[80:83], v[112:115]
  buffer_load_dwordx4 v9, s[12:15], s24 offen offset:1024 sc1 lds
  v_mfma_f32_16x16x32_bf16 v[116:119], v[40:43], v[76:79], v[116:119]
  ds_read_b128 v[36:39], v19 offset:17408
  s_add_u32 s24, s24, s38
  v_mfma_f32_16x16x32_bf16 v[120:123], v[40:43], v[80:83], v[120:123]
  s_waitcnt vmcnt(7)
  s_waitcnt lgkmcnt(6)
  v_mfma_f32_16x16x32_bf16 v[124:127], v[44:47], v[76:79], v[124:127]
  ds_read_b128 v[40:43], v19 offset:18432
  ds_read_b128 v[84:87], v21 offset:16384
  v_mfma_f32_16x16x32_bf16 v[128:131], v[44:47], v[80:83], v[128:131]
  ds_read_b128 v[88:91], v21 offset:18432
  v_mfma_f32_16x16x32_bf16 v[132:135], v[48:51], v[76:79], v[132:135]
  ds_read_b128 v[44:47], v19 offset:19456
  v_mfma_f32_16x16x32_bf16 v[136:139], v[48:51], v[80:83], v[136:139]
  ds_read_b128 v[48:51], v19 offset:20480
  s_waitcnt lgkmcnt(9)
  v_mfma_f32_16x16x32_bf16 v[140:143], v[52:55], v[76:79], v[140:143]
  ds_read_b128 v[92:95], v22 offset:16384
  v_mfma_f32_16x16x32_bf16 v[144:147], v[52:55], v[80:83], v[144:147]
  ds_read_b128 v[52:55], v19 offset:21504
  ds_read_b128 v[96:99], v22 offset:18432
  v_mfma_f32_16x16x32_bf16 v[148:151], v[56:59], v[76:79], v[148:151]
  s_mov_b32 m0, s73
  v_mfma_f32_16x16x32_bf16 v[152:155], v[56:59], v[80:83], v[152:155]
  ds_read_b128 v[56:59], v19 offset:22528
  s_waitcnt lgkmcnt(11)
  v_mfma_f32_16x16x32_bf16 v[156:159], v[60:63], v[76:79], v[156:159]
  buffer_load_dwordx4 v14, s[52:55], s25 offen offset:2048 lds
  v_mfma_f32_16x16x32_bf16 v[160:163], v[60:63], v[80:83], v[160:163]
  ds_read_b128 v[60:63], v19 offset:23552
  v_mfma_f32_16x16x32_bf16 v[164:167], v[64:67], v[76:79], v[164:167]
  buffer_load_dwordx4 v15, s[52:55], s25 offen offset:3072 lds
  v_mfma_f32_16x16x32_bf16 v[168:171], v[64:67], v[80:83], v[168:171]
  ds_read_b128 v[64:67], v19 offset:47104
  s_barrier
  s_waitcnt lgkmcnt(12)
  s_waitcnt lgkmcnt(3)
  v_mfma_f32_16x16x32_bf16 v[100:103], v[32:35], v[84:87], v[100:103]
  s_mov_b32 m0, s67
  v_mfma_f32_16x16x32_bf16 v[104:107], v[32:35], v[88:91], v[104:107]
  ds_read_b128 v[32:35], v19 offset:24576
  v_mfma_f32_16x16x32_bf16 v[108:111], v[36:39], v[84:87], v[108:111]
  buffer_load_dwordx4 v9, s[12:15], s24 offen sc1 lds
  v_mfma_f32_16x16x32_bf16 v[112:115], v[36:39], v[88:91], v[112:115]
  buffer_load_dwordx4 v9, s[12:15], s24 offen offset:1024 sc1 lds
  v_mfma_f32_16x16x32_bf16 v[116:119], v[40:43], v[84:87], v[116:119]
  ds_read_b128 v[36:39], v19 offset:25600
  s_add_u32 s24, s24, s38
  v_mfma_f32_16x16x32_bf16 v[120:123], v[40:43], v[88:91], v[120:123]
  s_addk_i32 s25, 128
  s_mov_b32 m0, s63
  v_mfma_f32_16x16x32_bf16 v[124:127], v[44:47], v[84:87], v[124:127]
  ds_read_b128 v[40:43], v19 offset:26624
  v_mfma_f32_16x16x32_bf16 v[128:131], v[44:47], v[88:91], v[128:131]
  buffer_load_dwordx4 v12, s[52:55], s25 offen offset:0 lds
  v_mfma_f32_16x16x32_bf16 v[132:135], v[48:51], v[84:87], v[132:135]
  ds_read_b128 v[44:47], v19 offset:27648
  v_mfma_f32_16x16x32_bf16 v[136:139], v[48:51], v[88:91], v[136:139]
  ds_read_b128 v[48:51], v19 offset:28672
  s_waitcnt lgkmcnt(7)
  v_mfma_f32_16x16x32_bf16 v[140:143], v[52:55], v[84:87], v[140:143]
  buffer_load_dwordx4 v13, s[52:55], s25 offen offset:1024 lds
  v_mfma_f32_16x16x32_bf16 v[144:147], v[52:55], v[88:91], v[144:147]
  ds_read_b128 v[52:55], v19 offset:29696
  v_mfma_f32_16x16x32_bf16 v[148:151], v[56:59], v[84:87], v[148:151]
  v_mfma_f32_16x16x32_bf16 v[152:155], v[56:59], v[88:91], v[152:155]
  ds_read_b128 v[56:59], v19 offset:30720
  s_waitcnt lgkmcnt(7)
  v_mfma_f32_16x16x32_bf16 v[156:159], v[60:63], v[84:87], v[156:159]
  v_mfma_f32_16x16x32_bf16 v[160:163], v[60:63], v[88:91], v[160:163]
  ds_read_b128 v[60:63], v19 offset:31744
  v_mfma_f32_16x16x32_bf16 v[164:167], v[64:67], v[84:87], v[164:167]
  v_mfma_f32_16x16x32_bf16 v[168:171], v[64:67], v[88:91], v[168:171]
  ds_read_b128 v[64:67], v19 offset:48128
  s_waitcnt vmcnt(10)
  s_barrier
  s_waitcnt lgkmcnt(8)
  v_mfma_f32_16x16x32_bf16 v[100:103], v[32:35], v[92:95], v[100:103]
  s_mov_b32 m0, s68
  v_mfma_f32_16x16x32_bf16 v[104:107], v[32:35], v[96:99], v[104:107]
  ds_read_b128 v[32:35], v19 offset:32768
  s_waitcnt lgkmcnt(7)
  v_mfma_f32_16x16x32_bf16 v[108:111], v[36:39], v[92:95], v[108:111]
  buffer_load_dwordx4 v9, s[12:15], s24 offen sc1 lds
  v_mfma_f32_16x16x32_bf16 v[112:115], v[36:39], v[96:99], v[112:115]
  buffer_load_dwordx4 v9, s[12:15], s24 offen offset:1024 sc1 lds
  v_mfma_f32_16x16x32_bf16 v[116:119], v[40:43], v[92:95], v[116:119]
  ds_read_b128 v[36:39], v19 offset:33792
  s_waitcnt vmcnt(6)
  v_mfma_f32_16x16x32_bf16 v[120:123], v[40:43], v[96:99], v[120:123]
  ds_read_b128 v[68:71], v21 offset:0
  s_waitcnt lgkmcnt(7)
  v_mfma_f32_16x16x32_bf16 v[124:127], v[44:47], v[92:95], v[124:127]
  ds_read_b128 v[40:43], v19 offset:34816
  v_mfma_f32_16x16x32_bf16 v[128:131], v[44:47], v[96:99], v[128:131]
  ds_read_b128 v[72:75], v21 offset:2048
  v_mfma_f32_16x16x32_bf16 v[132:135], v[48:51], v[92:95], v[132:135]
  ds_read_b128 v[44:47], v19 offset:35840
  ds_read_b128 v[76:79], v22 offset:0
  v_mfma_f32_16x16x32_bf16 v[136:139], v[48:51], v[96:99], v[136:139]
  ds_read_b128 v[48:51], v19 offset:36864
  s_waitcnt lgkmcnt(10)
  v_mfma_f32_16x16x32_bf16 v[140:143], v[52:55], v[92:95], v[140:143]
  ds_read_b128 v[80:83], v22 offset:2048
  s_mov_b32 m0, s63
  v_mfma_f32_16x16x32_bf16 v[144:147], v[52:55], v[96:99], v[144:147]
  ds_read_b128 v[52:55], v19 offset:37888
  v_mfma_f32_16x16x32_bf16 v[148:151], v[56:59], v[92:95], v[148:151]
  buffer_load_dwordx4 v14, s[52:55], s25 offen offset:2048 lds
  v_mfma_f32_16x16x32_bf16 v[152:155], v[56:59], v[96:99], v[152:155]
  ds_read_b128 v[56:59], v19 offset:38912
  s_waitcnt lgkmcnt(11)
  v_mfma_f32_16x16x32_bf16 v[156:159], v[60:63], v[92:95], v[156:159]
  buffer_load_dwordx4 v15, s[52:55], s25 offen offset:3072 lds
  v_mfma_f32_16x16x32_bf16 v[160:163], v[60:63], v[96:99], v[160:163]
  ds_read_b128 v[60:63], v19 offset:39936
  v_mfma_f32_16x16x32_bf16 v[164:167], v[64:67], v[92:95], v[164:167]
  v_mfma_f32_16x16x32_bf16 v[168:171], v[64:67], v[96:99], v[168:171]
  ds_read_b128 v[64:67], v19 offset:40960
  s_barrier
  s_waitcnt lgkmcnt(12)
  s_waitcnt lgkmcnt(4)
  v_mfma_f32_16x16x32_bf16 v[100:103], v[32:35], v[68:71], v[100:103]
  s_xor_b32 s24, s37, 12
  s_mul_i32 s24, s24, 589824
  v_mfma_f32_16x16x32_bf16 v[104:107], v[32:35], v[72:75], v[104:107]
  s_mov_b32 m0, s69
  v_mfma_f32_16x16x32_bf16 v[108:111], v[36:39], v[68:71], v[108:111]
  ds_read_b128 v[32:35], v19 offset:0
  v_mfma_f32_16x16x32_bf16 v[112:115], v[36:39], v[72:75], v[112:115]
  buffer_load_dwordx4 v9, s[12:15], s24 offen sc1 lds
  v_mfma_f32_16x16x32_bf16 v[116:119], v[40:43], v[68:71], v[116:119]
  ds_read_b128 v[36:39], v19 offset:1024
  v_mfma_f32_16x16x32_bf16 v[120:123], v[40:43], v[72:75], v[120:123]
  ds_read_b128 v[40:43], v19 offset:2048
  v_mfma_f32_16x16x32_bf16 v[124:127], v[44:47], v[68:71], v[124:127]
  buffer_load_dwordx4 v9, s[12:15], s24 offen offset:1024 sc1 lds
  s_mov_b32 m0, s72
  v_mfma_f32_16x16x32_bf16 v[128:131], v[44:47], v[72:75], v[128:131]
  buffer_load_dwordx4 v10, s[12:15], s24 offen sc1 lds
  v_mfma_f32_16x16x32_bf16 v[132:135], v[48:51], v[68:71], v[132:135]
  ds_read_b128 v[44:47], v19 offset:3072
  s_add_u32 s24, s24, s38
  v_mfma_f32_16x16x32_bf16 v[136:139], v[48:51], v[72:75], v[136:139]
  ds_read_b128 v[48:51], v19 offset:4096
  s_waitcnt lgkmcnt(7)
  v_mfma_f32_16x16x32_bf16 v[140:143], v[52:55], v[68:71], v[140:143]
  s_xor_b32 s25, s37, 12
  s_lshl_b32 s25, s25, 8
  s_mov_b32 m0, s73
  v_mfma_f32_16x16x32_bf16 v[144:147], v[52:55], v[72:75], v[144:147]
  ds_read_b128 v[52:55], v19 offset:5120
  v_mfma_f32_16x16x32_bf16 v[148:151], v[56:59], v[68:71], v[148:151]
  buffer_load_dwordx4 v12, s[52:55], s25 offen offset:0 lds
  v_mfma_f32_16x16x32_bf16 v[152:155], v[56:59], v[72:75], v[152:155]
  ds_read_b128 v[56:59], v19 offset:6144
  s_waitcnt lgkmcnt(7)
  v_mfma_f32_16x16x32_bf16 v[156:159], v[60:63], v[68:71], v[156:159]
  buffer_load_dwordx4 v13, s[52:55], s25 offen offset:1024 lds
  v_mfma_f32_16x16x32_bf16 v[160:163], v[60:63], v[72:75], v[160:163]
  ds_read_b128 v[60:63], v19 offset:7168
  v_mfma_f32_16x16x32_bf16 v[164:167], v[64:67], v[68:71], v[164:167]
  v_mfma_f32_16x16x32_bf16 v[168:171], v[64:67], v[72:75], v[168:171]
  ds_read_b128 v[64:67], v19 offset:41984
  s_waitcnt vmcnt(11)
  s_barrier
  s_waitcnt lgkmcnt(8)
  v_mfma_f32_16x16x32_bf16 v[100:103], v[32:35], v[76:79], v[100:103]
  s_mov_b32 m0, s70
  v_mfma_f32_16x16x32_bf16 v[104:107], v[32:35], v[80:83], v[104:107]
  ds_read_b128 v[32:35], v19 offset:8192
  s_waitcnt lgkmcnt(7)
  v_mfma_f32_16x16x32_bf16 v[108:111], v[36:39], v[76:79], v[108:111]
  buffer_load_dwordx4 v9, s[12:15], s24 offen sc1 lds
  v_mfma_f32_16x16x32_bf16 v[112:115], v[36:39], v[80:83], v[112:115]
  buffer_load_dwordx4 v9, s[12:15], s24 offen offset:1024 sc1 lds
  v_mfma_f32_16x16x32_bf16 v[116:119], v[40:43], v[76:79], v[116:119]
  ds_read_b128 v[36:39], v19 offset:9216
  s_add_u32 s24, s24, s38
  v_mfma_f32_16x16x32_bf16 v[120:123], v[40:43], v[80:83], v[120:123]
  s_waitcnt vmcnt(7)
  s_waitcnt lgkmcnt(6)
  v_mfma_f32_16x16x32_bf16 v[124:127], v[44:47], v[76:79], v[124:127]
  ds_read_b128 v[40:43], v19 offset:10240
  ds_read_b128 v[84:87], v21 offset:16384
  v_mfma_f32_16x16x32_bf16 v[128:131], v[44:47], v[80:83], v[128:131]
  ds_read_b128 v[88:91], v21 offset:18432
  v_mfma_f32_16x16x32_bf16 v[132:135], v[48:51], v[76:79], v[132:135]
  ds_read_b128 v[44:47], v19 offset:11264
  v_mfma_f32_16x16x32_bf16 v[136:139], v[48:51], v[80:83], v[136:139]
  ds_read_b128 v[48:51], v19 offset:12288
  s_waitcnt lgkmcnt(9)
  v_mfma_f32_16x16x32_bf16 v[140:143], v[52:55], v[76:79], v[140:143]
  ds_read_b128 v[92:95], v22 offset:16384
  v_mfma_f32_16x16x32_bf16 v[144:147], v[52:55], v[80:83], v[144:147]
  ds_read_b128 v[52:55], v19 offset:13312
  ds_read_b128 v[96:99], v22 offset:18432
  v_mfma_f32_16x16x32_bf16 v[148:151], v[56:59], v[76:79], v[148:151]
  s_mov_b32 m0, s73
  v_mfma_f32_16x16x32_bf16 v[152:155], v[56:59], v[80:83], v[152:155]
  ds_read_b128 v[56:59], v19 offset:14336
  s_waitcnt lgkmcnt(11)
  v_mfma_f32_16x16x32_bf16 v[156:159], v[60:63], v[76:79], v[156:159]
  buffer_load_dwordx4 v14, s[52:55], s25 offen offset:2048 lds
  v_mfma_f32_16x16x32_bf16 v[160:163], v[60:63], v[80:83], v[160:163]
  ds_read_b128 v[60:63], v19 offset:15360
  v_mfma_f32_16x16x32_bf16 v[164:167], v[64:67], v[76:79], v[164:167]
  buffer_load_dwordx4 v15, s[52:55], s25 offen offset:3072 lds
  v_mfma_f32_16x16x32_bf16 v[168:171], v[64:67], v[80:83], v[168:171]
  ds_read_b128 v[64:67], v19 offset:43008
  s_barrier
  s_waitcnt lgkmcnt(12)
  s_waitcnt lgkmcnt(3)
  v_mfma_f32_16x16x32_bf16 v[100:103], v[32:35], v[84:87], v[100:103]
  s_mov_b32 m0, s66
  v_mfma_f32_16x16x32_bf16 v[104:107], v[32:35], v[88:91], v[104:107]
  ds_read_b128 v[32:35], v19 offset:16384
  v_mfma_f32_16x16x32_bf16 v[108:111], v[36:39], v[84:87], v[108:111]
  buffer_load_dwordx4 v9, s[12:15], s24 offen sc1 lds
  v_mfma_f32_16x16x32_bf16 v[112:115], v[36:39], v[88:91], v[112:115]
  buffer_load_dwordx4 v9, s[12:15], s24 offen offset:1024 sc1 lds
  v_mfma_f32_16x16x32_bf16 v[116:119], v[40:43], v[84:87], v[116:119]
  ds_read_b128 v[36:39], v19 offset:17408
  s_add_u32 s24, s24, s38
  v_mfma_f32_16x16x32_bf16 v[120:123], v[40:43], v[88:91], v[120:123]
  s_addk_i32 s25, 128
  s_mov_b32 m0, s63
  v_mfma_f32_16x16x32_bf16 v[124:127], v[44:47], v[84:87], v[124:127]
  ds_read_b128 v[40:43], v19 offset:18432
  v_mfma_f32_16x16x32_bf16 v[128:131], v[44:47], v[88:91], v[128:131]
  buffer_load_dwordx4 v12, s[52:55], s25 offen offset:0 lds
  v_mfma_f32_16x16x32_bf16 v[132:135], v[48:51], v[84:87], v[132:135]
  ds_read_b128 v[44:47], v19 offset:19456
  v_mfma_f32_16x16x32_bf16 v[136:139], v[48:51], v[88:91], v[136:139]
  ds_read_b128 v[48:51], v19 offset:20480
  s_waitcnt lgkmcnt(7)
  v_mfma_f32_16x16x32_bf16 v[140:143], v[52:55], v[84:87], v[140:143]
  buffer_load_dwordx4 v13, s[52:55], s25 offen offset:1024 lds
  v_mfma_f32_16x16x32_bf16 v[144:147], v[52:55], v[88:91], v[144:147]
  ds_read_b128 v[52:55], v19 offset:21504
  v_mfma_f32_16x16x32_bf16 v[148:151], v[56:59], v[84:87], v[148:151]
  v_mfma_f32_16x16x32_bf16 v[152:155], v[56:59], v[88:91], v[152:155]
  ds_read_b128 v[56:59], v19 offset:22528
  s_waitcnt lgkmcnt(7)
  v_mfma_f32_16x16x32_bf16 v[156:159], v[60:63], v[84:87], v[156:159]
  v_mfma_f32_16x16x32_bf16 v[160:163], v[60:63], v[88:91], v[160:163]
  ds_read_b128 v[60:63], v19 offset:23552
  v_mfma_f32_16x16x32_bf16 v[164:167], v[64:67], v[84:87], v[164:167]
  v_mfma_f32_16x16x32_bf16 v[168:171], v[64:67], v[88:91], v[168:171]
  ds_read_b128 v[64:67], v19 offset:44032
  s_waitcnt vmcnt(10)
  s_barrier
  s_waitcnt lgkmcnt(8)
  v_mfma_f32_16x16x32_bf16 v[100:103], v[32:35], v[92:95], v[100:103]
  s_mov_b32 m0, s67
  v_mfma_f32_16x16x32_bf16 v[104:107], v[32:35], v[96:99], v[104:107]
  ds_read_b128 v[32:35], v19 offset:24576
  s_waitcnt lgkmcnt(7)
  v_mfma_f32_16x16x32_bf16 v[108:111], v[36:39], v[92:95], v[108:111]
  buffer_load_dwordx4 v9, s[12:15], s24 offen sc1 lds
  v_mfma_f32_16x16x32_bf16 v[112:115], v[36:39], v[96:99], v[112:115]
  buffer_load_dwordx4 v9, s[12:15], s24 offen offset:1024 sc1 lds
  v_mfma_f32_16x16x32_bf16 v[116:119], v[40:43], v[92:95], v[116:119]
  ds_read_b128 v[36:39], v19 offset:25600
  s_waitcnt vmcnt(6)
  v_mfma_f32_16x16x32_bf16 v[120:123], v[40:43], v[96:99], v[120:123]
  ds_read_b128 v[68:71], v21 offset:0
  s_waitcnt lgkmcnt(7)
  v_mfma_f32_16x16x32_bf16 v[124:127], v[44:47], v[92:95], v[124:127]
  ds_read_b128 v[40:43], v19 offset:26624
  v_mfma_f32_16x16x32_bf16 v[128:131], v[44:47], v[96:99], v[128:131]
  ds_read_b128 v[72:75], v21 offset:2048
  v_mfma_f32_16x16x32_bf16 v[132:135], v[48:51], v[92:95], v[132:135]
  ds_read_b128 v[44:47], v19 offset:27648
  ds_read_b128 v[76:79], v22 offset:0
  v_mfma_f32_16x16x32_bf16 v[136:139], v[48:51], v[96:99], v[136:139]
  ds_read_b128 v[48:51], v19 offset:28672
  s_waitcnt lgkmcnt(10)
  v_mfma_f32_16x16x32_bf16 v[140:143], v[52:55], v[92:95], v[140:143]
  ds_read_b128 v[80:83], v22 offset:2048
  s_mov_b32 m0, s63
  v_mfma_f32_16x16x32_bf16 v[144:147], v[52:55], v[96:99], v[144:147]
  ds_read_b128 v[52:55], v19 offset:29696
  v_mfma_f32_16x16x32_bf16 v[148:151], v[56:59], v[92:95], v[148:151]
  buffer_load_dwordx4 v14, s[52:55], s25 offen offset:2048 lds
  v_mfma_f32_16x16x32_bf16 v[152:155], v[56:59], v[96:99], v[152:155]
  ds_read_b128 v[56:59], v19 offset:30720
  s_waitcnt lgkmcnt(11)
  v_mfma_f32_16x16x32_bf16 v[156:159], v[60:63], v[92:95], v[156:159]
  buffer_load_dwordx4 v15, s[52:55], s25 offen offset:3072 lds
  v_mfma_f32_16x16x32_bf16 v[160:163], v[60:63], v[96:99], v[160:163]
  ds_read_b128 v[60:63], v19 offset:31744
  v_mfma_f32_16x16x32_bf16 v[164:167], v[64:67], v[92:95], v[164:167]
  v_mfma_f32_16x16x32_bf16 v[168:171], v[64:67], v[96:99], v[168:171]
  ds_read_b128 v[64:67], v19 offset:45056
  s_barrier
  s_waitcnt lgkmcnt(12)
  s_waitcnt lgkmcnt(4)
  v_mfma_f32_16x16x32_bf16 v[100:103], v[32:35], v[68:71], v[100:103]
  s_xor_b32 s24, s37, 13
  s_mul_i32 s24, s24, 589824
  v_mfma_f32_16x16x32_bf16 v[104:107], v[32:35], v[72:75], v[104:107]
  s_mov_b32 m0, s68
  v_mfma_f32_16x16x32_bf16 v[108:111], v[36:39], v[68:71], v[108:111]
  ds_read_b128 v[32:35], v19 offset:32768
  v_mfma_f32_16x16x32_bf16 v[112:115], v[36:39], v[72:75], v[112:115]
  buffer_load_dwordx4 v9, s[12:15], s24 offen sc1 lds
  v_mfma_f32_16x16x32_bf16 v[116:119], v[40:43], v[68:71], v[116:119]
  ds_read_b128 v[36:39], v19 offset:33792
  v_mfma_f32_16x16x32_bf16 v[120:123], v[40:43], v[72:75], v[120:123]
  ds_read_b128 v[40:43], v19 offset:34816
  v_mfma_f32_16x16x32_bf16 v[124:127], v[44:47], v[68:71], v[124:127]
  buffer_load_dwordx4 v9, s[12:15], s24 offen offset:1024 sc1 lds
  s_mov_b32 m0, s71
  v_mfma_f32_16x16x32_bf16 v[128:131], v[44:47], v[72:75], v[128:131]
  buffer_load_dwordx4 v10, s[12:15], s24 offen sc1 lds
  v_mfma_f32_16x16x32_bf16 v[132:135], v[48:51], v[68:71], v[132:135]
  ds_read_b128 v[44:47], v19 offset:35840
  s_add_u32 s24, s24, s38
  v_mfma_f32_16x16x32_bf16 v[136:139], v[48:51], v[72:75], v[136:139]
  ds_read_b128 v[48:51], v19 offset:36864
  s_waitcnt lgkmcnt(7)
  v_mfma_f32_16x16x32_bf16 v[140:143], v[52:55], v[68:71], v[140:143]
  s_xor_b32 s25, s37, 13
  s_lshl_b32 s25, s25, 8
  s_mov_b32 m0, s73
  v_mfma_f32_16x16x32_bf16 v[144:147], v[52:55], v[72:75], v[144:147]
  ds_read_b128 v[52:55], v19 offset:37888
  v_mfma_f32_16x16x32_bf16 v[148:151], v[56:59], v[68:71], v[148:151]
  buffer_load_dwordx4 v12, s[52:55], s25 offen offset:0 lds
  v_mfma_f32_16x16x32_bf16 v[152:155], v[56:59], v[72:75], v[152:155]
  ds_read_b128 v[56:59], v19 offset:38912
  s_waitcnt lgkmcnt(7)
  v_mfma_f32_16x16x32_bf16 v[156:159], v[60:63], v[68:71], v[156:159]
  buffer_load_dwordx4 v13, s[52:55], s25 offen offset:1024 lds
  v_mfma_f32_16x16x32_bf16 v[160:163], v[60:63], v[72:75], v[160:163]
  ds_read_b128 v[60:63], v19 offset:39936
  v_mfma_f32_16x16x32_bf16 v[164:167], v[64:67], v[68:71], v[164:167]
  v_mfma_f32_16x16x32_bf16 v[168:171], v[64:67], v[72:75], v[168:171]
  ds_read_b128 v[64:67], v19 offset:46080
  s_waitcnt vmcnt(11)
  s_barrier
  s_waitcnt lgkmcnt(8)
  v_mfma_f32_16x16x32_bf16 v[100:103], v[32:35], v[76:79], v[100:103]
  s_mov_b32 m0, s69
  v_mfma_f32_16x16x32_bf16 v[104:107], v[32:35], v[80:83], v[104:107]
  ds_read_b128 v[32:35], v19 offset:0
  s_waitcnt lgkmcnt(7)
  v_mfma_f32_16x16x32_bf16 v[108:111], v[36:39], v[76:79], v[108:111]
  buffer_load_dwordx4 v9, s[12:15], s24 offen sc1 lds
  v_mfma_f32_16x16x32_bf16 v[112:115], v[36:39], v[80:83], v[112:115]
  buffer_load_dwordx4 v9, s[12:15], s24 offen offset:1024 sc1 lds
  v_mfma_f32_16x16x32_bf16 v[116:119], v[40:43], v[76:79], v[116:119]
  ds_read_b128 v[36:39], v19 offset:1024
  s_add_u32 s24, s24, s38
  v_mfma_f32_16x16x32_bf16 v[120:123], v[40:43], v[80:83], v[120:123]
  s_waitcnt vmcnt(7)
  s_waitcnt lgkmcnt(6)
  v_mfma_f32_16x16x32_bf16 v[124:127], v[44:47], v[76:79], v[124:127]
  ds_read_b128 v[40:43], v19 offset:2048
  ds_read_b128 v[84:87], v21 offset:16384
  v_mfma_f32_16x16x32_bf16 v[128:131], v[44:47], v[80:83], v[128:131]
  ds_read_b128 v[88:91], v21 offset:18432
  v_mfma_f32_16x16x32_bf16 v[132:135], v[48:51], v[76:79], v[132:135]
  ds_read_b128 v[44:47], v19 offset:3072
  v_mfma_f32_16x16x32_bf16 v[136:139], v[48:51], v[80:83], v[136:139]
  ds_read_b128 v[48:51], v19 offset:4096
  s_waitcnt lgkmcnt(9)
  v_mfma_f32_16x16x32_bf16 v[140:143], v[52:55], v[76:79], v[140:143]
  ds_read_b128 v[92:95], v22 offset:16384
  v_mfma_f32_16x16x32_bf16 v[144:147], v[52:55], v[80:83], v[144:147]
  ds_read_b128 v[52:55], v19 offset:5120
  ds_read_b128 v[96:99], v22 offset:18432
  v_mfma_f32_16x16x32_bf16 v[148:151], v[56:59], v[76:79], v[148:151]
  s_mov_b32 m0, s73
  v_mfma_f32_16x16x32_bf16 v[152:155], v[56:59], v[80:83], v[152:155]
  ds_read_b128 v[56:59], v19 offset:6144
  s_waitcnt lgkmcnt(11)
  v_mfma_f32_16x16x32_bf16 v[156:159], v[60:63], v[76:79], v[156:159]
  buffer_load_dwordx4 v14, s[52:55], s25 offen offset:2048 lds
  v_mfma_f32_16x16x32_bf16 v[160:163], v[60:63], v[80:83], v[160:163]
  ds_read_b128 v[60:63], v19 offset:7168
  v_mfma_f32_16x16x32_bf16 v[164:167], v[64:67], v[76:79], v[164:167]
  buffer_load_dwordx4 v15, s[52:55], s25 offen offset:3072 lds
  v_mfma_f32_16x16x32_bf16 v[168:171], v[64:67], v[80:83], v[168:171]
  ds_read_b128 v[64:67], v19 offset:47104
  s_barrier
  s_waitcnt lgkmcnt(12)
  s_waitcnt lgkmcnt(3)
  v_mfma_f32_16x16x32_bf16 v[100:103], v[32:35], v[84:87], v[100:103]
  s_mov_b32 m0, s70
  v_mfma_f32_16x16x32_bf16 v[104:107], v[32:35], v[88:91], v[104:107]
  ds_read_b128 v[32:35], v19 offset:8192
  v_mfma_f32_16x16x32_bf16 v[108:111], v[36:39], v[84:87], v[108:111]
  buffer_load_dwordx4 v9, s[12:15], s24 offen sc1 lds
  v_mfma_f32_16x16x32_bf16 v[112:115], v[36:39], v[88:91], v[112:115]
  buffer_load_dwordx4 v9, s[12:15], s24 offen offset:1024 sc1 lds
  v_mfma_f32_16x16x32_bf16 v[116:119], v[40:43], v[84:87], v[116:119]
  ds_read_b128 v[36:39], v19 offset:9216
  s_add_u32 s24, s24, s38
  v_mfma_f32_16x16x32_bf16 v[120:123], v[40:43], v[88:91], v[120:123]
  s_addk_i32 s25, 128
  s_mov_b32 m0, s63
  v_mfma_f32_16x16x32_bf16 v[124:127], v[44:47], v[84:87], v[124:127]
  ds_read_b128 v[40:43], v19 offset:10240
  v_mfma_f32_16x16x32_bf16 v[128:131], v[44:47], v[88:91], v[128:131]
  buffer_load_dwordx4 v12, s[52:55], s25 offen offset:0 lds
  v_mfma_f32_16x16x32_bf16 v[132:135], v[48:51], v[84:87], v[132:135]
  ds_read_b128 v[44:47], v19 offset:11264
  v_mfma_f32_16x16x32_bf16 v[136:139], v[48:51], v[88:91], v[136:139]
  ds_read_b128 v[48:51], v19 offset:12288
  s_waitcnt lgkmcnt(7)
  v_mfma_f32_16x16x32_bf16 v[140:143], v[52:55], v[84:87], v[140:143]
  buffer_load_dwordx4 v13, s[52:55], s25 offen offset:1024 lds
  v_mfma_f32_16x16x32_bf16 v[144:147], v[52:55], v[88:91], v[144:147]
  ds_read_b128 v[52:55], v19 offset:13312
  v_mfma_f32_16x16x32_bf16 v[148:151], v[56:59], v[84:87], v[148:151]
  v_mfma_f32_16x16x32_bf16 v[152:155], v[56:59], v[88:91], v[152:155]
  ds_read_b128 v[56:59], v19 offset:14336
  s_waitcnt lgkmcnt(7)
  v_mfma_f32_16x16x32_bf16 v[156:159], v[60:63], v[84:87], v[156:159]
  v_mfma_f32_16x16x32_bf16 v[160:163], v[60:63], v[88:91], v[160:163]
  ds_read_b128 v[60:63], v19 offset:15360
  v_mfma_f32_16x16x32_bf16 v[164:167], v[64:67], v[84:87], v[164:167]
  v_mfma_f32_16x16x32_bf16 v[168:171], v[64:67], v[88:91], v[168:171]
  ds_read_b128 v[64:67], v19 offset:48128
  s_waitcnt vmcnt(10)
  s_barrier
  s_waitcnt lgkmcnt(8)
  v_mfma_f32_16x16x32_bf16 v[100:103], v[32:35], v[92:95], v[100:103]
  s_mov_b32 m0, s66
  v_mfma_f32_16x16x32_bf16 v[104:107], v[32:35], v[96:99], v[104:107]
  ds_read_b128 v[32:35], v19 offset:16384
  s_waitcnt lgkmcnt(7)
  v_mfma_f32_16x16x32_bf16 v[108:111], v[36:39], v[92:95], v[108:111]
  buffer_load_dwordx4 v9, s[12:15], s24 offen sc1 lds
  v_mfma_f32_16x16x32_bf16 v[112:115], v[36:39], v[96:99], v[112:115]
  buffer_load_dwordx4 v9, s[12:15], s24 offen offset:1024 sc1 lds
  v_mfma_f32_16x16x32_bf16 v[116:119], v[40:43], v[92:95], v[116:119]
  ds_read_b128 v[36:39], v19 offset:17408
  s_waitcnt vmcnt(6)
  v_mfma_f32_16x16x32_bf16 v[120:123], v[40:43], v[96:99], v[120:123]
  ds_read_b128 v[68:71], v21 offset:0
  s_waitcnt lgkmcnt(7)
  v_mfma_f32_16x16x32_bf16 v[124:127], v[44:47], v[92:95], v[124:127]
  ds_read_b128 v[40:43], v19 offset:18432
  v_mfma_f32_16x16x32_bf16 v[128:131], v[44:47], v[96:99], v[128:131]
  ds_read_b128 v[72:75], v21 offset:2048
  v_mfma_f32_16x16x32_bf16 v[132:135], v[48:51], v[92:95], v[132:135]
  ds_read_b128 v[44:47], v19 offset:19456
  ds_read_b128 v[76:79], v22 offset:0
  v_mfma_f32_16x16x32_bf16 v[136:139], v[48:51], v[96:99], v[136:139]
  ds_read_b128 v[48:51], v19 offset:20480
  s_waitcnt lgkmcnt(10)
  v_mfma_f32_16x16x32_bf16 v[140:143], v[52:55], v[92:95], v[140:143]
  ds_read_b128 v[80:83], v22 offset:2048
  s_mov_b32 m0, s63
  v_mfma_f32_16x16x32_bf16 v[144:147], v[52:55], v[96:99], v[144:147]
  ds_read_b128 v[52:55], v19 offset:21504
  v_mfma_f32_16x16x32_bf16 v[148:151], v[56:59], v[92:95], v[148:151]
  buffer_load_dwordx4 v14, s[52:55], s25 offen offset:2048 lds
  v_mfma_f32_16x16x32_bf16 v[152:155], v[56:59], v[96:99], v[152:155]
  ds_read_b128 v[56:59], v19 offset:22528
  s_waitcnt lgkmcnt(11)
  v_mfma_f32_16x16x32_bf16 v[156:159], v[60:63], v[92:95], v[156:159]
  buffer_load_dwordx4 v15, s[52:55], s25 offen offset:3072 lds
  v_mfma_f32_16x16x32_bf16 v[160:163], v[60:63], v[96:99], v[160:163]
  ds_read_b128 v[60:63], v19 offset:23552
  v_mfma_f32_16x16x32_bf16 v[164:167], v[64:67], v[92:95], v[164:167]
  v_mfma_f32_16x16x32_bf16 v[168:171], v[64:67], v[96:99], v[168:171]
  ds_read_b128 v[64:67], v19 offset:40960
  s_barrier
  s_waitcnt lgkmcnt(12)
  s_waitcnt lgkmcnt(4)
  v_mfma_f32_16x16x32_bf16 v[100:103], v[32:35], v[68:71], v[100:103]
  s_xor_b32 s24, s37, 14
  s_mul_i32 s24, s24, 589824
  v_mfma_f32_16x16x32_bf16 v[104:107], v[32:35], v[72:75], v[104:107]
  s_mov_b32 m0, s67
  v_mfma_f32_16x16x32_bf16 v[108:111], v[36:39], v[68:71], v[108:111]
  ds_read_b128 v[32:35], v19 offset:24576
  v_mfma_f32_16x16x32_bf16 v[112:115], v[36:39], v[72:75], v[112:115]
  buffer_load_dwordx4 v9, s[12:15], s24 offen sc1 lds
  v_mfma_f32_16x16x32_bf16 v[116:119], v[40:43], v[68:71], v[116:119]
  ds_read_b128 v[36:39], v19 offset:25600
  v_mfma_f32_16x16x32_bf16 v[120:123], v[40:43], v[72:75], v[120:123]
  ds_read_b128 v[40:43], v19 offset:26624
  v_mfma_f32_16x16x32_bf16 v[124:127], v[44:47], v[68:71], v[124:127]
  buffer_load_dwordx4 v9, s[12:15], s24 offen offset:1024 sc1 lds
  s_mov_b32 m0, s72
  v_mfma_f32_16x16x32_bf16 v[128:131], v[44:47], v[72:75], v[128:131]
  buffer_load_dwordx4 v10, s[12:15], s24 offen sc1 lds
  v_mfma_f32_16x16x32_bf16 v[132:135], v[48:51], v[68:71], v[132:135]
  ds_read_b128 v[44:47], v19 offset:27648
  s_add_u32 s24, s24, s38
  v_mfma_f32_16x16x32_bf16 v[136:139], v[48:51], v[72:75], v[136:139]
  ds_read_b128 v[48:51], v19 offset:28672
  s_waitcnt lgkmcnt(7)
  v_mfma_f32_16x16x32_bf16 v[140:143], v[52:55], v[68:71], v[140:143]
  s_xor_b32 s25, s37, 14
  s_lshl_b32 s25, s25, 8
  s_mov_b32 m0, s73
  v_mfma_f32_16x16x32_bf16 v[144:147], v[52:55], v[72:75], v[144:147]
  ds_read_b128 v[52:55], v19 offset:29696
  v_mfma_f32_16x16x32_bf16 v[148:151], v[56:59], v[68:71], v[148:151]
  buffer_load_dwordx4 v12, s[52:55], s25 offen offset:0 lds
  v_mfma_f32_16x16x32_bf16 v[152:155], v[56:59], v[72:75], v[152:155]
  ds_read_b128 v[56:59], v19 offset:30720
  s_waitcnt lgkmcnt(7)
  v_mfma_f32_16x16x32_bf16 v[156:159], v[60:63], v[68:71], v[156:159]
  buffer_load_dwordx4 v13, s[52:55], s25 offen offset:1024 lds
  v_mfma_f32_16x16x32_bf16 v[160:163], v[60:63], v[72:75], v[160:163]
  ds_read_b128 v[60:63], v19 offset:31744
  v_mfma_f32_16x16x32_bf16 v[164:167], v[64:67], v[68:71], v[164:167]
  v_mfma_f32_16x16x32_bf16 v[168:171], v[64:67], v[72:75], v[168:171]
  ds_read_b128 v[64:67], v19 offset:41984
  s_waitcnt vmcnt(11)
  s_barrier
  s_waitcnt lgkmcnt(8)
  v_mfma_f32_16x16x32_bf16 v[100:103], v[32:35], v[76:79], v[100:103]
  s_mov_b32 m0, s68
  v_mfma_f32_16x16x32_bf16 v[104:107], v[32:35], v[80:83], v[104:107]
  ds_read_b128 v[32:35], v19 offset:32768
  s_waitcnt lgkmcnt(7)
  v_mfma_f32_16x16x32_bf16 v[108:111], v[36:39], v[76:79], v[108:111]
  buffer_load_dwordx4 v9, s[12:15], s24 offen sc1 lds
  v_mfma_f32_16x16x32_bf16 v[112:115], v[36:39], v[80:83], v[112:115]
  buffer_load_dwordx4 v9, s[12:15], s24 offen offset:1024 sc1 lds
  v_mfma_f32_16x16x32_bf16 v[116:119], v[40:43], v[76:79], v[116:119]
  ds_read_b128 v[36:39], v19 offset:33792
  s_add_u32 s24, s24, s38
  v_mfma_f32_16x16x32_bf16 v[120:123], v[40:43], v[80:83], v[120:123]
  s_waitcnt vmcnt(7)
  s_waitcnt lgkmcnt(6)
  v_mfma_f32_16x16x32_bf16 v[124:127], v[44:47], v[76:79], v[124:127]
  ds_read_b128 v[40:43], v19 offset:34816
  ds_read_b128 v[84:87], v21 offset:16384
  v_mfma_f32_16x16x32_bf16 v[128:131], v[44:47], v[80:83], v[128:131]
  ds_read_b128 v[88:91], v21 offset:18432
  v_mfma_f32_16x16x32_bf16 v[132:135], v[48:51], v[76:79], v[132:135]
  ds_read_b128 v[44:47], v19 offset:35840
  v_mfma_f32_16x16x32_bf16 v[136:139], v[48:51], v[80:83], v[136:139]
  ds_read_b128 v[48:51], v19 offset:36864
  s_waitcnt lgkmcnt(9)
  v_mfma_f32_16x16x32_bf16 v[140:143], v[52:55], v[76:79], v[140:143]
  ds_read_b128 v[92:95], v22 offset:16384
  v_mfma_f32_16x16x32_bf16 v[144:147], v[52:55], v[80:83], v[144:147]
  ds_read_b128 v[52:55], v19 offset:37888
  ds_read_b128 v[96:99], v22 offset:18432
  v_mfma_f32_16x16x32_bf16 v[148:151], v[56:59], v[76:79], v[148:151]
  s_mov_b32 m0, s73
  v_mfma_f32_16x16x32_bf16 v[152:155], v[56:59], v[80:83], v[152:155]
  ds_read_b128 v[56:59], v19 offset:38912
  s_waitcnt lgkmcnt(11)
  v_mfma_f32_16x16x32_bf16 v[156:159], v[60:63], v[76:79], v[156:159]
  buffer_load_dwordx4 v14, s[52:55], s25 offen offset:2048 lds
  v_mfma_f32_16x16x32_bf16 v[160:163], v[60:63], v[80:83], v[160:163]
  ds_read_b128 v[60:63], v19 offset:39936
  v_mfma_f32_16x16x32_bf16 v[164:167], v[64:67], v[76:79], v[164:167]
  buffer_load_dwordx4 v15, s[52:55], s25 offen offset:3072 lds
  v_mfma_f32_16x16x32_bf16 v[168:171], v[64:67], v[80:83], v[168:171]
  ds_read_b128 v[64:67], v19 offset:43008
  s_barrier
  s_waitcnt lgkmcnt(12)
  s_waitcnt lgkmcnt(3)
  v_mfma_f32_16x16x32_bf16 v[100:103], v[32:35], v[84:87], v[100:103]
  s_mov_b32 m0, s69
  v_mfma_f32_16x16x32_bf16 v[104:107], v[32:35], v[88:91], v[104:107]
  ds_read_b128 v[32:35], v19 offset:0
  v_mfma_f32_16x16x32_bf16 v[108:111], v[36:39], v[84:87], v[108:111]
  buffer_load_dwordx4 v9, s[12:15], s24 offen sc1 lds
  v_mfma_f32_16x16x32_bf16 v[112:115], v[36:39], v[88:91], v[112:115]
  buffer_load_dwordx4 v9, s[12:15], s24 offen offset:1024 sc1 lds
  v_mfma_f32_16x16x32_bf16 v[116:119], v[40:43], v[84:87], v[116:119]
  ds_read_b128 v[36:39], v19 offset:1024
  s_add_u32 s24, s24, s38
  v_mfma_f32_16x16x32_bf16 v[120:123], v[40:43], v[88:91], v[120:123]
  s_addk_i32 s25, 128
  s_mov_b32 m0, s63
  v_mfma_f32_16x16x32_bf16 v[124:127], v[44:47], v[84:87], v[124:127]
  ds_read_b128 v[40:43], v19 offset:2048
  v_mfma_f32_16x16x32_bf16 v[128:131], v[44:47], v[88:91], v[128:131]
  buffer_load_dwordx4 v12, s[52:55], s25 offen offset:0 lds
  v_mfma_f32_16x16x32_bf16 v[132:135], v[48:51], v[84:87], v[132:135]
  ds_read_b128 v[44:47], v19 offset:3072
  v_mfma_f32_16x16x32_bf16 v[136:139], v[48:51], v[88:91], v[136:139]
  ds_read_b128 v[48:51], v19 offset:4096
  s_waitcnt lgkmcnt(7)
  v_mfma_f32_16x16x32_bf16 v[140:143], v[52:55], v[84:87], v[140:143]
  buffer_load_dwordx4 v13, s[52:55], s25 offen offset:1024 lds
  v_mfma_f32_16x16x32_bf16 v[144:147], v[52:55], v[88:91], v[144:147]
  ds_read_b128 v[52:55], v19 offset:5120
  v_mfma_f32_16x16x32_bf16 v[148:151], v[56:59], v[84:87], v[148:151]
  v_mfma_f32_16x16x32_bf16 v[152:155], v[56:59], v[88:91], v[152:155]
  ds_read_b128 v[56:59], v19 offset:6144
  s_waitcnt lgkmcnt(7)
  v_mfma_f32_16x16x32_bf16 v[156:159], v[60:63], v[84:87], v[156:159]
  v_mfma_f32_16x16x32_bf16 v[160:163], v[60:63], v[88:91], v[160:163]
  ds_read_b128 v[60:63], v19 offset:7168
  v_mfma_f32_16x16x32_bf16 v[164:167], v[64:67], v[84:87], v[164:167]
  v_mfma_f32_16x16x32_bf16 v[168:171], v[64:67], v[88:91], v[168:171]
  ds_read_b128 v[64:67], v19 offset:44032
  s_waitcnt vmcnt(10)
  s_barrier
  s_waitcnt lgkmcnt(8)
  v_mfma_f32_16x16x32_bf16 v[100:103], v[32:35], v[92:95], v[100:103]
  s_mov_b32 m0, s70
  v_mfma_f32_16x16x32_bf16 v[104:107], v[32:35], v[96:99], v[104:107]
  ds_read_b128 v[32:35], v19 offset:8192
  s_waitcnt lgkmcnt(7)
  v_mfma_f32_16x16x32_bf16 v[108:111], v[36:39], v[92:95], v[108:111]
  buffer_load_dwordx4 v9, s[12:15], s24 offen sc1 lds
  v_mfma_f32_16x16x32_bf16 v[112:115], v[36:39], v[96:99], v[112:115]
  buffer_load_dwordx4 v9, s[12:15], s24 offen offset:1024 sc1 lds
  v_mfma_f32_16x16x32_bf16 v[116:119], v[40:43], v[92:95], v[116:119]
  ds_read_b128 v[36:39], v19 offset:9216
  s_waitcnt vmcnt(6)
  v_mfma_f32_16x16x32_bf16 v[120:123], v[40:43], v[96:99], v[120:123]
  ds_read_b128 v[68:71], v21 offset:0
  s_waitcnt lgkmcnt(7)
  v_mfma_f32_16x16x32_bf16 v[124:127], v[44:47], v[92:95], v[124:127]
  ds_read_b128 v[40:43], v19 offset:10240
  v_mfma_f32_16x16x32_bf16 v[128:131], v[44:47], v[96:99], v[128:131]
  ds_read_b128 v[72:75], v21 offset:2048
  v_mfma_f32_16x16x32_bf16 v[132:135], v[48:51], v[92:95], v[132:135]
  ds_read_b128 v[44:47], v19 offset:11264
  ds_read_b128 v[76:79], v22 offset:0
  v_mfma_f32_16x16x32_bf16 v[136:139], v[48:51], v[96:99], v[136:139]
  ds_read_b128 v[48:51], v19 offset:12288
  s_waitcnt lgkmcnt(10)
  v_mfma_f32_16x16x32_bf16 v[140:143], v[52:55], v[92:95], v[140:143]
  ds_read_b128 v[80:83], v22 offset:2048
  s_mov_b32 m0, s63
  v_mfma_f32_16x16x32_bf16 v[144:147], v[52:55], v[96:99], v[144:147]
  ds_read_b128 v[52:55], v19 offset:13312
  v_mfma_f32_16x16x32_bf16 v[148:151], v[56:59], v[92:95], v[148:151]
  buffer_load_dwordx4 v14, s[52:55], s25 offen offset:2048 lds
  v_mfma_f32_16x16x32_bf16 v[152:155], v[56:59], v[96:99], v[152:155]
  ds_read_b128 v[56:59], v19 offset:14336
  s_waitcnt lgkmcnt(11)
  v_mfma_f32_16x16x32_bf16 v[156:159], v[60:63], v[92:95], v[156:159]
  buffer_load_dwordx4 v15, s[52:55], s25 offen offset:3072 lds
  v_mfma_f32_16x16x32_bf16 v[160:163], v[60:63], v[96:99], v[160:163]
  ds_read_b128 v[60:63], v19 offset:15360
  v_mfma_f32_16x16x32_bf16 v[164:167], v[64:67], v[92:95], v[164:167]
  v_mfma_f32_16x16x32_bf16 v[168:171], v[64:67], v[96:99], v[168:171]
  ds_read_b128 v[64:67], v19 offset:45056
  s_barrier
  s_waitcnt lgkmcnt(12)
  s_waitcnt lgkmcnt(4)
  v_mfma_f32_16x16x32_bf16 v[100:103], v[32:35], v[68:71], v[100:103]
  s_xor_b32 s24, s37, 15
  s_mul_i32 s24, s24, 589824
  v_mfma_f32_16x16x32_bf16 v[104:107], v[32:35], v[72:75], v[104:107]
  s_mov_b32 m0, s66
  v_mfma_f32_16x16x32_bf16 v[108:111], v[36:39], v[68:71], v[108:111]
  ds_read_b128 v[32:35], v19 offset:16384
  v_mfma_f32_16x16x32_bf16 v[112:115], v[36:39], v[72:75], v[112:115]
  buffer_load_dwordx4 v9, s[12:15], s24 offen sc1 lds
  v_mfma_f32_16x16x32_bf16 v[116:119], v[40:43], v[68:71], v[116:119]
  ds_read_b128 v[36:39], v19 offset:17408
  v_mfma_f32_16x16x32_bf16 v[120:123], v[40:43], v[72:75], v[120:123]
  ds_read_b128 v[40:43], v19 offset:18432
  v_mfma_f32_16x16x32_bf16 v[124:127], v[44:47], v[68:71], v[124:127]
  buffer_load_dwordx4 v9, s[12:15], s24 offen offset:1024 sc1 lds
  s_mov_b32 m0, s71
  v_mfma_f32_16x16x32_bf16 v[128:131], v[44:47], v[72:75], v[128:131]
  buffer_load_dwordx4 v10, s[12:15], s24 offen sc1 lds
  v_mfma_f32_16x16x32_bf16 v[132:135], v[48:51], v[68:71], v[132:135]
  ds_read_b128 v[44:47], v19 offset:19456
  s_add_u32 s24, s24, s38
  v_mfma_f32_16x16x32_bf16 v[136:139], v[48:51], v[72:75], v[136:139]
  ds_read_b128 v[48:51], v19 offset:20480
  s_waitcnt lgkmcnt(7)
  v_mfma_f32_16x16x32_bf16 v[140:143], v[52:55], v[68:71], v[140:143]
  s_xor_b32 s25, s37, 15
  s_lshl_b32 s25, s25, 8
  s_mov_b32 m0, s73
  v_mfma_f32_16x16x32_bf16 v[144:147], v[52:55], v[72:75], v[144:147]
  ds_read_b128 v[52:55], v19 offset:21504
  v_mfma_f32_16x16x32_bf16 v[148:151], v[56:59], v[68:71], v[148:151]
  buffer_load_dwordx4 v12, s[52:55], s25 offen offset:0 lds
  v_mfma_f32_16x16x32_bf16 v[152:155], v[56:59], v[72:75], v[152:155]
  ds_read_b128 v[56:59], v19 offset:22528
  s_waitcnt lgkmcnt(7)
  v_mfma_f32_16x16x32_bf16 v[156:159], v[60:63], v[68:71], v[156:159]
  buffer_load_dwordx4 v13, s[52:55], s25 offen offset:1024 lds
  v_mfma_f32_16x16x32_bf16 v[160:163], v[60:63], v[72:75], v[160:163]
  ds_read_b128 v[60:63], v19 offset:23552
  v_mfma_f32_16x16x32_bf16 v[164:167], v[64:67], v[68:71], v[164:167]
  v_mfma_f32_16x16x32_bf16 v[168:171], v[64:67], v[72:75], v[168:171]
  ds_read_b128 v[64:67], v19 offset:46080
  s_waitcnt vmcnt(11)
  s_barrier
  s_waitcnt lgkmcnt(8)
  v_mfma_f32_16x16x32_bf16 v[100:103], v[32:35], v[76:79], v[100:103]
  s_mov_b32 m0, s67
  v_mfma_f32_16x16x32_bf16 v[104:107], v[32:35], v[80:83], v[104:107]
  ds_read_b128 v[32:35], v19 offset:24576
  s_waitcnt lgkmcnt(7)
  v_mfma_f32_16x16x32_bf16 v[108:111], v[36:39], v[76:79], v[108:111]
  buffer_load_dwordx4 v9, s[12:15], s24 offen sc1 lds
  v_mfma_f32_16x16x32_bf16 v[112:115], v[36:39], v[80:83], v[112:115]
  buffer_load_dwordx4 v9, s[12:15], s24 offen offset:1024 sc1 lds
  v_mfma_f32_16x16x32_bf16 v[116:119], v[40:43], v[76:79], v[116:119]
  ds_read_b128 v[36:39], v19 offset:25600
  s_add_u32 s24, s24, s38
  v_mfma_f32_16x16x32_bf16 v[120:123], v[40:43], v[80:83], v[120:123]
  s_waitcnt vmcnt(7)
  s_waitcnt lgkmcnt(6)
  v_mfma_f32_16x16x32_bf16 v[124:127], v[44:47], v[76:79], v[124:127]
  ds_read_b128 v[40:43], v19 offset:26624
  ds_read_b128 v[84:87], v21 offset:16384
  v_mfma_f32_16x16x32_bf16 v[128:131], v[44:47], v[80:83], v[128:131]
  ds_read_b128 v[88:91], v21 offset:18432
  v_mfma_f32_16x16x32_bf16 v[132:135], v[48:51], v[76:79], v[132:135]
  ds_read_b128 v[44:47], v19 offset:27648
  v_mfma_f32_16x16x32_bf16 v[136:139], v[48:51], v[80:83], v[136:139]
  ds_read_b128 v[48:51], v19 offset:28672
  s_waitcnt lgkmcnt(9)
  v_mfma_f32_16x16x32_bf16 v[140:143], v[52:55], v[76:79], v[140:143]
  ds_read_b128 v[92:95], v22 offset:16384
  v_mfma_f32_16x16x32_bf16 v[144:147], v[52:55], v[80:83], v[144:147]
  ds_read_b128 v[52:55], v19 offset:29696
  ds_read_b128 v[96:99], v22 offset:18432
  v_mfma_f32_16x16x32_bf16 v[148:151], v[56:59], v[76:79], v[148:151]
  s_mov_b32 m0, s73
  v_mfma_f32_16x16x32_bf16 v[152:155], v[56:59], v[80:83], v[152:155]
  ds_read_b128 v[56:59], v19 offset:30720
  s_waitcnt lgkmcnt(11)
  v_mfma_f32_16x16x32_bf16 v[156:159], v[60:63], v[76:79], v[156:159]
  buffer_load_dwordx4 v14, s[52:55], s25 offen offset:2048 lds
  v_mfma_f32_16x16x32_bf16 v[160:163], v[60:63], v[80:83], v[160:163]
  ds_read_b128 v[60:63], v19 offset:31744
  v_mfma_f32_16x16x32_bf16 v[164:167], v[64:67], v[76:79], v[164:167]
  buffer_load_dwordx4 v15, s[52:55], s25 offen offset:3072 lds
  v_mfma_f32_16x16x32_bf16 v[168:171], v[64:67], v[80:83], v[168:171]
  ds_read_b128 v[64:67], v19 offset:47104
  s_barrier
  v_bfe_u32 v27, v1, 2, 2
  v_lshlrev_b32 v27, 3, v27
  v_and_b32 v28, 3, v1
  s_lshl_b32 s44, s23, 5
  v_add3_u32 v27, v27, v28, s44
  v_lshlrev_b32 v28, 1, v27
  v_lshlrev_b32 v11, 3, v27
  global_load_ushort v244, v28, s[56:57]
  global_load_ushort v245, v28, s[56:57] offset:8
  s_mov_b32 s44, 24780800
  buffer_load_dwordx2 v[246:247], v11, s[12:15], s44 offen offset:0 sc0 sc1
  buffer_load_dwordx2 v[248:249], v11, s[12:15], s44 offen offset:32 sc0 sc1
  s_waitcnt lgkmcnt(12)
  s_waitcnt lgkmcnt(3)
  v_mfma_f32_16x16x32_bf16 v[100:103], v[32:35], v[84:87], v[100:103]
  s_mov_b32 m0, s68
  v_mfma_f32_16x16x32_bf16 v[104:107], v[32:35], v[88:91], v[104:107]
  ds_read_b128 v[32:35], v19 offset:32768
  v_mfma_f32_16x16x32_bf16 v[108:111], v[36:39], v[84:87], v[108:111]
  buffer_load_dwordx4 v9, s[12:15], s24 offen sc1 lds
  v_mfma_f32_16x16x32_bf16 v[112:115], v[36:39], v[88:91], v[112:115]
  buffer_load_dwordx4 v9, s[12:15], s24 offen offset:1024 sc1 lds
  v_mfma_f32_16x16x32_bf16 v[116:119], v[40:43], v[84:87], v[116:119]
  ds_read_b128 v[36:39], v19 offset:33792
  s_add_u32 s24, s24, s38
  v_mfma_f32_16x16x32_bf16 v[120:123], v[40:43], v[88:91], v[120:123]
  s_addk_i32 s25, 128
  s_mov_b32 m0, s63
  v_mfma_f32_16x16x32_bf16 v[124:127], v[44:47], v[84:87], v[124:127]
  ds_read_b128 v[40:43], v19 offset:34816
  v_mfma_f32_16x16x32_bf16 v[128:131], v[44:47], v[88:91], v[128:131]
  buffer_load_dwordx4 v12, s[52:55], s25 offen offset:0 lds
  v_mfma_f32_16x16x32_bf16 v[132:135], v[48:51], v[84:87], v[132:135]
  ds_read_b128 v[44:47], v19 offset:35840
  v_mfma_f32_16x16x32_bf16 v[136:139], v[48:51], v[88:91], v[136:139]
  ds_read_b128 v[48:51], v19 offset:36864
  s_waitcnt lgkmcnt(7)
  v_mfma_f32_16x16x32_bf16 v[140:143], v[52:55], v[84:87], v[140:143]
  buffer_load_dwordx4 v13, s[52:55], s25 offen offset:1024 lds
  v_mfma_f32_16x16x32_bf16 v[144:147], v[52:55], v[88:91], v[144:147]
  ds_read_b128 v[52:55], v19 offset:37888
  v_mfma_f32_16x16x32_bf16 v[148:151], v[56:59], v[84:87], v[148:151]
  v_mfma_f32_16x16x32_bf16 v[152:155], v[56:59], v[88:91], v[152:155]
  ds_read_b128 v[56:59], v19 offset:38912
  s_waitcnt lgkmcnt(7)
  v_mfma_f32_16x16x32_bf16 v[156:159], v[60:63], v[84:87], v[156:159]
  v_mfma_f32_16x16x32_bf16 v[160:163], v[60:63], v[88:91], v[160:163]
  ds_read_b128 v[60:63], v19 offset:39936
  v_mfma_f32_16x16x32_bf16 v[164:167], v[64:67], v[84:87], v[164:167]
  v_mfma_f32_16x16x32_bf16 v[168:171], v[64:67], v[88:91], v[168:171]
  ds_read_b128 v[64:67], v19 offset:48128
  s_waitcnt vmcnt(14)
  s_barrier
  s_waitcnt lgkmcnt(8)
  v_mfma_f32_16x16x32_bf16 v[100:103], v[32:35], v[92:95], v[100:103]
  s_mov_b32 m0, s69
  v_mfma_f32_16x16x32_bf16 v[104:107], v[32:35], v[96:99], v[104:107]
  ds_read_b128 v[32:35], v19 offset:0
  s_waitcnt lgkmcnt(7)
  v_mfma_f32_16x16x32_bf16 v[108:111], v[36:39], v[92:95], v[108:111]
  buffer_load_dwordx4 v9, s[12:15], s24 offen sc1 lds
  v_mfma_f32_16x16x32_bf16 v[112:115], v[36:39], v[96:99], v[112:115]
  buffer_load_dwordx4 v9, s[12:15], s24 offen offset:1024 sc1 lds
  v_mfma_f32_16x16x32_bf16 v[116:119], v[40:43], v[92:95], v[116:119]
  ds_read_b128 v[36:39], v19 offset:1024
  s_waitcnt vmcnt(10)
  v_mfma_f32_16x16x32_bf16 v[120:123], v[40:43], v[96:99], v[120:123]
  ds_read_b128 v[68:71], v21 offset:0
  s_waitcnt lgkmcnt(7)
  v_mfma_f32_16x16x32_bf16 v[124:127], v[44:47], v[92:95], v[124:127]
  ds_read_b128 v[40:43], v19 offset:2048
  v_mfma_f32_16x16x32_bf16 v[128:131], v[44:47], v[96:99], v[128:131]
  ds_read_b128 v[72:75], v21 offset:2048
  v_mfma_f32_16x16x32_bf16 v[132:135], v[48:51], v[92:95], v[132:135]
  ds_read_b128 v[44:47], v19 offset:3072
  ds_read_b128 v[76:79], v22 offset:0
  v_mfma_f32_16x16x32_bf16 v[136:139], v[48:51], v[96:99], v[136:139]
  ds_read_b128 v[48:51], v19 offset:4096
  s_waitcnt lgkmcnt(10)
  v_mfma_f32_16x16x32_bf16 v[140:143], v[52:55], v[92:95], v[140:143]
  ds_read_b128 v[80:83], v22 offset:2048
  s_mov_b32 m0, s63
  v_mfma_f32_16x16x32_bf16 v[144:147], v[52:55], v[96:99], v[144:147]
  ds_read_b128 v[52:55], v19 offset:5120
  v_mfma_f32_16x16x32_bf16 v[148:151], v[56:59], v[92:95], v[148:151]
  buffer_load_dwordx4 v14, s[52:55], s25 offen offset:2048 lds
  v_mfma_f32_16x16x32_bf16 v[152:155], v[56:59], v[96:99], v[152:155]
  ds_read_b128 v[56:59], v19 offset:6144
  s_waitcnt lgkmcnt(11)
  v_mfma_f32_16x16x32_bf16 v[156:159], v[60:63], v[92:95], v[156:159]
  buffer_load_dwordx4 v15, s[52:55], s25 offen offset:3072 lds
  v_mfma_f32_16x16x32_bf16 v[160:163], v[60:63], v[96:99], v[160:163]
  ds_read_b128 v[60:63], v19 offset:7168
  v_mfma_f32_16x16x32_bf16 v[164:167], v[64:67], v[92:95], v[164:167]
  v_mfma_f32_16x16x32_bf16 v[168:171], v[64:67], v[96:99], v[168:171]
  ds_read_b128 v[64:67], v19 offset:40960
  s_barrier
  s_waitcnt lgkmcnt(12)
  s_waitcnt lgkmcnt(4)
  v_mfma_f32_16x16x32_bf16 v[100:103], v[32:35], v[68:71], v[100:103]
  v_mfma_f32_16x16x32_bf16 v[104:107], v[32:35], v[72:75], v[104:107]
  ds_read_b128 v[32:35], v19 offset:8192
  v_mfma_f32_16x16x32_bf16 v[108:111], v[36:39], v[68:71], v[108:111]
  v_mfma_f32_16x16x32_bf16 v[112:115], v[36:39], v[72:75], v[112:115]
  ds_read_b128 v[36:39], v19 offset:9216
  v_mfma_f32_16x16x32_bf16 v[116:119], v[40:43], v[68:71], v[116:119]
  v_mfma_f32_16x16x32_bf16 v[120:123], v[40:43], v[72:75], v[120:123]
  ds_read_b128 v[40:43], v19 offset:10240
  v_mfma_f32_16x16x32_bf16 v[124:127], v[44:47], v[68:71], v[124:127]
  v_mfma_f32_16x16x32_bf16 v[128:131], v[44:47], v[72:75], v[128:131]
  ds_read_b128 v[44:47], v19 offset:11264
  v_mfma_f32_16x16x32_bf16 v[132:135], v[48:51], v[68:71], v[132:135]
  v_mfma_f32_16x16x32_bf16 v[136:139], v[48:51], v[72:75], v[136:139]
  ds_read_b128 v[48:51], v19 offset:12288
  s_waitcnt lgkmcnt(7)
  v_mfma_f32_16x16x32_bf16 v[140:143], v[52:55], v[68:71], v[140:143]
  v_mfma_f32_16x16x32_bf16 v[144:147], v[52:55], v[72:75], v[144:147]
  ds_read_b128 v[52:55], v19 offset:13312
  v_mfma_f32_16x16x32_bf16 v[148:151], v[56:59], v[68:71], v[148:151]
  v_mfma_f32_16x16x32_bf16 v[152:155], v[56:59], v[72:75], v[152:155]
  ds_read_b128 v[56:59], v19 offset:14336
  s_waitcnt lgkmcnt(7)
  v_mfma_f32_16x16x32_bf16 v[156:159], v[60:63], v[68:71], v[156:159]
  v_mfma_f32_16x16x32_bf16 v[160:163], v[60:63], v[72:75], v[160:163]
  ds_read_b128 v[60:63], v19 offset:15360
  v_mfma_f32_16x16x32_bf16 v[164:167], v[64:67], v[68:71], v[164:167]
  v_mfma_f32_16x16x32_bf16 v[168:171], v[64:67], v[72:75], v[168:171]
  ds_read_b128 v[64:67], v19 offset:41984
  s_waitcnt vmcnt(6)
  s_barrier
  s_and_b32 s44, s22, 1
  s_lshl_b32 s66, s21, 1
  s_add_u32 s66, s66, s44
  s_lshr_b32 s67, s22, 1
  s_lshl_b32 s68, s21, 8
  s_add_u32 s68, s68, 25387008
  s_lshl_b32 s69, s67, 9
  s_add_u32 s69, s69, 25370624
  v_lshlrev_b32 v7, 2, v1
  v_min_u32 v8, 44, v1
  v_lshlrev_b32 v8, 3, v8
  buffer_load_dword v4, v7, s[12:15], s68 offen sc0 sc1
  buffer_load_dwordx2 v[2:3], v8, s[12:15], s69 offen sc0 sc1
  s_waitcnt lgkmcnt(8)
  v_mfma_f32_16x16x32_bf16 v[100:103], v[32:35], v[76:79], v[100:103]
  s_waitcnt vmcnt(2)
  ds_read_b128 v[84:87], v21 offset:16384
  v_mfma_f32_16x16x32_bf16 v[104:107], v[32:35], v[80:83], v[104:107]
  ds_read_b128 v[88:91], v21 offset:18432
  s_waitcnt lgkmcnt(8)
  v_mfma_f32_16x16x32_bf16 v[108:111], v[36:39], v[76:79], v[108:111]
  ds_read_b128 v[32:35], v19 offset:16384
  v_mfma_f32_16x16x32_bf16 v[112:115], v[36:39], v[80:83], v[112:115]
  ds_read_b128 v[92:95], v22 offset:16384
  v_mfma_f32_16x16x32_bf16 v[116:119], v[40:43], v[76:79], v[116:119]
  ds_read_b128 v[36:39], v19 offset:17408
  v_mfma_f32_16x16x32_bf16 v[120:123], v[40:43], v[80:83], v[120:123]
  ds_read_b128 v[96:99], v22 offset:18432
  s_waitcnt lgkmcnt(10)
  v_mfma_f32_16x16x32_bf16 v[124:127], v[44:47], v[76:79], v[124:127]
  ds_read_b128 v[40:43], v19 offset:18432
  v_mfma_f32_16x16x32_bf16 v[128:131], v[44:47], v[80:83], v[128:131]
  ds_read_b128 v[44:47], v19 offset:19456
  v_mfma_f32_16x16x32_bf16 v[132:135], v[48:51], v[76:79], v[132:135]
  v_mfma_f32_16x16x32_bf16 v[136:139], v[48:51], v[80:83], v[136:139]
  ds_read_b128 v[48:51], v19 offset:20480
  s_waitcnt lgkmcnt(11)
  v_mfma_f32_16x16x32_bf16 v[140:143], v[52:55], v[76:79], v[140:143]
  v_mfma_f32_16x16x32_bf16 v[144:147], v[52:55], v[80:83], v[144:147]
  ds_read_b128 v[52:55], v19 offset:21504
  v_mfma_f32_16x16x32_bf16 v[148:151], v[56:59], v[76:79], v[148:151]
  v_mfma_f32_16x16x32_bf16 v[152:155], v[56:59], v[80:83], v[152:155]
  ds_read_b128 v[56:59], v19 offset:22528
  s_waitcnt lgkmcnt(11)
  v_mfma_f32_16x16x32_bf16 v[156:159], v[60:63], v[76:79], v[156:159]
  v_mfma_f32_16x16x32_bf16 v[160:163], v[60:63], v[80:83], v[160:163]
  ds_read_b128 v[60:63], v19 offset:23552
  v_mfma_f32_16x16x32_bf16 v[164:167], v[64:67], v[76:79], v[164:167]
  v_mfma_f32_16x16x32_bf16 v[168:171], v[64:67], v[80:83], v[168:171]
  ds_read_b128 v[64:67], v19 offset:43008
  s_barrier
  s_setprio 0
  s_waitcnt lgkmcnt(10)
  s_waitcnt lgkmcnt(7)
  v_mfma_f32_16x16x32_bf16 v[100:103], v[32:35], v[84:87], v[100:103]
  v_mfma_f32_16x16x32_bf16 v[104:107], v[32:35], v[88:91], v[104:107]
  ds_read_b128 v[32:35], v19 offset:24576
  s_waitcnt lgkmcnt(7)
  v_mfma_f32_16x16x32_bf16 v[108:111], v[36:39], v[84:87], v[108:111]
  v_mfma_f32_16x16x32_bf16 v[112:115], v[36:39], v[88:91], v[112:115]
  ds_read_b128 v[36:39], v19 offset:25600
  v_mfma_f32_16x16x32_bf16 v[116:119], v[40:43], v[84:87], v[116:119]
  v_mfma_f32_16x16x32_bf16 v[120:123], v[40:43], v[88:91], v[120:123]
  ds_read_b128 v[40:43], v19 offset:26624
  s_waitcnt lgkmcnt(7)
  v_mfma_f32_16x16x32_bf16 v[124:127], v[44:47], v[84:87], v[124:127]
  v_mfma_f32_16x16x32_bf16 v[128:131], v[44:47], v[88:91], v[128:131]
  ds_read_b128 v[44:47], v19 offset:27648
  v_mfma_f32_16x16x32_bf16 v[132:135], v[48:51], v[84:87], v[132:135]
  v_mfma_f32_16x16x32_bf16 v[136:139], v[48:51], v[88:91], v[136:139]
  ds_read_b128 v[48:51], v19 offset:28672
  s_waitcnt lgkmcnt(7)
  v_mfma_f32_16x16x32_bf16 v[140:143], v[52:55], v[84:87], v[140:143]
  v_mfma_f32_16x16x32_bf16 v[144:147], v[52:55], v[88:91], v[144:147]
  ds_read_b128 v[52:55], v19 offset:29696
  v_mfma_f32_16x16x32_bf16 v[148:151], v[56:59], v[84:87], v[148:151]
  v_mfma_f32_16x16x32_bf16 v[152:155], v[56:59], v[88:91], v[152:155]
  ds_read_b128 v[56:59], v19 offset:30720
  s_waitcnt lgkmcnt(7)
  v_mfma_f32_16x16x32_bf16 v[156:159], v[60:63], v[84:87], v[156:159]
  v_mfma_f32_16x16x32_bf16 v[160:163], v[60:63], v[88:91], v[160:163]
  ds_read_b128 v[60:63], v19 offset:31744
  v_mfma_f32_16x16x32_bf16 v[164:167], v[64:67], v[84:87], v[164:167]
  v_mfma_f32_16x16x32_bf16 v[168:171], v[64:67], v[88:91], v[168:171]
  ds_read_b128 v[64:67], v19 offset:44032
  s_waitcnt lgkmcnt(8)
  v_mfma_f32_16x16x32_bf16 v[100:103], v[32:35], v[92:95], v[100:103]
  v_mfma_f32_16x16x32_bf16 v[104:107], v[32:35], v[96:99], v[104:107]
  s_waitcnt lgkmcnt(6)
  v_mfma_f32_16x16x32_bf16 v[108:111], v[36:39], v[92:95], v[108:111]
  v_mfma_f32_16x16x32_bf16 v[112:115], v[36:39], v[96:99], v[112:115]
  v_mfma_f32_16x16x32_bf16 v[116:119], v[40:43], v[92:95], v[116:119]
  v_mfma_f32_16x16x32_bf16 v[120:123], v[40:43], v[96:99], v[120:123]
  s_waitcnt lgkmcnt(4)
  v_mfma_f32_16x16x32_bf16 v[124:127], v[44:47], v[92:95], v[124:127]
  v_mfma_f32_16x16x32_bf16 v[128:131], v[44:47], v[96:99], v[128:131]
  v_mfma_f32_16x16x32_bf16 v[132:135], v[48:51], v[92:95], v[132:135]
  v_mfma_f32_16x16x32_bf16 v[136:139], v[48:51], v[96:99], v[136:139]
  s_waitcnt lgkmcnt(2)
  v_mfma_f32_16x16x32_bf16 v[140:143], v[52:55], v[92:95], v[140:143]
  v_mfma_f32_16x16x32_bf16 v[144:147], v[52:55], v[96:99], v[144:147]
  v_mfma_f32_16x16x32_bf16 v[148:151], v[56:59], v[92:95], v[148:151]
  v_mfma_f32_16x16x32_bf16 v[152:155], v[56:59], v[96:99], v[152:155]
  s_waitcnt lgkmcnt(0)
  v_mfma_f32_16x16x32_bf16 v[156:159], v[60:63], v[92:95], v[156:159]
  v_mfma_f32_16x16x32_bf16 v[160:163], v[60:63], v[96:99], v[160:163]
  v_mfma_f32_16x16x32_bf16 v[164:167], v[64:67], v[92:95], v[164:167]
  v_mfma_f32_16x16x32_bf16 v[168:171], v[64:67], v[96:99], v[168:171]
  s_setprio 2
  s_waitcnt vmcnt(0)
  s_mov_b32 s51, 300000
  s_branch POLLC_22
POLL_21:
  s_mov_b32 s44, 24780800
  buffer_load_dwordx2 v[246:247], v11, s[12:15], s44 offen offset:0 sc0 sc1
  buffer_load_dwordx2 v[248:249], v11, s[12:15], s44 offen offset:32 sc0 sc1
  s_waitcnt vmcnt(0)
POLLC_22:
  v_xor_b32 v27, s62, v247
  v_xor_b32 v28, s62, v249
  v_or_b32 v27, v27, v28
  v_cmp_ne_u32 vcc, 0, v27
  s_nop 4
  s_cbranch_vccz POLLOK_23
  s_sleep 1
  s_sub_u32 s51, s51, 1
  s_cmp_lg_u32 s51, 0
  s_cbranch_scc1 POLL_21
POLLOK_23:
  s_mov_b32 s51, 300000
  s_branch POLLC_25
POLL_24:
  buffer_load_dword v4, v7, s[12:15], s68 offen sc0 sc1
  buffer_load_dwordx2 v[2:3], v8, s[12:15], s69 offen sc0 sc1
  s_waitcnt vmcnt(0)
POLLC_25:
  v_xor_b32 v27, s62, v2
  v_xor_b32 v28, s62, v3
  v_or_b32 v27, v27, v28
  v_xor_b32 v28, s62, v4
  v_or_b32 v27, v27, v28
  v_cmp_ne_u32 vcc, 0, v27
  s_nop 4
  s_cbranch_vccz POLLOK_26
  s_sleep 1
  s_sub_u32 s51, s51, 1
  s_cmp_lg_u32 s51, 0
  s_cbranch_scc1 POLL_24
POLLOK_26:
  v_sub_f32 v246, 1.0, v246
  v_lshlrev_b32 v244, 16, v244
  v_mul_f32 v250, v244, v246
  v_sub_f32 v248, 1.0, v248
  v_lshlrev_b32 v245, 16, v245
  v_mul_f32 v252, v245, v248
  s_mul_i32 s44, s23, 180
  s_lshr_b32 s45, s22, 2
  s_mul_i32 s45, s45, 18
  s_add_u32 s44, s44, s45
  s_lshl_b32 s44, s44, 10
  s_add_u32 s44, s44, 9521152
  s_and_b32 s45, s22, 3
  s_lshl_b32 s46, s45, 12
  s_add_u32 s46, s46, s44
  s_add_u32 s47, s46, 92160
  s_lshr_b32 s48, s45, 1
  s_lshl_b32 s48, s48, 10
  s_add_u32 s48, s48, s44
  s_and_b32 s49, s45, 1
  s_lshl_b32 s49, s49, 3
  s_add_u32 s48, s48, s49
  s_add_u32 s48, s48, 16384
  s_add_u32 s49, s48, 92160
  v_pk_fma_f32 v[100:101], v[100:101], v[246:247], v[250:251] op_sel_hi:[1,0,0]
  v_pk_fma_f32 v[102:103], v[102:103], v[246:247], v[250:251] op_sel_hi:[1,0,0]
  v_pk_fma_f32 v[108:109], v[108:109], v[246:247], v[250:251] op_sel_hi:[1,0,0]
  v_pk_fma_f32 v[110:111], v[110:111], v[246:247], v[250:251] op_sel_hi:[1,0,0]
  v_pk_mul_f32 v[100:101], v[100:101], v[172:173]
  v_pk_mul_f32 v[102:103], v[102:103], v[174:175]
  v_pk_mul_f32 v[108:109], v[108:109], v[180:181]
  v_pk_mul_f32 v[110:111], v[110:111], v[182:183]
  v_cvt_pk_bf16_f32 v32, v100, v101
  v_cvt_pk_bf16_f32 v33, v102, v103
  v_cvt_pk_bf16_f32 v34, v108, v109
  v_cvt_pk_bf16_f32 v35, v110, v111
  v_min_u32 v32, -2, v32
  v_min_u32 v33, -2, v33
  v_min_u32 v34, -2, v34
  v_min_u32 v35, -2, v35
  buffer_store_dwordx4 v[32:35], v19, s[12:15], s46 offen offset:0 sc0 sc1
  v_pk_fma_f32 v[104:105], v[104:105], v[248:249], v[252:253] op_sel_hi:[1,0,0]
  v_pk_fma_f32 v[106:107], v[106:107], v[248:249], v[252:253] op_sel_hi:[1,0,0]
  v_pk_fma_f32 v[112:113], v[112:113], v[248:249], v[252:253] op_sel_hi:[1,0,0]
  v_pk_fma_f32 v[114:115], v[114:115], v[248:249], v[252:253] op_sel_hi:[1,0,0]
  v_pk_mul_f32 v[104:105], v[104:105], v[176:177]
  v_pk_mul_f32 v[106:107], v[106:107], v[178:179]
  v_pk_mul_f32 v[112:113], v[112:113], v[184:185]
  v_pk_mul_f32 v[114:115], v[114:115], v[186:187]
  v_cvt_pk_bf16_f32 v36, v104, v105
  v_cvt_pk_bf16_f32 v37, v106, v107
  v_cvt_pk_bf16_f32 v38, v112, v113
  v_cvt_pk_bf16_f32 v39, v114, v115
  v_min_u32 v36, -2, v36
  v_min_u32 v37, -2, v37
  v_min_u32 v38, -2, v38
  v_min_u32 v39, -2, v39
  buffer_store_dwordx4 v[36:39], v19, s[12:15], s47 offen offset:0 sc0 sc1
  v_pk_fma_f32 v[116:117], v[116:117], v[246:247], v[250:251] op_sel_hi:[1,0,0]
  v_pk_fma_f32 v[118:119], v[118:119], v[246:247], v[250:251] op_sel_hi:[1,0,0]
  v_pk_fma_f32 v[124:125], v[124:125], v[246:247], v[250:251] op_sel_hi:[1,0,0]
  v_pk_fma_f32 v[126:127], v[126:127], v[246:247], v[250:251] op_sel_hi:[1,0,0]
  v_pk_mul_f32 v[116:117], v[116:117], v[188:189]
  v_pk_mul_f32 v[118:119], v[118:119], v[190:191]
  v_pk_mul_f32 v[124:125], v[124:125], v[196:197]
  v_pk_mul_f32 v[126:127], v[126:127], v[198:199]
  v_cvt_pk_bf16_f32 v40, v116, v117
  v_cvt_pk_bf16_f32 v41, v118, v119
  v_cvt_pk_bf16_f32 v42, v124, v125
  v_cvt_pk_bf16_f32 v43, v126, v127
  v_min_u32 v40, -2, v40
  v_min_u32 v41, -2, v41
  v_min_u32 v42, -2, v42
  v_min_u32 v43, -2, v43
  buffer_store_dwordx4 v[40:43], v19, s[12:15], s46 offen offset:1024 sc0 sc1
  v_pk_fma_f32 v[120:121], v[120:121], v[248:249], v[252:253] op_sel_hi:[1,0,0]
  v_pk_fma_f32 v[122:123], v[122:123], v[248:249], v[252:253] op_sel_hi:[1,0,0]
  v_pk_fma_f32 v[128:129], v[128:129], v[248:249], v[252:253] op_sel_hi:[1,0,0]
  v_pk_fma_f32 v[130:131], v[130:131], v[248:249], v[252:253] op_sel_hi:[1,0,0]
  v_pk_mul_f32 v[120:121], v[120:121], v[192:193]
  v_pk_mul_f32 v[122:123], v[122:123], v[194:195]
  v_pk_mul_f32 v[128:129], v[128:129], v[200:201]
  v_pk_mul_f32 v[130:131], v[130:131], v[202:203]
  v_cvt_pk_bf16_f32 v44, v120, v121
  v_cvt_pk_bf16_f32 v45, v122, v123
  v_cvt_pk_bf16_f32 v46, v128, v129
  v_cvt_pk_bf16_f32 v47, v130, v131
  v_min_u32 v44, -2, v44
  v_min_u32 v45, -2, v45
  v_min_u32 v46, -2, v46
  v_min_u32 v47, -2, v47
  buffer_store_dwordx4 v[44:47], v19, s[12:15], s47 offen offset:1024 sc0 sc1
  v_pk_fma_f32 v[132:133], v[132:133], v[246:247], v[250:251] op_sel_hi:[1,0,0]
  v_pk_fma_f32 v[134:135], v[134:135], v[246:247], v[250:251] op_sel_hi:[1,0,0]
  v_pk_fma_f32 v[140:141], v[140:141], v[246:247], v[250:251] op_sel_hi:[1,0,0]
  v_pk_fma_f32 v[142:143], v[142:143], v[246:247], v[250:251] op_sel_hi:[1,0,0]
  v_pk_mul_f32 v[132:133], v[132:133], v[204:205]
  v_pk_mul_f32 v[134:135], v[134:135], v[206:207]
  v_pk_mul_f32 v[140:141], v[140:141], v[212:213]
  v_pk_mul_f32 v[142:143], v[142:143], v[214:215]
  v_cvt_pk_bf16_f32 v48, v132, v133
  v_cvt_pk_bf16_f32 v49, v134, v135
  v_cvt_pk_bf16_f32 v50, v140, v141
  v_cvt_pk_bf16_f32 v51, v142, v143
  v_min_u32 v48, -2, v48
  v_min_u32 v49, -2, v49
  v_min_u32 v50, -2, v50
  v_min_u32 v51, -2, v51
  buffer_store_dwordx4 v[48:51], v19, s[12:15], s46 offen offset:2048 sc0 sc1
  v_pk_fma_f32 v[136:137], v[136:137], v[248:249], v[252:253] op_sel_hi:[1,0,0]
  v_pk_fma_f32 v[138:139], v[138:139], v[248:249], v[252:253] op_sel_hi:[1,0,0]
  v_pk_fma_f32 v[144:145], v[144:145], v[248:249], v[252:253] op_sel_hi:[1,0,0]
  v_pk_fma_f32 v[146:147], v[146:147], v[248:249], v[252:253] op_sel_hi:[1,0,0]
  v_pk_mul_f32 v[136:137], v[136:137], v[208:209]
  v_pk_mul_f32 v[138:139], v[138:139], v[210:211]
  v_pk_mul_f32 v[144:145], v[144:145], v[216:217]
  v_pk_mul_f32 v[146:147], v[146:147], v[218:219]
  v_cvt_pk_bf16_f32 v52, v136, v137
  v_cvt_pk_bf16_f32 v53, v138, v139
  v_cvt_pk_bf16_f32 v54, v144, v145
  v_cvt_pk_bf16_f32 v55, v146, v147
  v_min_u32 v52, -2, v52
  v_min_u32 v53, -2, v53
  v_min_u32 v54, -2, v54
  v_min_u32 v55, -2, v55
  buffer_store_dwordx4 v[52:55], v19, s[12:15], s47 offen offset:2048 sc0 sc1
  v_pk_fma_f32 v[148:149], v[148:149], v[246:247], v[250:251] op_sel_hi:[1,0,0]
  v_pk_fma_f32 v[150:151], v[150:151], v[246:247], v[250:251] op_sel_hi:[1,0,0]
  v_pk_fma_f32 v[156:157], v[156:157], v[246:247], v[250:251] op_sel_hi:[1,0,0]
  v_pk_fma_f32 v[158:159], v[158:159], v[246:247], v[250:251] op_sel_hi:[1,0,0]
  v_pk_mul_f32 v[148:149], v[148:149], v[220:221]
  v_pk_mul_f32 v[150:151], v[150:151], v[222:223]
  v_pk_mul_f32 v[156:157], v[156:157], v[228:229]
  v_pk_mul_f32 v[158:159], v[158:159], v[230:231]
  v_cvt_pk_bf16_f32 v56, v148, v149
  v_cvt_pk_bf16_f32 v57, v150, v151
  v_cvt_pk_bf16_f32 v58, v156, v157
  v_cvt_pk_bf16_f32 v59, v158, v159
  v_min_u32 v56, -2, v56
  v_min_u32 v57, -2, v57
  v_min_u32 v58, -2, v58
  v_min_u32 v59, -2, v59
  buffer_store_dwordx4 v[56:59], v19, s[12:15], s46 offen offset:3072 sc0 sc1
  v_pk_fma_f32 v[152:153], v[152:153], v[248:249], v[252:253] op_sel_hi:[1,0,0]
  v_pk_fma_f32 v[154:155], v[154:155], v[248:249], v[252:253] op_sel_hi:[1,0,0]
  v_pk_fma_f32 v[160:161], v[160:161], v[248:249], v[252:253] op_sel_hi:[1,0,0]
  v_pk_fma_f32 v[162:163], v[162:163], v[248:249], v[252:253] op_sel_hi:[1,0,0]
  v_pk_mul_f32 v[152:153], v[152:153], v[224:225]
  v_pk_mul_f32 v[154:155], v[154:155], v[226:227]
  v_pk_mul_f32 v[160:161], v[160:161], v[232:233]
  v_pk_mul_f32 v[162:163], v[162:163], v[234:235]
  v_cvt_pk_bf16_f32 v60, v152, v153
  v_cvt_pk_bf16_f32 v61, v154, v155
  v_cvt_pk_bf16_f32 v62, v160, v161
  v_cvt_pk_bf16_f32 v63, v162, v163
  v_min_u32 v60, -2, v60
  v_min_u32 v61, -2, v61
  v_min_u32 v62, -2, v62
  v_min_u32 v63, -2, v63
  buffer_store_dwordx4 v[60:63], v19, s[12:15], s47 offen offset:3072 sc0 sc1
  v_pk_fma_f32 v[164:165], v[164:165], v[246:247], v[250:251] op_sel_hi:[1,0,0]
  v_pk_fma_f32 v[166:167], v[166:167], v[246:247], v[250:251] op_sel_hi:[1,0,0]
  v_pk_mul_f32 v[164:165], v[164:165], v[236:237]
  v_pk_mul_f32 v[166:167], v[166:167], v[238:239]
  v_cvt_pk_bf16_f32 v64, v164, v165
  v_cvt_pk_bf16_f32 v65, v166, v167
  v_min_u32 v64, -2, v64
  v_min_u32 v65, -2, v65
  buffer_store_dwordx2 v[64:65], v19, s[12:15], s48 offen sc0 sc1
  v_pk_fma_f32 v[168:169], v[168:169], v[248:249], v[252:253] op_sel_hi:[1,0,0]
  v_pk_fma_f32 v[170:171], v[170:171], v[248:249], v[252:253] op_sel_hi:[1,0,0]
  v_pk_mul_f32 v[168:169], v[168:169], v[240:241]
  v_pk_mul_f32 v[170:171], v[170:171], v[242:243]
  v_cvt_pk_bf16_f32 v68, v168, v169
  v_cvt_pk_bf16_f32 v69, v170, v171
  v_min_u32 v68, -2, v68
  v_min_u32 v69, -2, v69
  buffer_store_dwordx2 v[68:69], v19, s[12:15], s49 offen sc0 sc1
  s_mul_i32 s44, s20, 18
  s_add_u32 s44, s44, 18
  s_mul_i32 s45, s20, 5
  s_cmp_eq_u32 s20, 3
  s_cselect_b32 s46, 1, 0
  s_sub_u32 s45, s45, s46
  s_mul_i32 s46, s67, 90
  s_add_u32 s25, s44, s46
  s_mul_i32 s25, s25, 4608
  s_add_u32 s25, s25, 21299200
  s_add_u32 s31, s45, s46
  s_mul_i32 s31, s31, 4608
  s_add_u32 s31, s31, 21299200
  v_lshrrev_b32 v6, 4, v1
  v_lshlrev_b32 v6, 3, v6
  v_and_b32 v9, 7, v1
  v_add_u32 v6, v6, v9
  v_lshlrev_b32 v6, 4, v6
  v_bfe_u32 v9, v1, 3, 1
  v_mul_u32_u24 v9, 4608, v9
  v_add_u32 v6, v6, v9
  v_add_u32 v6, 4096, v6
  v_mov_b32 v12, v19
  buffer_load_dwordx4 v[112:115], v12, s[12:15], s25 offen offset:0 sc1
  buffer_load_dwordx4 v[116:119], v12, s[12:15], s25 offen offset:1024 sc1
  buffer_load_dwordx4 v[120:123], v12, s[12:15], s25 offen offset:2048 sc1
  buffer_load_dwordx4 v[124:127], v12, s[12:15], s25 offen offset:3072 sc1
  buffer_load_dwordx4 v[240:243], v6, s[12:15], s25 offen sc1
  s_add_u32 s25, s25, 4608
  buffer_load_dwordx4 v[144:147], v12, s[12:15], s25 offen offset:0 sc1
  buffer_load_dwordx4 v[148:151], v12, s[12:15], s25 offen offset:1024 sc1
  buffer_load_dwordx4 v[152:155], v12, s[12:15], s25 offen offset:2048 sc1
  buffer_load_dwordx4 v[156:159], v12, s[12:15], s25 offen offset:3072 sc1
  s_add_u32 s25, s25, 4608
  s_mul_i32 s46, s66, 360
  s_add_u32 s28, s44, s46
  s_lshl_b32 s28, s28, 10
  s_add_u32 s28, s28, 9502720
  s_add_u32 s30, s45, s46
  s_lshl_b32 s30, s30, 10
  s_add_u32 s30, s30, 9502720
  s_add_u32 s44, s20, 0
  s_and_b32 s44, s44, 3
  s_mul_i32 s44, s44, 92160
  v_add_u32 v2, s44, v12
  s_add_u32 s44, s20, 1
  s_and_b32 s44, s44, 3
  s_mul_i32 s44, s44, 92160
  v_add_u32 v3, s44, v12
  s_add_u32 s44, s20, 2
  s_and_b32 s44, s44, 3
  s_mul_i32 s44, s44, 92160
  v_add_u32 v4, s44, v12
  s_add_u32 s44, s20, 3
  s_and_b32 s44, s44, 3
  s_mul_i32 s44, s44, 92160
  v_add_u32 v5, s44, v12
  s_mov_b32 s8, s64
  s_mov_b32 s9, s65
  s_mov_b32 s10, 2359296
  s_mov_b32 s11, 0x00020000
  s_mov_b32 s51, 300000
  s_waitcnt vmcnt(9)
  s_add_u32 s24, s28, 0
  buffer_load_dwordx4 v[128:131], v2, s[12:15], s24 offen sc1
  buffer_load_dwordx4 v[132:135], v3, s[12:15], s24 offen sc1
  buffer_load_dwordx4 v[136:139], v4, s[12:15], s24 offen sc1
  buffer_load_dwordx4 v[140:143], v5, s[12:15], s24 offen sc1
  s_add_u32 s24, s28, 1024
  buffer_load_dwordx4 v[160:163], v2, s[12:15], s24 offen sc1
  buffer_load_dwordx4 v[164:167], v3, s[12:15], s24 offen sc1
  buffer_load_dwordx4 v[168:171], v4, s[12:15], s24 offen sc1
  buffer_load_dwordx4 v[172:175], v5, s[12:15], s24 offen sc1
  buffer_load_dwordx4 v[176:179], v12, s[12:15], s25 offen offset:0 sc1
  buffer_load_dwordx4 v[180:183], v12, s[12:15], s25 offen offset:1024 sc1
  buffer_load_dwordx4 v[184:187], v12, s[12:15], s25 offen offset:2048 sc1
  buffer_load_dwordx4 v[188:191], v12, s[12:15], s25 offen offset:3072 sc1
  buffer_load_dwordx4 v[244:247], v6, s[12:15], s25 offen sc1
  s_add_u32 s25, s25, 4608
  s_add_u32 s24, s28, 2048
  buffer_load_dwordx4 v[192:195], v2, s[12:15], s24 offen sc1
  buffer_load_dwordx4 v[196:199], v3, s[12:15], s24 offen sc1
  buffer_load_dwordx4 v[200:203], v4, s[12:15], s24 offen sc1
  buffer_load_dwordx4 v[204:207], v5, s[12:15], s24 offen sc1
  buffer_load_dwordx4 v[208:211], v12, s[12:15], s25 offen offset:0 sc1
  buffer_load_dwordx4 v[212:215], v12, s[12:15], s25 offen offset:1024 sc1
  buffer_load_dwordx4 v[216:219], v12, s[12:15], s25 offen offset:2048 sc1
  buffer_load_dwordx4 v[220:223], v12, s[12:15], s25 offen offset:3072 sc1
  s_add_u32 s25, s25, 4608
  s_add_u32 s24, s28, 3072
  buffer_load_dwordx4 v[224:227], v2, s[12:15], s24 offen sc1
  buffer_load_dwordx4 v[228:231], v3, s[12:15], s24 offen sc1
  buffer_load_dwordx4 v[232:235], v4, s[12:15], s24 offen sc1
  buffer_load_dwordx4 v[236:239], v5, s[12:15], s24 offen sc1
  s_add_u32 s44, s20, 1
  s_and_b32 s44, s44, 3
  s_mul_i32 s44, s44, 15360
  v_add_u32 v252, s44, v12
  s_add_u32 s44, s20, 2
  s_and_b32 s44, s44, 3
  s_mul_i32 s44, s44, 15360
  v_add_u32 v253, s44, v12
  s_add_u32 s44, s20, 3
  s_and_b32 s44, s44, 3
  s_mul_i32 s44, s44, 15360
  v_add_u32 v254, s44, v12
  s_mul_i32 s26, s20, 15360
  v_add_u32 v8, s26, v12
  s_lshl_b32 s27, s66, 6
  s_lshr_b32 s44, s20, 1
  s_lshl_b32 s44, s44, 5
  s_add_u32 s27, s27, s44
  s_and_b32 s44, s20, 1
  s_lshl_b32 s44, s44, 2
  s_add_u32 s27, s27, s44
  v_bfe_u32 v13, v1, 2, 2
  v_lshlrev_b32 v13, 3, v13
  v_and_b32 v14, 3, v1
  v_add3_u32 v13, v13, v14, s27
  v_mul_u32_u24 v13, 1152, v13
  v_lshrrev_b32 v14, 4, v1
  v_lshl_add_u32 v15, v14, 3, v13
  v_lshl_add_u32 v13, v14, 4, v13
  s_mul_i32 s27, s67, 144
  s_setprio 0
  s_waitcnt vmcnt(21)
P3_C_28:
  v_max3_u32 v9, v128, v129, v130
  v_max3_u32 v10, v131, v132, v133
  v_max3_u32 v9, v134, v135, v9
  v_max3_u32 v10, v136, v137, v10
  v_max3_u32 v9, v138, v139, v9
  v_max3_u32 v10, v140, v141, v10
  v_max3_u32 v9, v142, v143, v9
  v_max_u32 v9, v9, v10
  v_cmp_eq_u32 vcc, -1, v9
  s_nop 4
  s_cbranch_vccz P3_OK_29
  s_sleep 4
  s_add_u32 s24, s28, 0
  buffer_load_dwordx4 v[128:131], v2, s[12:15], s24 offen sc1
  buffer_load_dwordx4 v[132:135], v3, s[12:15], s24 offen sc1
  buffer_load_dwordx4 v[136:139], v4, s[12:15], s24 offen sc1
  buffer_load_dwordx4 v[140:143], v5, s[12:15], s24 offen sc1
  s_waitcnt vmcnt(0)
  s_sub_u32 s51, s51, 1
  s_cmp_lt_i32 s51, 1
  s_cbranch_scc0 P3_C_28
P3_OK_29:
  v_mfma_f32_16x16x32_bf16 v[20:23], v[112:115], v[132:135], 0
  v_mfma_f32_16x16x32_bf16 v[36:39], v[116:119], v[132:135], 0
  v_mfma_f32_16x16x32_bf16 v[52:55], v[120:123], v[132:135], 0
  v_mfma_f32_16x16x32_bf16 v[68:71], v[124:127], v[132:135], 0
  v_mfma_f32_16x16x32_bf16 v[84:87], v[240:243], v[132:135], 0
  v_mfma_f32_16x16x32_bf16 v[24:27], v[112:115], v[136:139], 0
  v_mfma_f32_16x16x32_bf16 v[40:43], v[116:119], v[136:139], 0
  v_mfma_f32_16x16x32_bf16 v[56:59], v[120:123], v[136:139], 0
  v_mfma_f32_16x16x32_bf16 v[72:75], v[124:127], v[136:139], 0
  v_mfma_f32_16x16x32_bf16 v[88:91], v[240:243], v[136:139], 0
  v_mfma_f32_16x16x32_bf16 v[28:31], v[112:115], v[140:143], 0
  v_mfma_f32_16x16x32_bf16 v[44:47], v[116:119], v[140:143], 0
  v_mfma_f32_16x16x32_bf16 v[60:63], v[120:123], v[140:143], 0
  v_mfma_f32_16x16x32_bf16 v[76:79], v[124:127], v[140:143], 0
  v_mfma_f32_16x16x32_bf16 v[92:95], v[240:243], v[140:143], 0
  v_mfma_f32_16x16x32_bf16 v[16:19], v[112:115], v[128:131], 0
  v_mfma_f32_16x16x32_bf16 v[32:35], v[116:119], v[128:131], 0
  v_mfma_f32_16x16x32_bf16 v[48:51], v[120:123], v[128:131], 0
  v_mfma_f32_16x16x32_bf16 v[64:67], v[124:127], v[128:131], 0
  v_mfma_f32_16x16x32_bf16 v[80:83], v[240:243], v[128:131], 0
  buffer_load_dwordx4 v[112:115], v12, s[12:15], s25 offen offset:0 sc1
  buffer_load_dwordx4 v[116:119], v12, s[12:15], s25 offen offset:1024 sc1
  buffer_load_dwordx4 v[120:123], v12, s[12:15], s25 offen offset:2048 sc1
  buffer_load_dwordx4 v[124:127], v12, s[12:15], s25 offen offset:3072 sc1
  buffer_load_dwordx4 v[248:251], v6, s[12:15], s25 offen sc1
  s_add_u32 s25, s25, 4608
  s_add_u32 s24, s28, 4096
  buffer_load_dwordx4 v[128:131], v2, s[12:15], s24 offen sc1
  buffer_load_dwordx4 v[132:135], v3, s[12:15], s24 offen sc1
  buffer_load_dwordx4 v[136:139], v4, s[12:15], s24 offen sc1
  buffer_load_dwordx4 v[140:143], v5, s[12:15], s24 offen sc1
  s_waitcnt vmcnt(26)
P3_C_30:
  v_max3_u32 v9, v160, v161, v162
  v_max3_u32 v10, v163, v164, v165
  v_max3_u32 v9, v166, v167, v9
  v_max3_u32 v10, v168, v169, v10
  v_max3_u32 v9, v170, v171, v9
  v_max3_u32 v10, v172, v173, v10
  v_max3_u32 v9, v174, v175, v9
  v_max_u32 v9, v9, v10
  v_cmp_eq_u32 vcc, -1, v9
  s_nop 4
  s_cbranch_vccz P3_OK_31
  s_sleep 4
  s_add_u32 s24, s28, 1024
  buffer_load_dwordx4 v[160:163], v2, s[12:15], s24 offen sc1
  buffer_load_dwordx4 v[164:167], v3, s[12:15], s24 offen sc1
  buffer_load_dwordx4 v[168:171], v4, s[12:15], s24 offen sc1
  buffer_load_dwordx4 v[172:175], v5, s[12:15], s24 offen sc1
  s_waitcnt vmcnt(0)
  s_sub_u32 s51, s51, 1
  s_cmp_lt_i32 s51, 1
  s_cbranch_scc0 P3_C_30
P3_OK_31:
  v_mfma_f32_16x16x32_bf16 v[20:23], v[144:147], v[164:167], v[20:23]
  v_mfma_f32_16x16x32_bf16 v[36:39], v[148:151], v[164:167], v[36:39]
  v_mfma_f32_16x16x32_bf16 v[52:55], v[152:155], v[164:167], v[52:55]
  v_mfma_f32_16x16x32_bf16 v[68:71], v[156:159], v[164:167], v[68:71]
  v_mfma_f32_16x16x32_bf16 v[100:103], v[240:243], v[164:167], 0
  v_mfma_f32_16x16x32_bf16 v[24:27], v[144:147], v[168:171], v[24:27]
  v_mfma_f32_16x16x32_bf16 v[40:43], v[148:151], v[168:171], v[40:43]
  v_mfma_f32_16x16x32_bf16 v[56:59], v[152:155], v[168:171], v[56:59]
  v_mfma_f32_16x16x32_bf16 v[72:75], v[156:159], v[168:171], v[72:75]
  v_mfma_f32_16x16x32_bf16 v[104:107], v[240:243], v[168:171], 0
  v_mfma_f32_16x16x32_bf16 v[28:31], v[144:147], v[172:175], v[28:31]
  v_mfma_f32_16x16x32_bf16 v[44:47], v[148:151], v[172:175], v[44:47]
  v_mfma_f32_16x16x32_bf16 v[60:63], v[152:155], v[172:175], v[60:63]
  v_mfma_f32_16x16x32_bf16 v[76:79], v[156:159], v[172:175], v[76:79]
  v_mfma_f32_16x16x32_bf16 v[108:111], v[240:243], v[172:175], 0
  v_mfma_f32_16x16x32_bf16 v[16:19], v[144:147], v[160:163], v[16:19]
  v_mfma_f32_16x16x32_bf16 v[32:35], v[148:151], v[160:163], v[32:35]
  v_mfma_f32_16x16x32_bf16 v[48:51], v[152:155], v[160:163], v[48:51]
  v_mfma_f32_16x16x32_bf16 v[64:67], v[156:159], v[160:163], v[64:67]
  v_mfma_f32_16x16x32_bf16 v[96:99], v[240:243], v[160:163], 0
  buffer_load_dwordx4 v[144:147], v12, s[12:15], s25 offen offset:0 sc1
  buffer_load_dwordx4 v[148:151], v12, s[12:15], s25 offen offset:1024 sc1
  buffer_load_dwordx4 v[152:155], v12, s[12:15], s25 offen offset:2048 sc1
  buffer_load_dwordx4 v[156:159], v12, s[12:15], s25 offen offset:3072 sc1
  s_add_u32 s25, s25, 4608
  s_add_u32 s24, s28, 5120
  buffer_load_dwordx4 v[160:163], v2, s[12:15], s24 offen sc1
  buffer_load_dwordx4 v[164:167], v3, s[12:15], s24 offen sc1
  buffer_load_dwordx4 v[168:171], v4, s[12:15], s24 offen sc1
  buffer_load_dwordx4 v[172:175], v5, s[12:15], s24 offen sc1
  s_waitcnt vmcnt(25)
P3_C_32:
  v_max3_u32 v9, v192, v193, v194
  v_max3_u32 v10, v195, v196, v197
  v_max3_u32 v9, v198, v199, v9
  v_max3_u32 v10, v200, v201, v10
  v_max3_u32 v9, v202, v203, v9
  v_max3_u32 v10, v204, v205, v10
  v_max3_u32 v9, v206, v207, v9
  v_max_u32 v9, v9, v10
  v_cmp_eq_u32 vcc, -1, v9
  s_nop 4
  s_cbranch_vccz P3_OK_33
  s_sleep 4
  s_add_u32 s24, s28, 2048
  buffer_load_dwordx4 v[192:195], v2, s[12:15], s24 offen sc1
  buffer_load_dwordx4 v[196:199], v3, s[12:15], s24 offen sc1
  buffer_load_dwordx4 v[200:203], v4, s[12:15], s24 offen sc1
  buffer_load_dwordx4 v[204:207], v5, s[12:15], s24 offen sc1
  s_waitcnt vmcnt(0)
  s_sub_u32 s51, s51, 1
  s_cmp_lt_i32 s51, 1
  s_cbranch_scc0 P3_C_32
P3_OK_33:
  v_mfma_f32_16x16x32_bf16 v[20:23], v[176:179], v[196:199], v[20:23]
  v_mfma_f32_16x16x32_bf16 v[36:39], v[180:183], v[196:199], v[36:39]
  v_mfma_f32_16x16x32_bf16 v[52:55], v[184:187], v[196:199], v[52:55]
  v_mfma_f32_16x16x32_bf16 v[68:71], v[188:191], v[196:199], v[68:71]
  v_mfma_f32_16x16x32_bf16 v[84:87], v[244:247], v[196:199], v[84:87]
  v_mfma_f32_16x16x32_bf16 v[24:27], v[176:179], v[200:203], v[24:27]
  v_mfma_f32_16x16x32_bf16 v[40:43], v[180:183], v[200:203], v[40:43]
  v_mfma_f32_16x16x32_bf16 v[56:59], v[184:187], v[200:203], v[56:59]
  v_mfma_f32_16x16x32_bf16 v[72:75], v[188:191], v[200:203], v[72:75]
  v_mfma_f32_16x16x32_bf16 v[88:91], v[244:247], v[200:203], v[88:91]
  v_mfma_f32_16x16x32_bf16 v[28:31], v[176:179], v[204:207], v[28:31]
  v_mfma_f32_16x16x32_bf16 v[44:47], v[180:183], v[204:207], v[44:47]
  v_mfma_f32_16x16x32_bf16 v[60:63], v[184:187], v[204:207], v[60:63]
  v_mfma_f32_16x16x32_bf16 v[76:79], v[188:191], v[204:207], v[76:79]
  v_mfma_f32_16x16x32_bf16 v[92:95], v[244:247], v[204:207], v[92:95]
  v_mfma_f32_16x16x32_bf16 v[16:19], v[176:179], v[192:195], v[16:19]
  v_mfma_f32_16x16x32_bf16 v[32:35], v[180:183], v[192:195], v[32:35]
  v_mfma_f32_16x16x32_bf16 v[48:51], v[184:187], v[192:195], v[48:51]
  v_mfma_f32_16x16x32_bf16 v[64:67], v[188:191], v[192:195], v[64:67]
  v_mfma_f32_16x16x32_bf16 v[80:83], v[244:247], v[192:195], v[80:83]
  buffer_load_dwordx4 v[176:179], v12, s[12:15], s25 offen offset:0 sc1
  buffer_load_dwordx4 v[180:183], v12, s[12:15], s25 offen offset:1024 sc1
  buffer_load_dwordx4 v[184:187], v12, s[12:15], s25 offen offset:2048 sc1
  buffer_load_dwordx4 v[188:191], v12, s[12:15], s25 offen offset:3072 sc1
  buffer_load_dwordx4 v[240:243], v6, s[12:15], s25 offen sc1
  s_add_u32 s25, s25, 4608
  s_add_u32 s24, s28, 6144
  buffer_load_dwordx4 v[192:195], v2, s[12:15], s24 offen sc1
  buffer_load_dwordx4 v[196:199], v3, s[12:15], s24 offen sc1
  buffer_load_dwordx4 v[200:203], v4, s[12:15], s24 offen sc1
  buffer_load_dwordx4 v[204:207], v5, s[12:15], s24 offen sc1
  s_waitcnt vmcnt(26)
P3_C_34:
  v_max3_u32 v9, v224, v225, v226
  v_max3_u32 v10, v227, v228, v229
  v_max3_u32 v9, v230, v231, v9
  v_max3_u32 v10, v232, v233, v10
  v_max3_u32 v9, v234, v235, v9
  v_max3_u32 v10, v236, v237, v10
  v_max3_u32 v9, v238, v239, v9
  v_max_u32 v9, v9, v10
  v_cmp_eq_u32 vcc, -1, v9
  s_nop 4
  s_cbranch_vccz P3_OK_35
  s_sleep 4
  s_add_u32 s24, s28, 3072
  buffer_load_dwordx4 v[224:227], v2, s[12:15], s24 offen sc1
  buffer_load_dwordx4 v[228:231], v3, s[12:15], s24 offen sc1
  buffer_load_dwordx4 v[232:235], v4, s[12:15], s24 offen sc1
  buffer_load_dwordx4 v[236:239], v5, s[12:15], s24 offen sc1
  s_waitcnt vmcnt(0)
  s_sub_u32 s51, s51, 1
  s_cmp_lt_i32 s51, 1
  s_cbranch_scc0 P3_C_34
P3_OK_35:
  v_mfma_f32_16x16x32_bf16 v[20:23], v[208:211], v[228:231], v[20:23]
  v_mfma_f32_16x16x32_bf16 v[36:39], v[212:215], v[228:231], v[36:39]
  v_mfma_f32_16x16x32_bf16 v[52:55], v[216:219], v[228:231], v[52:55]
  v_mfma_f32_16x16x32_bf16 v[68:71], v[220:223], v[228:231], v[68:71]
  v_mfma_f32_16x16x32_bf16 v[100:103], v[244:247], v[228:231], v[100:103]
  v_mfma_f32_16x16x32_bf16 v[24:27], v[208:211], v[232:235], v[24:27]
  v_mfma_f32_16x16x32_bf16 v[40:43], v[212:215], v[232:235], v[40:43]
  v_mfma_f32_16x16x32_bf16 v[56:59], v[216:219], v[232:235], v[56:59]
  v_mfma_f32_16x16x32_bf16 v[72:75], v[220:223], v[232:235], v[72:75]
  v_mfma_f32_16x16x32_bf16 v[104:107], v[244:247], v[232:235], v[104:107]
  v_mfma_f32_16x16x32_bf16 v[28:31], v[208:211], v[236:239], v[28:31]
  v_mfma_f32_16x16x32_bf16 v[44:47], v[212:215], v[236:239], v[44:47]
  v_mfma_f32_16x16x32_bf16 v[60:63], v[216:219], v[236:239], v[60:63]
  v_mfma_f32_16x16x32_bf16 v[76:79], v[220:223], v[236:239], v[76:79]
  v_mfma_f32_16x16x32_bf16 v[108:111], v[244:247], v[236:239], v[108:111]
  v_mfma_f32_16x16x32_bf16 v[16:19], v[208:211], v[224:227], v[16:19]
  v_mfma_f32_16x16x32_bf16 v[32:35], v[212:215], v[224:227], v[32:35]
  v_mfma_f32_16x16x32_bf16 v[48:51], v[216:219], v[224:227], v[48:51]
  v_mfma_f32_16x16x32_bf16 v[64:67], v[220:223], v[224:227], v[64:67]
  v_mfma_f32_16x16x32_bf16 v[96:99], v[244:247], v[224:227], v[96:99]
  buffer_load_dwordx4 v[208:211], v12, s[12:15], s25 offen offset:0 sc1
  buffer_load_dwordx4 v[212:215], v12, s[12:15], s25 offen offset:1024 sc1
  buffer_load_dwordx4 v[216:219], v12, s[12:15], s25 offen offset:2048 sc1
  buffer_load_dwordx4 v[220:223], v12, s[12:15], s25 offen offset:3072 sc1
  s_add_u32 s25, s25, 4608
  s_add_u32 s24, s28, 7168
  buffer_load_dwordx4 v[224:227], v2, s[12:15], s24 offen sc1
  buffer_load_dwordx4 v[228:231], v3, s[12:15], s24 offen sc1
  buffer_load_dwordx4 v[232:235], v4, s[12:15], s24 offen sc1
  buffer_load_dwordx4 v[236:239], v5, s[12:15], s24 offen sc1
  s_waitcnt vmcnt(25)
P3_C_36:
  v_max3_u32 v9, v128, v129, v130
  v_max3_u32 v10, v131, v132, v133
  v_max3_u32 v9, v134, v135, v9
  v_max3_u32 v10, v136, v137, v10
  v_max3_u32 v9, v138, v139, v9
  v_max3_u32 v10, v140, v141, v10
  v_max3_u32 v9, v142, v143, v9
  v_max_u32 v9, v9, v10
  v_cmp_eq_u32 vcc, -1, v9
  s_nop 4
  s_cbranch_vccz P3_OK_37
  s_sleep 4
  s_add_u32 s24, s28, 4096
  buffer_load_dwordx4 v[128:131], v2, s[12:15], s24 offen sc1
  buffer_load_dwordx4 v[132:135], v3, s[12:15], s24 offen sc1
  buffer_load_dwordx4 v[136:139], v4, s[12:15], s24 offen sc1
  buffer_load_dwordx4 v[140:143], v5, s[12:15], s24 offen sc1
  s_waitcnt vmcnt(0)
  s_sub_u32 s51, s51, 1
  s_cmp_lt_i32 s51, 1
  s_cbranch_scc0 P3_C_36
P3_OK_37:
  v_mfma_f32_16x16x32_bf16 v[20:23], v[112:115], v[132:135], v[20:23]
  v_mfma_f32_16x16x32_bf16 v[36:39], v[116:119], v[132:135], v[36:39]
  v_mfma_f32_16x16x32_bf16 v[52:55], v[120:123], v[132:135], v[52:55]
  v_mfma_f32_16x16x32_bf16 v[68:71], v[124:127], v[132:135], v[68:71]
  v_mfma_f32_16x16x32_bf16 v[84:87], v[248:251], v[132:135], v[84:87]
  v_mfma_f32_16x16x32_bf16 v[24:27], v[112:115], v[136:139], v[24:27]
  v_mfma_f32_16x16x32_bf16 v[40:43], v[116:119], v[136:139], v[40:43]
  v_mfma_f32_16x16x32_bf16 v[56:59], v[120:123], v[136:139], v[56:59]
  v_mfma_f32_16x16x32_bf16 v[72:75], v[124:127], v[136:139], v[72:75]
  v_mfma_f32_16x16x32_bf16 v[88:91], v[248:251], v[136:139], v[88:91]
  v_mfma_f32_16x16x32_bf16 v[28:31], v[112:115], v[140:143], v[28:31]
  v_mfma_f32_16x16x32_bf16 v[44:47], v[116:119], v[140:143], v[44:47]
  v_mfma_f32_16x16x32_bf16 v[60:63], v[120:123], v[140:143], v[60:63]
  v_mfma_f32_16x16x32_bf16 v[76:79], v[124:127], v[140:143], v[76:79]
  v_mfma_f32_16x16x32_bf16 v[92:95], v[248:251], v[140:143], v[92:95]
  v_mfma_f32_16x16x32_bf16 v[16:19], v[112:115], v[128:131], v[16:19]
  v_mfma_f32_16x16x32_bf16 v[32:35], v[116:119], v[128:131], v[32:35]
  v_mfma_f32_16x16x32_bf16 v[48:51], v[120:123], v[128:131], v[48:51]
  v_mfma_f32_16x16x32_bf16 v[64:67], v[124:127], v[128:131], v[64:67]
  v_mfma_f32_16x16x32_bf16 v[80:83], v[248:251], v[128:131], v[80:83]
  buffer_load_dwordx4 v[112:115], v12, s[12:15], s25 offen offset:0 sc1
  buffer_load_dwordx4 v[116:119], v12, s[12:15], s25 offen offset:1024 sc1
  buffer_load_dwordx4 v[120:123], v12, s[12:15], s25 offen offset:2048 sc1
  buffer_load_dwordx4 v[124:127], v12, s[12:15], s25 offen offset:3072 sc1
  buffer_load_dwordx4 v[244:247], v6, s[12:15], s25 offen sc1
  s_add_u32 s25, s25, 4608
  s_add_u32 s24, s28, 8192
  buffer_load_dwordx4 v[128:131], v2, s[12:15], s24 offen sc1
  buffer_load_dwordx4 v[132:135], v3, s[12:15], s24 offen sc1
  buffer_load_dwordx4 v[136:139], v4, s[12:15], s24 offen sc1
  buffer_load_dwordx4 v[140:143], v5, s[12:15], s24 offen sc1
  s_waitcnt vmcnt(26)
P3_C_38:
  v_max3_u32 v9, v160, v161, v162
  v_max3_u32 v10, v163, v164, v165
  v_max3_u32 v9, v166, v167, v9
  v_max3_u32 v10, v168, v169, v10
  v_max3_u32 v9, v170, v171, v9
  v_max3_u32 v10, v172, v173, v10
  v_max3_u32 v9, v174, v175, v9
  v_max_u32 v9, v9, v10
  v_cmp_eq_u32 vcc, -1, v9
  s_nop 4
  s_cbranch_vccz P3_OK_39
  s_sleep 4
  s_add_u32 s24, s28, 5120
  buffer_load_dwordx4 v[160:163], v2, s[12:15], s24 offen sc1
  buffer_load_dwordx4 v[164:167], v3, s[12:15], s24 offen sc1
  buffer_load_dwordx4 v[168:171], v4, s[12:15], s24 offen sc1
  buffer_load_dwordx4 v[172:175], v5, s[12:15], s24 offen sc1
  s_waitcnt vmcnt(0)
  s_sub_u32 s51, s51, 1
  s_cmp_lt_i32 s51, 1
  s_cbranch_scc0 P3_C_38
P3_OK_39:
  v_mfma_f32_16x16x32_bf16 v[20:23], v[144:147], v[164:167], v[20:23]
  v_mfma_f32_16x16x32_bf16 v[36:39], v[148:151], v[164:167], v[36:39]
  v_mfma_f32_16x16x32_bf16 v[52:55], v[152:155], v[164:167], v[52:55]
  v_mfma_f32_16x16x32_bf16 v[68:71], v[156:159], v[164:167], v[68:71]
  v_mfma_f32_16x16x32_bf16 v[100:103], v[248:251], v[164:167], v[100:103]
  v_mfma_f32_16x16x32_bf16 v[24:27], v[144:147], v[168:171], v[24:27]
  v_mfma_f32_16x16x32_bf16 v[40:43], v[148:151], v[168:171], v[40:43]
  v_mfma_f32_16x16x32_bf16 v[56:59], v[152:155], v[168:171], v[56:59]
  v_mfma_f32_16x16x32_bf16 v[72:75], v[156:159], v[168:171], v[72:75]
  v_mfma_f32_16x16x32_bf16 v[104:107], v[248:251], v[168:171], v[104:107]
  v_mfma_f32_16x16x32_bf16 v[28:31], v[144:147], v[172:175], v[28:31]
  v_mfma_f32_16x16x32_bf16 v[44:47], v[148:151], v[172:175], v[44:47]
  v_mfma_f32_16x16x32_bf16 v[60:63], v[152:155], v[172:175], v[60:63]
  v_mfma_f32_16x16x32_bf16 v[76:79], v[156:159], v[172:175], v[76:79]
  v_mfma_f32_16x16x32_bf16 v[108:111], v[248:251], v[172:175], v[108:111]
  v_mfma_f32_16x16x32_bf16 v[16:19], v[144:147], v[160:163], v[16:19]
  v_mfma_f32_16x16x32_bf16 v[32:35], v[148:151], v[160:163], v[32:35]
  v_mfma_f32_16x16x32_bf16 v[48:51], v[152:155], v[160:163], v[48:51]
  v_mfma_f32_16x16x32_bf16 v[64:67], v[156:159], v[160:163], v[64:67]
  v_mfma_f32_16x16x32_bf16 v[96:99], v[248:251], v[160:163], v[96:99]
  buffer_load_dwordx4 v[144:147], v12, s[12:15], s25 offen offset:0 sc1
  buffer_load_dwordx4 v[148:151], v12, s[12:15], s25 offen offset:1024 sc1
  buffer_load_dwordx4 v[152:155], v12, s[12:15], s25 offen offset:2048 sc1
  buffer_load_dwordx4 v[156:159], v12, s[12:15], s25 offen offset:3072 sc1
  s_add_u32 s25, s25, 4608
  s_add_u32 s24, s28, 9216
  buffer_load_dwordx4 v[160:163], v2, s[12:15], s24 offen sc1
  buffer_load_dwordx4 v[164:167], v3, s[12:15], s24 offen sc1
  buffer_load_dwordx4 v[168:171], v4, s[12:15], s24 offen sc1
  buffer_load_dwordx4 v[172:175], v5, s[12:15], s24 offen sc1
  s_waitcnt vmcnt(25)
P3_C_40:
  v_max3_u32 v9, v192, v193, v194
  v_max3_u32 v10, v195, v196, v197
  v_max3_u32 v9, v198, v199, v9
  v_max3_u32 v10, v200, v201, v10
  v_max3_u32 v9, v202, v203, v9
  v_max3_u32 v10, v204, v205, v10
  v_max3_u32 v9, v206, v207, v9
  v_max_u32 v9, v9, v10
  v_cmp_eq_u32 vcc, -1, v9
  s_nop 4
  s_cbranch_vccz P3_OK_41
  s_sleep 4
  s_add_u32 s24, s28, 6144
  buffer_load_dwordx4 v[192:195], v2, s[12:15], s24 offen sc1
  buffer_load_dwordx4 v[196:199], v3, s[12:15], s24 offen sc1
  buffer_load_dwordx4 v[200:203], v4, s[12:15], s24 offen sc1
  buffer_load_dwordx4 v[204:207], v5, s[12:15], s24 offen sc1
  s_waitcnt vmcnt(0)
  s_sub_u32 s51, s51, 1
  s_cmp_lt_i32 s51, 1
  s_cbranch_scc0 P3_C_40
P3_OK_41:
  v_mfma_f32_16x16x32_bf16 v[20:23], v[176:179], v[196:199], v[20:23]
  v_mfma_f32_16x16x32_bf16 v[36:39], v[180:183], v[196:199], v[36:39]
  v_mfma_f32_16x16x32_bf16 v[52:55], v[184:187], v[196:199], v[52:55]
  v_mfma_f32_16x16x32_bf16 v[68:71], v[188:191], v[196:199], v[68:71]
  v_mfma_f32_16x16x32_bf16 v[84:87], v[240:243], v[196:199], v[84:87]
  v_mfma_f32_16x16x32_bf16 v[24:27], v[176:179], v[200:203], v[24:27]
  v_mfma_f32_16x16x32_bf16 v[40:43], v[180:183], v[200:203], v[40:43]
  v_mfma_f32_16x16x32_bf16 v[56:59], v[184:187], v[200:203], v[56:59]
  v_mfma_f32_16x16x32_bf16 v[72:75], v[188:191], v[200:203], v[72:75]
  v_mfma_f32_16x16x32_bf16 v[88:91], v[240:243], v[200:203], v[88:91]
  v_mfma_f32_16x16x32_bf16 v[28:31], v[176:179], v[204:207], v[28:31]
  v_mfma_f32_16x16x32_bf16 v[44:47], v[180:183], v[204:207], v[44:47]
  v_mfma_f32_16x16x32_bf16 v[60:63], v[184:187], v[204:207], v[60:63]
  v_mfma_f32_16x16x32_bf16 v[76:79], v[188:191], v[204:207], v[76:79]
  v_mfma_f32_16x16x32_bf16 v[92:95], v[240:243], v[204:207], v[92:95]
  v_mfma_f32_16x16x32_bf16 v[16:19], v[176:179], v[192:195], v[16:19]
  v_mfma_f32_16x16x32_bf16 v[32:35], v[180:183], v[192:195], v[32:35]
  v_mfma_f32_16x16x32_bf16 v[48:51], v[184:187], v[192:195], v[48:51]
  v_mfma_f32_16x16x32_bf16 v[64:67], v[188:191], v[192:195], v[64:67]
  v_mfma_f32_16x16x32_bf16 v[80:83], v[240:243], v[192:195], v[80:83]
  buffer_load_dwordx4 v[176:179], v12, s[12:15], s25 offen offset:0 sc1
  buffer_load_dwordx4 v[180:183], v12, s[12:15], s25 offen offset:1024 sc1
  buffer_load_dwordx4 v[184:187], v12, s[12:15], s25 offen offset:2048 sc1
  buffer_load_dwordx4 v[188:191], v12, s[12:15], s25 offen offset:3072 sc1
  buffer_load_dwordx4 v[248:251], v6, s[12:15], s25 offen sc1
  s_add_u32 s25, s25, 4608
  s_add_u32 s24, s28, 10240
  buffer_load_dwordx4 v[192:195], v2, s[12:15], s24 offen sc1
  buffer_load_dwordx4 v[196:199], v3, s[12:15], s24 offen sc1
  buffer_load_dwordx4 v[200:203], v4, s[12:15], s24 offen sc1
  buffer_load_dwordx4 v[204:207], v5, s[12:15], s24 offen sc1
  s_waitcnt vmcnt(26)
P3_C_42:
  v_max3_u32 v9, v224, v225, v226
  v_max3_u32 v10, v227, v228, v229
  v_max3_u32 v9, v230, v231, v9
  v_max3_u32 v10, v232, v233, v10
  v_max3_u32 v9, v234, v235, v9
  v_max3_u32 v10, v236, v237, v10
  v_max3_u32 v9, v238, v239, v9
  v_max_u32 v9, v9, v10
  v_cmp_eq_u32 vcc, -1, v9
  s_nop 4
  s_cbranch_vccz P3_OK_43
  s_sleep 4
  s_add_u32 s24, s28, 7168
  buffer_load_dwordx4 v[224:227], v2, s[12:15], s24 offen sc1
  buffer_load_dwordx4 v[228:231], v3, s[12:15], s24 offen sc1
  buffer_load_dwordx4 v[232:235], v4, s[12:15], s24 offen sc1
  buffer_load_dwordx4 v[236:239], v5, s[12:15], s24 offen sc1
  s_waitcnt vmcnt(0)
  s_sub_u32 s51, s51, 1
  s_cmp_lt_i32 s51, 1
  s_cbranch_scc0 P3_C_42
P3_OK_43:
  v_mfma_f32_16x16x32_bf16 v[20:23], v[208:211], v[228:231], v[20:23]
  v_mfma_f32_16x16x32_bf16 v[36:39], v[212:215], v[228:231], v[36:39]
  v_mfma_f32_16x16x32_bf16 v[52:55], v[216:219], v[228:231], v[52:55]
  v_mfma_f32_16x16x32_bf16 v[68:71], v[220:223], v[228:231], v[68:71]
  v_mfma_f32_16x16x32_bf16 v[100:103], v[240:243], v[228:231], v[100:103]
  v_mfma_f32_16x16x32_bf16 v[24:27], v[208:211], v[232:235], v[24:27]
  v_mfma_f32_16x16x32_bf16 v[40:43], v[212:215], v[232:235], v[40:43]
  v_mfma_f32_16x16x32_bf16 v[56:59], v[216:219], v[232:235], v[56:59]
  v_mfma_f32_16x16x32_bf16 v[72:75], v[220:223], v[232:235], v[72:75]
  v_mfma_f32_16x16x32_bf16 v[104:107], v[240:243], v[232:235], v[104:107]
  v_mfma_f32_16x16x32_bf16 v[28:31], v[208:211], v[236:239], v[28:31]
  v_mfma_f32_16x16x32_bf16 v[44:47], v[212:215], v[236:239], v[44:47]
  v_mfma_f32_16x16x32_bf16 v[60:63], v[216:219], v[236:239], v[60:63]
  v_mfma_f32_16x16x32_bf16 v[76:79], v[220:223], v[236:239], v[76:79]
  v_mfma_f32_16x16x32_bf16 v[108:111], v[240:243], v[236:239], v[108:111]
  v_mfma_f32_16x16x32_bf16 v[16:19], v[208:211], v[224:227], v[16:19]
  v_mfma_f32_16x16x32_bf16 v[32:35], v[212:215], v[224:227], v[32:35]
  v_mfma_f32_16x16x32_bf16 v[48:51], v[216:219], v[224:227], v[48:51]
  v_mfma_f32_16x16x32_bf16 v[64:67], v[220:223], v[224:227], v[64:67]
  v_mfma_f32_16x16x32_bf16 v[96:99], v[240:243], v[224:227], v[96:99]
  buffer_load_dwordx4 v[208:211], v12, s[12:15], s25 offen offset:0 sc1
  buffer_load_dwordx4 v[212:215], v12, s[12:15], s25 offen offset:1024 sc1
  buffer_load_dwordx4 v[216:219], v12, s[12:15], s25 offen offset:2048 sc1
  buffer_load_dwordx4 v[220:223], v12, s[12:15], s25 offen offset:3072 sc1
  s_add_u32 s25, s25, 4608
  s_add_u32 s24, s28, 11264
  buffer_load_dwordx4 v[224:227], v2, s[12:15], s24 offen sc1
  buffer_load_dwordx4 v[228:231], v3, s[12:15], s24 offen sc1
  buffer_load_dwordx4 v[232:235], v4, s[12:15], s24 offen sc1
  buffer_load_dwordx4 v[236:239], v5, s[12:15], s24 offen sc1
  s_waitcnt vmcnt(25)
P3_C_44:
  v_max3_u32 v9, v128, v129, v130
  v_max3_u32 v10, v131, v132, v133
  v_max3_u32 v9, v134, v135, v9
  v_max3_u32 v10, v136, v137, v10
  v_max3_u32 v9, v138, v139, v9
  v_max3_u32 v10, v140, v141, v10
  v_max3_u32 v9, v142, v143, v9
  v_max_u32 v9, v9, v10
  v_cmp_eq_u32 vcc, -1, v9
  s_nop 4
  s_cbranch_vccz P3_OK_45
  s_sleep 4
  s_add_u32 s24, s28, 8192
  buffer_load_dwordx4 v[128:131], v2, s[12:15], s24 offen sc1
  buffer_load_dwordx4 v[132:135], v3, s[12:15], s24 offen sc1
  buffer_load_dwordx4 v[136:139], v4, s[12:15], s24 offen sc1
  buffer_load_dwordx4 v[140:143], v5, s[12:15], s24 offen sc1
  s_waitcnt vmcnt(0)
  s_sub_u32 s51, s51, 1
  s_cmp_lt_i32 s51, 1
  s_cbranch_scc0 P3_C_44
P3_OK_45:
  v_mfma_f32_16x16x32_bf16 v[20:23], v[112:115], v[132:135], v[20:23]
  v_mfma_f32_16x16x32_bf16 v[36:39], v[116:119], v[132:135], v[36:39]
  v_mfma_f32_16x16x32_bf16 v[52:55], v[120:123], v[132:135], v[52:55]
  v_mfma_f32_16x16x32_bf16 v[68:71], v[124:127], v[132:135], v[68:71]
  v_mfma_f32_16x16x32_bf16 v[84:87], v[244:247], v[132:135], v[84:87]
  v_mfma_f32_16x16x32_bf16 v[24:27], v[112:115], v[136:139], v[24:27]
  v_mfma_f32_16x16x32_bf16 v[40:43], v[116:119], v[136:139], v[40:43]
  v_mfma_f32_16x16x32_bf16 v[56:59], v[120:123], v[136:139], v[56:59]
  v_mfma_f32_16x16x32_bf16 v[72:75], v[124:127], v[136:139], v[72:75]
  v_mfma_f32_16x16x32_bf16 v[88:91], v[244:247], v[136:139], v[88:91]
  v_mfma_f32_16x16x32_bf16 v[28:31], v[112:115], v[140:143], v[28:31]
  v_mfma_f32_16x16x32_bf16 v[44:47], v[116:119], v[140:143], v[44:47]
  v_mfma_f32_16x16x32_bf16 v[60:63], v[120:123], v[140:143], v[60:63]
  v_mfma_f32_16x16x32_bf16 v[76:79], v[124:127], v[140:143], v[76:79]
  v_mfma_f32_16x16x32_bf16 v[92:95], v[244:247], v[140:143], v[92:95]
  v_mfma_f32_16x16x32_bf16 v[16:19], v[112:115], v[128:131], v[16:19]
  v_mfma_f32_16x16x32_bf16 v[32:35], v[116:119], v[128:131], v[32:35]
  v_mfma_f32_16x16x32_bf16 v[48:51], v[120:123], v[128:131], v[48:51]
  v_mfma_f32_16x16x32_bf16 v[64:67], v[124:127], v[128:131], v[64:67]
  v_mfma_f32_16x16x32_bf16 v[80:83], v[244:247], v[128:131], v[80:83]
  buffer_load_dwordx4 v[112:115], v12, s[12:15], s25 offen offset:0 sc1
  buffer_load_dwordx4 v[116:119], v12, s[12:15], s25 offen offset:1024 sc1
  buffer_load_dwordx4 v[120:123], v12, s[12:15], s25 offen offset:2048 sc1
  buffer_load_dwordx4 v[124:127], v12, s[12:15], s25 offen offset:3072 sc1
  buffer_load_dwordx4 v[240:243], v6, s[12:15], s25 offen sc1
  s_add_u32 s25, s25, 4608
  s_add_u32 s24, s28, 12288
  buffer_load_dwordx4 v[128:131], v2, s[12:15], s24 offen sc1
  buffer_load_dwordx4 v[132:135], v3, s[12:15], s24 offen sc1
  buffer_load_dwordx4 v[136:139], v4, s[12:15], s24 offen sc1
  buffer_load_dwordx4 v[140:143], v5, s[12:15], s24 offen sc1
  s_waitcnt vmcnt(26)
P3_C_46:
  v_max3_u32 v9, v160, v161, v162
  v_max3_u32 v10, v163, v164, v165
  v_max3_u32 v9, v166, v167, v9
  v_max3_u32 v10, v168, v169, v10
  v_max3_u32 v9, v170, v171, v9
  v_max3_u32 v10, v172, v173, v10
  v_max3_u32 v9, v174, v175, v9
  v_max_u32 v9, v9, v10
  v_cmp_eq_u32 vcc, -1, v9
  s_nop 4
  s_cbranch_vccz P3_OK_47
  s_sleep 4
  s_add_u32 s24, s28, 9216
  buffer_load_dwordx4 v[160:163], v2, s[12:15], s24 offen sc1
  buffer_load_dwordx4 v[164:167], v3, s[12:15], s24 offen sc1
  buffer_load_dwordx4 v[168:171], v4, s[12:15], s24 offen sc1
  buffer_load_dwordx4 v[172:175], v5, s[12:15], s24 offen sc1
  s_waitcnt vmcnt(0)
  s_sub_u32 s51, s51, 1
  s_cmp_lt_i32 s51, 1
  s_cbranch_scc0 P3_C_46
P3_OK_47:
  v_mfma_f32_16x16x32_bf16 v[20:23], v[144:147], v[164:167], v[20:23]
  v_mfma_f32_16x16x32_bf16 v[36:39], v[148:151], v[164:167], v[36:39]
  v_mfma_f32_16x16x32_bf16 v[52:55], v[152:155], v[164:167], v[52:55]
  v_mfma_f32_16x16x32_bf16 v[68:71], v[156:159], v[164:167], v[68:71]
  v_mfma_f32_16x16x32_bf16 v[100:103], v[244:247], v[164:167], v[100:103]
  v_mfma_f32_16x16x32_bf16 v[24:27], v[144:147], v[168:171], v[24:27]
  v_mfma_f32_16x16x32_bf16 v[40:43], v[148:151], v[168:171], v[40:43]
  v_mfma_f32_16x16x32_bf16 v[56:59], v[152:155], v[168:171], v[56:59]
  v_mfma_f32_16x16x32_bf16 v[72:75], v[156:159], v[168:171], v[72:75]
  v_mfma_f32_16x16x32_bf16 v[104:107], v[244:247], v[168:171], v[104:107]
  v_mfma_f32_16x16x32_bf16 v[28:31], v[144:147], v[172:175], v[28:31]
  v_mfma_f32_16x16x32_bf16 v[44:47], v[148:151], v[172:175], v[44:47]
  v_mfma_f32_16x16x32_bf16 v[60:63], v[152:155], v[172:175], v[60:63]
  v_mfma_f32_16x16x32_bf16 v[76:79], v[156:159], v[172:175], v[76:79]
  v_mfma_f32_16x16x32_bf16 v[108:111], v[244:247], v[172:175], v[108:111]
  v_mfma_f32_16x16x32_bf16 v[16:19], v[144:147], v[160:163], v[16:19]
  v_mfma_f32_16x16x32_bf16 v[32:35], v[148:151], v[160:163], v[32:35]
  v_mfma_f32_16x16x32_bf16 v[48:51], v[152:155], v[160:163], v[48:51]
  v_mfma_f32_16x16x32_bf16 v[64:67], v[156:159], v[160:163], v[64:67]
  v_mfma_f32_16x16x32_bf16 v[96:99], v[244:247], v[160:163], v[96:99]
  buffer_load_dwordx4 v[144:147], v12, s[12:15], s25 offen offset:0 sc1
  buffer_load_dwordx4 v[148:151], v12, s[12:15], s25 offen offset:1024 sc1
  buffer_load_dwordx4 v[152:155], v12, s[12:15], s25 offen offset:2048 sc1
  buffer_load_dwordx4 v[156:159], v12, s[12:15], s25 offen offset:3072 sc1
  s_add_u32 s25, s25, 4608
  s_add_u32 s24, s28, 13312
  buffer_load_dwordx4 v[160:163], v2, s[12:15], s24 offen sc1
  buffer_load_dwordx4 v[164:167], v3, s[12:15], s24 offen sc1
  buffer_load_dwordx4 v[168:171], v4, s[12:15], s24 offen sc1
  buffer_load_dwordx4 v[172:175], v5, s[12:15], s24 offen sc1
  s_waitcnt vmcnt(25)
P3_C_48:
  v_max3_u32 v9, v192, v193, v194
  v_max3_u32 v10, v195, v196, v197
  v_max3_u32 v9, v198, v199, v9
  v_max3_u32 v10, v200, v201, v10
  v_max3_u32 v9, v202, v203, v9
  v_max3_u32 v10, v204, v205, v10
  v_max3_u32 v9, v206, v207, v9
  v_max_u32 v9, v9, v10
  v_cmp_eq_u32 vcc, -1, v9
  s_nop 4
  s_cbranch_vccz P3_OK_49
  s_sleep 4
  s_add_u32 s24, s28, 10240
  buffer_load_dwordx4 v[192:195], v2, s[12:15], s24 offen sc1
  buffer_load_dwordx4 v[196:199], v3, s[12:15], s24 offen sc1
  buffer_load_dwordx4 v[200:203], v4, s[12:15], s24 offen sc1
  buffer_load_dwordx4 v[204:207], v5, s[12:15], s24 offen sc1
  s_waitcnt vmcnt(0)
  s_sub_u32 s51, s51, 1
  s_cmp_lt_i32 s51, 1
  s_cbranch_scc0 P3_C_48
P3_OK_49:
  v_mfma_f32_16x16x32_bf16 v[20:23], v[176:179], v[196:199], v[20:23]
  v_mfma_f32_16x16x32_bf16 v[36:39], v[180:183], v[196:199], v[36:39]
  v_mfma_f32_16x16x32_bf16 v[52:55], v[184:187], v[196:199], v[52:55]
  v_mfma_f32_16x16x32_bf16 v[68:71], v[188:191], v[196:199], v[68:71]
  v_mfma_f32_16x16x32_bf16 v[84:87], v[248:251], v[196:199], v[84:87]
  v_mfma_f32_16x16x32_bf16 v[24:27], v[176:179], v[200:203], v[24:27]
  v_mfma_f32_16x16x32_bf16 v[40:43], v[180:183], v[200:203], v[40:43]
  v_mfma_f32_16x16x32_bf16 v[56:59], v[184:187], v[200:203], v[56:59]
  v_mfma_f32_16x16x32_bf16 v[72:75], v[188:191], v[200:203], v[72:75]
  v_mfma_f32_16x16x32_bf16 v[88:91], v[248:251], v[200:203], v[88:91]
  v_mfma_f32_16x16x32_bf16 v[28:31], v[176:179], v[204:207], v[28:31]
  v_mfma_f32_16x16x32_bf16 v[44:47], v[180:183], v[204:207], v[44:47]
  v_mfma_f32_16x16x32_bf16 v[60:63], v[184:187], v[204:207], v[60:63]
  v_mfma_f32_16x16x32_bf16 v[76:79], v[188:191], v[204:207], v[76:79]
  v_mfma_f32_16x16x32_bf16 v[92:95], v[248:251], v[204:207], v[92:95]
  v_mfma_f32_16x16x32_bf16 v[16:19], v[176:179], v[192:195], v[16:19]
  v_mfma_f32_16x16x32_bf16 v[32:35], v[180:183], v[192:195], v[32:35]
  v_mfma_f32_16x16x32_bf16 v[48:51], v[184:187], v[192:195], v[48:51]
  v_mfma_f32_16x16x32_bf16 v[64:67], v[188:191], v[192:195], v[64:67]
  v_mfma_f32_16x16x32_bf16 v[80:83], v[248:251], v[192:195], v[80:83]
  buffer_load_dwordx4 v[176:179], v12, s[12:15], s25 offen offset:0 sc1
  buffer_load_dwordx4 v[180:183], v12, s[12:15], s25 offen offset:1024 sc1
  buffer_load_dwordx4 v[184:187], v12, s[12:15], s25 offen offset:2048 sc1
  buffer_load_dwordx4 v[188:191], v12, s[12:15], s25 offen offset:3072 sc1
  buffer_load_dwordx4 v[244:247], v6, s[12:15], s25 offen sc1
  s_add_u32 s25, s25, 4608
  s_add_u32 s24, s28, 14336
  buffer_load_dwordx4 v[192:195], v2, s[12:15], s24 offen sc1
  buffer_load_dwordx4 v[196:199], v3, s[12:15], s24 offen sc1
  buffer_load_dwordx4 v[200:203], v4, s[12:15], s24 offen sc1
  buffer_load_dwordx4 v[204:207], v5, s[12:15], s24 offen sc1
  s_waitcnt vmcnt(26)
P3_C_50:
  v_max3_u32 v9, v224, v225, v226
  v_max3_u32 v10, v227, v228, v229
  v_max3_u32 v9, v230, v231, v9
  v_max3_u32 v10, v232, v233, v10
  v_max3_u32 v9, v234, v235, v9
  v_max3_u32 v10, v236, v237, v10
  v_max3_u32 v9, v238, v239, v9
  v_max_u32 v9, v9, v10
  v_cmp_eq_u32 vcc, -1, v9
  s_nop 4
  s_cbranch_vccz P3_OK_51
  s_sleep 4
  s_add_u32 s24, s28, 11264
  buffer_load_dwordx4 v[224:227], v2, s[12:15], s24 offen sc1
  buffer_load_dwordx4 v[228:231], v3, s[12:15], s24 offen sc1
  buffer_load_dwordx4 v[232:235], v4, s[12:15], s24 offen sc1
  buffer_load_dwordx4 v[236:239], v5, s[12:15], s24 offen sc1
  s_waitcnt vmcnt(0)
  s_sub_u32 s51, s51, 1
  s_cmp_lt_i32 s51, 1
  s_cbranch_scc0 P3_C_50
P3_OK_51:
  v_mfma_f32_16x16x32_bf16 v[20:23], v[208:211], v[228:231], v[20:23]
  v_mfma_f32_16x16x32_bf16 v[36:39], v[212:215], v[228:231], v[36:39]
  v_mfma_f32_16x16x32_bf16 v[52:55], v[216:219], v[228:231], v[52:55]
  v_mfma_f32_16x16x32_bf16 v[68:71], v[220:223], v[228:231], v[68:71]
  v_mfma_f32_16x16x32_bf16 v[100:103], v[248:251], v[228:231], v[100:103]
  v_mfma_f32_16x16x32_bf16 v[24:27], v[208:211], v[232:235], v[24:27]
  v_mfma_f32_16x16x32_bf16 v[40:43], v[212:215], v[232:235], v[40:43]
  v_mfma_f32_16x16x32_bf16 v[56:59], v[216:219], v[232:235], v[56:59]
  v_mfma_f32_16x16x32_bf16 v[72:75], v[220:223], v[232:235], v[72:75]
  v_mfma_f32_16x16x32_bf16 v[104:107], v[248:251], v[232:235], v[104:107]
  v_mfma_f32_16x16x32_bf16 v[28:31], v[208:211], v[236:239], v[28:31]
  v_mfma_f32_16x16x32_bf16 v[44:47], v[212:215], v[236:239], v[44:47]
  v_mfma_f32_16x16x32_bf16 v[60:63], v[216:219], v[236:239], v[60:63]
  v_mfma_f32_16x16x32_bf16 v[76:79], v[220:223], v[236:239], v[76:79]
  v_mfma_f32_16x16x32_bf16 v[108:111], v[248:251], v[236:239], v[108:111]
  v_mfma_f32_16x16x32_bf16 v[16:19], v[208:211], v[224:227], v[16:19]
  v_mfma_f32_16x16x32_bf16 v[32:35], v[212:215], v[224:227], v[32:35]
  v_mfma_f32_16x16x32_bf16 v[48:51], v[216:219], v[224:227], v[48:51]
  v_mfma_f32_16x16x32_bf16 v[64:67], v[220:223], v[224:227], v[64:67]
  v_mfma_f32_16x16x32_bf16 v[96:99], v[248:251], v[224:227], v[96:99]
  buffer_load_dwordx4 v[208:211], v12, s[12:15], s25 offen offset:0 sc1
  buffer_load_dwordx4 v[212:215], v12, s[12:15], s25 offen offset:1024 sc1
  buffer_load_dwordx4 v[216:219], v12, s[12:15], s25 offen offset:2048 sc1
  buffer_load_dwordx4 v[220:223], v12, s[12:15], s25 offen offset:3072 sc1
  s_add_u32 s25, s25, 4608
  s_add_u32 s24, s28, 15360
  buffer_load_dwordx4 v[224:227], v2, s[12:15], s24 offen sc1
  buffer_load_dwordx4 v[228:231], v3, s[12:15], s24 offen sc1
  buffer_load_dwordx4 v[232:235], v4, s[12:15], s24 offen sc1
  buffer_load_dwordx4 v[236:239], v5, s[12:15], s24 offen sc1
  s_waitcnt vmcnt(25)
P3_C_52:
  v_max3_u32 v9, v128, v129, v130
  v_max3_u32 v10, v131, v132, v133
  v_max3_u32 v9, v134, v135, v9
  v_max3_u32 v10, v136, v137, v10
  v_max3_u32 v9, v138, v139, v9
  v_max3_u32 v10, v140, v141, v10
  v_max3_u32 v9, v142, v143, v9
  v_max_u32 v9, v9, v10
  v_cmp_eq_u32 vcc, -1, v9
  s_nop 4
  s_cbranch_vccz P3_OK_53
  s_sleep 4
  s_add_u32 s24, s28, 12288
  buffer_load_dwordx4 v[128:131], v2, s[12:15], s24 offen sc1
  buffer_load_dwordx4 v[132:135], v3, s[12:15], s24 offen sc1
  buffer_load_dwordx4 v[136:139], v4, s[12:15], s24 offen sc1
  buffer_load_dwordx4 v[140:143], v5, s[12:15], s24 offen sc1
  s_waitcnt vmcnt(0)
  s_sub_u32 s51, s51, 1
  s_cmp_lt_i32 s51, 1
  s_cbranch_scc0 P3_C_52
P3_OK_53:
  v_mfma_f32_16x16x32_bf16 v[20:23], v[112:115], v[132:135], v[20:23]
  v_mfma_f32_16x16x32_bf16 v[36:39], v[116:119], v[132:135], v[36:39]
  v_mfma_f32_16x16x32_bf16 v[52:55], v[120:123], v[132:135], v[52:55]
  v_mfma_f32_16x16x32_bf16 v[68:71], v[124:127], v[132:135], v[68:71]
  v_mfma_f32_16x16x32_bf16 v[84:87], v[240:243], v[132:135], v[84:87]
  v_mfma_f32_16x16x32_bf16 v[24:27], v[112:115], v[136:139], v[24:27]
  v_mfma_f32_16x16x32_bf16 v[40:43], v[116:119], v[136:139], v[40:43]
  v_mfma_f32_16x16x32_bf16 v[56:59], v[120:123], v[136:139], v[56:59]
  v_mfma_f32_16x16x32_bf16 v[72:75], v[124:127], v[136:139], v[72:75]
  v_mfma_f32_16x16x32_bf16 v[88:91], v[240:243], v[136:139], v[88:91]
  v_mfma_f32_16x16x32_bf16 v[28:31], v[112:115], v[140:143], v[28:31]
  v_mfma_f32_16x16x32_bf16 v[44:47], v[116:119], v[140:143], v[44:47]
  v_mfma_f32_16x16x32_bf16 v[60:63], v[120:123], v[140:143], v[60:63]
  v_mfma_f32_16x16x32_bf16 v[76:79], v[124:127], v[140:143], v[76:79]
  v_mfma_f32_16x16x32_bf16 v[92:95], v[240:243], v[140:143], v[92:95]
  v_mfma_f32_16x16x32_bf16 v[16:19], v[112:115], v[128:131], v[16:19]
  v_mfma_f32_16x16x32_bf16 v[32:35], v[116:119], v[128:131], v[32:35]
  v_mfma_f32_16x16x32_bf16 v[48:51], v[120:123], v[128:131], v[48:51]
  v_mfma_f32_16x16x32_bf16 v[64:67], v[124:127], v[128:131], v[64:67]
  v_mfma_f32_16x16x32_bf16 v[80:83], v[240:243], v[128:131], v[80:83]
  buffer_load_dwordx4 v[112:115], v12, s[12:15], s25 offen offset:0 sc1
  buffer_load_dwordx4 v[116:119], v12, s[12:15], s25 offen offset:1024 sc1
  buffer_load_dwordx4 v[120:123], v12, s[12:15], s25 offen offset:2048 sc1
  buffer_load_dwordx4 v[124:127], v12, s[12:15], s25 offen offset:3072 sc1
  buffer_load_dwordx4 v[248:251], v6, s[12:15], s25 offen sc1
  s_add_u32 s25, s25, 4608
  s_add_u32 s24, s28, 16384
  buffer_load_dwordx4 v[128:131], v2, s[12:15], s24 offen sc1
  buffer_load_dwordx4 v[132:135], v3, s[12:15], s24 offen sc1
  buffer_load_dwordx4 v[136:139], v4, s[12:15], s24 offen sc1
  buffer_load_dwordx4 v[140:143], v5, s[12:15], s24 offen sc1
  s_waitcnt vmcnt(26)
P3_C_54:
  v_max3_u32 v9, v160, v161, v162
  v_max3_u32 v10, v163, v164, v165
  v_max3_u32 v9, v166, v167, v9
  v_max3_u32 v10, v168, v169, v10
  v_max3_u32 v9, v170, v171, v9
  v_max3_u32 v10, v172, v173, v10
  v_max3_u32 v9, v174, v175, v9
  v_max_u32 v9, v9, v10
  v_cmp_eq_u32 vcc, -1, v9
  s_nop 4
  s_cbranch_vccz P3_OK_55
  s_sleep 4
  s_add_u32 s24, s28, 13312
  buffer_load_dwordx4 v[160:163], v2, s[12:15], s24 offen sc1
  buffer_load_dwordx4 v[164:167], v3, s[12:15], s24 offen sc1
  buffer_load_dwordx4 v[168:171], v4, s[12:15], s24 offen sc1
  buffer_load_dwordx4 v[172:175], v5, s[12:15], s24 offen sc1
  s_waitcnt vmcnt(0)
  s_sub_u32 s51, s51, 1
  s_cmp_lt_i32 s51, 1
  s_cbranch_scc0 P3_C_54
P3_OK_55:
  v_mfma_f32_16x16x32_bf16 v[20:23], v[144:147], v[164:167], v[20:23]
  v_mfma_f32_16x16x32_bf16 v[36:39], v[148:151], v[164:167], v[36:39]
  v_mfma_f32_16x16x32_bf16 v[52:55], v[152:155], v[164:167], v[52:55]
  v_mfma_f32_16x16x32_bf16 v[68:71], v[156:159], v[164:167], v[68:71]
  v_mfma_f32_16x16x32_bf16 v[100:103], v[240:243], v[164:167], v[100:103]
  v_mfma_f32_16x16x32_bf16 v[24:27], v[144:147], v[168:171], v[24:27]
  v_mfma_f32_16x16x32_bf16 v[40:43], v[148:151], v[168:171], v[40:43]
  v_mfma_f32_16x16x32_bf16 v[56:59], v[152:155], v[168:171], v[56:59]
  v_mfma_f32_16x16x32_bf16 v[72:75], v[156:159], v[168:171], v[72:75]
  v_mfma_f32_16x16x32_bf16 v[104:107], v[240:243], v[168:171], v[104:107]
  v_mfma_f32_16x16x32_bf16 v[28:31], v[144:147], v[172:175], v[28:31]
  v_mfma_f32_16x16x32_bf16 v[44:47], v[148:151], v[172:175], v[44:47]
  v_mfma_f32_16x16x32_bf16 v[60:63], v[152:155], v[172:175], v[60:63]
  v_mfma_f32_16x16x32_bf16 v[76:79], v[156:159], v[172:175], v[76:79]
  v_mfma_f32_16x16x32_bf16 v[108:111], v[240:243], v[172:175], v[108:111]
  v_mfma_f32_16x16x32_bf16 v[16:19], v[144:147], v[160:163], v[16:19]
  v_mfma_f32_16x16x32_bf16 v[32:35], v[148:151], v[160:163], v[32:35]
  v_mfma_f32_16x16x32_bf16 v[48:51], v[152:155], v[160:163], v[48:51]
  v_mfma_f32_16x16x32_bf16 v[64:67], v[156:159], v[160:163], v[64:67]
  v_mfma_f32_16x16x32_bf16 v[96:99], v[240:243], v[160:163], v[96:99]
  buffer_load_dwordx4 v[144:147], v12, s[12:15], s25 offen offset:0 sc1
  buffer_load_dwordx4 v[148:151], v12, s[12:15], s25 offen offset:1024 sc1
  buffer_load_dwordx4 v[152:155], v12, s[12:15], s25 offen offset:2048 sc1
  buffer_load_dwordx4 v[156:159], v12, s[12:15], s25 offen offset:3072 sc1
  s_add_u32 s25, s25, 4608
  s_add_u32 s24, s28, 17408
  buffer_load_dwordx4 v[160:163], v2, s[12:15], s24 offen sc1
  buffer_load_dwordx4 v[164:167], v3, s[12:15], s24 offen sc1
  buffer_load_dwordx4 v[168:171], v4, s[12:15], s24 offen sc1
  buffer_load_dwordx4 v[172:175], v5, s[12:15], s24 offen sc1
  s_waitcnt vmcnt(25)
P3_C_56:
  v_max3_u32 v9, v192, v193, v194
  v_max3_u32 v10, v195, v196, v197
  v_max3_u32 v9, v198, v199, v9
  v_max3_u32 v10, v200, v201, v10
  v_max3_u32 v9, v202, v203, v9
  v_max3_u32 v10, v204, v205, v10
  v_max3_u32 v9, v206, v207, v9
  v_max_u32 v9, v9, v10
  v_cmp_eq_u32 vcc, -1, v9
  s_nop 4
  s_cbranch_vccz P3_OK_57
  s_sleep 4
  s_add_u32 s24, s28, 14336
  buffer_load_dwordx4 v[192:195], v2, s[12:15], s24 offen sc1
  buffer_load_dwordx4 v[196:199], v3, s[12:15], s24 offen sc1
  buffer_load_dwordx4 v[200:203], v4, s[12:15], s24 offen sc1
  buffer_load_dwordx4 v[204:207], v5, s[12:15], s24 offen sc1
  s_waitcnt vmcnt(0)
  s_sub_u32 s51, s51, 1
  s_cmp_lt_i32 s51, 1
  s_cbranch_scc0 P3_C_56
P3_OK_57:
  v_mfma_f32_16x16x32_bf16 v[20:23], v[176:179], v[196:199], v[20:23]
  v_mfma_f32_16x16x32_bf16 v[36:39], v[180:183], v[196:199], v[36:39]
  v_mfma_f32_16x16x32_bf16 v[52:55], v[184:187], v[196:199], v[52:55]
  v_mfma_f32_16x16x32_bf16 v[68:71], v[188:191], v[196:199], v[68:71]
  v_mfma_f32_16x16x32_bf16 v[84:87], v[244:247], v[196:199], v[84:87]
  v_mfma_f32_16x16x32_bf16 v[24:27], v[176:179], v[200:203], v[24:27]
  v_mfma_f32_16x16x32_bf16 v[40:43], v[180:183], v[200:203], v[40:43]
  v_mfma_f32_16x16x32_bf16 v[56:59], v[184:187], v[200:203], v[56:59]
  v_mfma_f32_16x16x32_bf16 v[72:75], v[188:191], v[200:203], v[72:75]
  v_mfma_f32_16x16x32_bf16 v[88:91], v[244:247], v[200:203], v[88:91]
  v_mfma_f32_16x16x32_bf16 v[28:31], v[176:179], v[204:207], v[28:31]
  v_mfma_f32_16x16x32_bf16 v[44:47], v[180:183], v[204:207], v[44:47]
  v_mfma_f32_16x16x32_bf16 v[60:63], v[184:187], v[204:207], v[60:63]
  v_mfma_f32_16x16x32_bf16 v[76:79], v[188:191], v[204:207], v[76:79]
  v_mfma_f32_16x16x32_bf16 v[92:95], v[244:247], v[204:207], v[92:95]
  v_mfma_f32_16x16x32_bf16 v[16:19], v[176:179], v[192:195], v[16:19]
  v_mfma_f32_16x16x32_bf16 v[32:35], v[180:183], v[192:195], v[32:35]
  v_mfma_f32_16x16x32_bf16 v[48:51], v[184:187], v[192:195], v[48:51]
  v_mfma_f32_16x16x32_bf16 v[64:67], v[188:191], v[192:195], v[64:67]
  v_mfma_f32_16x16x32_bf16 v[80:83], v[244:247], v[192:195], v[80:83]
  s_mov_b32 s25, s31
  buffer_load_dwordx4 v[176:179], v12, s[12:15], s25 offen offset:0 sc1
  buffer_load_dwordx4 v[180:183], v12, s[12:15], s25 offen offset:1024 sc1
  buffer_load_dwordx4 v[184:187], v12, s[12:15], s25 offen offset:2048 sc1
  buffer_load_dwordx4 v[188:191], v12, s[12:15], s25 offen offset:3072 sc1
  buffer_load_dwordx4 v[240:243], v6, s[12:15], s25 offen sc1
  s_add_u32 s25, s25, 4608
  s_add_u32 s24, s30, 0
  buffer_load_dwordx4 v[192:195], v2, s[12:15], s24 offen sc1
  buffer_load_dwordx4 v[196:199], v3, s[12:15], s24 offen sc1
  buffer_load_dwordx4 v[200:203], v4, s[12:15], s24 offen sc1
  buffer_load_dwordx4 v[204:207], v5, s[12:15], s24 offen sc1
  s_waitcnt vmcnt(26)
P3_C_58:
  v_max3_u32 v9, v224, v225, v226
  v_max3_u32 v10, v227, v228, v229
  v_max3_u32 v9, v230, v231, v9
  v_max3_u32 v10, v232, v233, v10
  v_max3_u32 v9, v234, v235, v9
  v_max3_u32 v10, v236, v237, v10
  v_max3_u32 v9, v238, v239, v9
  v_max_u32 v9, v9, v10
  v_cmp_eq_u32 vcc, -1, v9
  s_nop 4
  s_cbranch_vccz P3_OK_59
  s_sleep 4
  s_add_u32 s24, s28, 15360
  buffer_load_dwordx4 v[224:227], v2, s[12:15], s24 offen sc1
  buffer_load_dwordx4 v[228:231], v3, s[12:15], s24 offen sc1
  buffer_load_dwordx4 v[232:235], v4, s[12:15], s24 offen sc1
  buffer_load_dwordx4 v[236:239], v5, s[12:15], s24 offen sc1
  s_waitcnt vmcnt(0)
  s_sub_u32 s51, s51, 1
  s_cmp_lt_i32 s51, 1
  s_cbranch_scc0 P3_C_58
P3_OK_59:
  v_mfma_f32_16x16x32_bf16 v[20:23], v[208:211], v[228:231], v[20:23]
  v_mfma_f32_16x16x32_bf16 v[36:39], v[212:215], v[228:231], v[36:39]
  v_mfma_f32_16x16x32_bf16 v[52:55], v[216:219], v[228:231], v[52:55]
  v_mfma_f32_16x16x32_bf16 v[68:71], v[220:223], v[228:231], v[68:71]
  v_mfma_f32_16x16x32_bf16 v[100:103], v[244:247], v[228:231], v[100:103]
  v_mfma_f32_16x16x32_bf16 v[24:27], v[208:211], v[232:235], v[24:27]
  v_mfma_f32_16x16x32_bf16 v[40:43], v[212:215], v[232:235], v[40:43]
  v_mfma_f32_16x16x32_bf16 v[56:59], v[216:219], v[232:235], v[56:59]
  v_mfma_f32_16x16x32_bf16 v[72:75], v[220:223], v[232:235], v[72:75]
  v_mfma_f32_16x16x32_bf16 v[104:107], v[244:247], v[232:235], v[104:107]
  v_mfma_f32_16x16x32_bf16 v[28:31], v[208:211], v[236:239], v[28:31]
  v_mfma_f32_16x16x32_bf16 v[44:47], v[212:215], v[236:239], v[44:47]
  v_mfma_f32_16x16x32_bf16 v[60:63], v[216:219], v[236:239], v[60:63]
  v_mfma_f32_16x16x32_bf16 v[76:79], v[220:223], v[236:239], v[76:79]
  v_mfma_f32_16x16x32_bf16 v[108:111], v[244:247], v[236:239], v[108:111]
  v_mfma_f32_16x16x32_bf16 v[16:19], v[208:211], v[224:227], v[16:19]
  v_mfma_f32_16x16x32_bf16 v[32:35], v[212:215], v[224:227], v[32:35]
  v_mfma_f32_16x16x32_bf16 v[48:51], v[216:219], v[224:227], v[48:51]
  v_mfma_f32_16x16x32_bf16 v[64:67], v[220:223], v[224:227], v[64:67]
  v_mfma_f32_16x16x32_bf16 v[96:99], v[244:247], v[224:227], v[96:99]
  buffer_load_dwordx4 v[208:211], v12, s[12:15], s25 offen offset:0 sc1
  buffer_load_dwordx4 v[212:215], v12, s[12:15], s25 offen offset:1024 sc1
  buffer_load_dwordx4 v[216:219], v12, s[12:15], s25 offen offset:2048 sc1
  buffer_load_dwordx4 v[220:223], v12, s[12:15], s25 offen offset:3072 sc1
  s_add_u32 s25, s25, 4608
  s_add_u32 s24, s30, 1024
  buffer_load_dwordx4 v[224:227], v2, s[12:15], s24 offen sc1
  buffer_load_dwordx4 v[228:231], v3, s[12:15], s24 offen sc1
  buffer_load_dwordx4 v[232:235], v4, s[12:15], s24 offen sc1
  buffer_load_dwordx4 v[236:239], v5, s[12:15], s24 offen sc1
  s_waitcnt vmcnt(25)
P3_C_60:
  v_max3_u32 v9, v128, v129, v130
  v_max3_u32 v10, v131, v132, v133
  v_max3_u32 v9, v134, v135, v9
  v_max3_u32 v10, v136, v137, v10
  v_max3_u32 v9, v138, v139, v9
  v_max3_u32 v10, v140, v141, v10
  v_max3_u32 v9, v142, v143, v9
  v_max_u32 v9, v9, v10
  v_cmp_eq_u32 vcc, -1, v9
  s_nop 4
  s_cbranch_vccz P3_OK_61
  s_sleep 4
  s_add_u32 s24, s28, 16384
  buffer_load_dwordx4 v[128:131], v2, s[12:15], s24 offen sc1
  buffer_load_dwordx4 v[132:135], v3, s[12:15], s24 offen sc1
  buffer_load_dwordx4 v[136:139], v4, s[12:15], s24 offen sc1
  buffer_load_dwordx4 v[140:143], v5, s[12:15], s24 offen sc1
  s_waitcnt vmcnt(0)
  s_sub_u32 s51, s51, 1
  s_cmp_lt_i32 s51, 1
  s_cbranch_scc0 P3_C_60
P3_OK_61:
  v_mfma_f32_16x16x32_bf16 v[20:23], v[112:115], v[132:135], v[20:23]
  v_mfma_f32_16x16x32_bf16 v[36:39], v[116:119], v[132:135], v[36:39]
  v_mfma_f32_16x16x32_bf16 v[52:55], v[120:123], v[132:135], v[52:55]
  v_mfma_f32_16x16x32_bf16 v[68:71], v[124:127], v[132:135], v[68:71]
  v_mfma_f32_16x16x32_bf16 v[84:87], v[248:251], v[132:135], v[84:87]
  v_mfma_f32_16x16x32_bf16 v[24:27], v[112:115], v[136:139], v[24:27]
  v_mfma_f32_16x16x32_bf16 v[40:43], v[116:119], v[136:139], v[40:43]
  v_mfma_f32_16x16x32_bf16 v[56:59], v[120:123], v[136:139], v[56:59]
  v_mfma_f32_16x16x32_bf16 v[72:75], v[124:127], v[136:139], v[72:75]
  v_mfma_f32_16x16x32_bf16 v[88:91], v[248:251], v[136:139], v[88:91]
  v_mfma_f32_16x16x32_bf16 v[28:31], v[112:115], v[140:143], v[28:31]
  v_mfma_f32_16x16x32_bf16 v[44:47], v[116:119], v[140:143], v[44:47]
  v_mfma_f32_16x16x32_bf16 v[60:63], v[120:123], v[140:143], v[60:63]
  v_mfma_f32_16x16x32_bf16 v[76:79], v[124:127], v[140:143], v[76:79]
  v_mfma_f32_16x16x32_bf16 v[92:95], v[248:251], v[140:143], v[92:95]
  v_mfma_f32_16x16x32_bf16 v[16:19], v[112:115], v[128:131], v[16:19]
  v_mfma_f32_16x16x32_bf16 v[32:35], v[116:119], v[128:131], v[32:35]
  v_mfma_f32_16x16x32_bf16 v[48:51], v[120:123], v[128:131], v[48:51]
  v_mfma_f32_16x16x32_bf16 v[64:67], v[124:127], v[128:131], v[64:67]
  v_mfma_f32_16x16x32_bf16 v[80:83], v[248:251], v[128:131], v[80:83]
  buffer_load_dwordx4 v[112:115], v12, s[12:15], s25 offen offset:0 sc1
  buffer_load_dwordx4 v[116:119], v12, s[12:15], s25 offen offset:1024 sc1
  buffer_load_dwordx4 v[120:123], v12, s[12:15], s25 offen offset:2048 sc1
  buffer_load_dwordx4 v[124:127], v12, s[12:15], s25 offen offset:3072 sc1
  buffer_load_dwordx4 v[244:247], v6, s[12:15], s25 offen sc1
  s_add_u32 s25, s25, 4608
  s_add_u32 s24, s30, 2048
  buffer_load_dwordx4 v[128:131], v2, s[12:15], s24 offen sc1
  buffer_load_dwordx4 v[132:135], v3, s[12:15], s24 offen sc1
  buffer_load_dwordx4 v[136:139], v4, s[12:15], s24 offen sc1
  buffer_load_dwordx4 v[140:143], v5, s[12:15], s24 offen sc1
  s_waitcnt vmcnt(26)
P3_C_62:
  v_max3_u32 v9, v160, v161, v162
  v_max3_u32 v10, v163, v164, v165
  v_max3_u32 v9, v166, v167, v9
  v_max3_u32 v10, v168, v169, v10
  v_max3_u32 v9, v170, v171, v9
  v_max3_u32 v10, v172, v173, v10
  v_max3_u32 v9, v174, v175, v9
  v_max_u32 v9, v9, v10
  v_cmp_eq_u32 vcc, -1, v9
  s_nop 4
  s_cbranch_vccz P3_OK_63
  s_sleep 4
  s_add_u32 s24, s28, 17408
  buffer_load_dwordx4 v[160:163], v2, s[12:15], s24 offen sc1
  buffer_load_dwordx4 v[164:167], v3, s[12:15], s24 offen sc1
  buffer_load_dwordx4 v[168:171], v4, s[12:15], s24 offen sc1
  buffer_load_dwordx4 v[172:175], v5, s[12:15], s24 offen sc1
  s_waitcnt vmcnt(0)
  s_sub_u32 s51, s51, 1
  s_cmp_lt_i32 s51, 1
  s_cbranch_scc0 P3_C_62
P3_OK_63:
  v_mfma_f32_16x16x32_bf16 v[20:23], v[144:147], v[164:167], v[20:23]
  v_mfma_f32_16x16x32_bf16 v[36:39], v[148:151], v[164:167], v[36:39]
  v_mfma_f32_16x16x32_bf16 v[52:55], v[152:155], v[164:167], v[52:55]
  v_mfma_f32_16x16x32_bf16 v[68:71], v[156:159], v[164:167], v[68:71]
  v_mfma_f32_16x16x32_bf16 v[100:103], v[248:251], v[164:167], v[100:103]
  v_mfma_f32_16x16x32_bf16 v[24:27], v[144:147], v[168:171], v[24:27]
  v_mfma_f32_16x16x32_bf16 v[40:43], v[148:151], v[168:171], v[40:43]
  v_mfma_f32_16x16x32_bf16 v[56:59], v[152:155], v[168:171], v[56:59]
  v_mfma_f32_16x16x32_bf16 v[72:75], v[156:159], v[168:171], v[72:75]
  v_mfma_f32_16x16x32_bf16 v[104:107], v[248:251], v[168:171], v[104:107]
  v_mfma_f32_16x16x32_bf16 v[28:31], v[144:147], v[172:175], v[28:31]
  v_mfma_f32_16x16x32_bf16 v[44:47], v[148:151], v[172:175], v[44:47]
  v_mfma_f32_16x16x32_bf16 v[60:63], v[152:155], v[172:175], v[60:63]
  v_mfma_f32_16x16x32_bf16 v[76:79], v[156:159], v[172:175], v[76:79]
  v_mfma_f32_16x16x32_bf16 v[108:111], v[248:251], v[172:175], v[108:111]
  v_mfma_f32_16x16x32_bf16 v[16:19], v[144:147], v[160:163], v[16:19]
  v_mfma_f32_16x16x32_bf16 v[32:35], v[148:151], v[160:163], v[32:35]
  v_mfma_f32_16x16x32_bf16 v[48:51], v[152:155], v[160:163], v[48:51]
  v_mfma_f32_16x16x32_bf16 v[64:67], v[156:159], v[160:163], v[64:67]
  v_mfma_f32_16x16x32_bf16 v[96:99], v[248:251], v[160:163], v[96:99]
  buffer_load_dwordx4 v[144:147], v12, s[12:15], s25 offen offset:0 sc1
  buffer_load_dwordx4 v[148:151], v12, s[12:15], s25 offen offset:1024 sc1
  buffer_load_dwordx4 v[152:155], v12, s[12:15], s25 offen offset:2048 sc1
  buffer_load_dwordx4 v[156:159], v12, s[12:15], s25 offen offset:3072 sc1
  s_add_u32 s25, s25, 4608
  s_add_u32 s24, s30, 3072
  buffer_load_dwordx4 v[160:163], v2, s[12:15], s24 offen sc1
  buffer_load_dwordx4 v[164:167], v3, s[12:15], s24 offen sc1
  buffer_load_dwordx4 v[168:171], v4, s[12:15], s24 offen sc1
  buffer_load_dwordx4 v[172:175], v5, s[12:15], s24 offen sc1
  s_waitcnt vmcnt(25)
P3_C_64:
  v_max3_u32 v9, v192, v193, v194
  v_max3_u32 v10, v195, v196, v197
  v_max3_u32 v9, v198, v199, v9
  v_max3_u32 v10, v200, v201, v10
  v_max3_u32 v9, v202, v203, v9
  v_max3_u32 v10, v204, v205, v10
  v_max3_u32 v9, v206, v207, v9
  v_max_u32 v9, v9, v10
  v_cmp_eq_u32 vcc, -1, v9
  s_nop 4
  s_cbranch_vccz P3_OK_65
  s_sleep 4
  s_add_u32 s24, s30, 0
  buffer_load_dwordx4 v[192:195], v2, s[12:15], s24 offen sc1
  buffer_load_dwordx4 v[196:199], v3, s[12:15], s24 offen sc1
  buffer_load_dwordx4 v[200:203], v4, s[12:15], s24 offen sc1
  buffer_load_dwordx4 v[204:207], v5, s[12:15], s24 offen sc1
  s_waitcnt vmcnt(0)
  s_sub_u32 s51, s51, 1
  s_cmp_lt_i32 s51, 1
  s_cbranch_scc0 P3_C_64
P3_OK_65:
  v_mfma_f32_16x16x32_bf16 v[20:23], v[176:179], v[196:199], v[20:23]
  v_mfma_f32_16x16x32_bf16 v[36:39], v[180:183], v[196:199], v[36:39]
  v_mfma_f32_16x16x32_bf16 v[52:55], v[184:187], v[196:199], v[52:55]
  v_mfma_f32_16x16x32_bf16 v[68:71], v[188:191], v[196:199], v[68:71]
  v_mfma_f32_16x16x32_bf16 v[84:87], v[240:243], v[196:199], v[84:87]
  v_mfma_f32_16x16x32_bf16 v[24:27], v[176:179], v[200:203], v[24:27]
  v_mfma_f32_16x16x32_bf16 v[40:43], v[180:183], v[200:203], v[40:43]
  v_mfma_f32_16x16x32_bf16 v[56:59], v[184:187], v[200:203], v[56:59]
  v_mfma_f32_16x16x32_bf16 v[72:75], v[188:191], v[200:203], v[72:75]
  v_mfma_f32_16x16x32_bf16 v[88:91], v[240:243], v[200:203], v[88:91]
  v_mfma_f32_16x16x32_bf16 v[28:31], v[176:179], v[204:207], v[28:31]
  v_mfma_f32_16x16x32_bf16 v[44:47], v[180:183], v[204:207], v[44:47]
  v_mfma_f32_16x16x32_bf16 v[60:63], v[184:187], v[204:207], v[60:63]
  v_mfma_f32_16x16x32_bf16 v[76:79], v[188:191], v[204:207], v[76:79]
  v_mfma_f32_16x16x32_bf16 v[92:95], v[240:243], v[204:207], v[92:95]
  v_mfma_f32_16x16x32_bf16 v[16:19], v[176:179], v[192:195], v[16:19]
  v_mfma_f32_16x16x32_bf16 v[32:35], v[180:183], v[192:195], v[32:35]
  v_mfma_f32_16x16x32_bf16 v[48:51], v[184:187], v[192:195], v[48:51]
  v_mfma_f32_16x16x32_bf16 v[64:67], v[188:191], v[192:195], v[64:67]
  v_mfma_f32_16x16x32_bf16 v[80:83], v[240:243], v[192:195], v[80:83]
  s_cmp_ge_u32 s20, 2
  s_cbranch_scc1 P3_NL_66
  buffer_load_dwordx4 v[176:179], v12, s[12:15], s25 offen offset:0 sc1
  buffer_load_dwordx4 v[180:183], v12, s[12:15], s25 offen offset:1024 sc1
  buffer_load_dwordx4 v[184:187], v12, s[12:15], s25 offen offset:2048 sc1
  buffer_load_dwordx4 v[188:191], v12, s[12:15], s25 offen offset:3072 sc1
  buffer_load_dwordx4 v[248:251], v6, s[12:15], s25 offen sc1
  s_add_u32 s25, s25, 4608
  s_add_u32 s24, s30, 4096
  buffer_load_dwordx4 v[192:195], v2, s[12:15], s24 offen sc1
  buffer_load_dwordx4 v[196:199], v3, s[12:15], s24 offen sc1
  buffer_load_dwordx4 v[200:203], v4, s[12:15], s24 offen sc1
  buffer_load_dwordx4 v[204:207], v5, s[12:15], s24 offen sc1
P3_NL_66:
  s_waitcnt vmcnt(17)
P3_C_67:
  v_max3_u32 v9, v224, v225, v226
  v_max3_u32 v10, v227, v228, v229
  v_max3_u32 v9, v230, v231, v9
  v_max3_u32 v10, v232, v233, v10
  v_max3_u32 v9, v234, v235, v9
  v_max3_u32 v10, v236, v237, v10
  v_max3_u32 v9, v238, v239, v9
  v_max_u32 v9, v9, v10
  v_cmp_eq_u32 vcc, -1, v9
  s_nop 4
  s_cbranch_vccz P3_OK_68
  s_sleep 4
  s_add_u32 s24, s30, 1024
  buffer_load_dwordx4 v[224:227], v2, s[12:15], s24 offen sc1
  buffer_load_dwordx4 v[228:231], v3, s[12:15], s24 offen sc1
  buffer_load_dwordx4 v[232:235], v4, s[12:15], s24 offen sc1
  buffer_load_dwordx4 v[236:239], v5, s[12:15], s24 offen sc1
  s_waitcnt vmcnt(0)
  s_sub_u32 s51, s51, 1
  s_cmp_lt_i32 s51, 1
  s_cbranch_scc0 P3_C_67
P3_OK_68:
  v_mfma_f32_16x16x32_bf16 v[20:23], v[208:211], v[228:231], v[20:23]
  v_mfma_f32_16x16x32_bf16 v[36:39], v[212:215], v[228:231], v[36:39]
  v_mfma_f32_16x16x32_bf16 v[52:55], v[216:219], v[228:231], v[52:55]
  v_mfma_f32_16x16x32_bf16 v[68:71], v[220:223], v[228:231], v[68:71]
  v_mfma_f32_16x16x32_bf16 v[100:103], v[240:243], v[228:231], v[100:103]
  v_mfma_f32_16x16x32_bf16 v[24:27], v[208:211], v[232:235], v[24:27]
  v_mfma_f32_16x16x32_bf16 v[40:43], v[212:215], v[232:235], v[40:43]
  v_mfma_f32_16x16x32_bf16 v[56:59], v[216:219], v[232:235], v[56:59]
  v_mfma_f32_16x16x32_bf16 v[72:75], v[220:223], v[232:235], v[72:75]
  v_mfma_f32_16x16x32_bf16 v[104:107], v[240:243], v[232:235], v[104:107]
  v_mfma_f32_16x16x32_bf16 v[28:31], v[208:211], v[236:239], v[28:31]
  v_mfma_f32_16x16x32_bf16 v[44:47], v[212:215], v[236:239], v[44:47]
  v_mfma_f32_16x16x32_bf16 v[60:63], v[216:219], v[236:239], v[60:63]
  v_mfma_f32_16x16x32_bf16 v[76:79], v[220:223], v[236:239], v[76:79]
  v_mfma_f32_16x16x32_bf16 v[108:111], v[240:243], v[236:239], v[108:111]
  v_mfma_f32_16x16x32_bf16 v[16:19], v[208:211], v[224:227], v[16:19]
  v_mfma_f32_16x16x32_bf16 v[32:35], v[212:215], v[224:227], v[32:35]
  v_mfma_f32_16x16x32_bf16 v[48:51], v[216:219], v[224:227], v[48:51]
  v_mfma_f32_16x16x32_bf16 v[64:67], v[220:223], v[224:227], v[64:67]
  v_mfma_f32_16x16x32_bf16 v[96:99], v[240:243], v[224:227], v[96:99]
  s_waitcnt vmcnt(8)
P3_C_69:
  v_max3_u32 v9, v128, v129, v130
  v_max3_u32 v10, v131, v132, v133
  v_max3_u32 v9, v134, v135, v9
  v_max3_u32 v10, v136, v137, v10
  v_max3_u32 v9, v138, v139, v9
  v_max3_u32 v10, v140, v141, v10
  v_max3_u32 v9, v142, v143, v9
  v_max_u32 v9, v9, v10
  v_cmp_eq_u32 vcc, -1, v9
  s_nop 4
  s_cbranch_vccz P3_OK_70
  s_sleep 4
  s_add_u32 s24, s30, 2048
  buffer_load_dwordx4 v[128:131], v2, s[12:15], s24 offen sc1
  buffer_load_dwordx4 v[132:135], v3, s[12:15], s24 offen sc1
  buffer_load_dwordx4 v[136:139], v4, s[12:15], s24 offen sc1
  buffer_load_dwordx4 v[140:143], v5, s[12:15], s24 offen sc1
  s_waitcnt vmcnt(0)
  s_sub_u32 s51, s51, 1
  s_cmp_lt_i32 s51, 1
  s_cbranch_scc0 P3_C_69
P3_OK_70:
  v_mfma_f32_16x16x32_bf16 v[20:23], v[112:115], v[132:135], v[20:23]
  v_mfma_f32_16x16x32_bf16 v[36:39], v[116:119], v[132:135], v[36:39]
  v_mfma_f32_16x16x32_bf16 v[52:55], v[120:123], v[132:135], v[52:55]
  v_mfma_f32_16x16x32_bf16 v[68:71], v[124:127], v[132:135], v[68:71]
  v_mfma_f32_16x16x32_bf16 v[84:87], v[244:247], v[132:135], v[84:87]
  v_mfma_f32_16x16x32_bf16 v[24:27], v[112:115], v[136:139], v[24:27]
  v_mfma_f32_16x16x32_bf16 v[40:43], v[116:119], v[136:139], v[40:43]
  v_mfma_f32_16x16x32_bf16 v[56:59], v[120:123], v[136:139], v[56:59]
  v_mfma_f32_16x16x32_bf16 v[72:75], v[124:127], v[136:139], v[72:75]
  v_mfma_f32_16x16x32_bf16 v[88:91], v[244:247], v[136:139], v[88:91]
  v_mfma_f32_16x16x32_bf16 v[28:31], v[112:115], v[140:143], v[28:31]
  v_mfma_f32_16x16x32_bf16 v[44:47], v[116:119], v[140:143], v[44:47]
  v_mfma_f32_16x16x32_bf16 v[60:63], v[120:123], v[140:143], v[60:63]
  v_mfma_f32_16x16x32_bf16 v[76:79], v[124:127], v[140:143], v[76:79]
  v_mfma_f32_16x16x32_bf16 v[92:95], v[244:247], v[140:143], v[92:95]
  v_mfma_f32_16x16x32_bf16 v[16:19], v[112:115], v[128:131], v[16:19]
  v_mfma_f32_16x16x32_bf16 v[32:35], v[116:119], v[128:131], v[32:35]
  v_mfma_f32_16x16x32_bf16 v[48:51], v[120:123], v[128:131], v[48:51]
  v_mfma_f32_16x16x32_bf16 v[64:67], v[124:127], v[128:131], v[64:67]
  v_mfma_f32_16x16x32_bf16 v[80:83], v[244:247], v[128:131], v[80:83]
  s_waitcnt vmcnt(0)
P3_C_71:
  v_max3_u32 v9, v160, v161, v162
  v_max3_u32 v10, v163, v164, v165
  v_max3_u32 v9, v166, v167, v9
  v_max3_u32 v10, v168, v169, v10
  v_max3_u32 v9, v170, v171, v9
  v_max3_u32 v10, v172, v173, v10
  v_max3_u32 v9, v174, v175, v9
  v_max_u32 v9, v9, v10
  v_cmp_eq_u32 vcc, -1, v9
  s_nop 4
  s_cbranch_vccz P3_OK_72
  s_sleep 4
  s_add_u32 s24, s30, 3072
  buffer_load_dwordx4 v[160:163], v2, s[12:15], s24 offen sc1
  buffer_load_dwordx4 v[164:167], v3, s[12:15], s24 offen sc1
  buffer_load_dwordx4 v[168:171], v4, s[12:15], s24 offen sc1
  buffer_load_dwordx4 v[172:175], v5, s[12:15], s24 offen sc1
  s_waitcnt vmcnt(0)
  s_sub_u32 s51, s51, 1
  s_cmp_lt_i32 s51, 1
  s_cbranch_scc0 P3_C_71
P3_OK_72:
  v_mfma_f32_16x16x32_bf16 v[20:23], v[144:147], v[164:167], v[20:23]
  v_mfma_f32_16x16x32_bf16 v[36:39], v[148:151], v[164:167], v[36:39]
  v_mfma_f32_16x16x32_bf16 v[52:55], v[152:155], v[164:167], v[52:55]
  v_mfma_f32_16x16x32_bf16 v[68:71], v[156:159], v[164:167], v[68:71]
  v_mfma_f32_16x16x32_bf16 v[100:103], v[244:247], v[164:167], v[100:103]
  v_mfma_f32_16x16x32_bf16 v[24:27], v[144:147], v[168:171], v[24:27]
  v_mfma_f32_16x16x32_bf16 v[40:43], v[148:151], v[168:171], v[40:43]
  v_mfma_f32_16x16x32_bf16 v[56:59], v[152:155], v[168:171], v[56:59]
  v_mfma_f32_16x16x32_bf16 v[72:75], v[156:159], v[168:171], v[72:75]
  v_mfma_f32_16x16x32_bf16 v[104:107], v[244:247], v[168:171], v[104:107]
  v_mfma_f32_16x16x32_bf16 v[28:31], v[144:147], v[172:175], v[28:31]
  v_mfma_f32_16x16x32_bf16 v[44:47], v[148:151], v[172:175], v[44:47]
  v_mfma_f32_16x16x32_bf16 v[60:63], v[152:155], v[172:175], v[60:63]
  v_mfma_f32_16x16x32_bf16 v[76:79], v[156:159], v[172:175], v[76:79]
  v_mfma_f32_16x16x32_bf16 v[108:111], v[244:247], v[172:175], v[108:111]
  v_mfma_f32_16x16x32_bf16 v[16:19], v[144:147], v[160:163], v[16:19]
  v_mfma_f32_16x16x32_bf16 v[32:35], v[148:151], v[160:163], v[32:35]
  v_mfma_f32_16x16x32_bf16 v[48:51], v[152:155], v[160:163], v[48:51]
  v_mfma_f32_16x16x32_bf16 v[64:67], v[156:159], v[160:163], v[64:67]
  v_mfma_f32_16x16x32_bf16 v[96:99], v[244:247], v[160:163], v[96:99]
  s_cmp_ge_u32 s20, 2
  s_cbranch_scc1 P3_SKIP_27
  s_waitcnt vmcnt(0)
P3_C_73:
  v_max3_u32 v9, v192, v193, v194
  v_max3_u32 v10, v195, v196, v197
  v_max3_u32 v9, v198, v199, v9
  v_max3_u32 v10, v200, v201, v10
  v_max3_u32 v9, v202, v203, v9
  v_max3_u32 v10, v204, v205, v10
  v_max3_u32 v9, v206, v207, v9
  v_max_u32 v9, v9, v10
  v_cmp_eq_u32 vcc, -1, v9
  s_nop 4
  s_cbranch_vccz P3_OK_74
  s_sleep 4
  s_add_u32 s24, s30, 4096
  buffer_load_dwordx4 v[192:195], v2, s[12:15], s24 offen sc1
  buffer_load_dwordx4 v[196:199], v3, s[12:15], s24 offen sc1
  buffer_load_dwordx4 v[200:203], v4, s[12:15], s24 offen sc1
  buffer_load_dwordx4 v[204:207], v5, s[12:15], s24 offen sc1
  s_waitcnt vmcnt(0)
  s_sub_u32 s51, s51, 1
  s_cmp_lt_i32 s51, 1
  s_cbranch_scc0 P3_C_73
P3_OK_74:
  v_mfma_f32_16x16x32_bf16 v[20:23], v[176:179], v[196:199], v[20:23]
  v_mfma_f32_16x16x32_bf16 v[36:39], v[180:183], v[196:199], v[36:39]
  v_mfma_f32_16x16x32_bf16 v[52:55], v[184:187], v[196:199], v[52:55]
  v_mfma_f32_16x16x32_bf16 v[68:71], v[188:191], v[196:199], v[68:71]
  v_mfma_f32_16x16x32_bf16 v[84:87], v[248:251], v[196:199], v[84:87]
  v_mfma_f32_16x16x32_bf16 v[24:27], v[176:179], v[200:203], v[24:27]
  v_mfma_f32_16x16x32_bf16 v[40:43], v[180:183], v[200:203], v[40:43]
  v_mfma_f32_16x16x32_bf16 v[56:59], v[184:187], v[200:203], v[56:59]
  v_mfma_f32_16x16x32_bf16 v[72:75], v[188:191], v[200:203], v[72:75]
  v_mfma_f32_16x16x32_bf16 v[88:91], v[248:251], v[200:203], v[88:91]
  v_mfma_f32_16x16x32_bf16 v[28:31], v[176:179], v[204:207], v[28:31]
  v_mfma_f32_16x16x32_bf16 v[44:47], v[180:183], v[204:207], v[44:47]
  v_mfma_f32_16x16x32_bf16 v[60:63], v[184:187], v[204:207], v[60:63]
  v_mfma_f32_16x16x32_bf16 v[76:79], v[188:191], v[204:207], v[76:79]
  v_mfma_f32_16x16x32_bf16 v[92:95], v[248:251], v[204:207], v[92:95]
  v_mfma_f32_16x16x32_bf16 v[16:19], v[176:179], v[192:195], v[16:19]
  v_mfma_f32_16x16x32_bf16 v[32:35], v[180:183], v[192:195], v[32:35]
  v_mfma_f32_16x16x32_bf16 v[48:51], v[184:187], v[192:195], v[48:51]
  v_mfma_f32_16x16x32_bf16 v[64:67], v[188:191], v[192:195], v[64:67]
  v_mfma_f32_16x16x32_bf16 v[80:83], v[248:251], v[192:195], v[80:83]
P3_SKIP_27:
  s_setprio 3
  ds_write_b128 v252, v[20:23] offset:0
  ds_write_b128 v252, v[36:39] offset:1024
  ds_write_b128 v252, v[52:55] offset:2048
  ds_write_b128 v252, v[68:71] offset:3072
  ds_write_b128 v253, v[24:27] offset:5120
  ds_write_b128 v253, v[40:43] offset:6144
  ds_write_b128 v253, v[56:59] offset:7168
  ds_write_b128 v253, v[72:75] offset:8192
  ds_write_b128 v254, v[28:31] offset:10240
  ds_write_b128 v254, v[44:47] offset:11264
  ds_write_b128 v254, v[60:63] offset:12288
  ds_write_b128 v254, v[76:79] offset:13312
  s_mov_b32 exec_lo, 0
  v_mov_b32 v80, v96
  v_mov_b32 v81, v97
  v_mov_b32 v82, v98
  v_mov_b32 v83, v99
  v_mov_b32 v84, v100
  v_mov_b32 v85, v101
  v_mov_b32 v86, v102
  v_mov_b32 v87, v103
  v_mov_b32 v88, v104
  v_mov_b32 v89, v105
  v_mov_b32 v90, v106
  v_mov_b32 v91, v107
  v_mov_b32 v92, v108
  v_mov_b32 v93, v109
  v_mov_b32 v94, v110
  v_mov_b32 v95, v111
  s_mov_b64 exec, -1
  ds_write_b128 v252, v[84:87] offset:4096
  ds_write_b128 v253, v[88:91] offset:9216
  ds_write_b128 v254, v[92:95] offset:14336
  s_waitcnt vmcnt(0) lgkmcnt(0)
  s_barrier
  ds_read_b128 v[112:115], v8 offset:0
  ds_read_b128 v[116:119], v8 offset:5120
  ds_read_b128 v[120:123], v8 offset:10240
  ds_read_b128 v[124:127], v8 offset:1024
  ds_read_b128 v[128:131], v8 offset:6144
  ds_read_b128 v[132:135], v8 offset:11264
  ds_read_b128 v[136:139], v8 offset:2048
  ds_read_b128 v[140:143], v8 offset:7168
  ds_read_b128 v[144:147], v8 offset:12288
  ds_read_b128 v[148:151], v8 offset:3072
  ds_read_b128 v[152:155], v8 offset:8192
  ds_read_b128 v[156:159], v8 offset:13312
  ds_read_b128 v[160:163], v8 offset:4096
  ds_read_b128 v[164:167], v8 offset:9216
  ds_read_b128 v[168:171], v8 offset:14336
  s_waitcnt lgkmcnt(12)
  v_pk_add_f32 v[112:113], v[112:113], v[116:117]
  v_pk_add_f32 v[16:17], v[16:17], v[120:121]
  v_pk_add_f32 v[114:115], v[114:115], v[118:119]
  v_pk_add_f32 v[18:19], v[18:19], v[122:123]
  v_pk_add_f32 v[112:113], v[112:113], v[16:17]
  v_pk_add_f32 v[114:115], v[114:115], v[18:19]
  v_cvt_pk_bf16_f32 v176, v112, v113
  v_cvt_pk_bf16_f32 v177, v114, v115
  s_waitcnt lgkmcnt(9)
  v_pk_add_f32 v[124:125], v[124:125], v[128:129]
  v_pk_add_f32 v[32:33], v[32:33], v[132:133]
  v_pk_add_f32 v[126:127], v[126:127], v[130:131]
  v_pk_add_f32 v[34:35], v[34:35], v[134:135]
  v_pk_add_f32 v[124:125], v[124:125], v[32:33]
  v_pk_add_f32 v[126:127], v[126:127], v[34:35]
  v_cvt_pk_bf16_f32 v178, v124, v125
  v_cvt_pk_bf16_f32 v179, v126, v127
  buffer_store_dwordx4 v[176:179], v13, s[8:11], s27 offen offset:0
  s_waitcnt lgkmcnt(6)
  v_pk_add_f32 v[136:137], v[136:137], v[140:141]
  v_pk_add_f32 v[48:49], v[48:49], v[144:145]
  v_pk_add_f32 v[138:139], v[138:139], v[142:143]
  v_pk_add_f32 v[50:51], v[50:51], v[146:147]
  v_pk_add_f32 v[136:137], v[136:137], v[48:49]
  v_pk_add_f32 v[138:139], v[138:139], v[50:51]
  v_cvt_pk_bf16_f32 v180, v136, v137
  v_cvt_pk_bf16_f32 v181, v138, v139
  s_waitcnt lgkmcnt(3)
  v_pk_add_f32 v[148:149], v[148:149], v[152:153]
  v_pk_add_f32 v[64:65], v[64:65], v[156:157]
  v_pk_add_f32 v[150:151], v[150:151], v[154:155]
  v_pk_add_f32 v[66:67], v[66:67], v[158:159]
  v_pk_add_f32 v[148:149], v[148:149], v[64:65]
  v_pk_add_f32 v[150:151], v[150:151], v[66:67]
  v_cvt_pk_bf16_f32 v182, v148, v149
  v_cvt_pk_bf16_f32 v183, v150, v151
  buffer_store_dwordx4 v[180:183], v13, s[8:11], s27 offen offset:64
  s_waitcnt lgkmcnt(0)
  v_pk_add_f32 v[160:161], v[160:161], v[164:165]
  v_pk_add_f32 v[80:81], v[80:81], v[168:169]
  v_pk_add_f32 v[162:163], v[162:163], v[166:167]
  v_pk_add_f32 v[82:83], v[82:83], v[170:171]
  v_pk_add_f32 v[160:161], v[160:161], v[80:81]
  v_pk_add_f32 v[162:163], v[162:163], v[82:83]
  v_mov_b32 v80, v160
  v_mov_b32 v81, v161
  v_mov_b32 v82, v162
  v_mov_b32 v83, v163
  v_permlane32_swap_b32 v160, v80
  v_permlane32_swap_b32 v161, v81
  v_permlane32_swap_b32 v162, v82
  v_permlane32_swap_b32 v163, v83
  v_pk_add_f32 v[160:161], v[160:161], v[80:81]
  v_pk_add_f32 v[162:163], v[162:163], v[82:83]
  v_cvt_pk_bf16_f32 v184, v160, v161
  v_cvt_pk_bf16_f32 v185, v162, v163
  s_mov_b32 exec_hi, 0
  buffer_store_dwordx2 v[184:185], v15, s[8:11], s27 offen offset:128
  s_mov_b64 exec, -1
  s_or_b32 s44, s2, s20
  s_cmp_lg_u32 s44, 0
  s_cbranch_scc1 K_DONE
  v_mov_b32 v2, 0
  global_store_dword v2, v2, s[16:17] sc0 sc1
  s_branch K_DONE
K_ATT:
  s_sub_u32 s3, s2, 256
  s_load_dwordx2 s[4:5], s[0:1], 0
  s_load_dwordx4 s[16:19], s[0:1], 96
  s_load_dwordx4 s[56:59], s[0:1], 72
  s_load_dwordx2 s[36:37], s[0:1], 32
  s_load_dwordx2 s[60:61], s[0:1], 56
  v_lshrrev_b32 v1, 6, v0
  s_nop 0
  v_readfirstlane_b32 s20, v1
  v_and_b32 v1, 63, v0
  s_and_b32 s24, s3, 3
  s_lshr_b32 s25, s3, 3
  s_lshl_b32 s21, s24, 3
  s_and_b32 s23, s25, 7
  s_add_u32 s21, s21, s23
  s_and_b32 s22, s3, 4
  s_lshr_b32 s23, s25, 3
  s_add_u32 s22, s22, s23
  s_lshl_b32 s23, s21, 2
  s_add_u32 s23, s23, s20
  s_lshr_b32 s44, s23, 1
  s_lshl_b32 s44, s44, 5
  s_and_b32 s45, s23, 1
  s_lshl_b32 s45, s45, 2
  s_add_u32 s44, s44, s45
  v_bfe_u32 v3, v1, 2, 2
  v_lshlrev_b32 v3, 3, v3
  v_and_b32 v10, 3, v1
  v_add3_u32 v3, v3, v10, s44
  v_lshlrev_b32 v3, 3, v3
  s_mul_i32 s26, s20, 10240
  s_lshl_b32 s27, s25, 2
  s_add_u32 s27, s27, s20
  s_getpc_b64 s[8:9]
K_PC:
  s_sub_u32 s8, s8, K_PC-K_GEMM
  s_subb_u32 s9, s9, 0
  s_mul_i32 s45, s27, 5
  v_min_u32 v10, 4, v1
  v_add_u32 v10, s45, v10
  v_min_u32 v10, 537, v10
  v_lshlrev_b32 v238, 7, v10
  global_load_dword v239, v238, s[8:9]
  v_lshlrev_b32 v10, 4, v1
  s_waitcnt lgkmcnt(0)
  s_mov_b32 s12, s18
  s_mov_b32 s13, s19
  s_mov_b32 s14, 29360128
  s_mov_b32 s15, 0x00020000
  s_mul_i32 s44, s23, 90
  s_lshl_b32 s52, s22, 1
  s_add_u32 s52, s52, s44
  s_lshl_b32 s52, s52, 10
  s_add_u32 s52, s52, 9502720
  s_lshr_b32 s53, s22, 2
  s_add_u32 s53, s53, s44
  s_lshl_b32 s53, s53, 10
  s_and_b32 s47, s22, 3
  s_lshl_b32 s47, s47, 8
  s_add_u32 s53, s53, s47
  s_add_u32 s53, s53, 9519104
  s_mul_i32 s54, s22, 9
  s_add_u32 s54, s54, s44
  s_lshl_b32 s54, s54, 10
  s_add_u32 s54, s54, 9521152
  s_add_u32 s55, s54, 9216
  v_mov_b32 v224, -1
  v_mov_b32 v225, -1
  v_mov_b32 v226, -1
  v_mov_b32 v227, -1
  v_lshlrev_b32 v228, 2, v1
  s_cmp_lg_u32 s3, 0
  s_cbranch_scc1 NOW_75
  s_add_u32 s44, s26, 24616960
  buffer_store_dwordx4 v[224:227], v10, s[12:15], s44 offen sc0 sc1
  s_add_u32 s44, s44, 1024
  buffer_store_dwordx4 v[224:227], v10, s[12:15], s44 offen sc0 sc1
  s_add_u32 s44, s44, 1024
  buffer_store_dwordx4 v[224:227], v10, s[12:15], s44 offen sc0 sc1
  s_add_u32 s44, s44, 1024
  buffer_store_dwordx4 v[224:227], v10, s[12:15], s44 offen sc0 sc1
  s_add_u32 s44, s44, 1024
  buffer_store_dwordx4 v[224:227], v10, s[12:15], s44 offen sc0 sc1
  s_add_u32 s44, s44, 1024
  buffer_store_dwordx4 v[224:227], v10, s[12:15], s44 offen sc0 sc1
  s_add_u32 s44, s44, 1024
  buffer_store_dwordx4 v[224:227], v10, s[12:15], s44 offen sc0 sc1
  s_add_u32 s44, s44, 1024
  buffer_store_dwordx4 v[224:227], v10, s[12:15], s44 offen sc0 sc1
  s_add_u32 s44, s44, 1024
  buffer_store_dwordx4 v[224:227], v10, s[12:15], s44 offen sc0 sc1
  s_add_u32 s44, s44, 1024
  buffer_store_dwordx4 v[224:227], v10, s[12:15], s44 offen sc0 sc1
  s_add_u32 s44, s44, 1024
  s_memrealtime s[44:45]
  s_waitcnt vmcnt(0) lgkmcnt(0)
  s_barrier
  s_cmp_lg_u32 s20, 0
  s_cbranch_scc1 NOW_75
  v_mov_b32 v29, 0
  s_or_b32 s44, s44, 1
  v_mov_b32 v28, s44
  global_store_dword v29, v28, s[16:17] sc0 sc1
NOW_75:
  s_mul_i32 s63, s3, 3
  s_add_u32 s63, s63, s20
  s_and_b32 s64, s63, 7
  s_lshr_b32 s65, s63, 3
  s_cmp_lt_u32 s65, 18
  s_cselect_b32 s40, s36, s56
  s_cselect_b32 s41, s37, s57
  s_mov_b32 s42, 2654208
  s_cselect_b32 s42, 663552, s42
  s_mov_b32 s43, 0x00020000
  s_sub_u32 s44, s65, 18
  s_mul_i32 s45, s44, 57
  s_lshr_b32 s45, s45, 10
  s_mul_i32 s46, s45, 18
  s_sub_u32 s44, s44, s46
  s_lshl_b32 s46, s45, 9
  s_lshl_b32 s47, s45, 6
  s_add_u32 s47, s47, 1536
  s_cmp_lt_u32 s44, 16
  s_cselect_b32 s46, s46, s47
  s_lshl_b32 s44, s44, 5
  s_add_u32 s44, s44, s46
  s_mov_b32 s45, 4
  s_mov_b32 s46, 8
  s_mov_b32 s47, 16
  s_mov_b32 s48, 2
  s_sub_u32 s49, s65, 16
  s_mul_i32 s49, s49, 288
  s_add_u32 s49, s49, 16
  s_cmp_lt_u32 s65, 18
  s_cselect_b32 s44, s49, s44
  s_cselect_b32 s45, 72, s45
  s_cselect_b32 s46, 144, s46
  s_cselect_b32 s47, 36, s47
  s_cselect_b32 s48, 18, s48
  s_mul_i32 s49, s65, 36
  s_cmp_lt_u32 s65, 16
  s_cselect_b32 s44, s49, s44
  s_cselect_b32 s45, 18, s45
  s_cselect_b32 s46, 4, s46
  s_cselect_b32 s47, 8, s47
  s_cselect_b32 s48, 2, s48
  s_mul_i32 s44, s44, 1152
  s_mul_i32 s45, s45, 1152
  s_mul_i32 s46, s46, 1152
  s_mul_i32 s47, s47, 1152
  s_mul_i32 s49, s64, 144
  s_add_u32 s66, s44, s49
  s_add_u32 s67, s66, s47
  s_add_u32 s68, s66, s45
  s_add_u32 s69, s67, s45
  s_add_u32 s70, s66, s46
  s_add_u32 s71, s67, s46
  s_add_u32 s72, s68, s46
  s_add_u32 s73, s69, s46
  v_lshrrev_b32 v140, 5, v1
  v_mul_lo_u32 v140, v140, s48
  v_bfe_u32 v5, v1, 4, 1
  v_add_u32 v140, v140, v5
  v_mul_u32_u24 v140, 1152, v140
  v_and_b32 v5, 15, v1
  v_min_u32 v5, 8, v5
  v_lshl_add_u32 v140, v5, 4, v140
  v_lshrrev_b32 v5, 4, v1
  v_bfe_u32 v6, v1, 2, 2
  v_lshlrev_b32 v7, 11, v5
  v_lshl_add_u32 v7, v6, 8, v7
  s_add_u32 s44, s26, 40960
  v_add_u32 v7, s44, v7
  v_and_b32 v6, 3, v1
  v_lshl_add_u32 v142, v6, 3, v7
  v_lshl_add_u32 v141, v6, 4, v7
  v_and_b32 v6, 7, v1
  v_lshl_add_u32 v5, v5, 3, v6
  v_lshlrev_b32 v5, 4, v5
  v_add_u32 v143, 4096, v5
  s_setprio 0
  s_mov_b32 s31, s26
  v_add_u32 v15, s31, v10
  s_mov_b32 s30, 24616960
  s_cmp_lg_u32 s20, 0
  s_cbranch_scc1 KVR_76
  s_waitcnt vmcnt(0)
  v_mov_b32 v2, 0
  global_load_dword v4, v2, s[16:17] sc0 sc1
  s_waitcnt vmcnt(0)
  s_mov_b32 s51, 300000
NONCE_77:
  v_readfirstlane_b32 s62, v4
  s_nop 1
  s_cmp_lg_u32 s62, 0
  s_cbranch_scc1 NONCE_OK_78
  s_sleep 32
  global_load_dword v4, v2, s[16:17] sc0 sc1
  s_waitcnt vmcnt(0)
  s_sub_u32 s51, s51, 1
  s_cmp_lg_u32 s51, 0
  s_cbranch_scc1 NONCE_77
NONCE_OK_78:
  v_mov_b32 v4, s62
  ds_write_b32 v2, v4
  s_waitcnt lgkmcnt(0)
KVR_76:
  s_barrier
  v_mov_b32 v2, 0
  ds_read_b32 v40, v2
  s_lshl_b32 s48, s23, 3
  s_add_u32 s48, s48, s22
  s_mul_i32 s48, s48, 2304
  s_add_u32 s48, s48, 25452544
  buffer_store_dwordx4 v[224:227], v10, s[12:15], s48 offen offset:0 sc0 sc1
  buffer_store_dwordx4 v[224:227], v10, s[12:15], s48 offen offset:1024 sc0 sc1
  buffer_store_dword v224, v228, s[12:15], s48 offen offset:2048 sc0 sc1
  s_lshl_b32 s44, s3, 5
  s_add_u32 s44, s44, s20
  s_lshl_b32 s44, s44, 2
  s_add_u32 s44, s44, 25419776
  v_and_b32 v11, 31, v1
  v_lshlrev_b32 v11, 2, v11
  v_add_u32 v11, 1024, v11
  s_waitcnt vmcnt(0) lgkmcnt(0)
  v_readfirstlane_b32 s62, v40
  v_mov_b32 v42, 0
  s_nop 0
  v_mov_b32 v43, s62
  s_mov_b64 exec, 1
  buffer_store_dword v43, v42, s[12:15], s44 offen sc0 sc1
  s_mov_b64 exec, -1
  v_mov_b32 v85, 0
  v_mov_b32 v86, 0
  v_mov_b32 v87, 0
  v_mov_b32 v101, 0x3f803f80
  v_mov_b32 v102, 0x3f803f80
  v_mov_b32 v103, 0
  v_mov_b32 v93, 0
  v_mov_b32 v94, 0
  v_mov_b32 v95, 0
  v_mov_b32 v109, 0x3f803f80
  v_mov_b32 v110, 0x3f803f80
  v_mov_b32 v111, 0
  v_lshrrev_b32 v2, 5, v1
  v_lshlrev_b32 v2, 2, v2
  v_bfe_u32 v4, v1, 3, 1
  v_lshl_add_u32 v2, v4, 1, v2
  v_mul_u32_u24 v12, 168, v2
  v_add_u32 v12, 1152, v12
  v_bfe_u32 v4, v1, 4, 1
  v_bfe_u32 v13, v1, 2, 1
  v_mul_u32_u24 v14, 168, v4
  v_add_u32 v14, v14, v12
  v_and_b32 v8, 1, v1
  v_lshl_add_u32 v8, v8, 1, v13
  v_lshl_add_u32 v8, v8, 3, v14
  v_add_u32 v8, 128, v8
  v_add_u32 v9, 160, v14
  v_and_b32 v2, 2, v1
  v_cmp_eq_u32 vcc, 0, v2
  s_nop 1
  v_cndmask_b32 v232, v9, v8, vcc
  v_cndmask_b32 v233, v8, v9, vcc
  v_lshl_add_u32 v2, v4, 1, v13
  v_lshl_add_u32 v12, v2, 5, v12
  v_and_b32 v2, 3, v1
  v_lshl_add_u32 v12, v2, 3, v12
  v_mul_u32_u24 v14, 0xaaaa, v13
  v_add_u32 v14, 0x4444, v14
  v_mul_u32_u24 v13, 0xaaaa, v4
  v_add_u32 v13, 0x4444, v13
  v_add_u32 v5, 40960, v10
  v_add_u32 v6, 40960, v11
  v_add_u32 v7, 40960, v12
  v_add_u32 v234, 40960, v232
  v_add_u32 v235, 40960, v233
  s_and_b32 s49, s3, 7
  s_lshl_b32 s49, s49, 9
  s_add_u32 s49, s49, 25321472
  v_min_u32 v230, 47, v1
  v_lshlrev_b32 v230, 3, v230
  s_mov_b32 s51, 300000
QH_81:
  s_sleep 12
  buffer_load_dword v2, v11, s[12:15], s48 offen offset:1152 sc1
  s_sub_u32 s51, s51, 1
  s_waitcnt vmcnt(0)
  v_cmp_eq_u32 vcc, -1, v2
  s_cmp_eq_u32 s51, 1
  s_cbranch_scc1 QW_79
  s_nop 2
  s_cbranch_vccnz QH_81
  s_setprio 3
QW_79:
  buffer_load_dwordx4 v[80:83], v10, s[12:15], s48 offen offset:0 sc1
  buffer_load_dword v128, v11, s[12:15], s48 offen offset:0 sc1
  buffer_load_dwordx4 v[88:91], v10, s[12:15], s48 offen offset:1152 sc1
  buffer_load_dword v129, v11, s[12:15], s48 offen offset:1152 sc1
  s_waitcnt vmcnt(0)
  v_max_u32 v2, v128, v129
  v_max3_u32 v2, v80, v81, v2
  v_max3_u32 v2, v82, v83, v2
  v_max3_u32 v2, v88, v89, v2
  v_max3_u32 v2, v90, v91, v2
  v_cmp_eq_u32 vcc, -1, v2
  s_nop 4
  s_cbranch_vccz QOK_80
  s_sleep 2
  s_sub_u32 s51, s51, 1
  s_cmp_lg_u32 s51, 0
  s_cbranch_scc1 QW_79
QOK_80:
  v_add_u32 v4, 40960, v15
  s_mov_b32 s51, 300000
KW_82:
  s_mov_b32 s30, 24616960
  s_add_u32 m0, s31, 40960
  s_nop 0
  buffer_load_dwordx4 v15, s[12:15], s30 offen offset:0 sc1 lds
  buffer_load_dwordx4 v15, s[12:15], s30 offen offset:1024 sc1 lds
  buffer_load_dwordx4 v15, s[12:15], s30 offen offset:2048 sc1 lds
  buffer_load_dwordx4 v15, s[12:15], s30 offen offset:3072 sc1 lds
  s_add_u32 s30, s30, 4096
  s_add_u32 m0, s31, 45056
  s_nop 0
  buffer_load_dwordx4 v15, s[12:15], s30 offen offset:0 sc1 lds
  buffer_load_dwordx4 v15, s[12:15], s30 offen offset:1024 sc1 lds
  buffer_load_dwordx4 v15, s[12:15], s30 offen offset:2048 sc1 lds
  buffer_load_dwordx4 v15, s[12:15], s30 offen offset:3072 sc1 lds
  s_add_u32 s30, s30, 4096
  s_add_u32 m0, s31, 49152
  s_nop 0
  buffer_load_dwordx4 v15, s[12:15], s30 offen offset:0 sc1 lds
  buffer_load_dwordx4 v15, s[12:15], s30 offen offset:1024 sc1 lds
  s_add_u32 s30, s30, 4096
  s_add_u32 s30, s30, 27648
  s_waitcnt vmcnt(0)
  ds_read_b128 v[16:19], v4 offset:0
  ds_read_b128 v[20:23], v4 offset:1024
  ds_read_b128 v[24:27], v4 offset:2048
  ds_read_b128 v[28:31], v4 offset:3072
  ds_read_b128 v[32:35], v4 offset:4096
  ds_read_b128 v[36:39], v4 offset:5120
  ds_read_b128 v[40:43], v4 offset:6144
  ds_read_b128 v[44:47], v4 offset:7168
  ds_read_b128 v[48:51], v4 offset:8192
  ds_read_b128 v[52:55], v4 offset:9216
  s_waitcnt lgkmcnt(0)
  v_max_u32 v2, v16, v17
  v_max_u32 v8, v18, v19
  v_max3_u32 v2, v20, v21, v2
  v_max3_u32 v8, v22, v23, v8
  v_max3_u32 v2, v24, v25, v2
  v_max3_u32 v8, v26, v27, v8
  v_max3_u32 v2, v28, v29, v2
  v_max3_u32 v8, v30, v31, v8
  v_max3_u32 v2, v32, v33, v2
  v_max3_u32 v8, v34, v35, v8
  v_max3_u32 v2, v36, v37, v2
  v_max3_u32 v8, v38, v39, v8
  v_max3_u32 v2, v40, v41, v2
  v_max3_u32 v8, v42, v43, v8
  v_max3_u32 v2, v44, v45, v2
  v_max3_u32 v8, v46, v47, v8
  v_max3_u32 v2, v48, v49, v2
  v_max3_u32 v8, v50, v51, v8
  v_max3_u32 v2, v52, v53, v2
  v_max3_u32 v8, v54, v55, v8
  v_max_u32 v2, v2, v8
  v_cmp_eq_u32 vcc, -1, v2
  s_nop 4
  s_cbranch_vccz KOK_83
  s_sleep 8
  s_sub_u32 s51, s51, 1
  s_cmp_lg_u32 s51, 0
  s_cbranch_scc1 KW_82
KOK_83:
  v_cmp_gt_u32 vcc, 32, v1
  s_nop 1
  v_cndmask_b32 v84, 0, v128, vcc
  v_cndmask_b32 v92, 0, v129, vcc
  s_setprio 1
  s_mov_b32 s33, 0
  s_mov_b32 s39, 4
  s_barrier
  ds_read_b128 v[96:99], v5 offset:0
  ds_read_b32 v100, v6 offset:0
  s_waitcnt lgkmcnt(0)
  v_mfma_f32_32x32x16_bf16 v[16:31], v[96:99], v[80:83], 0
  v_mfma_f32_32x32x16_bf16 v[16:31], v[100:103], v[84:87], v[16:31]
  v_mfma_f32_32x32x16_bf16 v[32:47], v[96:99], v[88:91], 0
  v_mfma_f32_32x32x16_bf16 v[32:47], v[100:103], v[92:95], v[32:47]
  s_nop 9
  v_max3_f32 v8, v16, v17, v18
  v_max_f32 v8, v8, v19
  v_max3_f32 v8, v20, v21, v8
  v_max3_f32 v8, v22, v23, v8
  v_max3_f32 v8, v24, v25, v8
  v_max3_f32 v8, v26, v27, v8
  v_max3_f32 v8, v28, v29, v8
  v_max3_f32 v8, v30, v31, v8
  v_mov_b32 v2, v8
  s_nop 1
  v_permlane32_swap_b32 v8, v2
  v_max_f32 v8, v8, v2
  v_sub_f32 v2, 0xc2c00000, v8
  v_and_b32 v4, 0xffff0000, v2
  v_sub_f32 v2, v2, v4
  v_and_b32 v236, 0xffff0000, v2
  v_sub_f32 v2, v2, v236
  v_lshrrev_b32 v4, 16, v4
  v_or_b32 v4, v4, v236
  v_lshrrev_b32 v2, 16, v2
  v_cmp_gt_u32 vcc, 32, v1
  s_nop 1
  v_cndmask_b32 v85, 0, v4, vcc
  v_cndmask_b32 v86, 0, v2, vcc
  v_max3_f32 v9, v32, v33, v34
  v_max_f32 v9, v9, v35
  v_max3_f32 v9, v36, v37, v9
  v_max3_f32 v9, v38, v39, v9
  v_max3_f32 v9, v40, v41, v9
  v_max3_f32 v9, v42, v43, v9
  v_max3_f32 v9, v44, v45, v9
  v_max3_f32 v9, v46, v47, v9
  v_mov_b32 v2, v9
  s_nop 1
  v_permlane32_swap_b32 v9, v2
  v_max_f32 v9, v9, v2
  v_sub_f32 v2, 0xc2c00000, v9
  v_and_b32 v4, 0xffff0000, v2
  v_sub_f32 v2, v2, v4
  v_and_b32 v236, 0xffff0000, v2
  v_sub_f32 v2, v2, v236
  v_lshrrev_b32 v4, 16, v4
  v_or_b32 v4, v4, v236
  v_lshrrev_b32 v2, 16, v2
  v_cmp_gt_u32 vcc, 32, v1
  s_nop 1
  v_cndmask_b32 v93, 0, v4, vcc
  v_cndmask_b32 v94, 0, v2, vcc
ATT_PASS_84:
  ds_read_b128 v[96:99], v5 offset:0
  ds_read_b32 v100, v6 offset:0
  ds_read_b128 v[104:107], v5 offset:2496
  ds_read_b32 v108, v6 offset:2496
  ds_read_b64_tr_b16 v[112:113], v7 offset:0
  ds_read_b64_tr_b16 v[114:115], v7 offset:168
  ds_read_b64_tr_b16 v[116:117], v234 offset:0
  ds_read_b64_tr_b16 v[118:119], v235 offset:0
  v_mov_b32 v48, 0
  v_mov_b32 v49, 0
  v_mov_b32 v50, 0
  v_mov_b32 v51, 0
  v_mov_b32 v52, 0
  v_mov_b32 v53, 0
  v_mov_b32 v54, 0
  v_mov_b32 v55, 0
  v_mov_b32 v56, 0
  v_mov_b32 v57, 0
  v_mov_b32 v58, 0
  v_mov_b32 v59, 0
  v_mov_b32 v60, 0
  v_mov_b32 v61, 0
  v_mov_b32 v62, 0
  v_mov_b32 v63, 0
  v_mov_b32 v64, 0
  v_mov_b32 v65, 0
  v_mov_b32 v66, 0
  v_mov_b32 v67, 0
  v_mov_b32 v68, 0
  v_mov_b32 v69, 0
  v_mov_b32 v70, 0
  v_mov_b32 v71, 0
  v_mov_b32 v72, 0
  v_mov_b32 v73, 0
  v_mov_b32 v74, 0
  v_mov_b32 v75, 0
  v_mov_b32 v76, 0
  v_mov_b32 v77, 0
  v_mov_b32 v78, 0
  v_mov_b32 v79, 0
  v_mov_b32 v128, 0
  v_mov_b32 v248, 0
  v_mov_b32 v120, 0
  v_mov_b32 v129, 0
  v_mov_b32 v249, 0
  v_mov_b32 v121, 0
  v_mov_b32 v130, 0
  v_mov_b32 v250, 0
  v_mov_b32 v122, 0
  v_mov_b32 v131, 0
  v_mov_b32 v251, 0
  v_mov_b32 v123, 0
  v_mov_b32 v132, 0
  v_mov_b32 v252, 0
  v_mov_b32 v124, 0
  v_mov_b32 v133, 0
  v_mov_b32 v253, 0
  v_mov_b32 v125, 0
  v_mov_b32 v134, 0
  v_mov_b32 v254, 0
  v_mov_b32 v126, 0
  v_mov_b32 v135, 0
  v_mov_b32 v255, 0
  v_mov_b32 v127, 0
  s_mov_b32 s34, 0
  s_add_u32 s35, s31, 40960
  s_mov_b32 s37, 4294926336
  s_waitcnt lgkmcnt(0)
  v_mfma_f32_32x32x16_bf16 v[16:31], v[96:99], v[80:83], 0
  v_mfma_f32_32x32x16_bf16 v[16:31], v[100:103], v[84:87], v[16:31]
  s_nop 7
ATT_LOOP_85:
  s_waitcnt lgkmcnt(0)
  s_cmp_lg_u32 s34, 0
  s_cbranch_scc1 ATT_P_88
  s_setprio 1
ATT_P_88:
  v_mfma_f32_32x32x16_bf16 v[32:47], v[96:99], v[88:91], 0
  v_exp_f32 v16, v16
  v_exp_f32 v17, v17
  v_exp_f32 v18, v18
  v_exp_f32 v19, v19
  v_smfmac_f32_32x32x32_bf16 v[64:79], v[120:123], v[248:255], v13
  ds_read_b64_tr_b16 v[120:121], v7 offset:2496
  ds_read_b64_tr_b16 v[122:123], v7 offset:2664
  v_exp_f32 v20, v20
  v_exp_f32 v21, v21
  v_exp_f32 v22, v22
  v_exp_f32 v23, v23
  v_mfma_f32_32x32x16_bf16 v[32:47], v[100:103], v[92:95], v[32:47]
  v_cvt_pk_bf16_f32 v240, v16, v17
  v_cvt_pk_bf16_f32 v241, v18, v19
  v_cvt_pk_bf16_f32 v242, v20, v21
  v_cvt_pk_bf16_f32 v243, v22, v23
  v_exp_f32 v24, v24
  v_exp_f32 v25, v25
  v_exp_f32 v26, v26
  v_exp_f32 v27, v27
  v_smfmac_f32_16x16x64_bf16 v[132:135], v[124:127], v[248:255], v14
  ds_read_b64_tr_b16 v[124:125], v234 offset:2496
  ds_read_b64_tr_b16 v[126:127], v235 offset:2496
  v_exp_f32 v28, v28
  v_exp_f32 v29, v29
  v_exp_f32 v30, v30
  v_exp_f32 v31, v31
  v_cvt_pk_bf16_f32 v244, v24, v25
  v_cvt_pk_bf16_f32 v245, v26, v27
  v_cvt_pk_bf16_f32 v246, v28, v29
  v_cvt_pk_bf16_f32 v247, v30, v31
  v_mfma_f32_32x32x16_bf16 v[16:31], v[104:107], v[80:83], 0
  v_exp_f32 v32, v32
  v_exp_f32 v33, v33
  v_exp_f32 v34, v34
  v_exp_f32 v35, v35
  v_smfmac_f32_32x32x32_bf16 v[48:63], v[112:115], v[240:247], v13
  ds_read_b128 v[96:99], v5 offset:4992
  ds_read_b32 v100, v6 offset:4992
  v_exp_f32 v36, v36
  v_exp_f32 v37, v37
  v_exp_f32 v38, v38
  v_exp_f32 v39, v39
  v_mfma_f32_32x32x16_bf16 v[16:31], v[108:111], v[84:87], v[16:31]
  v_cvt_pk_bf16_f32 v248, v32, v33
  v_cvt_pk_bf16_f32 v249, v34, v35
  v_cvt_pk_bf16_f32 v250, v36, v37
  v_cvt_pk_bf16_f32 v251, v38, v39
  v_exp_f32 v40, v40
  v_exp_f32 v41, v41
  v_exp_f32 v42, v42
  v_exp_f32 v43, v43
  v_smfmac_f32_16x16x64_bf16 v[128:131], v[116:119], v[240:247], v14
  v_exp_f32 v44, v44
  v_exp_f32 v45, v45
  v_exp_f32 v46, v46
  v_exp_f32 v47, v47
  v_cvt_pk_bf16_f32 v252, v40, v41
  v_cvt_pk_bf16_f32 v253, v42, v43
  v_cvt_pk_bf16_f32 v254, v44, v45
  v_cvt_pk_bf16_f32 v255, v46, v47
  v_mfma_f32_32x32x16_bf16 v[32:47], v[104:107], v[88:91], 0
  v_exp_f32 v16, v16
  v_exp_f32 v17, v17
  v_exp_f32 v18, v18
  v_exp_f32 v19, v19
  v_smfmac_f32_32x32x32_bf16 v[64:79], v[112:115], v[248:255], v13
  ds_read_b64_tr_b16 v[112:113], v7 offset:4992
  ds_read_b64_tr_b16 v[114:115], v7 offset:5160
  v_exp_f32 v20, v20
  v_exp_f32 v21, v21
  v_exp_f32 v22, v22
  v_exp_f32 v23, v23
  v_mfma_f32_32x32x16_bf16 v[32:47], v[108:111], v[92:95], v[32:47]
  v_cvt_pk_bf16_f32 v240, v16, v17
  v_cvt_pk_bf16_f32 v241, v18, v19
  v_cvt_pk_bf16_f32 v242, v20, v21
  v_cvt_pk_bf16_f32 v243, v22, v23
  v_exp_f32 v24, v24
  v_exp_f32 v25, v25
  v_exp_f32 v26, v26
  v_exp_f32 v27, v27
  v_smfmac_f32_16x16x64_bf16 v[132:135], v[116:119], v[248:255], v14
  ds_read_b64_tr_b16 v[116:117], v234 offset:4992
  ds_read_b64_tr_b16 v[118:119], v235 offset:4992
  v_exp_f32 v28, v28
  v_exp_f32 v29, v29
  v_exp_f32 v30, v30
  v_exp_f32 v31, v31
  v_cvt_pk_bf16_f32 v244, v24, v25
  v_cvt_pk_bf16_f32 v245, v26, v27
  v_cvt_pk_bf16_f32 v246, v28, v29
  v_cvt_pk_bf16_f32 v247, v30, v31
  s_waitcnt lgkmcnt(4)
  v_mfma_f32_32x32x16_bf16 v[16:31], v[96:99], v[80:83], 0
  v_exp_f32 v32, v32
  v_exp_f32 v33, v33
  v_exp_f32 v34, v34
  v_exp_f32 v35, v35
  v_smfmac_f32_32x32x32_bf16 v[48:63], v[120:123], v[240:247], v13
  ds_read_b128 v[104:107], v5 offset:7488
  ds_read_b32 v108, v6 offset:7488
  v_exp_f32 v36, v36
  v_exp_f32 v37, v37
  v_exp_f32 v38, v38
  v_exp_f32 v39, v39
  v_mfma_f32_32x32x16_bf16 v[16:31], v[100:103], v[84:87], v[16:31]
  v_cvt_pk_bf16_f32 v248, v32, v33
  v_cvt_pk_bf16_f32 v249, v34, v35
  v_cvt_pk_bf16_f32 v250, v36, v37
  v_cvt_pk_bf16_f32 v251, v38, v39
  v_exp_f32 v40, v40
  v_exp_f32 v41, v41
  v_exp_f32 v42, v42
  v_exp_f32 v43, v43
  v_smfmac_f32_16x16x64_bf16 v[128:131], v[124:127], v[240:247], v14
  v_exp_f32 v44, v44
  v_exp_f32 v45, v45
  v_exp_f32 v46, v46
  v_exp_f32 v47, v47
  v_cvt_pk_bf16_f32 v252, v40, v41
  v_cvt_pk_bf16_f32 v253, v42, v43
  v_cvt_pk_bf16_f32 v254, v44, v45
  v_cvt_pk_bf16_f32 v255, v46, v47
  s_cmp_lg_u32 s39, 4
  s_cbranch_scc1 ATT_C1_89
  s_setprio 3
  buffer_load_dwordx2 v[138:139], v230, s[12:15], s49 offen sc0 sc1
  s_setprio 1
ATT_C1_89:
  v_mfma_f32_32x32x16_bf16 v[32:47], v[96:99], v[88:91], 0
  v_exp_f32 v16, v16
  v_exp_f32 v17, v17
  v_exp_f32 v18, v18
  v_exp_f32 v19, v19
  v_smfmac_f32_32x32x32_bf16 v[64:79], v[120:123], v[248:255], v13
  ds_read_b64_tr_b16 v[120:121], v7 offset:7488
  ds_read_b64_tr_b16 v[122:123], v7 offset:7656
  v_exp_f32 v20, v20
  v_exp_f32 v21, v21
  v_exp_f32 v22, v22
  v_exp_f32 v23, v23
  v_mfma_f32_32x32x16_bf16 v[32:47], v[100:103], v[92:95], v[32:47]
  v_cvt_pk_bf16_f32 v240, v16, v17
  v_cvt_pk_bf16_f32 v241, v18, v19
  v_cvt_pk_bf16_f32 v242, v20, v21
  v_cvt_pk_bf16_f32 v243, v22, v23
  v_exp_f32 v24, v24
  v_exp_f32 v25, v25
  v_exp_f32 v26, v26
  v_exp_f32 v27, v27
  v_smfmac_f32_16x16x64_bf16 v[132:135], v[124:127], v[248:255], v14
  ds_read_b64_tr_b16 v[124:125], v234 offset:7488
  ds_read_b64_tr_b16 v[126:127], v235 offset:7488
  v_exp_f32 v28, v28
  v_exp_f32 v29, v29
  v_exp_f32 v30, v30
  v_exp_f32 v31, v31
  v_cvt_pk_bf16_f32 v244, v24, v25
  v_cvt_pk_bf16_f32 v245, v26, v27
  v_cvt_pk_bf16_f32 v246, v28, v29
  v_cvt_pk_bf16_f32 v247, v30, v31
  s_waitcnt lgkmcnt(4)
  v_mfma_f32_32x32x16_bf16 v[16:31], v[104:107], v[80:83], 0
  v_exp_f32 v32, v32
  v_exp_f32 v33, v33
  v_exp_f32 v34, v34
  v_exp_f32 v35, v35
  v_smfmac_f32_32x32x32_bf16 v[48:63], v[112:115], v[240:247], v13
  ds_read_b128 v[96:99], v5 offset:9984
  ds_read_b32 v100, v6 offset:9984
  v_exp_f32 v36, v36
  v_exp_f32 v37, v37
  v_exp_f32 v38, v38
  v_exp_f32 v39, v39
  v_mfma_f32_32x32x16_bf16 v[16:31], v[108:111], v[84:87], v[16:31]
  v_cvt_pk_bf16_f32 v248, v32, v33
  v_cvt_pk_bf16_f32 v249, v34, v35
  v_cvt_pk_bf16_f32 v250, v36, v37
  v_cvt_pk_bf16_f32 v251, v38, v39
  v_exp_f32 v40, v40
  v_exp_f32 v41, v41
  v_exp_f32 v42, v42
  v_exp_f32 v43, v43
  v_smfmac_f32_16x16x64_bf16 v[128:131], v[116:119], v[240:247], v14
  v_exp_f32 v44, v44
  v_exp_f32 v45, v45
  v_exp_f32 v46, v46
  v_exp_f32 v47, v47
  v_cvt_pk_bf16_f32 v252, v40, v41
  v_cvt_pk_bf16_f32 v253, v42, v43
  v_cvt_pk_bf16_f32 v254, v44, v45
  v_cvt_pk_bf16_f32 v255, v46, v47
  v_mfma_f32_32x32x16_bf16 v[32:47], v[104:107], v[88:91], 0
  v_exp_f32 v16, v16
  v_exp_f32 v17, v17
  v_exp_f32 v18, v18
  v_exp_f32 v19, v19
  v_smfmac_f32_32x32x32_bf16 v[64:79], v[112:115], v[248:255], v13
  ds_read_b64_tr_b16 v[112:113], v7 offset:9984
  ds_read_b64_tr_b16 v[114:115], v7 offset:10152
  v_exp_f32 v20, v20
  v_exp_f32 v21, v21
  v_exp_f32 v22, v22
  v_exp_f32 v23, v23
  v_mfma_f32_32x32x16_bf16 v[32:47], v[108:111], v[92:95], v[32:47]
  v_cvt_pk_bf16_f32 v240, v16, v17
  v_cvt_pk_bf16_f32 v241, v18, v19
  v_cvt_pk_bf16_f32 v242, v20, v21
  v_cvt_pk_bf16_f32 v243, v22, v23
  v_exp_f32 v24, v24
  v_exp_f32 v25, v25
  v_exp_f32 v26, v26
  v_exp_f32 v27, v27
  v_smfmac_f32_16x16x64_bf16 v[132:135], v[116:119], v[248:255], v14
  ds_read_b64_tr_b16 v[116:117], v234 offset:9984
  ds_read_b64_tr_b16 v[118:119], v235 offset:9984
  v_exp_f32 v28, v28
  v_exp_f32 v29, v29
  v_exp_f32 v30, v30
  v_exp_f32 v31, v31
  v_cvt_pk_bf16_f32 v244, v24, v25
  v_cvt_pk_bf16_f32 v245, v26, v27
  v_cvt_pk_bf16_f32 v246, v28, v29
  v_cvt_pk_bf16_f32 v247, v30, v31
  s_waitcnt lgkmcnt(4)
  v_mfma_f32_32x32x16_bf16 v[16:31], v[96:99], v[80:83], 0
  v_exp_f32 v32, v32
  v_exp_f32 v33, v33
  v_exp_f32 v34, v34
  v_exp_f32 v35, v35
  v_smfmac_f32_32x32x32_bf16 v[48:63], v[120:123], v[240:247], v13
  ds_read_b128 v[104:107], v5 offset:12480
  ds_read_b32 v108, v6 offset:12480
  v_exp_f32 v36, v36
  v_exp_f32 v37, v37
  v_exp_f32 v38, v38
  v_exp_f32 v39, v39
  v_mfma_f32_32x32x16_bf16 v[16:31], v[100:103], v[84:87], v[16:31]
  v_cvt_pk_bf16_f32 v248, v32, v33
  v_cvt_pk_bf16_f32 v249, v34, v35
  v_cvt_pk_bf16_f32 v250, v36, v37
  v_cvt_pk_bf16_f32 v251, v38, v39
  v_exp_f32 v40, v40
  v_exp_f32 v41, v41
  v_exp_f32 v42, v42
  v_exp_f32 v43, v43
  v_smfmac_f32_16x16x64_bf16 v[128:131], v[124:127], v[240:247], v14
  v_exp_f32 v44, v44
  v_exp_f32 v45, v45
  v_exp_f32 v46, v46
  v_exp_f32 v47, v47
  v_cvt_pk_bf16_f32 v252, v40, v41
  v_cvt_pk_bf16_f32 v253, v42, v43
  v_cvt_pk_bf16_f32 v254, v44, v45
  v_cvt_pk_bf16_f32 v255, v46, v47
  s_cmp_lg_u32 s39, 1
  s_cbranch_scc1 ATT_S1_90
  s_waitcnt vmcnt(0)
  s_setprio 3
  s_cmp_eq_u32 s20, 3
  s_cbranch_scc1 SJ_G_91
  s_cmp_ge_u32 s63, 720
  s_cbranch_scc1 SJ_E_92
  ds_read_b64_tr_b16 v[148:149], v141 offset:0
  ds_read_b64_tr_b16 v[150:151], v141 offset:1024
  ds_read_b64_tr_b16 v[152:153], v141 offset:8
  ds_read_b64_tr_b16 v[154:155], v141 offset:1032
  ds_read_b64_tr_b16 v[156:157], v141 offset:64
  ds_read_b64_tr_b16 v[158:159], v141 offset:1088
  ds_read_b64_tr_b16 v[160:161], v141 offset:72
  ds_read_b64_tr_b16 v[162:163], v141 offset:1096
  ds_read_b64_tr_b16 v[164:165], v142 offset:128
  ds_read_b64_tr_b16 v[166:167], v142 offset:1152
  s_mul_i32 s44, s64, 90
  s_add_u32 s44, s44, s65
  s_mul_i32 s44, s44, 4608
  s_add_u32 s44, s44, 21299200
  s_waitcnt lgkmcnt(0)
  buffer_store_dwordx4 v[148:151], v10, s[12:15], s44 offen offset:0 sc0 sc1
  buffer_store_dwordx4 v[152:155], v10, s[12:15], s44 offen offset:1024 sc0 sc1
  buffer_store_dwordx4 v[156:159], v10, s[12:15], s44 offen offset:2048 sc0 sc1
  buffer_store_dwordx4 v[160:163], v10, s[12:15], s44 offen offset:3072 sc0 sc1
  s_mov_b32 exec_lo, 0x00ff00ff
  s_mov_b32 exec_hi, 0x00ff00ff
  buffer_store_dwordx4 v[164:167], v143, s[12:15], s44 offen sc0 sc1
  s_mov_b64 exec, -1
  s_branch SJ_E_92
SJ_G_91:
  v_mov_b32 v144, 0
  v_mov_b32 v145, 0
  v_dot2c_f32_bf16 v144, v148, v184
  v_dot2c_f32_bf16 v145, v149, v185
  v_dot2c_f32_bf16 v144, v150, v186
  v_dot2c_f32_bf16 v145, v151, v187
  v_dot2c_f32_bf16 v144, v152, v188
  v_dot2c_f32_bf16 v145, v153, v189
  v_dot2c_f32_bf16 v144, v154, v190
  v_dot2c_f32_bf16 v145, v155, v191
  v_dot2c_f32_bf16 v144, v156, v192
  v_dot2c_f32_bf16 v145, v157, v193
  v_dot2c_f32_bf16 v144, v158, v194
  v_dot2c_f32_bf16 v145, v159, v195
  v_dot2c_f32_bf16 v144, v160, v196
  v_dot2c_f32_bf16 v145, v161, v197
  v_dot2c_f32_bf16 v144, v162, v198
  v_dot2c_f32_bf16 v145, v163, v199
  v_dot2c_f32_bf16 v144, v164, v200
  v_dot2c_f32_bf16 v145, v165, v201
  v_dot2c_f32_bf16 v144, v166, v202
  v_dot2c_f32_bf16 v145, v167, v203
  v_dot2c_f32_bf16 v144, v168, v204
  v_dot2c_f32_bf16 v145, v169, v205
  v_dot2c_f32_bf16 v144, v170, v206
  v_dot2c_f32_bf16 v145, v171, v207
  v_dot2c_f32_bf16 v144, v172, v208
  v_dot2c_f32_bf16 v145, v173, v209
  v_dot2c_f32_bf16 v144, v174, v210
  v_dot2c_f32_bf16 v145, v175, v211
  v_dot2c_f32_bf16 v144, v176, v212
  v_dot2c_f32_bf16 v145, v177, v213
  v_dot2c_f32_bf16 v144, v178, v214
  v_dot2c_f32_bf16 v145, v179, v215
  v_dot2c_f32_bf16 v144, v180, v216
  v_dot2c_f32_bf16 v145, v181, v217
  v_dot2c_f32_bf16 v144, v182, v218
  v_dot2c_f32_bf16 v145, v183, v219
  s_nop 3
  v_add_f32 v144, v144, v145
  s_nop 1
  v_add_f32_dpp v144, v144, v144 quad_perm:[1,0,3,2] row_mask:0xf bank_mask:0xf
  s_nop 1
  v_add_f32_dpp v144, v144, v144 quad_perm:[2,3,0,1] row_mask:0xf bank_mask:0xf
  s_nop 1
  v_add_f32_dpp v144, v144, v144 row_half_mirror row_mask:0xf bank_mask:0xf
  v_mul_f32 v144, 0xbfb8aa3b, v144
  v_exp_f32 v144, v144
  s_nop 0
  v_add_f32 v144, 1.0, v144
  v_rcp_f32 v144, v144
  v_mov_b32 v145, s62
  v_lshlrev_b32 v140, 3, v140
  s_mov_b32 s44, 24780800
  s_mov_b32 exec_lo, 0x01010101
  s_mov_b32 exec_hi, 0x01010101
  buffer_store_dwordx2 v[144:145], v140, s[12:15], s44 offen sc0 sc1
  s_mov_b64 exec, -1
SJ_E_92:
  s_add_u32 m0, s31, 40960
  s_nop 0
  buffer_load_dwordx4 v15, s[12:15], s30 offen offset:0 sc1 lds
  buffer_load_dwordx4 v15, s[12:15], s30 offen offset:1024 sc1 lds
  buffer_load_dwordx4 v15, s[12:15], s30 offen offset:2048 sc1 lds
  buffer_load_dwordx4 v15, s[12:15], s30 offen offset:3072 sc1 lds
  s_add_u32 s30, s30, 4096
  s_add_u32 m0, s31, 45056
  s_nop 0
  buffer_load_dwordx4 v15, s[12:15], s30 offen offset:0 sc1 lds
  buffer_load_dwordx4 v15, s[12:15], s30 offen offset:1024 sc1 lds
  buffer_load_dwordx4 v15, s[12:15], s30 offen offset:2048 sc1 lds
  buffer_load_dwordx4 v15, s[12:15], s30 offen offset:3072 sc1 lds
  s_add_u32 s30, s30, 4096
  s_add_u32 m0, s31, 49152
  s_nop 0
  buffer_load_dwordx4 v15, s[12:15], s30 offen offset:0 sc1 lds
  buffer_load_dwordx4 v15, s[12:15], s30 offen offset:1024 sc1 lds
  s_add_u32 s30, s30, 4096
  s_add_u32 s30, s30, 27648
  s_mov_b32 s39, 2
  s_setprio 1
ATT_S1_90:
  v_mfma_f32_32x32x16_bf16 v[32:47], v[96:99], v[88:91], 0
  v_exp_f32 v16, v16
  v_exp_f32 v17, v17
  v_exp_f32 v18, v18
  v_exp_f32 v19, v19
  v_smfmac_f32_32x32x32_bf16 v[64:79], v[120:123], v[248:255], v13
  ds_read_b64_tr_b16 v[120:121], v7 offset:12480
  ds_read_b64_tr_b16 v[122:123], v7 offset:12648
  v_exp_f32 v20, v20
  v_exp_f32 v21, v21
  v_exp_f32 v22, v22
  v_exp_f32 v23, v23
  v_mfma_f32_32x32x16_bf16 v[32:47], v[100:103], v[92:95], v[32:47]
  v_cvt_pk_bf16_f32 v240, v16, v17
  v_cvt_pk_bf16_f32 v241, v18, v19
  v_cvt_pk_bf16_f32 v242, v20, v21
  v_cvt_pk_bf16_f32 v243, v22, v23
  v_exp_f32 v24, v24
  v_exp_f32 v25, v25
  v_exp_f32 v26, v26
  v_exp_f32 v27, v27
  v_smfmac_f32_16x16x64_bf16 v[132:135], v[124:127], v[248:255], v14
  ds_read_b64_tr_b16 v[124:125], v234 offset:12480
  ds_read_b64_tr_b16 v[126:127], v235 offset:12480
  v_exp_f32 v28, v28
  v_exp_f32 v29, v29
  v_exp_f32 v30, v30
  v_exp_f32 v31, v31
  v_cvt_pk_bf16_f32 v244, v24, v25
  v_cvt_pk_bf16_f32 v245, v26, v27
  v_cvt_pk_bf16_f32 v246, v28, v29
  v_cvt_pk_bf16_f32 v247, v30, v31
  s_cmp_ge_u32 s54, s55
  s_cbranch_scc1 ATT_M_93
  s_setprio 3
  buffer_store_dwordx4 v[224:227], v10, s[12:15], s54 offen sc0 sc1
  s_add_u32 s54, s54, 1024
  s_setprio 1
ATT_M_93:
  s_waitcnt lgkmcnt(4)
  v_mfma_f32_32x32x16_bf16 v[16:31], v[104:107], v[80:83], 0
  v_exp_f32 v32, v32
  v_exp_f32 v33, v33
  v_exp_f32 v34, v34
  v_exp_f32 v35, v35
  v_smfmac_f32_32x32x32_bf16 v[48:63], v[112:115], v[240:247], v13
  ds_read_b128 v[96:99], v5 offset:14976
  ds_read_b32 v100, v6 offset:14976
  v_exp_f32 v36, v36
  v_exp_f32 v37, v37
  v_exp_f32 v38, v38
  v_exp_f32 v39, v39
  v_mfma_f32_32x32x16_bf16 v[16:31], v[108:111], v[84:87], v[16:31]
  v_cvt_pk_bf16_f32 v248, v32, v33
  v_cvt_pk_bf16_f32 v249, v34, v35
  v_cvt_pk_bf16_f32 v250, v36, v37
  v_cvt_pk_bf16_f32 v251, v38, v39
  v_exp_f32 v40, v40
  v_exp_f32 v41, v41
  v_exp_f32 v42, v42
  v_exp_f32 v43, v43
  v_smfmac_f32_16x16x64_bf16 v[128:131], v[116:119], v[240:247], v14
  v_exp_f32 v44, v44
  v_exp_f32 v45, v45
  v_exp_f32 v46, v46
  v_exp_f32 v47, v47
  v_cvt_pk_bf16_f32 v252, v40, v41
  v_cvt_pk_bf16_f32 v253, v42, v43
  v_cvt_pk_bf16_f32 v254, v44, v45
  v_cvt_pk_bf16_f32 v255, v46, v47
  s_cmp_lg_u32 s39, 4
  s_cbranch_scc1 ATT_C1_94
  s_setprio 3
  s_waitcnt vmcnt(0)
  s_mov_b32 s51, 300000
  s_branch POLLC_96
POLL_95:
  buffer_load_dwordx2 v[138:139], v230, s[12:15], s49 offen sc0 sc1
  s_waitcnt vmcnt(0)
POLLC_96:
  v_xor_b32 v236, s62, v138
  v_xor_b32 v237, s62, v139
  v_or_b32 v236, v236, v237
  v_cmp_ne_u32 vcc, 0, v236
  s_nop 4
  s_cbranch_vccz POLLOK_97
  s_sleep 6
  s_sub_u32 s51, s51, 1
  s_cmp_lg_u32 s51, 0
  s_cbranch_scc1 POLL_95
POLLOK_97:
  s_add_u32 m0, s31, 0
  s_nop 0
  buffer_load_dwordx4 v15, s[12:15], s30 offen offset:0 sc1 lds
  buffer_load_dwordx4 v15, s[12:15], s30 offen offset:1024 sc1 lds
  buffer_load_dwordx4 v15, s[12:15], s30 offen offset:2048 sc1 lds
  buffer_load_dwordx4 v15, s[12:15], s30 offen offset:3072 sc1 lds
  s_add_u32 s30, s30, 4096
  s_add_u32 m0, s31, 4096
  s_nop 0
  buffer_load_dwordx4 v15, s[12:15], s30 offen offset:0 sc1 lds
  buffer_load_dwordx4 v15, s[12:15], s30 offen offset:1024 sc1 lds
  buffer_load_dwordx4 v15, s[12:15], s30 offen offset:2048 sc1 lds
  buffer_load_dwordx4 v15, s[12:15], s30 offen offset:3072 sc1 lds
  s_add_u32 s30, s30, 4096
  s_add_u32 m0, s31, 8192
  s_nop 0
  buffer_load_dwordx4 v15, s[12:15], s30 offen offset:0 sc1 lds
  buffer_load_dwordx4 v15, s[12:15], s30 offen offset:1024 sc1 lds
  s_add_u32 s30, s30, 4096
  s_add_u32 s30, s30, 27648
  buffer_store_dwordx4 v[224:227], v10, s[12:15], s52 offen offset:0 sc0 sc1
  buffer_store_dwordx4 v[224:227], v10, s[12:15], s52 offen offset:1024 sc0 sc1
  buffer_store_dword v224, v228, s[12:15], s53 offen sc0 sc1
  s_mov_b32 s39, 0
  s_setprio 1
ATT_C1_94:
  v_mfma_f32_32x32x16_bf16 v[32:47], v[104:107], v[88:91], 0
  v_exp_f32 v16, v16
  v_exp_f32 v17, v17
  v_exp_f32 v18, v18
  v_exp_f32 v19, v19
  v_smfmac_f32_32x32x32_bf16 v[64:79], v[112:115], v[248:255], v13
  ds_read_b64_tr_b16 v[112:113], v7 offset:14976
  ds_read_b64_tr_b16 v[114:115], v7 offset:15144
  v_exp_f32 v20, v20
  v_exp_f32 v21, v21
  v_exp_f32 v22, v22
  v_exp_f32 v23, v23
  v_mfma_f32_32x32x16_bf16 v[32:47], v[108:111], v[92:95], v[32:47]
  v_cvt_pk_bf16_f32 v240, v16, v17
  v_cvt_pk_bf16_f32 v241, v18, v19
  v_cvt_pk_bf16_f32 v242, v20, v21
  v_cvt_pk_bf16_f32 v243, v22, v23
  v_exp_f32 v24, v24
  v_exp_f32 v25, v25
  v_exp_f32 v26, v26
  v_exp_f32 v27, v27
  v_smfmac_f32_16x16x64_bf16 v[132:135], v[116:119], v[248:255], v14
  ds_read_b64_tr_b16 v[116:117], v234 offset:14976
  ds_read_b64_tr_b16 v[118:119], v235 offset:14976
  v_exp_f32 v28, v28
  v_exp_f32 v29, v29
  v_exp_f32 v30, v30
  v_exp_f32 v31, v31
  v_cvt_pk_bf16_f32 v244, v24, v25
  v_cvt_pk_bf16_f32 v245, v26, v27
  v_cvt_pk_bf16_f32 v246, v28, v29
  v_cvt_pk_bf16_f32 v247, v30, v31
  s_waitcnt lgkmcnt(4)
  v_mfma_f32_32x32x16_bf16 v[16:31], v[96:99], v[80:83], 0
  v_exp_f32 v32, v32
  v_exp_f32 v33, v33
  v_exp_f32 v34, v34
  v_exp_f32 v35, v35
  v_smfmac_f32_32x32x32_bf16 v[48:63], v[120:123], v[240:247], v13
  ds_read_b128 v[104:107], v5 offset:17472
  ds_read_b32 v108, v6 offset:17472
  v_exp_f32 v36, v36
  v_exp_f32 v37, v37
  v_exp_f32 v38, v38
  v_exp_f32 v39, v39
  v_mfma_f32_32x32x16_bf16 v[16:31], v[100:103], v[84:87], v[16:31]
  v_cvt_pk_bf16_f32 v248, v32, v33
  v_cvt_pk_bf16_f32 v249, v34, v35
  v_cvt_pk_bf16_f32 v250, v36, v37
  v_cvt_pk_bf16_f32 v251, v38, v39
  v_exp_f32 v40, v40
  v_exp_f32 v41, v41
  v_exp_f32 v42, v42
  v_exp_f32 v43, v43
  v_smfmac_f32_16x16x64_bf16 v[128:131], v[124:127], v[240:247], v14
  v_exp_f32 v44, v44
  v_exp_f32 v45, v45
  v_exp_f32 v46, v46
  v_exp_f32 v47, v47
  v_cvt_pk_bf16_f32 v252, v40, v41
  v_cvt_pk_bf16_f32 v253, v42, v43
  v_cvt_pk_bf16_f32 v254, v44, v45
  v_cvt_pk_bf16_f32 v255, v46, v47
  v_mfma_f32_32x32x16_bf16 v[32:47], v[96:99], v[88:91], 0
  v_exp_f32 v16, v16
  v_exp_f32 v17, v17
  v_exp_f32 v18, v18
  v_exp_f32 v19, v19
  v_smfmac_f32_32x32x32_bf16 v[64:79], v[120:123], v[248:255], v13
  ds_read_b64_tr_b16 v[120:121], v7 offset:17472
  ds_read_b64_tr_b16 v[122:123], v7 offset:17640
  v_exp_f32 v20, v20
  v_exp_f32 v21, v21
  v_exp_f32 v22, v22
  v_exp_f32 v23, v23
  v_mfma_f32_32x32x16_bf16 v[32:47], v[100:103], v[92:95], v[32:47]
  v_cvt_pk_bf16_f32 v240, v16, v17
  v_cvt_pk_bf16_f32 v241, v18, v19
  v_cvt_pk_bf16_f32 v242, v20, v21
  v_cvt_pk_bf16_f32 v243, v22, v23
  v_exp_f32 v24, v24
  v_exp_f32 v25, v25
  v_exp_f32 v26, v26
  v_exp_f32 v27, v27
  v_smfmac_f32_16x16x64_bf16 v[132:135], v[124:127], v[248:255], v14
  ds_read_b64_tr_b16 v[124:125], v234 offset:17472
  ds_read_b64_tr_b16 v[126:127], v235 offset:17472
  v_exp_f32 v28, v28
  v_exp_f32 v29, v29
  v_exp_f32 v30, v30
  v_exp_f32 v31, v31
  v_cvt_pk_bf16_f32 v244, v24, v25
  v_cvt_pk_bf16_f32 v245, v26, v27
  v_cvt_pk_bf16_f32 v246, v28, v29
  v_cvt_pk_bf16_f32 v247, v30, v31
  s_cmp_ge_u32 s54, s55
  s_cbranch_scc1 ATT_M_98
  s_setprio 3
  buffer_store_dwordx4 v[224:227], v10, s[12:15], s54 offen sc0 sc1
  s_add_u32 s54, s54, 1024
  s_setprio 1
ATT_M_98:
  s_waitcnt lgkmcnt(4)
  v_mfma_f32_32x32x16_bf16 v[16:31], v[104:107], v[80:83], 0
  v_exp_f32 v32, v32
  v_exp_f32 v33, v33
  v_exp_f32 v34, v34
  v_exp_f32 v35, v35
  v_smfmac_f32_32x32x32_bf16 v[48:63], v[112:115], v[240:247], v13
  ds_read_b128 v[96:99], v5 offset:19968
  ds_read_b32 v100, v6 offset:19968
  v_exp_f32 v36, v36
  v_exp_f32 v37, v37
  v_exp_f32 v38, v38
  v_exp_f32 v39, v39
  v_mfma_f32_32x32x16_bf16 v[16:31], v[108:111], v[84:87], v[16:31]
  v_cvt_pk_bf16_f32 v248, v32, v33
  v_cvt_pk_bf16_f32 v249, v34, v35
  v_cvt_pk_bf16_f32 v250, v36, v37
  v_cvt_pk_bf16_f32 v251, v38, v39
  v_exp_f32 v40, v40
  v_exp_f32 v41, v41
  v_exp_f32 v42, v42
  v_exp_f32 v43, v43
  v_smfmac_f32_16x16x64_bf16 v[128:131], v[116:119], v[240:247], v14
  v_exp_f32 v44, v44
  v_exp_f32 v45, v45
  v_exp_f32 v46, v46
  v_exp_f32 v47, v47
  v_cvt_pk_bf16_f32 v252, v40, v41
  v_cvt_pk_bf16_f32 v253, v42, v43
  v_cvt_pk_bf16_f32 v254, v44, v45
  v_cvt_pk_bf16_f32 v255, v46, v47
  v_mfma_f32_32x32x16_bf16 v[32:47], v[104:107], v[88:91], 0
  v_exp_f32 v16, v16
  v_exp_f32 v17, v17
  v_exp_f32 v18, v18
  v_exp_f32 v19, v19
  v_smfmac_f32_32x32x32_bf16 v[64:79], v[112:115], v[248:255], v13
  ds_read_b64_tr_b16 v[112:113], v7 offset:19968
  ds_read_b64_tr_b16 v[114:115], v7 offset:20136
  v_exp_f32 v20, v20
  v_exp_f32 v21, v21
  v_exp_f32 v22, v22
  v_exp_f32 v23, v23
  v_mfma_f32_32x32x16_bf16 v[32:47], v[108:111], v[92:95], v[32:47]
  v_cvt_pk_bf16_f32 v240, v16, v17
  v_cvt_pk_bf16_f32 v241, v18, v19
  v_cvt_pk_bf16_f32 v242, v20, v21
  v_cvt_pk_bf16_f32 v243, v22, v23
  v_exp_f32 v24, v24
  v_exp_f32 v25, v25
  v_exp_f32 v26, v26
  v_exp_f32 v27, v27
  v_smfmac_f32_16x16x64_bf16 v[132:135], v[116:119], v[248:255], v14
  ds_read_b64_tr_b16 v[116:117], v234 offset:19968
  ds_read_b64_tr_b16 v[118:119], v235 offset:19968
  v_exp_f32 v28, v28
  v_exp_f32 v29, v29
  v_exp_f32 v30, v30
  v_exp_f32 v31, v31
  v_cvt_pk_bf16_f32 v244, v24, v25
  v_cvt_pk_bf16_f32 v245, v26, v27
  v_cvt_pk_bf16_f32 v246, v28, v29
  v_cvt_pk_bf16_f32 v247, v30, v31
  s_waitcnt lgkmcnt(4)
  v_mfma_f32_32x32x16_bf16 v[16:31], v[96:99], v[80:83], 0
  v_exp_f32 v32, v32
  v_exp_f32 v33, v33
  v_exp_f32 v34, v34
  v_exp_f32 v35, v35
  v_smfmac_f32_32x32x32_bf16 v[48:63], v[120:123], v[240:247], v13
  ds_read_b128 v[104:107], v5 offset:22464
  ds_read_b32 v108, v6 offset:22464
  v_exp_f32 v36, v36
  v_exp_f32 v37, v37
  v_exp_f32 v38, v38
  v_exp_f32 v39, v39
  v_mfma_f32_32x32x16_bf16 v[16:31], v[100:103], v[84:87], v[16:31]
  v_cvt_pk_bf16_f32 v248, v32, v33
  v_cvt_pk_bf16_f32 v249, v34, v35
  v_cvt_pk_bf16_f32 v250, v36, v37
  v_cvt_pk_bf16_f32 v251, v38, v39
  v_exp_f32 v40, v40
  v_exp_f32 v41, v41
  v_exp_f32 v42, v42
  v_exp_f32 v43, v43
  v_smfmac_f32_16x16x64_bf16 v[128:131], v[124:127], v[240:247], v14
  v_exp_f32 v44, v44
  v_exp_f32 v45, v45
  v_exp_f32 v46, v46
  v_exp_f32 v47, v47
  v_cvt_pk_bf16_f32 v252, v40, v41
  v_cvt_pk_bf16_f32 v253, v42, v43
  v_cvt_pk_bf16_f32 v254, v44, v45
  v_cvt_pk_bf16_f32 v255, v46, v47
  v_mfma_f32_32x32x16_bf16 v[32:47], v[96:99], v[88:91], 0
  v_exp_f32 v16, v16
  v_exp_f32 v17, v17
  v_exp_f32 v18, v18
  v_exp_f32 v19, v19
  v_smfmac_f32_32x32x32_bf16 v[64:79], v[120:123], v[248:255], v13
  ds_read_b64_tr_b16 v[120:121], v7 offset:22464
  ds_read_b64_tr_b16 v[122:123], v7 offset:22632
  v_exp_f32 v20, v20
  v_exp_f32 v21, v21
  v_exp_f32 v22, v22
  v_exp_f32 v23, v23
  v_mfma_f32_32x32x16_bf16 v[32:47], v[100:103], v[92:95], v[32:47]
  v_cvt_pk_bf16_f32 v240, v16, v17
  v_cvt_pk_bf16_f32 v241, v18, v19
  v_cvt_pk_bf16_f32 v242, v20, v21
  v_cvt_pk_bf16_f32 v243, v22, v23
  v_exp_f32 v24, v24
  v_exp_f32 v25, v25
  v_exp_f32 v26, v26
  v_exp_f32 v27, v27
  v_smfmac_f32_16x16x64_bf16 v[132:135], v[124:127], v[248:255], v14
  ds_read_b64_tr_b16 v[124:125], v234 offset:22464
  ds_read_b64_tr_b16 v[126:127], v235 offset:22464
  v_exp_f32 v28, v28
  v_exp_f32 v29, v29
  v_exp_f32 v30, v30
  v_exp_f32 v31, v31
  v_cvt_pk_bf16_f32 v244, v24, v25
  v_cvt_pk_bf16_f32 v245, v26, v27
  v_cvt_pk_bf16_f32 v246, v28, v29
  v_cvt_pk_bf16_f32 v247, v30, v31
  s_cmp_ge_u32 s54, s55
  s_cbranch_scc1 ATT_M_99
  s_setprio 3
  buffer_store_dwordx4 v[224:227], v10, s[12:15], s54 offen sc0 sc1
  s_add_u32 s54, s54, 1024
  s_setprio 1
ATT_M_99:
  s_waitcnt lgkmcnt(4)
  v_mfma_f32_32x32x16_bf16 v[16:31], v[104:107], v[80:83], 0
  v_exp_f32 v32, v32
  v_exp_f32 v33, v33
  v_exp_f32 v34, v34
  v_exp_f32 v35, v35
  v_smfmac_f32_32x32x32_bf16 v[48:63], v[112:115], v[240:247], v13
  ds_read_b128 v[96:99], v5 offset:24960
  ds_read_b32 v100, v6 offset:24960
  v_exp_f32 v36, v36
  v_exp_f32 v37, v37
  v_exp_f32 v38, v38
  v_exp_f32 v39, v39
  v_mfma_f32_32x32x16_bf16 v[16:31], v[108:111], v[84:87], v[16:31]
  v_cvt_pk_bf16_f32 v248, v32, v33
  v_cvt_pk_bf16_f32 v249, v34, v35
  v_cvt_pk_bf16_f32 v250, v36, v37
  v_cvt_pk_bf16_f32 v251, v38, v39
  v_exp_f32 v40, v40
  v_exp_f32 v41, v41
  v_exp_f32 v42, v42
  v_exp_f32 v43, v43
  v_smfmac_f32_16x16x64_bf16 v[128:131], v[116:119], v[240:247], v14
  v_exp_f32 v44, v44
  v_exp_f32 v45, v45
  v_exp_f32 v46, v46
  v_exp_f32 v47, v47
  v_cvt_pk_bf16_f32 v252, v40, v41
  v_cvt_pk_bf16_f32 v253, v42, v43
  v_cvt_pk_bf16_f32 v254, v44, v45
  v_cvt_pk_bf16_f32 v255, v46, v47
  v_mfma_f32_32x32x16_bf16 v[32:47], v[104:107], v[88:91], 0
  v_exp_f32 v16, v16
  v_exp_f32 v17, v17
  v_exp_f32 v18, v18
  v_exp_f32 v19, v19
  v_smfmac_f32_32x32x32_bf16 v[64:79], v[112:115], v[248:255], v13
  ds_read_b64_tr_b16 v[112:113], v7 offset:24960
  ds_read_b64_tr_b16 v[114:115], v7 offset:25128
  v_exp_f32 v20, v20
  v_exp_f32 v21, v21
  v_exp_f32 v22, v22
  v_exp_f32 v23, v23
  v_mfma_f32_32x32x16_bf16 v[32:47], v[108:111], v[92:95], v[32:47]
  v_cvt_pk_bf16_f32 v240, v16, v17
  v_cvt_pk_bf16_f32 v241, v18, v19
  v_cvt_pk_bf16_f32 v242, v20, v21
  v_cvt_pk_bf16_f32 v243, v22, v23
  v_exp_f32 v24, v24
  v_exp_f32 v25, v25
  v_exp_f32 v26, v26
  v_exp_f32 v27, v27
  v_smfmac_f32_16x16x64_bf16 v[132:135], v[116:119], v[248:255], v14
  ds_read_b64_tr_b16 v[116:117], v234 offset:24960
  ds_read_b64_tr_b16 v[118:119], v235 offset:24960
  v_exp_f32 v28, v28
  v_exp_f32 v29, v29
  v_exp_f32 v30, v30
  v_exp_f32 v31, v31
  v_cvt_pk_bf16_f32 v244, v24, v25
  v_cvt_pk_bf16_f32 v245, v26, v27
  v_cvt_pk_bf16_f32 v246, v28, v29
  v_cvt_pk_bf16_f32 v247, v30, v31
  s_waitcnt lgkmcnt(4)
  v_mfma_f32_32x32x16_bf16 v[16:31], v[96:99], v[80:83], 0
  v_exp_f32 v32, v32
  v_exp_f32 v33, v33
  v_exp_f32 v34, v34
  v_exp_f32 v35, v35
  v_smfmac_f32_32x32x32_bf16 v[48:63], v[120:123], v[240:247], v13
  ds_read_b128 v[104:107], v5 offset:27456
  ds_read_b32 v108, v6 offset:27456
  v_exp_f32 v36, v36
  v_exp_f32 v37, v37
  v_exp_f32 v38, v38
  v_exp_f32 v39, v39
  v_mfma_f32_32x32x16_bf16 v[16:31], v[100:103], v[84:87], v[16:31]
  v_cvt_pk_bf16_f32 v248, v32, v33
  v_cvt_pk_bf16_f32 v249, v34, v35
  v_cvt_pk_bf16_f32 v250, v36, v37
  v_cvt_pk_bf16_f32 v251, v38, v39
  v_exp_f32 v40, v40
  v_exp_f32 v41, v41
  v_exp_f32 v42, v42
  v_exp_f32 v43, v43
  v_smfmac_f32_16x16x64_bf16 v[128:131], v[124:127], v[240:247], v14
  v_exp_f32 v44, v44
  v_exp_f32 v45, v45
  v_exp_f32 v46, v46
  v_exp_f32 v47, v47
  v_cvt_pk_bf16_f32 v252, v40, v41
  v_cvt_pk_bf16_f32 v253, v42, v43
  v_cvt_pk_bf16_f32 v254, v44, v45
  v_cvt_pk_bf16_f32 v255, v46, v47
  v_mfma_f32_32x32x16_bf16 v[32:47], v[96:99], v[88:91], 0
  v_exp_f32 v16, v16
  v_exp_f32 v17, v17
  v_exp_f32 v18, v18
  v_exp_f32 v19, v19
  v_smfmac_f32_32x32x32_bf16 v[64:79], v[120:123], v[248:255], v13
  ds_read_b64_tr_b16 v[120:121], v7 offset:27456
  ds_read_b64_tr_b16 v[122:123], v7 offset:27624
  v_exp_f32 v20, v20
  v_exp_f32 v21, v21
  v_exp_f32 v22, v22
  v_exp_f32 v23, v23
  v_mfma_f32_32x32x16_bf16 v[32:47], v[100:103], v[92:95], v[32:47]
  v_cvt_pk_bf16_f32 v240, v16, v17
  v_cvt_pk_bf16_f32 v241, v18, v19
  v_cvt_pk_bf16_f32 v242, v20, v21
  v_cvt_pk_bf16_f32 v243, v22, v23
  v_exp_f32 v24, v24
  v_exp_f32 v25, v25
  v_exp_f32 v26, v26
  v_exp_f32 v27, v27
  v_smfmac_f32_16x16x64_bf16 v[132:135], v[124:127], v[248:255], v14
  ds_read_b64_tr_b16 v[124:125], v234 offset:27456
  ds_read_b64_tr_b16 v[126:127], v235 offset:27456
  v_exp_f32 v28, v28
  v_exp_f32 v29, v29
  v_exp_f32 v30, v30
  v_exp_f32 v31, v31
  v_cvt_pk_bf16_f32 v244, v24, v25
  v_cvt_pk_bf16_f32 v245, v26, v27
  v_cvt_pk_bf16_f32 v246, v28, v29
  v_cvt_pk_bf16_f32 v247, v30, v31
  s_cmp_ge_u32 s54, s55
  s_cbranch_scc1 ATT_M_100
  s_setprio 3
  buffer_store_dwordx4 v[224:227], v10, s[12:15], s54 offen sc0 sc1
  s_add_u32 s54, s54, 1024
  s_setprio 1
ATT_M_100:
  s_waitcnt lgkmcnt(4)
  v_mfma_f32_32x32x16_bf16 v[16:31], v[104:107], v[80:83], 0
  v_exp_f32 v32, v32
  v_exp_f32 v33, v33
  v_exp_f32 v34, v34
  v_exp_f32 v35, v35
  v_smfmac_f32_32x32x32_bf16 v[48:63], v[112:115], v[240:247], v13
  ds_read_b128 v[96:99], v5 offset:29952
  ds_read_b32 v100, v6 offset:29952
  v_exp_f32 v36, v36
  v_exp_f32 v37, v37
  v_exp_f32 v38, v38
  v_exp_f32 v39, v39
  v_mfma_f32_32x32x16_bf16 v[16:31], v[108:111], v[84:87], v[16:31]
  v_cvt_pk_bf16_f32 v248, v32, v33
  v_cvt_pk_bf16_f32 v249, v34, v35
  v_cvt_pk_bf16_f32 v250, v36, v37
  v_cvt_pk_bf16_f32 v251, v38, v39
  v_exp_f32 v40, v40
  v_exp_f32 v41, v41
  v_exp_f32 v42, v42
  v_exp_f32 v43, v43
  v_smfmac_f32_16x16x64_bf16 v[128:131], v[116:119], v[240:247], v14
  v_exp_f32 v44, v44
  v_exp_f32 v45, v45
  v_exp_f32 v46, v46
  v_exp_f32 v47, v47
  v_cvt_pk_bf16_f32 v252, v40, v41
  v_cvt_pk_bf16_f32 v253, v42, v43
  v_cvt_pk_bf16_f32 v254, v44, v45
  v_cvt_pk_bf16_f32 v255, v46, v47
  v_mfma_f32_32x32x16_bf16 v[32:47], v[104:107], v[88:91], 0
  v_exp_f32 v16, v16
  v_exp_f32 v17, v17
  v_exp_f32 v18, v18
  v_exp_f32 v19, v19
  v_smfmac_f32_32x32x32_bf16 v[64:79], v[112:115], v[248:255], v13
  ds_read_b64_tr_b16 v[112:113], v7 offset:29952
  ds_read_b64_tr_b16 v[114:115], v7 offset:30120
  v_exp_f32 v20, v20
  v_exp_f32 v21, v21
  v_exp_f32 v22, v22
  v_exp_f32 v23, v23
  v_mfma_f32_32x32x16_bf16 v[32:47], v[108:111], v[92:95], v[32:47]
  v_cvt_pk_bf16_f32 v240, v16, v17
  v_cvt_pk_bf16_f32 v241, v18, v19
  v_cvt_pk_bf16_f32 v242, v20, v21
  v_cvt_pk_bf16_f32 v243, v22, v23
  v_exp_f32 v24, v24
  v_exp_f32 v25, v25
  v_exp_f32 v26, v26
  v_exp_f32 v27, v27
  v_smfmac_f32_16x16x64_bf16 v[132:135], v[116:119], v[248:255], v14
  ds_read_b64_tr_b16 v[116:117], v234 offset:29952
  ds_read_b64_tr_b16 v[118:119], v235 offset:29952
  v_exp_f32 v28, v28
  v_exp_f32 v29, v29
  v_exp_f32 v30, v30
  v_exp_f32 v31, v31
  v_cvt_pk_bf16_f32 v244, v24, v25
  v_cvt_pk_bf16_f32 v245, v26, v27
  v_cvt_pk_bf16_f32 v246, v28, v29
  v_cvt_pk_bf16_f32 v247, v30, v31
  s_waitcnt lgkmcnt(4)
  v_mfma_f32_32x32x16_bf16 v[16:31], v[96:99], v[80:83], 0
  v_exp_f32 v32, v32
  v_exp_f32 v33, v33
  v_exp_f32 v34, v34
  v_exp_f32 v35, v35
  v_smfmac_f32_32x32x32_bf16 v[48:63], v[120:123], v[240:247], v13
  ds_read_b128 v[104:107], v5 offset:32448
  ds_read_b32 v108, v6 offset:32448
  v_exp_f32 v36, v36
  v_exp_f32 v37, v37
  v_exp_f32 v38, v38
  v_exp_f32 v39, v39
  v_mfma_f32_32x32x16_bf16 v[16:31], v[100:103], v[84:87], v[16:31]
  v_cvt_pk_bf16_f32 v248, v32, v33
  v_cvt_pk_bf16_f32 v249, v34, v35
  v_cvt_pk_bf16_f32 v250, v36, v37
  v_cvt_pk_bf16_f32 v251, v38, v39
  v_exp_f32 v40, v40
  v_exp_f32 v41, v41
  v_exp_f32 v42, v42
  v_exp_f32 v43, v43
  v_smfmac_f32_16x16x64_bf16 v[128:131], v[124:127], v[240:247], v14
  v_exp_f32 v44, v44
  v_exp_f32 v45, v45
  v_exp_f32 v46, v46
  v_exp_f32 v47, v47
  v_cvt_pk_bf16_f32 v252, v40, v41
  v_cvt_pk_bf16_f32 v253, v42, v43
  v_cvt_pk_bf16_f32 v254, v44, v45
  v_cvt_pk_bf16_f32 v255, v46, v47
  v_mfma_f32_32x32x16_bf16 v[32:47], v[96:99], v[88:91], 0
  v_exp_f32 v16, v16
  v_exp_f32 v17, v17
  v_exp_f32 v18, v18
  v_exp_f32 v19, v19
  v_smfmac_f32_32x32x32_bf16 v[64:79], v[120:123], v[248:255], v13
  ds_read_b64_tr_b16 v[120:121], v7 offset:32448
  ds_read_b64_tr_b16 v[122:123], v7 offset:32616
  v_exp_f32 v20, v20
  v_exp_f32 v21, v21
  v_exp_f32 v22, v22
  v_exp_f32 v23, v23
  v_mfma_f32_32x32x16_bf16 v[32:47], v[100:103], v[92:95], v[32:47]
  v_cvt_pk_bf16_f32 v240, v16, v17
  v_cvt_pk_bf16_f32 v241, v18, v19
  v_cvt_pk_bf16_f32 v242, v20, v21
  v_cvt_pk_bf16_f32 v243, v22, v23
  v_exp_f32 v24, v24
  v_exp_f32 v25, v25
  v_exp_f32 v26, v26
  v_exp_f32 v27, v27
  v_smfmac_f32_16x16x64_bf16 v[132:135], v[124:127], v[248:255], v14
  ds_read_b64_tr_b16 v[124:125], v234 offset:32448
  ds_read_b64_tr_b16 v[126:127], v235 offset:32448
  v_exp_f32 v28, v28
  v_exp_f32 v29, v29
  v_exp_f32 v30, v30
  v_exp_f32 v31, v31
  v_cvt_pk_bf16_f32 v244, v24, v25
  v_cvt_pk_bf16_f32 v245, v26, v27
  v_cvt_pk_bf16_f32 v246, v28, v29
  v_cvt_pk_bf16_f32 v247, v30, v31
  s_cmp_ge_u32 s54, s55
  s_cbranch_scc1 ATT_M_101
  s_setprio 3
  buffer_store_dwordx4 v[224:227], v10, s[12:15], s54 offen sc0 sc1
  s_add_u32 s54, s54, 1024
  s_setprio 1
ATT_M_101:
  s_waitcnt lgkmcnt(4)
  v_mfma_f32_32x32x16_bf16 v[16:31], v[104:107], v[80:83], 0
  v_exp_f32 v32, v32
  v_exp_f32 v33, v33
  v_exp_f32 v34, v34
  v_exp_f32 v35, v35
  v_smfmac_f32_32x32x32_bf16 v[48:63], v[112:115], v[240:247], v13
  ds_read_b128 v[96:99], v5 offset:34944
  ds_read_b32 v100, v6 offset:34944
  v_exp_f32 v36, v36
  v_exp_f32 v37, v37
  v_exp_f32 v38, v38
  v_exp_f32 v39, v39
  v_mfma_f32_32x32x16_bf16 v[16:31], v[108:111], v[84:87], v[16:31]
  v_cvt_pk_bf16_f32 v248, v32, v33
  v_cvt_pk_bf16_f32 v249, v34, v35
  v_cvt_pk_bf16_f32 v250, v36, v37
  v_cvt_pk_bf16_f32 v251, v38, v39
  v_exp_f32 v40, v40
  v_exp_f32 v41, v41
  v_exp_f32 v42, v42
  v_exp_f32 v43, v43
  v_smfmac_f32_16x16x64_bf16 v[128:131], v[116:119], v[240:247], v14
  v_exp_f32 v44, v44
  v_exp_f32 v45, v45
  v_exp_f32 v46, v46
  v_exp_f32 v47, v47
  v_cvt_pk_bf16_f32 v252, v40, v41
  v_cvt_pk_bf16_f32 v253, v42, v43
  v_cvt_pk_bf16_f32 v254, v44, v45
  v_cvt_pk_bf16_f32 v255, v46, v47
  s_cmp_lg_u32 s39, 2
  s_cbranch_scc1 ATT_S2_102
  s_waitcnt vmcnt(0)
  s_setprio 3
  s_cmp_eq_u32 s20, 3
  s_cbranch_scc1 SJ_G_103
  s_cmp_ge_u32 s63, 720
  s_cbranch_scc1 SJ_E_104
  s_lshl_b32 s44, s64, 7
  s_add_u32 s44, s44, s65
  s_lshl_b32 s44, s44, 2
  s_add_u32 s44, s44, 25370624
  v_mov_b32 v144, 0
  v_mov_b32 v145, s62
  s_mov_b64 exec, 1
  buffer_store_dword v145, v144, s[12:15], s44 offen sc0 sc1
  s_mov_b64 exec, -1
  s_branch SJ_E_104
SJ_G_103:
SJ_E_104:
  s_lshl_b32 s44, s23, 3
  s_add_u32 s44, s44, s22
  s_lshl_b32 s44, s44, 2
  s_add_u32 s44, s44, 25387008
  v_mov_b32 v236, 0
  v_mov_b32 v237, s62
  s_mov_b64 exec, 1
  buffer_store_dword v237, v236, s[12:15], s44 offen sc0 sc1
  s_mov_b64 exec, -1
  s_mov_b32 s39, 3
  s_setprio 1
ATT_S2_102:
  v_mfma_f32_32x32x16_bf16 v[32:47], v[104:107], v[88:91], 0
  v_exp_f32 v16, v16
  v_exp_f32 v17, v17
  v_exp_f32 v18, v18
  v_exp_f32 v19, v19
  v_smfmac_f32_32x32x32_bf16 v[64:79], v[112:115], v[248:255], v13
  ds_read_b64_tr_b16 v[112:113], v7 offset:34944
  ds_read_b64_tr_b16 v[114:115], v7 offset:35112
  v_exp_f32 v20, v20
  v_exp_f32 v21, v21
  v_exp_f32 v22, v22
  v_exp_f32 v23, v23
  v_mfma_f32_32x32x16_bf16 v[32:47], v[108:111], v[92:95], v[32:47]
  v_cvt_pk_bf16_f32 v240, v16, v17
  v_cvt_pk_bf16_f32 v241, v18, v19
  v_cvt_pk_bf16_f32 v242, v20, v21
  v_cvt_pk_bf16_f32 v243, v22, v23
  v_exp_f32 v24, v24
  v_exp_f32 v25, v25
  v_exp_f32 v26, v26
  v_exp_f32 v27, v27
  v_smfmac_f32_16x16x64_bf16 v[132:135], v[116:119], v[248:255], v14
  ds_read_b64_tr_b16 v[116:117], v234 offset:34944
  ds_read_b64_tr_b16 v[118:119], v235 offset:34944
  v_exp_f32 v28, v28
  v_exp_f32 v29, v29
  v_exp_f32 v30, v30
  v_exp_f32 v31, v31
  v_cvt_pk_bf16_f32 v244, v24, v25
  v_cvt_pk_bf16_f32 v245, v26, v27
  v_cvt_pk_bf16_f32 v246, v28, v29
  v_cvt_pk_bf16_f32 v247, v30, v31
  s_waitcnt lgkmcnt(4)
  v_mfma_f32_32x32x16_bf16 v[16:31], v[96:99], v[80:83], 0
  v_exp_f32 v32, v32
  v_exp_f32 v33, v33
  v_exp_f32 v34, v34
  v_exp_f32 v35, v35
  v_smfmac_f32_32x32x32_bf16 v[48:63], v[120:123], v[240:247], v13
  ds_read_b128 v[104:107], v5 offset:37440
  ds_read_b32 v108, v6 offset:37440
  v_exp_f32 v36, v36
  v_exp_f32 v37, v37
  v_exp_f32 v38, v38
  v_exp_f32 v39, v39
  v_mfma_f32_32x32x16_bf16 v[16:31], v[100:103], v[84:87], v[16:31]
  v_cvt_pk_bf16_f32 v248, v32, v33
  v_cvt_pk_bf16_f32 v249, v34, v35
  v_cvt_pk_bf16_f32 v250, v36, v37
  v_cvt_pk_bf16_f32 v251, v38, v39
  v_exp_f32 v40, v40
  v_exp_f32 v41, v41
  v_exp_f32 v42, v42
  v_exp_f32 v43, v43
  v_smfmac_f32_16x16x64_bf16 v[128:131], v[124:127], v[240:247], v14
  v_exp_f32 v44, v44
  v_exp_f32 v45, v45
  v_exp_f32 v46, v46
  v_exp_f32 v47, v47
  v_cvt_pk_bf16_f32 v252, v40, v41
  v_cvt_pk_bf16_f32 v253, v42, v43
  v_cvt_pk_bf16_f32 v254, v44, v45
  v_cvt_pk_bf16_f32 v255, v46, v47
  v_mfma_f32_32x32x16_bf16 v[32:47], v[96:99], v[88:91], 0
  v_exp_f32 v16, v16
  v_exp_f32 v17, v17
  v_exp_f32 v18, v18
  v_exp_f32 v19, v19
  v_smfmac_f32_32x32x32_bf16 v[64:79], v[120:123], v[248:255], v13
  ds_read_b64_tr_b16 v[120:121], v7 offset:37440
  ds_read_b64_tr_b16 v[122:123], v7 offset:37608
  v_exp_f32 v20, v20
  v_exp_f32 v21, v21
  v_exp_f32 v22, v22
  v_exp_f32 v23, v23
  v_mfma_f32_32x32x16_bf16 v[32:47], v[100:103], v[92:95], v[32:47]
  v_cvt_pk_bf16_f32 v240, v16, v17
  v_cvt_pk_bf16_f32 v241, v18, v19
  v_cvt_pk_bf16_f32 v242, v20, v21
  v_cvt_pk_bf16_f32 v243, v22, v23
  v_exp_f32 v24, v24
  v_exp_f32 v25, v25
  v_exp_f32 v26, v26
  v_exp_f32 v27, v27
  v_smfmac_f32_16x16x64_bf16 v[132:135], v[124:127], v[248:255], v14
  ds_read_b64_tr_b16 v[124:125], v234 offset:37440
  ds_read_b64_tr_b16 v[126:127], v235 offset:37440
  v_exp_f32 v28, v28
  v_exp_f32 v29, v29
  v_exp_f32 v30, v30
  v_exp_f32 v31, v31
  v_cvt_pk_bf16_f32 v244, v24, v25
  v_cvt_pk_bf16_f32 v245, v26, v27
  v_cvt_pk_bf16_f32 v246, v28, v29
  v_cvt_pk_bf16_f32 v247, v30, v31
  s_waitcnt vmcnt(0) lgkmcnt(0)
  s_barrier
  v_add_u32 v5, s37, v5
  v_add_u32 v6, s37, v6
  v_add_u32 v7, s37, v7
  v_add_u32 v234, s37, v234
  v_add_u32 v235, s37, v235
  s_setprio 3
  s_cmp_ge_u32 s34, 2
  s_cbranch_scc1 ATT_NOKV_86
  s_cmp_eq_u32 s39, 0
  s_cbranch_scc1 ATT_S0_105
  s_add_u32 m0, s35, 0
  s_nop 0
  buffer_load_dwordx4 v15, s[12:15], s30 offen offset:0 sc1 lds
  buffer_load_dwordx4 v15, s[12:15], s30 offen offset:1024 sc1 lds
  buffer_load_dwordx4 v15, s[12:15], s30 offen offset:2048 sc1 lds
  buffer_load_dwordx4 v15, s[12:15], s30 offen offset:3072 sc1 lds
  s_add_u32 s30, s30, 4096
  s_add_u32 m0, s35, 4096
  s_nop 0
  buffer_load_dwordx4 v15, s[12:15], s30 offen offset:0 sc1 lds
  buffer_load_dwordx4 v15, s[12:15], s30 offen offset:1024 sc1 lds
  buffer_load_dwordx4 v15, s[12:15], s30 offen offset:2048 sc1 lds
  buffer_load_dwordx4 v15, s[12:15], s30 offen offset:3072 sc1 lds
  s_add_u32 s30, s30, 4096
  s_add_u32 m0, s35, 8192
  s_nop 0
  buffer_load_dwordx4 v15, s[12:15], s30 offen offset:0 sc1 lds
  buffer_load_dwordx4 v15, s[12:15], s30 offen offset:1024 sc1 lds
  s_add_u32 s30, s30, 4096
  s_add_u32 s30, s30, 27648
  s_branch ATT_NOKV_86
ATT_S0_105:
  s_cmp_eq_u32 s20, 3
  s_cbranch_scc1 SJ_G_106
  s_cmp_ge_u32 s63, 720
  s_cbranch_scc1 SJ_E_107
  s_add_u32 m0, s26, 40960
  s_nop 0
  buffer_load_dwordx4 v140, s[40:43], s66 offen lds
  s_add_u32 m0, s26, 41984
  s_nop 0
  buffer_load_dwordx4 v140, s[40:43], s67 offen lds
  s_add_u32 m0, s26, 43008
  s_nop 0
  buffer_load_dwordx4 v140, s[40:43], s68 offen lds
  s_add_u32 m0, s26, 44032
  s_nop 0
  buffer_load_dwordx4 v140, s[40:43], s69 offen lds
  s_add_u32 m0, s26, 45056
  s_nop 0
  buffer_load_dwordx4 v140, s[40:43], s70 offen lds
  s_add_u32 m0, s26, 46080
  s_nop 0
  buffer_load_dwordx4 v140, s[40:43], s71 offen lds
  s_add_u32 m0, s26, 47104
  s_nop 0
  buffer_load_dwordx4 v140, s[40:43], s72 offen lds
  s_add_u32 m0, s26, 48128
  s_nop 0
  buffer_load_dwordx4 v140, s[40:43], s73 offen lds
  s_branch SJ_E_107
SJ_G_106:
  v_lshrrev_b32 v140, 3, v1
  s_lshl_b32 s44, s3, 3
  v_add_u32 v140, s44, v140
  v_and_b32 v141, 7, v1
  v_lshlrev_b32 v141, 4, v141
  v_mul_u32_u24 v142, 1152, v140
  v_add_u32 v142, v142, v141
  global_load_dwordx4 v[148:151], v142, s[4:5] offset:0
  global_load_dwordx4 v[184:187], v141, s[58:59] offset:0
  global_load_dwordx4 v[152:155], v142, s[4:5] offset:128
  global_load_dwordx4 v[188:191], v141, s[58:59] offset:128
  global_load_dwordx4 v[156:159], v142, s[4:5] offset:256
  global_load_dwordx4 v[192:195], v141, s[58:59] offset:256
  global_load_dwordx4 v[160:163], v142, s[4:5] offset:384
  global_load_dwordx4 v[196:199], v141, s[58:59] offset:384
  global_load_dwordx4 v[164:167], v142, s[4:5] offset:512
  global_load_dwordx4 v[200:203], v141, s[58:59] offset:512
  global_load_dwordx4 v[168:171], v142, s[4:5] offset:640
  global_load_dwordx4 v[204:207], v141, s[58:59] offset:640
  global_load_dwordx4 v[172:175], v142, s[4:5] offset:768
  global_load_dwordx4 v[208:211], v141, s[58:59] offset:768
  global_load_dwordx4 v[176:179], v142, s[4:5] offset:896
  global_load_dwordx4 v[212:215], v141, s[58:59] offset:896
  global_load_dwordx4 v[180:183], v142, s[4:5] offset:1024
  global_load_dwordx4 v[216:219], v141, s[58:59] offset:1024
SJ_E_107:
  s_mov_b32 s39, 1
ATT_NOKV_86:
  s_mov_b32 s38, 24780800
  buffer_load_dwordx2 v[136:137], v3, s[12:15], s38 offen sc0 sc1
  s_setprio 1
  s_add_u32 s35, s35, s37
  s_sub_u32 s37, 0, s37
  v_mfma_f32_32x32x16_bf16 v[16:31], v[104:107], v[80:83], 0
  v_exp_f32 v32, v32
  v_exp_f32 v33, v33
  v_exp_f32 v34, v34
  v_exp_f32 v35, v35
  v_smfmac_f32_32x32x32_bf16 v[48:63], v[112:115], v[240:247], v13
  ds_read_b128 v[96:99], v5 offset:0
  ds_read_b32 v100, v6 offset:0
  v_exp_f32 v36, v36
  v_exp_f32 v37, v37
  v_exp_f32 v38, v38
  v_exp_f32 v39, v39
  v_mfma_f32_32x32x16_bf16 v[16:31], v[108:111], v[84:87], v[16:31]
  v_cvt_pk_bf16_f32 v248, v32, v33
  v_cvt_pk_bf16_f32 v249, v34, v35
  v_cvt_pk_bf16_f32 v250, v36, v37
  v_cvt_pk_bf16_f32 v251, v38, v39
  v_exp_f32 v40, v40
  v_exp_f32 v41, v41
  v_exp_f32 v42, v42
  v_exp_f32 v43, v43
  v_smfmac_f32_16x16x64_bf16 v[128:131], v[116:119], v[240:247], v14
  v_exp_f32 v44, v44
  v_exp_f32 v45, v45
  v_exp_f32 v46, v46
  v_exp_f32 v47, v47
  v_cvt_pk_bf16_f32 v252, v40, v41
  v_cvt_pk_bf16_f32 v253, v42, v43
  v_cvt_pk_bf16_f32 v254, v44, v45
  v_cvt_pk_bf16_f32 v255, v46, v47
  v_mfma_f32_32x32x16_bf16 v[32:47], v[104:107], v[88:91], 0
  v_exp_f32 v16, v16
  v_exp_f32 v17, v17
  v_exp_f32 v18, v18
  v_exp_f32 v19, v19
  v_smfmac_f32_32x32x32_bf16 v[64:79], v[112:115], v[248:255], v13
  ds_read_b64_tr_b16 v[112:113], v7 offset:0
  ds_read_b64_tr_b16 v[114:115], v7 offset:168
  v_exp_f32 v20, v20
  v_exp_f32 v21, v21
  v_exp_f32 v22, v22
  v_exp_f32 v23, v23
  v_mfma_f32_32x32x16_bf16 v[32:47], v[108:111], v[92:95], v[32:47]
  v_cvt_pk_bf16_f32 v240, v16, v17
  v_cvt_pk_bf16_f32 v241, v18, v19
  v_cvt_pk_bf16_f32 v242, v20, v21
  v_cvt_pk_bf16_f32 v243, v22, v23
  v_exp_f32 v24, v24
  v_exp_f32 v25, v25
  v_exp_f32 v26, v26
  v_exp_f32 v27, v27
  v_smfmac_f32_16x16x64_bf16 v[132:135], v[116:119], v[248:255], v14
  ds_read_b64_tr_b16 v[116:117], v234 offset:0
  ds_read_b64_tr_b16 v[118:119], v235 offset:0
  v_exp_f32 v28, v28
  v_exp_f32 v29, v29
  v_exp_f32 v30, v30
  v_exp_f32 v31, v31
  v_cvt_pk_bf16_f32 v244, v24, v25
  v_cvt_pk_bf16_f32 v245, v26, v27
  v_cvt_pk_bf16_f32 v246, v28, v29
  v_cvt_pk_bf16_f32 v247, v30, v31
  s_waitcnt lgkmcnt(4)
  v_mfma_f32_32x32x16_bf16 v[16:31], v[96:99], v[80:83], 0
  v_exp_f32 v32, v32
  v_exp_f32 v33, v33
  v_exp_f32 v34, v34
  v_exp_f32 v35, v35
  v_smfmac_f32_32x32x32_bf16 v[48:63], v[120:123], v[240:247], v13
  ds_read_b128 v[104:107], v5 offset:2496
  ds_read_b32 v108, v6 offset:2496
  v_exp_f32 v36, v36
  v_exp_f32 v37, v37
  v_exp_f32 v38, v38
  v_exp_f32 v39, v39
  v_mfma_f32_32x32x16_bf16 v[16:31], v[100:103], v[84:87], v[16:31]
  v_cvt_pk_bf16_f32 v248, v32, v33
  v_cvt_pk_bf16_f32 v249, v34, v35
  v_cvt_pk_bf16_f32 v250, v36, v37
  v_cvt_pk_bf16_f32 v251, v38, v39
  v_exp_f32 v40, v40
  v_exp_f32 v41, v41
  v_exp_f32 v42, v42
  v_exp_f32 v43, v43
  v_smfmac_f32_16x16x64_bf16 v[128:131], v[124:127], v[240:247], v14
  v_exp_f32 v44, v44
  v_exp_f32 v45, v45
  v_exp_f32 v46, v46
  v_exp_f32 v47, v47
  v_cvt_pk_bf16_f32 v252, v40, v41
  v_cvt_pk_bf16_f32 v253, v42, v43
  v_cvt_pk_bf16_f32 v254, v44, v45
  v_cvt_pk_bf16_f32 v255, v46, v47
  s_add_u32 s34, s34, 1
  s_cmp_lt_u32 s34, 4
  s_cbranch_scc1 ATT_LOOP_85
  v_smfmac_f32_32x32x32_bf16 v[64:79], v[120:123], v[248:255], v13
  v_smfmac_f32_16x16x64_bf16 v[132:135], v[124:127], v[248:255], v14
  s_setprio 3
  s_waitcnt vmcnt(0) lgkmcnt(0)
  s_cmp_lg_u32 s33, 0
  s_cbranch_scc1 ATT_FIN_87
  v_max_f32_e64 v2, |v48|, |v49|
  v_max3_f32 v2, |v50|, |v51|, v2
  v_max3_f32 v2, |v52|, |v53|, v2
  v_max3_f32 v2, |v54|, |v55|, v2
  v_max3_f32 v2, |v56|, |v57|, v2
  v_max3_f32 v2, |v58|, |v59|, v2
  v_max3_f32 v2, |v60|, |v61|, v2
  v_max3_f32 v2, |v62|, |v63|, v2
  v_max3_f32 v2, |v64|, |v65|, v2
  v_max3_f32 v2, |v66|, |v67|, v2
  v_max3_f32 v2, |v68|, |v69|, v2
  v_max3_f32 v2, |v70|, |v71|, v2
  v_max3_f32 v2, |v72|, |v73|, v2
  v_max3_f32 v2, |v74|, |v75|, v2
  v_max3_f32 v2, |v76|, |v77|, v2
  v_max3_f32 v2, |v78|, |v79|, v2
  v_max3_f32 v2, |v128|, |v129|, v2
  v_max3_f32 v2, |v130|, |v132|, v2
  v_max3_f32 v2, |v133|, |v134|, v2
  s_mov_b32 s44, 0x76800000
  v_cmp_ngt_f32 vcc, s44, v2
  v_mov_b32 v8, v130
  v_mov_b32 v236, v130
  v_mov_b32 v9, v134
  v_mov_b32 v237, v134
  v_permlane16_swap_b32 v8, v236
  s_nop 0
  v_permlane16_swap_b32 v9, v237
  v_add_f32 v8, v8, v236
  v_add_f32 v9, v9, v237
  s_mov_b32 s44, 0x1d800000
  v_cmp_nle_f32 s[46:47], s44, v8
  s_nop 1
  s_or_b64 vcc, vcc, s[46:47]
  v_cmp_nle_f32 s[46:47], s44, v9
  s_nop 1
  s_or_b64 vcc, vcc, s[46:47]
  s_cmp_lg_u64 vcc, 0
  s_cselect_b32 s44, 1, 0
  v_mov_b32 v2, s44
  s_lshl_b32 s45, s20, 2
  s_add_u32 s45, s45, 39936
  v_mov_b32 v4, s45
  ds_write_b32 v4, v2
  v_mov_b32 v4, 39936
  s_waitcnt lgkmcnt(0)
  s_barrier
  ds_read_b128 v[240:243], v4
  s_waitcnt lgkmcnt(0)
  v_or3_b32 v2, v240, v241, v242
  v_or_b32 v2, v2, v243
  s_nop 0
  v_readfirstlane_b32 s44, v2
  s_nop 1
  s_cmp_eq_u32 s44, 0
  s_cbranch_scc1 ATT_FIN_87
  s_mov_b32 s33, 1
  s_setprio 1
  v_mov_b32 v85, 0
  v_mov_b32 v86, 0
  v_mov_b32 v8, 0xff7fffff
  v_mov_b32 v93, 0
  v_mov_b32 v94, 0
  v_mov_b32 v9, 0xff7fffff
  s_mov_b32 s30, 24616960
  s_mov_b32 s34, 0
ATT_MC_108:
  s_barrier
  s_add_u32 m0, s31, 0
  s_nop 0
  buffer_load_dwordx4 v15, s[12:15], s30 offen offset:0 sc1 lds
  buffer_load_dwordx4 v15, s[12:15], s30 offen offset:1024 sc1 lds
  buffer_load_dwordx4 v15, s[12:15], s30 offen offset:2048 sc1 lds
  buffer_load_dwordx4 v15, s[12:15], s30 offen offset:3072 sc1 lds
  s_add_u32 s30, s30, 4096
  s_add_u32 m0, s31, 4096
  s_nop 0
  buffer_load_dwordx4 v15, s[12:15], s30 offen offset:0 sc1 lds
  buffer_load_dwordx4 v15, s[12:15], s30 offen offset:1024 sc1 lds
  buffer_load_dwordx4 v15, s[12:15], s30 offen offset:2048 sc1 lds
  buffer_load_dwordx4 v15, s[12:15], s30 offen offset:3072 sc1 lds
  s_add_u32 s30, s30, 4096
  s_add_u32 m0, s31, 8192
  s_nop 0
  buffer_load_dwordx4 v15, s[12:15], s30 offen offset:0 sc1 lds
  buffer_load_dwordx4 v15, s[12:15], s30 offen offset:1024 sc1 lds
  s_add_u32 s30, s30, 4096
  s_add_u32 s30, s30, 27648
  v_mov_b32 v5, v10
  v_mov_b32 v6, v11
  s_mov_b32 s36, 0
  s_waitcnt vmcnt(0)
  s_barrier
ATT_MT_109:
  ds_read_b128 v[96:99], v5 offset:0
  ds_read_b32 v100, v6 offset:0
  s_waitcnt lgkmcnt(0)
  v_mfma_f32_32x32x16_bf16 v[16:31], v[96:99], v[80:83], 0
  v_mfma_f32_32x32x16_bf16 v[16:31], v[100:103], v[84:87], v[16:31]
  v_mfma_f32_32x32x16_bf16 v[32:47], v[96:99], v[88:91], 0
  v_mfma_f32_32x32x16_bf16 v[32:47], v[100:103], v[92:95], v[32:47]
  v_add_u32 v5, 2496, v5
  v_add_u32 v6, 2496, v6
  s_nop 7
  v_max3_f32 v8, v16, v17, v8
  v_max3_f32 v8, v18, v19, v8
  v_max3_f32 v8, v20, v21, v8
  v_max3_f32 v8, v22, v23, v8
  v_max3_f32 v8, v24, v25, v8
  v_max3_f32 v8, v26, v27, v8
  v_max3_f32 v8, v28, v29, v8
  v_max3_f32 v8, v30, v31, v8
  v_max3_f32 v9, v32, v33, v9
  v_max3_f32 v9, v34, v35, v9
  v_max3_f32 v9, v36, v37, v9
  v_max3_f32 v9, v38, v39, v9
  v_max3_f32 v9, v40, v41, v9
  v_max3_f32 v9, v42, v43, v9
  v_max3_f32 v9, v44, v45, v9
  v_max3_f32 v9, v46, v47, v9
  s_add_u32 s36, s36, 1
  s_cmp_lt_u32 s36, 16
  s_cbranch_scc1 ATT_MT_109
  s_add_u32 s34, s34, 1
  s_cmp_lt_u32 s34, 4
  s_cbranch_scc1 ATT_MC_108
  v_mov_b32 v2, v8
  s_nop 1
  v_permlane32_swap_b32 v8, v2
  v_max_f32 v8, v8, v2
  v_sub_f32 v2, 0x80000000, v8
  v_and_b32 v4, 0xffff0000, v2
  v_sub_f32 v2, v2, v4
  v_and_b32 v236, 0xffff0000, v2
  v_sub_f32 v2, v2, v236
  v_lshrrev_b32 v4, 16, v4
  v_or_b32 v4, v4, v236
  v_lshrrev_b32 v2, 16, v2
  v_cmp_gt_u32 vcc, 32, v1
  s_nop 1
  v_cndmask_b32 v85, 0, v4, vcc
  v_cndmask_b32 v86, 0, v2, vcc
  v_mov_b32 v2, v9
  s_nop 1
  v_permlane32_swap_b32 v9, v2
  v_max_f32 v9, v9, v2
  v_sub_f32 v2, 0x80000000, v9
  v_and_b32 v4, 0xffff0000, v2
  v_sub_f32 v2, v2, v4
  v_and_b32 v236, 0xffff0000, v2
  v_sub_f32 v2, v2, v236
  v_lshrrev_b32 v4, 16, v4
  v_or_b32 v4, v4, v236
  v_lshrrev_b32 v2, 16, v2
  v_cmp_gt_u32 vcc, 32, v1
  s_nop 1
  v_cndmask_b32 v93, 0, v4, vcc
  v_cndmask_b32 v94, 0, v2, vcc
  s_barrier
  s_mov_b32 s30, 24616960
  s_add_u32 m0, s31, 40960
  s_nop 0
  buffer_load_dwordx4 v15, s[12:15], s30 offen offset:0 sc1 lds
  buffer_load_dwordx4 v15, s[12:15], s30 offen offset:1024 sc1 lds
  buffer_load_dwordx4 v15, s[12:15], s30 offen offset:2048 sc1 lds
  buffer_load_dwordx4 v15, s[12:15], s30 offen offset:3072 sc1 lds
  s_add_u32 s30, s30, 4096
  s_add_u32 m0, s31, 45056
  s_nop 0
  buffer_load_dwordx4 v15, s[12:15], s30 offen offset:0 sc1 lds
  buffer_load_dwordx4 v15, s[12:15], s30 offen offset:1024 sc1 lds
  buffer_load_dwordx4 v15, s[12:15], s30 offen offset:2048 sc1 lds
  buffer_load_dwordx4 v15, s[12:15], s30 offen offset:3072 sc1 lds
  s_add_u32 s30, s30, 4096
  s_add_u32 m0, s31, 49152
  s_nop 0
  buffer_load_dwordx4 v15, s[12:15], s30 offen offset:0 sc1 lds
  buffer_load_dwordx4 v15, s[12:15], s30 offen offset:1024 sc1 lds
  s_add_u32 s30, s30, 4096
  s_add_u32 s30, s30, 27648
  s_add_u32 m0, s31, 0
  s_nop 0
  buffer_load_dwordx4 v15, s[12:15], s30 offen offset:0 sc1 lds
  buffer_load_dwordx4 v15, s[12:15], s30 offen offset:1024 sc1 lds
  buffer_load_dwordx4 v15, s[12:15], s30 offen offset:2048 sc1 lds
  buffer_load_dwordx4 v15, s[12:15], s30 offen offset:3072 sc1 lds
  s_add_u32 s30, s30, 4096
  s_add_u32 m0, s31, 4096
  s_nop 0
  buffer_load_dwordx4 v15, s[12:15], s30 offen offset:0 sc1 lds
  buffer_load_dwordx4 v15, s[12:15], s30 offen offset:1024 sc1 lds
  buffer_load_dwordx4 v15, s[12:15], s30 offen offset:2048 sc1 lds
  buffer_load_dwordx4 v15, s[12:15], s30 offen offset:3072 sc1 lds
  s_add_u32 s30, s30, 4096
  s_add_u32 m0, s31, 8192
  s_nop 0
  buffer_load_dwordx4 v15, s[12:15], s30 offen offset:0 sc1 lds
  buffer_load_dwordx4 v15, s[12:15], s30 offen offset:1024 sc1 lds
  s_add_u32 s30, s30, 4096
  s_add_u32 s30, s30, 27648
  v_add_u32 v5, 40960, v10
  v_add_u32 v6, 40960, v11
  v_add_u32 v7, 40960, v12
  v_add_u32 v234, 40960, v232
  v_add_u32 v235, 40960, v233
  s_waitcnt vmcnt(10)
  s_barrier
  s_branch ATT_PASS_84
ATT_FIN_87:
  s_setprio 3
  v_and_b32 v4, 15, v1
  v_lshlrev_b32 v4, 4, v4
  v_lshrrev_b32 v5, 5, v1
  v_lshl_add_u32 v4, v5, 2, v4
  s_mov_b32 s51, 300000
  s_branch POLLC_111
POLL_110:
  s_mov_b32 s38, 24780800
  buffer_load_dwordx2 v[136:137], v3, s[12:15], s38 offen sc0 sc1
  s_waitcnt vmcnt(0)
POLLC_111:
  v_xor_b32 v8, s62, v137
  v_cmp_ne_u32 vcc, 0, v8
  s_nop 4
  s_cbranch_vccz POLLOK_112
  s_sleep 1
  s_sub_u32 s51, s51, 1
  s_cmp_lg_u32 s51, 0
  s_cbranch_scc1 POLL_110
POLLOK_112:
  v_and_b32 v5, 16, v1
  v_cmp_eq_u32 vcc, 0, v5
  v_mov_b32 v240, v128
  v_mov_b32 v241, v129
  v_mov_b32 v242, v130
  v_permlane16_swap_b32 v128, v240
  v_permlane16_swap_b32 v129, v241
  v_permlane16_swap_b32 v130, v242
  v_add_f32 v128, v128, v240
  v_add_f32 v129, v129, v241
  v_add_f32 v130, v130, v242
  v_rcp_f32 v6, v130
  s_nop 0
  v_mul_f32 v6, v6, v136
  v_pk_mul_f32 v[128:129], v[128:129], v[6:7] op_sel_hi:[1,0]
  v_mov_b32 v7, v6
  s_nop 1
  v_permlane32_swap_b32 v6, v7
  v_cndmask_b32 v6, v7, v6, vcc
  v_pk_add_f32 v[48:49], v[48:49], v[56:57]
  v_pk_add_f32 v[50:51], v[50:51], v[58:59]
  v_pk_add_f32 v[52:53], v[52:53], v[60:61]
  v_pk_add_f32 v[54:55], v[54:55], v[62:63]
  v_pk_mul_f32 v[48:49], v[48:49], v[6:7] op_sel_hi:[1,0]
  v_pk_mul_f32 v[50:51], v[50:51], v[6:7] op_sel_hi:[1,0]
  v_pk_mul_f32 v[52:53], v[52:53], v[6:7] op_sel_hi:[1,0]
  v_pk_mul_f32 v[54:55], v[54:55], v[6:7] op_sel_hi:[1,0]
  v_cvt_pk_bf16_f32 v16, v48, v49
  v_cvt_pk_bf16_f32 v17, v50, v51
  v_cvt_pk_bf16_f32 v18, v52, v53
  v_cvt_pk_bf16_f32 v19, v54, v55
  v_cvt_pk_bf16_f32 v20, v128, v129
  v_min_u32 v16, -2, v16
  v_min_u32 v17, -2, v17
  v_min_u32 v18, -2, v18
  v_min_u32 v19, -2, v19
  v_min_u32 v20, -2, v20
  buffer_store_dwordx4 v[16:19], v10, s[12:15], s52 offen offset:0 sc0 sc1
  s_mov_b32 exec_lo, 0xffff
  s_mov_b32 exec_hi, 0xffff
  buffer_store_dword v20, v4, s[12:15], s53 offen offset:0 sc0 sc1
  s_mov_b64 exec, -1
  v_mov_b32 v240, v132
  v_mov_b32 v241, v133
  v_mov_b32 v242, v134
  v_permlane16_swap_b32 v132, v240
  v_permlane16_swap_b32 v133, v241
  v_permlane16_swap_b32 v134, v242
  v_add_f32 v132, v132, v240
  v_add_f32 v133, v133, v241
  v_add_f32 v134, v134, v242
  v_rcp_f32 v6, v134
  s_nop 0
  v_mul_f32 v6, v6, v136
  v_pk_mul_f32 v[132:133], v[132:133], v[6:7] op_sel_hi:[1,0]
  v_mov_b32 v7, v6
  s_nop 1
  v_permlane32_swap_b32 v6, v7
  v_cndmask_b32 v6, v7, v6, vcc
  v_pk_add_f32 v[64:65], v[64:65], v[72:73]
  v_pk_add_f32 v[66:67], v[66:67], v[74:75]
  v_pk_add_f32 v[68:69], v[68:69], v[76:77]
  v_pk_add_f32 v[70:71], v[70:71], v[78:79]
  v_pk_mul_f32 v[64:65], v[64:65], v[6:7] op_sel_hi:[1,0]
  v_pk_mul_f32 v[66:67], v[66:67], v[6:7] op_sel_hi:[1,0]
  v_pk_mul_f32 v[68:69], v[68:69], v[6:7] op_sel_hi:[1,0]
  v_pk_mul_f32 v[70:71], v[70:71], v[6:7] op_sel_hi:[1,0]
  v_cvt_pk_bf16_f32 v24, v64, v65
  v_cvt_pk_bf16_f32 v25, v66, v67
  v_cvt_pk_bf16_f32 v26, v68, v69
  v_cvt_pk_bf16_f32 v27, v70, v71
  v_cvt_pk_bf16_f32 v28, v132, v133
  v_min_u32 v24, -2, v24
  v_min_u32 v25, -2, v25
  v_min_u32 v26, -2, v26
  v_min_u32 v27, -2, v27
  v_min_u32 v28, -2, v28
  buffer_store_dwordx4 v[24:27], v10, s[12:15], s52 offen offset:1024 sc0 sc1
  s_mov_b32 exec_lo, 0xffff
  s_mov_b32 exec_hi, 0xffff
  buffer_store_dword v28, v4, s[12:15], s53 offen offset:8 sc0 sc1
  s_mov_b64 exec, -1
K_DONE:
K_END:
  s_endpgm
.section .rodata,"a"
.p2align 6
.amdhsa_kernel gated_mix__grouped_kv_mqa__mixer_gmlp__prompt_kernel
  .amdhsa_next_free_vgpr 256
  .amdhsa_next_free_sgpr 96
  .amdhsa_accum_offset 256
  .amdhsa_group_segment_fixed_size 0
  .amdhsa_kernarg_size 112
  .amdhsa_user_sgpr_count 2
  .amdhsa_user_sgpr_kernarg_segment_ptr 1
  .amdhsa_system_sgpr_workgroup_id_x 1
.end_amdhsa_kernel
```
